```python
import torch

def _softmax(x, axis=-1):
    return torch.softmax(x, dim=axis)
def _gelu(x):
    return torch.nn.functional.gelu(x, approximate="tanh")
def _silu(x):
    return torch.nn.functional.silu(x)
def _sigmoid(x):
    return torch.sigmoid(x)
def _layernorm(x, axis=-1, eps=1e-5):
    m = x.mean(dim=axis, keepdim=True)
    v = x.var(dim=axis, keepdim=True, unbiased=False)
    return (x - m) / torch.sqrt(v + eps)
def _scatter_add(tgt, idx, src, axis=0):
    return tgt.clone().index_add_(axis, idx, src)
def _segment_sum(src, seg, n):
    out = torch.zeros((n,) + src.shape[1:], dtype=src.dtype)
    return out.index_add_(0, seg, src)
def _pad(x, pw):
    flat = tuple(v for pair in reversed(pw) for v in pair)
    return torch.nn.functional.pad(x, flat)

kernel_name = 'parallel_sum__sliding_local_dilated__glu_gated_bilinear__prompt'

def setup_inputs():

    _w = (lambda a: (lambda t: t.to(torch.bfloat16) if t.is_floating_point() else t)(torch.as_tensor(a)))
    def _A_setup():
        B, S, D = 1, 2048, 448
        return {
            "x": _w((lambda *s: torch.randn(*s, dtype=torch.bfloat16) * 0.05)(B, S, D)),
            "wqkv": _w((lambda *s: torch.randn(*s, dtype=torch.bfloat16) * 0.05)(D, 3 * D)),
            "wo": _w((lambda *s: torch.randn(*s, dtype=torch.bfloat16) * 0.05)(D, D)),
        }
    _A_in = _A_setup()

    def _B_setup():
        B, S, D, F = 1, 2048, 448, 1792
        return {
            "x": _w((lambda *s: torch.randn(*s, dtype=torch.bfloat16) * 0.05)(B, S, D)),
            "w_gate": _w((lambda *s: torch.randn(*s, dtype=torch.bfloat16) * 0.8)(D, F) * (D ** -0.5)),
            "w_up": _w((lambda *s: torch.randn(*s, dtype=torch.bfloat16) * 0.8)(D, F) * (D ** -0.5)),
            "w_down": _w((lambda *s: torch.randn(*s, dtype=torch.bfloat16) * 0.8)(F, D) * (F ** -0.5)),
        }
    _B_in = _B_setup()

    return {
        "A_x": _A_in["x"],
        "A_wqkv": _A_in["wqkv"],
        "A_wo": _A_in["wo"],
        "B_x": _B_in["x"],
        "B_w_gate": _B_in["w_gate"],
        "B_w_up": _B_in["w_up"],
        "B_w_down": _B_in["w_down"],
    }

def reference(A_x, A_wqkv, A_wo, B_x, B_w_gate, B_w_up, B_w_down):
    def _A_ref(x, wqkv, wo):
        B, S, D = x.shape
        H = 16; Dh = D // H
        W, dil = 8, 2
        qkv = (lambda x, *d: x.permute(*d))((x @ wqkv).reshape(B, S, 3, H, Dh), 2, 0, 3, 1, 4)
        q, k, v = qkv[0], qkv[1], qkv[2]
        scale = Dh ** -0.5
        pos = torch.arange(S)
        off = torch.arange(W) * dil
        idx = pos[:, None] - off[None, :]
        mask = idx >= 0
        idx_c = torch.where(mask, idx, 0).reshape(-1)
        kg = k[:, :, idx_c, :].reshape(B, H, S, W, Dh)
        vg = v[:, :, idx_c, :].reshape(B, H, S, W, Dh)
        logits = torch.einsum("bhsd,bhswd->bhsw", q, kg) * scale
        logits = torch.where(mask[None, None, :, :], logits, -1e9)
        attn = _softmax(logits, axis=-1)
        o = torch.einsum("bhsw,bhswd->bhsd", attn, vg)
        return (lambda x, *d: x.permute(*d))(o, 0, 2, 1, 3).reshape(B, S, D) @ wo

    def _B_ref(x, w_gate, w_up, w_down):
        g = torch.einsum("bsd,df->bsf", x, w_gate)
        u = torch.einsum("bsd,df->bsf", x, w_up)
        h = g * u
        return torch.einsum("bsf,fd->bsd", h, w_down)

    x = A_x
    xn = _layernorm(x, axis=-1)
    return x + _A_ref(xn, A_wqkv, A_wo) + _B_ref(xn, B_w_gate, B_w_up, B_w_down)
```

```asm
; @launch grid=(256,1,1) block=(256,1,1) lds=147456
.amdgcn_target "amdgcn-amd-amdhsa--gfx950"
.text
.globl parallel_sum__sliding_local_dilated__glu_gated_bilinear__prompt_kernel
.p2align 8
.type parallel_sum__sliding_local_dilated__glu_gated_bilinear__prompt_kernel,@function
parallel_sum__sliding_local_dilated__glu_gated_bilinear__prompt_kernel:
s_lshr_b32 s60, s2, 8
s_cmp_lg_u32 s60, 0
s_cbranch_scc1 L_end
s_getpc_b64 s[62:63]
L_pc_1:
s_lshr_b32 s61, s2, 3
v_lshrrev_b32 v38, 6, v0
v_lshl_add_u32 v38, s61, 2, v38
v_mul_u32_u24 v38, 5, v38
v_and_b32 v39, 7, v0
v_min_u32 v39, 4, v39
v_add_u32 v38, v38, v39
v_lshlrev_b32 v38, 7, v38
v_min_u32 v38, L_end-parallel_sum__sliding_local_dilated__glu_gated_bilinear__prompt_kernel-4, v38
s_sub_u32 s62, s62, L_pc_1-parallel_sum__sliding_local_dilated__glu_gated_bilinear__prompt_kernel
s_subb_u32 s63, s63, 0
v_add_co_u32 v38, vcc, s62, v38
v_mov_b32 v39, s63
s_nop 0
v_addc_co_u32 v39, vcc, 0, v39, vcc
global_load_dword v62, v[38:39], off
s_bitcmp1_b32 s2, 6
s_cbranch_scc1 L_Y
v_lshrrev_b32 v2, 7, v0
s_nop 0
v_readfirstlane_b32 s60, v2
s_nop 0
s_cmp_eq_u32 s60, 1
s_cbranch_scc1 L_X1
s_load_dwordx8 s[68:75], s[0:1], 0
s_load_dwordx8 s[76:83], s[0:1], 32
s_load_dwordx4 s[84:87], s[0:1], 64
v_and_b32 v1, 63, v0
v_lshrrev_b32 v2, 6, v0
s_and_b32 s60, s2, 7
s_lshr_b32 s61, s2, 3
v_readfirstlane_b32 s46, v2
s_and_b32 s62, s60, 1
s_and_b32 s63, s61, 7
s_lshl3_add_u32 s44, s62, s63
s_lshr_b32 s62, s60, 1
s_lshr_b32 s63, s61, 3
s_lshl2_add_u32 s45, s62, s63
s_lshr_b32 s49, s45, 1
s_lshr_b32 s47, s46, 1
s_and_b32 s48, s46, 1
s_lshl_b32 s66, s44, 7
s_mul_i32 s60, s44, 37
s_lshr_b32 s60, s60, 8
s_mul_i32 s60, s60, 7
s_sub_u32 s54, s44, s60
s_lshl_b32 s53, s54, 1
s_and_b32 s60, s45, 3
s_lshl_b32 s60, s60, 2
s_lshr_b32 s60, 0x7c20, s60
s_and_b32 s60, s60, 15
s_lshl_b32 s60, s60, 6
s_lshr_b32 s61, s45, 2
s_mul_i32 s61, s61, 0x380
s_add_u32 s67, s60, s61
s_mov_b32 s10, 1835008
s_mov_b32 s11, 0x20000
s_mov_b32 s14, 1204224
s_mov_b32 s15, 0x20000
s_mov_b32 s18, 1605632
s_mov_b32 s19, 0x20000
s_mov_b32 s22, s18
s_mov_b32 s23, 0x20000
v_lshrrev_b32 v34, 3, v1
v_and_b32 v35, 7, v1
v_lshrrev_b32 v36, 4, v1
v_xor_b32 v35, v35, v36
s_lshl_b32 s60, s46, 5
s_add_u32 s61, s60, s66
v_add_u32 v36, s61, v34
v_mul_u32_u24 v36, 0x380, v36
v_lshl_add_u32 v7, v35, 4, v36
v_xor_b32 v36, 64, v7
v_add_u32 v8, 0x1c00, v36
v_add_u32 v9, 0x3800, v7
v_add_u32 v10, 0x3800, v8
s_lshl_b32 s60, s46, 12
s_add_u32 s58, s60, 81920
s_lshl_b32 s60, s48, 3
s_add_u32 s61, s66, s60
s_sub_u32 s61, s61, 16
v_add_u32 v34, s61, v34
v_max_i32 v34, 0, v34
v_mul_u32_u24 v34, 0x380, v34
s_lshl_b32 s61, s48, 2
v_xor_b32 v35, s61, v35
v_lshl_add_u32 v11, v35, 4, v34
s_lshl_b32 s60, s48, 10
s_add_u32 s59, s60, 98304
s_waitcnt lgkmcnt(0)
s_mov_b64 s[8:9], s[68:69]
s_lshl_b32 s50, s54, 7
s_add_u32 s54, s54, 1
s_cmp_eq_u32 s54, 7
s_cselect_b32 s54, 0, s54
s_add_u32 m0, s58, 0
s_nop 0
buffer_load_dwordx4 v7, s[8:11], s50 offen lds
s_add_u32 m0, s58, 1024
s_nop 0
buffer_load_dwordx4 v8, s[8:11], s50 offen lds
s_add_u32 m0, s58, 2048
s_nop 0
buffer_load_dwordx4 v9, s[8:11], s50 offen lds
s_add_u32 m0, s58, 3072
s_nop 0
buffer_load_dwordx4 v10, s[8:11], s50 offen lds
s_add_u32 m0, s59, 0
s_nop 0
buffer_load_dwordx4 v11, s[8:11], s50 offen lds
s_mov_b64 s[12:13], s[70:71]
s_mov_b64 s[16:17], s[76:77]
s_mov_b64 s[20:21], s[78:79]
s_mov_b64 s[32:33], s[72:73]
s_mov_b64 s[36:37], s[80:81]
s_mov_b64 s[40:41], s[82:83]
s_mov_b64 s[4:5], s[84:85]
s_mov_b64 s[24:25], s[86:87]
s_lshl3_add_u32 s60, s45, s66
s_lshl1_add_u32 s80, s46, s60
v_lshrrev_b32 v40, 5, v1
v_add_u32 v40, s80, v40
v_mul_u32_u24 v40, 0x380, v40
v_and_b32 v41, 31, v1
v_lshl_add_u32 v40, v41, 4, v40
v_subrev_u32 v43, 24, v41
v_ashrrev_i32 v43, 31, v43
v_add_u32 v42, 0x200, v40
v_mov_b32 v41, 2146435072
v_bfi_b32 v42, v43, v42, v41
buffer_load_dwordx4 v[44:47], v40, s[8:11], 0 offen
buffer_load_dwordx4 v[48:51], v42, s[8:11], 0 offen
v_and_b32 v43, 1.0, v43
s_mul_i32 s61, s46, 192
s_mov_b32 s62, 43691
s_mul_i32 s63, s49, 112
v_add_u32 v34, s61, v1
v_mul_lo_u32 v35, v34, s62
v_lshrrev_b32 v35, 20, v35
v_mul_u32_u24 v36, 24, v35
v_sub_u32 v36, v34, v36
v_lshrrev_b32 v37, 1, v36
v_bfe_u32 v38, v35, 1, 1
v_bfe_u32 v39, v35, 3, 1
v_lshl_or_b32 v38, v39, 1, v38
v_xor_b32 v37, v37, v38
v_lshrrev_b32 v38, 2, v37
v_mul_u32_u24 v38, 896, v38
v_bfe_u32 v39, v37, 1, 1
v_mul_u32_u24 v39, 56, v39
v_add_u32 v38, v38, v39
v_and_b32 v37, 1, v37
v_lshl_add_u32 v38, v37, 5, v38
v_and_b32 v36, 1, v36
v_lshl_add_u32 v38, v36, 4, v38
v_mul_u32_u24 v35, 2688, v35
v_add_u32 v35, v35, v38
v_add_u32 v2, s63, v35
v_add_u32 v34, s61, v1
v_add_u32 v34, 64, v34
v_mul_lo_u32 v35, v34, s62
v_lshrrev_b32 v35, 20, v35
v_mul_u32_u24 v36, 24, v35
v_sub_u32 v36, v34, v36
v_lshrrev_b32 v37, 1, v36
v_bfe_u32 v38, v35, 1, 1
v_bfe_u32 v39, v35, 3, 1
v_lshl_or_b32 v38, v39, 1, v38
v_xor_b32 v37, v37, v38
v_lshrrev_b32 v38, 2, v37
v_mul_u32_u24 v38, 896, v38
v_bfe_u32 v39, v37, 1, 1
v_mul_u32_u24 v39, 56, v39
v_add_u32 v38, v38, v39
v_and_b32 v37, 1, v37
v_lshl_add_u32 v38, v37, 5, v38
v_and_b32 v36, 1, v36
v_lshl_add_u32 v38, v36, 4, v38
v_mul_u32_u24 v35, 2688, v35
v_add_u32 v35, v35, v38
v_add_u32 v3, s63, v35
v_add_u32 v34, s61, v1
v_add_u32 v34, 128, v34
v_mul_lo_u32 v35, v34, s62
v_lshrrev_b32 v35, 20, v35
v_mul_u32_u24 v36, 24, v35
v_sub_u32 v36, v34, v36
v_lshrrev_b32 v37, 1, v36
v_bfe_u32 v38, v35, 1, 1
v_bfe_u32 v39, v35, 3, 1
v_lshl_or_b32 v38, v39, 1, v38
v_xor_b32 v37, v37, v38
v_lshrrev_b32 v38, 2, v37
v_mul_u32_u24 v38, 896, v38
v_bfe_u32 v39, v37, 1, 1
v_mul_u32_u24 v39, 56, v39
v_add_u32 v38, v38, v39
v_and_b32 v37, 1, v37
v_lshl_add_u32 v38, v37, 5, v38
v_and_b32 v36, 1, v36
v_lshl_add_u32 v38, v36, 4, v38
v_mul_u32_u24 v35, 2688, v35
v_add_u32 v35, v35, v38
v_add_u32 v4, s63, v35
v_lshrrev_b32 v34, 3, v1
s_lshl_b32 s60, s46, 3
v_add_u32 v34, s60, v34
v_bfe_u32 v38, v34, 1, 1
v_bfe_u32 v39, v34, 3, 1
v_lshl_or_b32 v38, v39, 1, v38
v_lshlrev_b32 v38, 1, v38
v_and_b32 v36, 7, v1
v_xor_b32 v36, v36, v38
v_mul_u32_u24 v34, 3584, v34
v_add_u32 v34, s67, v34
v_lshl_add_u32 v5, v36, 4, v34
s_mul_i32 s55, s46, 3072
s_lshl_b32 s60, s46, 10
s_add_u32 s56, s60, 12288
s_add_u32 s57, s60, 16384
s_mul_i32 s52, s53, 114688
s_mul_i32 s51, s53, 86016
s_add_u32 s53, s53, 1
s_cmp_eq_u32 s53, 14
s_cselect_b32 s53, 0, s53
s_add_u32 m0, s55, 0
s_nop 0
buffer_load_dwordx4 v2, s[12:15], s51 offen lds
s_add_u32 m0, s55, 1024
s_nop 0
buffer_load_dwordx4 v3, s[12:15], s51 offen lds
s_add_u32 m0, s55, 2048
s_nop 0
buffer_load_dwordx4 v4, s[12:15], s51 offen lds
s_add_u32 m0, s56, 0
s_nop 0
buffer_load_dwordx4 v5, s[16:19], s52 offen lds
s_add_u32 m0, s57, 0
s_nop 0
buffer_load_dwordx4 v5, s[20:23], s52 offen lds
s_mul_i32 s52, s53, 114688
s_mul_i32 s51, s53, 86016
s_add_u32 s53, s53, 1
s_cmp_eq_u32 s53, 14
s_cselect_b32 s53, 0, s53
s_add_u32 m0, s55, 20480
s_nop 0
buffer_load_dwordx4 v2, s[12:15], s51 offen lds
s_add_u32 m0, s55, 21504
s_nop 0
buffer_load_dwordx4 v3, s[12:15], s51 offen lds
s_add_u32 m0, s55, 22528
s_nop 0
buffer_load_dwordx4 v4, s[12:15], s51 offen lds
s_add_u32 m0, s56, 20480
s_nop 0
buffer_load_dwordx4 v5, s[16:19], s52 offen lds
s_add_u32 m0, s57, 20480
s_nop 0
buffer_load_dwordx4 v5, s[20:23], s52 offen lds
s_lshl2_add_u32 s60, s2, s46
s_mul_i32 s60, s60, 14
v_min_u32 v38, 13, v1
v_add_u32 v38, s60, v38
v_lshlrev_b32 v38, 7, v38
buffer_load_dword v63, v38, s[8:11], 0 offen
s_mov_b32 s26, 16777216
s_mov_b32 s27, 0x20000
s_mov_b32 s6, 256
s_mov_b32 s7, 0x20000
s_mov_b32 s34, 401408
s_mov_b32 s35, 0x20000
s_mov_b32 s38, 1605632
s_mov_b32 s39, 0x20000
s_mov_b32 s42, 1835008
s_mov_b32 s43, 0x20000
s_lshl_b32 s60, s44, 1
s_add_u32 s60, s60, s47
s_lshl_b32 s60, s60, 4
s_add_u32 s60, s60, s45
s_lshl_b32 s60, s60, 1
s_add_u32 s60, s60, s48
s_lshl_b32 s60, s60, 2
s_add_u32 s77, s60, 9699328
s_cmp_lt_u32 s44, 7
s_cselect_b32 s60, 1, 0
s_xor_b32 s61, s47, 1
s_and_b32 s78, s60, s61
s_mul_i32 s61, s45, 7
s_add_u32 s61, s61, s44
s_lshl_b32 s61, s61, 1
s_add_u32 s61, s61, s48
s_lshl_b32 s61, s61, 10
s_add_u32 s3, s61, 9469952
s_lshl_b32 s61, s80, 3
s_add_u32 s82, s61, 9437184
v_mov_b32 v36, 0
v_mov_b32 v37, 0
v_mov_b32 v38, 0
v_mov_b32 v39, 0
s_cmp_eq_u32 s78, 0
s_cbranch_scc1 L_noclr_2
v_lshlrev_b32 v40, 4, v1
buffer_store_dwordx4 v[36:39], v40, s[24:27], s3 offen sc1
L_noclr_2:
buffer_store_dword v36, v36, s[24:27], s77 offen sc1
buffer_store_dwordx4 v[36:39], v36, s[24:27], s82 offen sc1
s_lshl2_add_u32 s60, s2, s46
s_mul_i32 s61, s60, 13
s_lshl_b32 s62, s60, 2
v_add_u32 v40, s61, v1
v_lshlrev_b32 v40, 7, v40
v_subrev_u32 v42, 13, v1
v_ashrrev_i32 v42, 31, v42
v_bfi_b32 v40, v42, v40, v41
buffer_load_dword v60, v40, s[36:39], 0 offen
v_add_u32 v40, s62, v1
v_lshlrev_b32 v40, 7, v40
v_subrev_u32 v42, 4, v1
v_ashrrev_i32 v42, 31, v42
v_bfi_b32 v40, v42, v40, v41
buffer_load_dword v61, v40, s[32:35], 0 offen
v_and_b32 v34, 15, v1
v_bfe_u32 v35, v34, 1, 3
v_lshrrev_b32 v36, 4, v1
v_lshlrev_b32 v37, 7, v34
s_lshl_b32 s60, s47, 13
s_add_u32 s60, s60, 81920
s_add_u32 s61, s60, 4096
v_or_b32 v38, 0, v36
v_xor_b32 v38, v38, v35
v_lshl_add_u32 v38, v38, 4, v37
v_add_u32 v20, s60, v38
v_add_u32 v22, s61, v38
v_add_u32 v24, 98304, v38
v_or_b32 v38, 4, v36
v_xor_b32 v38, v38, v35
v_lshl_add_u32 v38, v38, 4, v37
v_add_u32 v21, s60, v38
v_add_u32 v23, s61, v38
v_add_u32 v25, 98304, v38
v_lshrrev_b32 v34, 4, v1
v_bfe_u32 v35, v1, 2, 2
v_lshrrev_b32 v36, 1, v35
v_and_b32 v37, 1, v34
v_lshl_or_b32 v36, v37, 1, v36
v_lshl_add_u32 v35, v34, 3, v35
v_and_b32 v37, 3, v1
v_lshlrev_b32 v37, 3, v37
s_lshl_b32 s60, s48, 1
v_xor_b32 v38, s60, v36
v_lshl_add_u32 v38, v38, 5, v37
v_mul_u32_u24 v39, 384, v35
v_add_u32 v12, v39, v38
v_lshl_add_u32 v14, v35, 7, v38
s_lshl_b32 s60, s48, 1
s_add_u32 s60, s60, 1
v_xor_b32 v38, s60, v36
v_lshl_add_u32 v38, v38, 5, v37
v_mul_u32_u24 v39, 384, v35
v_add_u32 v13, v39, v38
v_lshl_add_u32 v15, v35, 7, v38
v_add_u32 v16, 40960, v12
v_add_u32 v17, 40960, v13
v_add_u32 v18, 40960, v14
v_add_u32 v19, 40960, v15
s_waitcnt vmcnt(15)
v_lshlrev_b32 v200, 16, v44
v_and_b32 v201, 0xffff0000, v44
v_lshlrev_b32 v202, 16, v45
v_and_b32 v203, 0xffff0000, v45
v_lshlrev_b32 v204, 16, v46
v_and_b32 v205, 0xffff0000, v46
v_lshlrev_b32 v206, 16, v47
v_and_b32 v207, 0xffff0000, v47
v_lshlrev_b32 v208, 16, v48
v_and_b32 v209, 0xffff0000, v48
v_lshlrev_b32 v210, 16, v49
v_and_b32 v211, 0xffff0000, v49
v_lshlrev_b32 v212, 16, v50
v_and_b32 v213, 0xffff0000, v50
v_lshlrev_b32 v214, 16, v51
v_and_b32 v215, 0xffff0000, v51
v_pk_add_f32 v[216:217], v[200:201], v[202:203]
v_pk_add_f32 v[218:219], v[204:205], v[206:207]
v_pk_add_f32 v[220:221], v[208:209], v[210:211]
v_pk_add_f32 v[222:223], v[212:213], v[214:215]
v_pk_add_f32 v[216:217], v[216:217], v[218:219]
v_pk_add_f32 v[220:221], v[220:221], v[222:223]
v_pk_add_f32 v[216:217], v[216:217], v[220:221]
v_add_f32 v216, v216, v217
s_nop 1
v_add_f32_dpp v216, v216, v216 row_ror:8 row_mask:0xf bank_mask:0xf
s_nop 1
v_add_f32_dpp v216, v216, v216 row_ror:4 row_mask:0xf bank_mask:0xf
s_nop 1
v_add_f32_dpp v216, v216, v216 row_ror:2 row_mask:0xf bank_mask:0xf
s_nop 1
v_add_f32_dpp v216, v216, v216 row_ror:1 row_mask:0xf bank_mask:0xf
v_mov_b32 v217, v216
s_nop 1
v_permlane16_swap_b32 v216, v217
v_add_f32 v216, v216, v217
v_mul_f32 v216, 0x3b124925, v216
v_sub_f32 v218, 0, v216
v_pk_add_f32 v[200:201], v[200:201], v[218:219] op_sel_hi:[1,0]
v_pk_add_f32 v[202:203], v[202:203], v[218:219] op_sel_hi:[1,0]
v_pk_add_f32 v[204:205], v[204:205], v[218:219] op_sel_hi:[1,0]
v_pk_add_f32 v[206:207], v[206:207], v[218:219] op_sel_hi:[1,0]
v_pk_add_f32 v[208:209], v[208:209], v[218:219] op_sel_hi:[1,0]
v_pk_add_f32 v[210:211], v[210:211], v[218:219] op_sel_hi:[1,0]
v_pk_add_f32 v[212:213], v[212:213], v[218:219] op_sel_hi:[1,0]
v_pk_add_f32 v[214:215], v[214:215], v[218:219] op_sel_hi:[1,0]
v_pk_mul_f32 v[220:221], v[200:201], v[200:201]
v_pk_mul_f32 v[222:223], v[208:209], v[208:209]
v_pk_fma_f32 v[220:221], v[202:203], v[202:203], v[220:221]
v_pk_fma_f32 v[222:223], v[210:211], v[210:211], v[222:223]
v_pk_fma_f32 v[220:221], v[204:205], v[204:205], v[220:221]
v_pk_fma_f32 v[222:223], v[212:213], v[212:213], v[222:223]
v_pk_fma_f32 v[220:221], v[206:207], v[206:207], v[220:221]
v_pk_fma_f32 v[222:223], v[214:215], v[214:215], v[222:223]
v_add_f32 v220, v220, v221
v_add_f32 v222, v222, v223
v_fma_f32 v220, v222, v43, v220
s_nop 1
v_add_f32_dpp v220, v220, v220 row_ror:8 row_mask:0xf bank_mask:0xf
s_nop 1
v_add_f32_dpp v220, v220, v220 row_ror:4 row_mask:0xf bank_mask:0xf
s_nop 1
v_add_f32_dpp v220, v220, v220 row_ror:2 row_mask:0xf bank_mask:0xf
s_nop 1
v_add_f32_dpp v220, v220, v220 row_ror:1 row_mask:0xf bank_mask:0xf
v_mov_b32 v221, v220
s_nop 1
v_permlane16_swap_b32 v220, v221
v_add_f32 v220, v220, v221
v_mov_b32 v221, 0x3727c5ac
v_fmac_f32 v221, 0x3b124925, v220
v_rsq_f32 v217, v221
s_nop 0
v_or_b32 v217, 1, v217
v_lshrrev_b32 v193, 5, v1
v_lshlrev_b32 v193, 3, v193
buffer_store_dwordx2 v[216:217], v193, s[24:27], s82 offen sc1
s_cmp_eq_u32 s78, 1
s_cbranch_scc1 L_csA_9
s_waitcnt vmcnt(11)
s_barrier
ds_read_b128 a[0:3], v20 offset:0
ds_read_b128 a[4:7], v20 offset:2048
ds_read_b128 a[8:11], v22 offset:0
ds_read_b128 a[12:15], v22 offset:2048
ds_read_b128 a[16:19], v24 offset:0
ds_read_b64_tr_b16 a[40:41], v12 offset:0
ds_read_b64_tr_b16 a[42:43], v12 offset:1536
ds_read_b64_tr_b16 a[44:45], v13 offset:0
ds_read_b64_tr_b16 a[46:47], v13 offset:1536
ds_read_b64_tr_b16 a[48:49], v12 offset:128
ds_read_b64_tr_b16 a[50:51], v12 offset:1664
ds_read_b64_tr_b16 a[52:53], v13 offset:128
ds_read_b64_tr_b16 a[54:55], v13 offset:1664
ds_read_b64_tr_b16 a[56:57], v12 offset:256
ds_read_b64_tr_b16 a[58:59], v12 offset:1792
ds_read_b64_tr_b16 a[60:61], v13 offset:256
ds_read_b64_tr_b16 a[62:63], v13 offset:1792
ds_read_b64_tr_b16 a[64:65], v14 offset:12288
ds_read_b64_tr_b16 a[66:67], v14 offset:12800
ds_read_b64_tr_b16 a[68:69], v15 offset:12288
ds_read_b64_tr_b16 a[70:71], v15 offset:12800
ds_read_b64_tr_b16 a[72:73], v14 offset:16384
ds_read_b64_tr_b16 a[74:75], v14 offset:16896
ds_read_b64_tr_b16 a[76:77], v15 offset:16384
ds_read_b64_tr_b16 a[78:79], v15 offset:16896
s_waitcnt lgkmcnt(15)
v_mfma_f32_16x16x32_bf16 v[64:67], a[40:43], a[0:3], 0
s_waitcnt vmcnt(6)
s_barrier
v_mfma_f32_16x16x32_bf16 v[68:71], a[40:43], a[4:7], 0
ds_read_b128 a[20:23], v21 offset:0
s_lshl_b32 s50, s54, 7
s_add_u32 s54, s54, 1
s_cmp_eq_u32 s54, 7
s_cselect_b32 s54, 0, s54
s_add_u32 m0, s58, 18432
v_mfma_f32_16x16x32_bf16 v[72:75], a[40:43], a[8:11], 0
buffer_load_dwordx4 v7, s[8:11], s50 offen lds
s_add_u32 m0, s58, 19456
v_mfma_f32_16x16x32_bf16 v[76:79], a[40:43], a[12:15], 0
buffer_load_dwordx4 v8, s[8:11], s50 offen lds
v_mfma_f32_16x16x32_bf16 v[80:83], a[44:47], a[0:3], 0
ds_read_b64_tr_b16 a[40:41], v12 offset:20480
v_mfma_f32_16x16x32_bf16 v[84:87], a[44:47], a[4:7], 0
ds_read_b64_tr_b16 a[42:43], v12 offset:22016
s_add_u32 m0, s58, 20480
v_mfma_f32_16x16x32_bf16 v[88:91], a[44:47], a[8:11], 0
buffer_load_dwordx4 v9, s[8:11], s50 offen lds
s_add_u32 m0, s58, 21504
v_mfma_f32_16x16x32_bf16 v[92:95], a[44:47], a[12:15], 0
buffer_load_dwordx4 v10, s[8:11], s50 offen lds
s_waitcnt lgkmcnt(15)
v_mfma_f32_16x16x32_bf16 v[96:99], a[48:51], a[0:3], 0
ds_read_b128 a[24:27], v21 offset:2048
v_mfma_f32_16x16x32_bf16 v[100:103], a[48:51], a[4:7], 0
ds_read_b64_tr_b16 a[44:45], v13 offset:20480
v_mfma_f32_16x16x32_bf16 v[104:107], a[48:51], a[8:11], 0
ds_read_b64_tr_b16 a[46:47], v13 offset:22016
s_add_u32 m0, s59, 18432
v_mfma_f32_16x16x32_bf16 v[108:111], a[48:51], a[12:15], 0
buffer_load_dwordx4 v11, s[8:11], s50 offen lds
s_mul_i32 s52, s53, 114688
s_mul_i32 s51, s53, 86016
s_add_u32 s53, s53, 1
s_cmp_eq_u32 s53, 14
s_cselect_b32 s53, 0, s53
s_add_u32 m0, s55, 40960
v_mfma_f32_16x16x32_bf16 v[224:227], a[48:51], a[16:19], 0
buffer_load_dwordx4 v2, s[12:15], s51 offen lds
v_mfma_f32_16x16x32_bf16 v[112:115], a[52:55], a[0:3], 0
ds_read_b128 a[28:31], v23 offset:0
v_mfma_f32_16x16x32_bf16 v[116:119], a[52:55], a[4:7], 0
ds_read_b64_tr_b16 a[48:49], v12 offset:20608
v_mfma_f32_16x16x32_bf16 v[120:123], a[52:55], a[8:11], 0
ds_read_b64_tr_b16 a[50:51], v12 offset:22144
s_add_u32 m0, s55, 41984
v_mfma_f32_16x16x32_bf16 v[124:127], a[52:55], a[12:15], 0
buffer_load_dwordx4 v3, s[12:15], s51 offen lds
s_add_u32 m0, s55, 43008
v_mfma_f32_16x16x32_bf16 v[228:231], a[52:55], a[16:19], 0
buffer_load_dwordx4 v4, s[12:15], s51 offen lds
s_waitcnt lgkmcnt(15)
v_mfma_f32_16x16x32_bf16 v[128:131], a[0:3], a[56:59], 0
ds_read_b128 a[32:35], v23 offset:2048
v_mfma_f32_16x16x32_bf16 v[132:135], a[4:7], a[56:59], 0
ds_read_b64_tr_b16 a[52:53], v13 offset:20608
v_mfma_f32_16x16x32_bf16 v[136:139], a[8:11], a[56:59], 0
ds_read_b64_tr_b16 a[54:55], v13 offset:22144
s_add_u32 m0, s56, 40960
v_mfma_f32_16x16x32_bf16 v[140:143], a[12:15], a[56:59], 0
buffer_load_dwordx4 v5, s[16:19], s52 offen lds
v_mfma_f32_16x16x32_bf16 v[144:147], a[0:3], a[60:63], 0
ds_read_b128 a[36:39], v25 offset:0
v_mfma_f32_16x16x32_bf16 v[148:151], a[4:7], a[60:63], 0
ds_read_b64_tr_b16 a[56:57], v12 offset:20736
s_add_u32 m0, s57, 40960
v_mfma_f32_16x16x32_bf16 v[152:155], a[8:11], a[60:63], 0
buffer_load_dwordx4 v5, s[20:23], s52 offen lds
s_lshl_b32 s50, s54, 7
s_add_u32 s54, s54, 1
s_cmp_eq_u32 s54, 7
s_cselect_b32 s54, 0, s54
s_add_u32 m0, s58, 36864
v_mfma_f32_16x16x32_bf16 v[156:159], a[12:15], a[60:63], 0
buffer_load_dwordx4 v7, s[8:11], s50 offen lds
s_waitcnt lgkmcnt(15)
v_mfma_f32_16x16x32_bf16 v[160:163], a[64:67], a[0:3], 0
ds_read_b64_tr_b16 a[58:59], v12 offset:22272
v_mfma_f32_16x16x32_bf16 v[164:167], a[64:67], a[4:7], 0
ds_read_b64_tr_b16 a[60:61], v13 offset:20736
s_add_u32 m0, s58, 37888
v_mfma_f32_16x16x32_bf16 v[168:171], a[64:67], a[8:11], 0
buffer_load_dwordx4 v8, s[8:11], s50 offen lds
s_add_u32 m0, s58, 38912
v_mfma_f32_16x16x32_bf16 v[172:175], a[64:67], a[12:15], 0
buffer_load_dwordx4 v9, s[8:11], s50 offen lds
v_mfma_f32_16x16x32_bf16 v[176:179], a[68:71], a[0:3], 0
ds_read_b64_tr_b16 a[62:63], v13 offset:22272
v_mfma_f32_16x16x32_bf16 v[180:183], a[68:71], a[4:7], 0
ds_read_b64_tr_b16 a[64:65], v14 offset:32768
s_mul_i32 s52, s53, 114688
s_mul_i32 s51, s53, 86016
s_add_u32 s53, s53, 1
s_cmp_eq_u32 s53, 14
s_cselect_b32 s53, 0, s53
s_add_u32 m0, s55, 61440
v_mfma_f32_16x16x32_bf16 v[184:187], a[68:71], a[8:11], 0
buffer_load_dwordx4 v2, s[12:15], s51 offen lds
s_add_u32 m0, s55, 62464
v_mfma_f32_16x16x32_bf16 v[188:191], a[68:71], a[12:15], 0
buffer_load_dwordx4 v3, s[12:15], s51 offen lds
s_waitcnt lgkmcnt(15)
v_mfma_f32_16x16x32_bf16 v[192:195], a[72:75], a[0:3], 0
ds_read_b64_tr_b16 a[66:67], v14 offset:33280
v_mfma_f32_16x16x32_bf16 v[196:199], a[72:75], a[4:7], 0
ds_read_b64_tr_b16 a[68:69], v15 offset:32768
s_add_u32 m0, s55, 63488
v_mfma_f32_16x16x32_bf16 v[200:203], a[72:75], a[8:11], 0
buffer_load_dwordx4 v4, s[12:15], s51 offen lds
s_add_u32 m0, s56, 61440
v_mfma_f32_16x16x32_bf16 v[204:207], a[72:75], a[12:15], 0
buffer_load_dwordx4 v5, s[16:19], s52 offen lds
v_mfma_f32_16x16x32_bf16 v[208:211], a[76:79], a[0:3], 0
ds_read_b64_tr_b16 a[70:71], v15 offset:33280
v_mfma_f32_16x16x32_bf16 v[212:215], a[76:79], a[4:7], 0
ds_read_b64_tr_b16 a[72:73], v14 offset:36864
v_mfma_f32_16x16x32_bf16 v[216:219], a[76:79], a[8:11], 0
ds_read_b64_tr_b16 a[74:75], v14 offset:37376
s_add_u32 m0, s57, 61440
v_mfma_f32_16x16x32_bf16 v[220:223], a[76:79], a[12:15], 0
buffer_load_dwordx4 v5, s[20:23], s52 offen lds
s_waitcnt lgkmcnt(10)
v_mfma_f32_16x16x32_bf16 v[64:67], a[40:43], a[20:23], v[64:67]
s_waitcnt vmcnt(8)
s_barrier
v_mfma_f32_16x16x32_bf16 v[68:71], a[40:43], a[24:27], v[68:71]
ds_read_b64_tr_b16 a[76:77], v15 offset:36864
v_mfma_f32_16x16x32_bf16 v[72:75], a[40:43], a[28:31], v[72:75]
ds_read_b64_tr_b16 a[78:79], v15 offset:37376
s_add_u32 m0, s58, 39936
v_mfma_f32_16x16x32_bf16 v[76:79], a[40:43], a[32:35], v[76:79]
buffer_load_dwordx4 v10, s[8:11], s50 offen lds
v_mfma_f32_16x16x32_bf16 v[80:83], a[44:47], a[20:23], v[80:83]
ds_read_b128 a[0:3], v20 offset:18432
v_mfma_f32_16x16x32_bf16 v[84:87], a[44:47], a[24:27], v[84:87]
ds_read_b64_tr_b16 a[40:41], v16 offset:0
v_mfma_f32_16x16x32_bf16 v[88:91], a[44:47], a[28:31], v[88:91]
ds_read_b64_tr_b16 a[42:43], v16 offset:1536
s_add_u32 m0, s59, 36864
v_mfma_f32_16x16x32_bf16 v[92:95], a[44:47], a[32:35], v[92:95]
buffer_load_dwordx4 v11, s[8:11], s50 offen lds
v_mfma_f32_16x16x32_bf16 v[96:99], a[48:51], a[20:23], v[96:99]
ds_read_b128 a[4:7], v20 offset:20480
v_mfma_f32_16x16x32_bf16 v[100:103], a[48:51], a[24:27], v[100:103]
s_cmp_lg_u32 s46, 0
s_cbranch_scc1 L_noinc_12
s_and_b32 s60, s2, 3
s_lshl_b32 s60, s60, 6
v_mov_b32 v36, 1
v_cmp_eq_u32 vcc, 0, v1
v_mov_b32 v37, 2146435072
v_mov_b32 v38, s60
s_nop 1
v_cndmask_b32 v37, v37, v38, vcc
buffer_atomic_add v36, v37, s[4:7], 0 offen
L_noinc_12:
v_mfma_f32_16x16x32_bf16 v[104:107], a[48:51], a[28:31], v[104:107]
ds_read_b64_tr_b16 a[44:45], v17 offset:0
v_mfma_f32_16x16x32_bf16 v[108:111], a[48:51], a[32:35], v[108:111]
ds_read_b64_tr_b16 a[46:47], v17 offset:1536
s_mul_i32 s52, s53, 114688
s_mul_i32 s51, s53, 86016
s_add_u32 s53, s53, 1
s_cmp_eq_u32 s53, 14
s_cselect_b32 s53, 0, s53
s_add_u32 m0, s55, 0
v_mfma_f32_16x16x32_bf16 v[224:227], a[48:51], a[36:39], v[224:227]
buffer_load_dwordx4 v2, s[12:15], s51 offen lds
v_mfma_f32_16x16x32_bf16 v[112:115], a[52:55], a[20:23], v[112:115]
ds_read_b128 a[8:11], v22 offset:18432
v_mfma_f32_16x16x32_bf16 v[116:119], a[52:55], a[24:27], v[116:119]
ds_read_b64_tr_b16 a[48:49], v16 offset:128
v_mfma_f32_16x16x32_bf16 v[120:123], a[52:55], a[28:31], v[120:123]
ds_read_b64_tr_b16 a[50:51], v16 offset:1664
v_mfma_f32_16x16x32_bf16 v[124:127], a[52:55], a[32:35], v[124:127]
ds_read_b128 a[12:15], v22 offset:20480
v_mfma_f32_16x16x32_bf16 v[228:231], a[52:55], a[36:39], v[228:231]
s_waitcnt lgkmcnt(15)
v_mfma_f32_16x16x32_bf16 v[128:131], a[20:23], a[56:59], v[128:131]
ds_read_b64_tr_b16 a[52:53], v17 offset:128
v_mfma_f32_16x16x32_bf16 v[132:135], a[24:27], a[56:59], v[132:135]
ds_read_b64_tr_b16 a[54:55], v17 offset:1664
v_mfma_f32_16x16x32_bf16 v[136:139], a[28:31], a[56:59], v[136:139]
ds_read_b128 a[16:19], v24 offset:18432
s_add_u32 m0, s55, 1024
v_mfma_f32_16x16x32_bf16 v[140:143], a[32:35], a[56:59], v[140:143]
buffer_load_dwordx4 v3, s[12:15], s51 offen lds
v_mfma_f32_16x16x32_bf16 v[144:147], a[20:23], a[60:63], v[144:147]
ds_read_b64_tr_b16 a[56:57], v16 offset:256
v_mfma_f32_16x16x32_bf16 v[148:151], a[24:27], a[60:63], v[148:151]
ds_read_b64_tr_b16 a[58:59], v16 offset:1792
v_mfma_f32_16x16x32_bf16 v[152:155], a[28:31], a[60:63], v[152:155]
s_add_u32 m0, s55, 2048
v_mfma_f32_16x16x32_bf16 v[156:159], a[32:35], a[60:63], v[156:159]
buffer_load_dwordx4 v4, s[12:15], s51 offen lds
s_waitcnt lgkmcnt(15)
v_mfma_f32_16x16x32_bf16 v[160:163], a[64:67], a[20:23], v[160:163]
ds_read_b64_tr_b16 a[60:61], v17 offset:256
v_mfma_f32_16x16x32_bf16 v[164:167], a[64:67], a[24:27], v[164:167]
ds_read_b64_tr_b16 a[62:63], v17 offset:1792
v_mfma_f32_16x16x32_bf16 v[168:171], a[64:67], a[28:31], v[168:171]
v_mfma_f32_16x16x32_bf16 v[172:175], a[64:67], a[32:35], v[172:175]
v_mfma_f32_16x16x32_bf16 v[176:179], a[68:71], a[20:23], v[176:179]
ds_read_b64_tr_b16 a[64:65], v18 offset:12288
v_mfma_f32_16x16x32_bf16 v[180:183], a[68:71], a[24:27], v[180:183]
ds_read_b64_tr_b16 a[66:67], v18 offset:12800
v_mfma_f32_16x16x32_bf16 v[184:187], a[68:71], a[28:31], v[184:187]
s_add_u32 m0, s56, 0
v_mfma_f32_16x16x32_bf16 v[188:191], a[68:71], a[32:35], v[188:191]
buffer_load_dwordx4 v5, s[16:19], s52 offen lds
v_mfma_f32_16x16x32_bf16 v[192:195], a[72:75], a[20:23], v[192:195]
ds_read_b64_tr_b16 a[68:69], v19 offset:12288
v_mfma_f32_16x16x32_bf16 v[196:199], a[72:75], a[24:27], v[196:199]
ds_read_b64_tr_b16 a[70:71], v19 offset:12800
v_mfma_f32_16x16x32_bf16 v[200:203], a[72:75], a[28:31], v[200:203]
s_add_u32 m0, s57, 0
v_mfma_f32_16x16x32_bf16 v[204:207], a[72:75], a[32:35], v[204:207]
buffer_load_dwordx4 v5, s[20:23], s52 offen lds
v_mfma_f32_16x16x32_bf16 v[208:211], a[76:79], a[20:23], v[208:211]
ds_read_b64_tr_b16 a[72:73], v18 offset:16384
v_mfma_f32_16x16x32_bf16 v[212:215], a[76:79], a[24:27], v[212:215]
ds_read_b64_tr_b16 a[74:75], v18 offset:16896
v_mfma_f32_16x16x32_bf16 v[216:219], a[76:79], a[28:31], v[216:219]
v_mfma_f32_16x16x32_bf16 v[220:223], a[76:79], a[32:35], v[220:223]
ds_read_b64_tr_b16 a[76:77], v19 offset:16384
ds_read_b64_tr_b16 a[78:79], v19 offset:16896
L_csJ_10:
s_waitcnt lgkmcnt(12)
v_mfma_f32_16x16x32_bf16 v[64:67], a[40:43], a[0:3], v[64:67]
s_waitcnt vmcnt(7)
s_barrier
v_mfma_f32_16x16x32_bf16 v[68:71], a[40:43], a[4:7], v[68:71]
ds_read_b128 a[20:23], v21 offset:18432
v_mfma_f32_16x16x32_bf16 v[72:75], a[40:43], a[8:11], v[72:75]
s_lshl_b32 s50, s54, 7
s_add_u32 s54, s54, 1
s_cmp_eq_u32 s54, 7
s_cselect_b32 s54, 0, s54
s_add_u32 m0, s58, 0
v_mfma_f32_16x16x32_bf16 v[76:79], a[40:43], a[12:15], v[76:79]
buffer_load_dwordx4 v7, s[8:11], s50 offen lds
v_mfma_f32_16x16x32_bf16 v[80:83], a[44:47], a[0:3], v[80:83]
ds_read_b64_tr_b16 a[40:41], v16 offset:20480
v_mfma_f32_16x16x32_bf16 v[84:87], a[44:47], a[4:7], v[84:87]
ds_read_b64_tr_b16 a[42:43], v16 offset:22016
v_mfma_f32_16x16x32_bf16 v[88:91], a[44:47], a[8:11], v[88:91]
ds_read_b128 a[24:27], v21 offset:20480
s_and_b32 s60, s2, 7
s_lshr_b32 s61, s2, 3
s_add_u32 m0, s58, 1024
v_mfma_f32_16x16x32_bf16 v[92:95], a[44:47], a[12:15], v[92:95]
buffer_load_dwordx4 v8, s[8:11], s50 offen lds
s_and_b32 s62, s61, 7
v_mfma_f32_16x16x32_bf16 v[96:99], a[48:51], a[0:3], v[96:99]
ds_read_b64_tr_b16 a[44:45], v17 offset:20480
v_mfma_f32_16x16x32_bf16 v[100:103], a[48:51], a[4:7], v[100:103]
ds_read_b64_tr_b16 a[46:47], v17 offset:22016
v_mfma_f32_16x16x32_bf16 v[104:107], a[48:51], a[8:11], v[104:107]
ds_read_b128 a[28:31], v23 offset:18432
s_lshr_b32 s63, s61, 4
s_lshl3_add_u32 s62, s63, s62
v_mfma_f32_16x16x32_bf16 v[108:111], a[48:51], a[12:15], v[108:111]
s_lshr_b32 s69, s62, 2
s_add_u32 m0, s58, 2048
v_mfma_f32_16x16x32_bf16 v[224:227], a[48:51], a[16:19], v[224:227]
buffer_load_dwordx4 v9, s[8:11], s50 offen lds
v_mfma_f32_16x16x32_bf16 v[112:115], a[52:55], a[0:3], v[112:115]
ds_read_b64_tr_b16 a[48:49], v16 offset:20608
v_mfma_f32_16x16x32_bf16 v[116:119], a[52:55], a[4:7], v[116:119]
ds_read_b64_tr_b16 a[50:51], v16 offset:22144
v_mfma_f32_16x16x32_bf16 v[120:123], a[52:55], a[8:11], v[120:123]
ds_read_b128 a[32:35], v23 offset:20480
s_and_b32 s63, s62, 3
s_mul_i32 s63, s63, 3
v_mfma_f32_16x16x32_bf16 v[124:127], a[52:55], a[12:15], v[124:127]
s_lshl4_add_u32 s68, s60, s63
s_mul_i32 s52, s53, 114688
s_mul_i32 s51, s53, 86016
s_add_u32 s53, s53, 1
s_cmp_eq_u32 s53, 14
s_cselect_b32 s53, 0, s53
s_add_u32 m0, s55, 20480
v_mfma_f32_16x16x32_bf16 v[228:231], a[52:55], a[16:19], v[228:231]
buffer_load_dwordx4 v2, s[12:15], s51 offen lds
s_waitcnt lgkmcnt(15)
v_mfma_f32_16x16x32_bf16 v[128:131], a[0:3], a[56:59], v[128:131]
ds_read_b64_tr_b16 a[52:53], v17 offset:20608
v_mfma_f32_16x16x32_bf16 v[132:135], a[4:7], a[56:59], v[132:135]
ds_read_b64_tr_b16 a[54:55], v17 offset:22144
v_mfma_f32_16x16x32_bf16 v[136:139], a[8:11], a[56:59], v[136:139]
ds_read_b128 a[36:39], v25 offset:18432
s_lshr_b32 s60, s46, 1
s_mul_i32 s60, s60, 448
v_mfma_f32_16x16x32_bf16 v[140:143], a[12:15], a[56:59], v[140:143]
s_and_b32 s61, s46, 1
v_mfma_f32_16x16x32_bf16 v[144:147], a[0:3], a[60:63], v[144:147]
ds_read_b64_tr_b16 a[56:57], v16 offset:20736
v_mfma_f32_16x16x32_bf16 v[148:151], a[4:7], a[60:63], v[148:151]
ds_read_b64_tr_b16 a[58:59], v16 offset:22272
s_mul_i32 s63, s61, 384
s_add_u32 s63, s63, s60
v_mfma_f32_16x16x32_bf16 v[152:155], a[8:11], a[60:63], v[152:155]
s_mul_i32 s71, s63, 0x380
s_add_u32 m0, s55, 21504
v_mfma_f32_16x16x32_bf16 v[156:159], a[12:15], a[60:63], v[156:159]
buffer_load_dwordx4 v3, s[12:15], s51 offen lds
s_waitcnt lgkmcnt(15)
v_mfma_f32_16x16x32_bf16 v[160:163], a[64:67], a[0:3], v[160:163]
ds_read_b64_tr_b16 a[60:61], v17 offset:20736
v_mfma_f32_16x16x32_bf16 v[164:167], a[64:67], a[4:7], v[164:167]
ds_read_b64_tr_b16 a[62:63], v17 offset:22272
s_mul_i32 s63, s61, 160
s_add_u32 s63, s63, s60
v_mfma_f32_16x16x32_bf16 v[168:171], a[64:67], a[8:11], v[168:171]
s_add_u32 s63, s63, 64
s_add_u32 m0, s55, 22528
v_mfma_f32_16x16x32_bf16 v[172:175], a[64:67], a[12:15], v[172:175]
buffer_load_dwordx4 v4, s[12:15], s51 offen lds
v_mfma_f32_16x16x32_bf16 v[176:179], a[68:71], a[0:3], v[176:179]
ds_read_b64_tr_b16 a[64:65], v18 offset:32768
v_mfma_f32_16x16x32_bf16 v[180:183], a[68:71], a[4:7], v[180:183]
ds_read_b64_tr_b16 a[66:67], v18 offset:33280
s_mul_i32 s70, s63, 0x380
s_mul_i32 s72, s46, 50176
v_mfma_f32_16x16x32_bf16 v[184:187], a[68:71], a[8:11], v[184:187]
s_lshl_b32 s74, s46, 12
s_add_u32 m0, s56, 20480
v_mfma_f32_16x16x32_bf16 v[188:191], a[68:71], a[12:15], v[188:191]
buffer_load_dwordx4 v5, s[16:19], s52 offen lds
v_mfma_f32_16x16x32_bf16 v[192:195], a[72:75], a[0:3], v[192:195]
ds_read_b64_tr_b16 a[68:69], v19 offset:32768
v_mfma_f32_16x16x32_bf16 v[196:199], a[72:75], a[4:7], v[196:199]
ds_read_b64_tr_b16 a[70:71], v19 offset:33280
s_mul_i32 s60, s68, 72
s_mul_i32 s61, s46, 9
v_mfma_f32_16x16x32_bf16 v[200:203], a[72:75], a[8:11], v[200:203]
s_add_u32 s60, s60, s61
s_add_u32 m0, s57, 20480
v_mfma_f32_16x16x32_bf16 v[204:207], a[72:75], a[12:15], v[204:207]
buffer_load_dwordx4 v5, s[20:23], s52 offen lds
v_mfma_f32_16x16x32_bf16 v[208:211], a[76:79], a[0:3], v[208:211]
ds_read_b64_tr_b16 a[72:73], v18 offset:36864
v_mfma_f32_16x16x32_bf16 v[212:215], a[76:79], a[4:7], v[212:215]
ds_read_b64_tr_b16 a[74:75], v18 offset:37376
s_lshl_b32 s73, s60, 10
s_lshl_b32 s60, s46, 4
v_mfma_f32_16x16x32_bf16 v[216:219], a[76:79], a[8:11], v[216:219]
s_add_u32 s79, s60, 9699328
v_mfma_f32_16x16x32_bf16 v[220:223], a[76:79], a[12:15], v[220:223]
s_waitcnt lgkmcnt(10)
v_mfma_f32_16x16x32_bf16 v[64:67], a[40:43], a[20:23], v[64:67]
s_waitcnt vmcnt(8)
s_barrier
v_mfma_f32_16x16x32_bf16 v[68:71], a[40:43], a[24:27], v[68:71]
ds_read_b64_tr_b16 a[76:77], v19 offset:36864
v_mfma_f32_16x16x32_bf16 v[72:75], a[40:43], a[28:31], v[72:75]
ds_read_b64_tr_b16 a[78:79], v19 offset:37376
s_add_u32 m0, s58, 3072
v_mfma_f32_16x16x32_bf16 v[76:79], a[40:43], a[32:35], v[76:79]
buffer_load_dwordx4 v10, s[8:11], s50 offen lds
v_mfma_f32_16x16x32_bf16 v[80:83], a[44:47], a[20:23], v[80:83]
ds_read_b128 a[0:3], v20 offset:36864
v_mfma_f32_16x16x32_bf16 v[84:87], a[44:47], a[24:27], v[84:87]
ds_read_b64_tr_b16 a[40:41], v12 offset:0
v_mfma_f32_16x16x32_bf16 v[88:91], a[44:47], a[28:31], v[88:91]
ds_read_b64_tr_b16 a[42:43], v12 offset:1536
s_add_u32 m0, s59, 0
v_mfma_f32_16x16x32_bf16 v[92:95], a[44:47], a[32:35], v[92:95]
buffer_load_dwordx4 v11, s[8:11], s50 offen lds
v_mfma_f32_16x16x32_bf16 v[96:99], a[48:51], a[20:23], v[96:99]
ds_read_b128 a[4:7], v20 offset:38912
v_min_u32 v36, 143, v0
v_mfma_f32_16x16x32_bf16 v[100:103], a[48:51], a[24:27], v[100:103]
v_sub_u32 v37, 127, v36
v_ashrrev_i32 v37, 31, v37
v_mfma_f32_16x16x32_bf16 v[104:107], a[48:51], a[28:31], v[104:107]
v_and_b32 v37, 0xffffff70, v37
ds_read_b64_tr_b16 a[44:45], v13 offset:0
v_mfma_f32_16x16x32_bf16 v[108:111], a[48:51], a[32:35], v[108:111]
ds_read_b64_tr_b16 a[46:47], v13 offset:1536
s_mul_i32 s52, s53, 114688
s_mul_i32 s51, s53, 86016
s_add_u32 s53, s53, 1
s_cmp_eq_u32 s53, 14
s_cselect_b32 s53, 0, s53
s_add_u32 m0, s55, 40960
v_mfma_f32_16x16x32_bf16 v[224:227], a[48:51], a[36:39], v[224:227]
buffer_load_dwordx4 v2, s[12:15], s51 offen lds
v_mfma_f32_16x16x32_bf16 v[112:115], a[52:55], a[20:23], v[112:115]
ds_read_b128 a[8:11], v22 offset:36864
v_add_u32 v36, v36, v37
v_mfma_f32_16x16x32_bf16 v[116:119], a[52:55], a[24:27], v[116:119]
v_add_u32 v36, s66, v36
v_max_i32 v36, 0, v36
v_mfma_f32_16x16x32_bf16 v[120:123], a[52:55], a[28:31], v[120:123]
v_lshlrev_b32 v26, 3, v36
ds_read_b64_tr_b16 a[48:49], v12 offset:128
v_mfma_f32_16x16x32_bf16 v[124:127], a[52:55], a[32:35], v[124:127]
ds_read_b64_tr_b16 a[50:51], v12 offset:1664
v_mfma_f32_16x16x32_bf16 v[228:231], a[52:55], a[36:39], v[228:231]
ds_read_b128 a[12:15], v22 offset:38912
v_min_u32 v28, 0xef, v0
s_waitcnt lgkmcnt(15)
v_mfma_f32_16x16x32_bf16 v[128:131], a[20:23], a[56:59], v[128:131]
v_lshlrev_b32 v28, 2, v28
v_add_u32 v28, 139392, v28
v_mfma_f32_16x16x32_bf16 v[132:135], a[24:27], a[56:59], v[132:135]
v_lshlrev_b32 v27, 4, v1
ds_read_b64_tr_b16 a[52:53], v13 offset:128
v_mfma_f32_16x16x32_bf16 v[136:139], a[28:31], a[56:59], v[136:139]
ds_read_b64_tr_b16 a[54:55], v13 offset:1664
s_add_u32 m0, s55, 41984
v_mfma_f32_16x16x32_bf16 v[140:143], a[32:35], a[56:59], v[140:143]
buffer_load_dwordx4 v3, s[12:15], s51 offen lds
v_mfma_f32_16x16x32_bf16 v[144:147], a[20:23], a[60:63], v[144:147]
ds_read_b128 a[16:19], v24 offset:36864
v_lshlrev_b32 v35, 6, v1
s_lshl_b32 s60, s46, 10
s_add_u32 s60, s60, 141312
v_mfma_f32_16x16x32_bf16 v[148:151], a[24:27], a[60:63], v[148:151]
v_add_u32 v33, s60, v27
ds_read_b64_tr_b16 a[56:57], v12 offset:256
v_mfma_f32_16x16x32_bf16 v[152:155], a[28:31], a[60:63], v[152:155]
ds_read_b64_tr_b16 a[58:59], v12 offset:1792
s_xor_b32 s61, s46, 2
s_lshl_b32 s61, s61, 10
s_add_u32 m0, s55, 43008
v_mfma_f32_16x16x32_bf16 v[156:159], a[32:35], a[60:63], v[156:159]
buffer_load_dwordx4 v4, s[12:15], s51 offen lds
s_add_u32 s61, s61, 141312
v_add_u32 v34, s61, v27
s_waitcnt lgkmcnt(15)
v_mfma_f32_16x16x32_bf16 v[160:163], a[64:67], a[20:23], v[160:163]
ds_read_b64_tr_b16 a[60:61], v13 offset:256
v_mfma_f32_16x16x32_bf16 v[164:167], a[64:67], a[24:27], v[164:167]
ds_read_b64_tr_b16 a[62:63], v13 offset:1792
s_mul_i32 s60, s48, 1088
s_add_u32 s60, s60, 137216
v_lshrrev_b32 v36, 4, v1
v_mfma_f32_16x16x32_bf16 v[168:171], a[64:67], a[28:31], v[168:171]
v_lshl_add_u32 v36, v36, 4, v27
v_mfma_f32_16x16x32_bf16 v[172:175], a[64:67], a[32:35], v[172:175]
v_mfma_f32_16x16x32_bf16 v[176:179], a[68:71], a[20:23], v[176:179]
ds_read_b64_tr_b16 a[64:65], v14 offset:12288
v_mfma_f32_16x16x32_bf16 v[180:183], a[68:71], a[24:27], v[180:183]
ds_read_b64_tr_b16 a[66:67], v14 offset:12800
v_add_u32 v29, s60, v36
s_mul_i32 s60, s45, 7
s_lshl_b32 s61, s47, 2
v_mfma_f32_16x16x32_bf16 v[184:187], a[68:71], a[28:31], v[184:187]
s_add_u32 s60, s60, s61
s_add_u32 m0, s56, 40960
v_mfma_f32_16x16x32_bf16 v[188:191], a[68:71], a[32:35], v[188:191]
buffer_load_dwordx4 v5, s[16:19], s52 offen lds
v_mfma_f32_16x16x32_bf16 v[192:195], a[72:75], a[20:23], v[192:195]
ds_read_b64_tr_b16 a[68:69], v15 offset:12288
v_mfma_f32_16x16x32_bf16 v[196:199], a[72:75], a[24:27], v[196:199]
ds_read_b64_tr_b16 a[70:71], v15 offset:12800
s_lshl_b32 s60, s60, 1
s_add_u32 s60, s60, s48
v_mfma_f32_16x16x32_bf16 v[200:203], a[72:75], a[28:31], v[200:203]
s_lshl_b32 s60, s60, 10
s_add_u32 s80, s60, 9469952
s_add_u32 m0, s57, 40960
v_mfma_f32_16x16x32_bf16 v[204:207], a[72:75], a[32:35], v[204:207]
buffer_load_dwordx4 v5, s[20:23], s52 offen lds
v_mfma_f32_16x16x32_bf16 v[208:211], a[76:79], a[20:23], v[208:211]
ds_read_b64_tr_b16 a[72:73], v14 offset:16384
v_mfma_f32_16x16x32_bf16 v[212:215], a[76:79], a[24:27], v[212:215]
ds_read_b64_tr_b16 a[74:75], v14 offset:16896
s_add_u32 s81, s80, 2048
s_add_u32 s82, s80, 4096
v_mfma_f32_16x16x32_bf16 v[216:219], a[76:79], a[28:31], v[216:219]
s_add_u32 s83, s80, 6144
v_mfma_f32_16x16x32_bf16 v[220:223], a[76:79], a[32:35], v[220:223]
s_cmp_eq_u32 s47, 1
s_cselect_b32 s83, 0xf0000000, s83
s_waitcnt lgkmcnt(10)
v_mfma_f32_16x16x32_bf16 v[64:67], a[40:43], a[0:3], v[64:67]
s_waitcnt vmcnt(7)
s_barrier
v_mfma_f32_16x16x32_bf16 v[68:71], a[40:43], a[4:7], v[68:71]
ds_read_b64_tr_b16 a[76:77], v15 offset:16384
v_mfma_f32_16x16x32_bf16 v[72:75], a[40:43], a[8:11], v[72:75]
ds_read_b64_tr_b16 a[78:79], v15 offset:16896
s_lshl_b32 s50, s54, 7
s_add_u32 s54, s54, 1
s_cmp_eq_u32 s54, 7
s_cselect_b32 s54, 0, s54
s_add_u32 m0, s58, 18432
v_mfma_f32_16x16x32_bf16 v[76:79], a[40:43], a[12:15], v[76:79]
buffer_load_dwordx4 v7, s[8:11], s50 offen lds
v_mfma_f32_16x16x32_bf16 v[80:83], a[44:47], a[0:3], v[80:83]
ds_read_b128 a[20:23], v21 offset:36864
v_mfma_f32_16x16x32_bf16 v[84:87], a[44:47], a[4:7], v[84:87]
ds_read_b64_tr_b16 a[40:41], v12 offset:20480
v_mfma_f32_16x16x32_bf16 v[88:91], a[44:47], a[8:11], v[88:91]
ds_read_b64_tr_b16 a[42:43], v12 offset:22016
s_add_u32 m0, s58, 19456
v_mfma_f32_16x16x32_bf16 v[92:95], a[44:47], a[12:15], v[92:95]
buffer_load_dwordx4 v8, s[8:11], s50 offen lds
v_mfma_f32_16x16x32_bf16 v[96:99], a[48:51], a[0:3], v[96:99]
ds_read_b128 a[24:27], v21 offset:38912
v_lshrrev_b32 v60, 3, v1
v_mfma_f32_16x16x32_bf16 v[100:103], a[48:51], a[4:7], v[100:103]
v_and_b32 v61, 7, v1
ds_read_b64_tr_b16 a[44:45], v13 offset:20480
v_mfma_f32_16x16x32_bf16 v[104:107], a[48:51], a[8:11], v[104:107]
ds_read_b64_tr_b16 a[46:47], v13 offset:22016
v_mfma_f32_16x16x32_bf16 v[108:111], a[48:51], a[12:15], v[108:111]
ds_read_b128 a[28:31], v23 offset:36864
v_bfe_u32 v62, v60, 1, 2
s_add_u32 m0, s58, 20480
v_mfma_f32_16x16x32_bf16 v[224:227], a[48:51], a[16:19], v[224:227]
buffer_load_dwordx4 v9, s[8:11], s50 offen lds
v_lshlrev_b32 v62, 1, v62
v_mfma_f32_16x16x32_bf16 v[112:115], a[52:55], a[0:3], v[112:115]
ds_read_b64_tr_b16 a[48:49], v12 offset:20608
v_mfma_f32_16x16x32_bf16 v[116:119], a[52:55], a[4:7], v[116:119]
ds_read_b64_tr_b16 a[50:51], v12 offset:22144
v_mfma_f32_16x16x32_bf16 v[120:123], a[52:55], a[8:11], v[120:123]
ds_read_b128 a[32:35], v23 offset:38912
v_xor_b32 v61, v61, v62
v_mfma_f32_16x16x32_bf16 v[124:127], a[52:55], a[12:15], v[124:127]
v_mul_u32_u24 v60, 896, v60
s_mul_i32 s52, s53, 114688
s_mul_i32 s51, s53, 86016
s_add_u32 s53, s53, 1
s_cmp_eq_u32 s53, 14
s_cselect_b32 s53, 0, s53
s_add_u32 m0, s55, 61440
v_mfma_f32_16x16x32_bf16 v[228:231], a[52:55], a[16:19], v[228:231]
buffer_load_dwordx4 v2, s[12:15], s51 offen lds
s_waitcnt lgkmcnt(15)
v_mfma_f32_16x16x32_bf16 v[128:131], a[0:3], a[56:59], v[128:131]
ds_read_b64_tr_b16 a[52:53], v13 offset:20608
v_mfma_f32_16x16x32_bf16 v[132:135], a[4:7], a[56:59], v[132:135]
ds_read_b64_tr_b16 a[54:55], v13 offset:22144
v_mfma_f32_16x16x32_bf16 v[136:139], a[8:11], a[56:59], v[136:139]
ds_read_b128 a[36:39], v25 offset:36864
v_lshl_add_u32 v60, v61, 4, v60
v_mfma_f32_16x16x32_bf16 v[140:143], a[12:15], a[56:59], v[140:143]
v_mfma_f32_16x16x32_bf16 v[144:147], a[0:3], a[60:63], v[144:147]
ds_read_b64_tr_b16 a[56:57], v12 offset:20736
v_mfma_f32_16x16x32_bf16 v[148:151], a[4:7], a[60:63], v[148:151]
ds_read_b64_tr_b16 a[58:59], v12 offset:22272
s_lshl_b32 s60, s69, 7
v_mfma_f32_16x16x32_bf16 v[152:155], a[8:11], a[60:63], v[152:155]
s_add_u32 m0, s55, 62464
v_mfma_f32_16x16x32_bf16 v[156:159], a[12:15], a[60:63], v[156:159]
buffer_load_dwordx4 v3, s[12:15], s51 offen lds
s_waitcnt lgkmcnt(15)
v_mfma_f32_16x16x32_bf16 v[160:163], a[64:67], a[0:3], v[160:163]
ds_read_b64_tr_b16 a[60:61], v13 offset:20736
v_mfma_f32_16x16x32_bf16 v[164:167], a[64:67], a[4:7], v[164:167]
ds_read_b64_tr_b16 a[62:63], v13 offset:22272
v_add_u32 v232, s60, v60
v_mfma_f32_16x16x32_bf16 v[168:171], a[64:67], a[8:11], v[168:171]
s_add_u32 m0, s55, 63488
v_mfma_f32_16x16x32_bf16 v[172:175], a[64:67], a[12:15], v[172:175]
buffer_load_dwordx4 v4, s[12:15], s51 offen lds
v_mfma_f32_16x16x32_bf16 v[176:179], a[68:71], a[0:3], v[176:179]
ds_read_b64_tr_b16 a[64:65], v14 offset:32768
v_mfma_f32_16x16x32_bf16 v[180:183], a[68:71], a[4:7], v[180:183]
ds_read_b64_tr_b16 a[66:67], v14 offset:33280
v_add_u32 v233, 6144, v232
v_mfma_f32_16x16x32_bf16 v[184:187], a[68:71], a[8:11], v[184:187]
s_add_u32 m0, s56, 61440
v_mfma_f32_16x16x32_bf16 v[188:191], a[68:71], a[12:15], v[188:191]
buffer_load_dwordx4 v5, s[16:19], s52 offen lds
v_mfma_f32_16x16x32_bf16 v[192:195], a[72:75], a[0:3], v[192:195]
ds_read_b64_tr_b16 a[68:69], v15 offset:32768
v_mfma_f32_16x16x32_bf16 v[196:199], a[72:75], a[4:7], v[196:199]
ds_read_b64_tr_b16 a[70:71], v15 offset:33280
v_add_u32 v234, 12288, v232
v_mfma_f32_16x16x32_bf16 v[200:203], a[72:75], a[8:11], v[200:203]
s_add_u32 m0, s57, 61440
v_mfma_f32_16x16x32_bf16 v[204:207], a[72:75], a[12:15], v[204:207]
buffer_load_dwordx4 v5, s[20:23], s52 offen lds
v_mfma_f32_16x16x32_bf16 v[208:211], a[76:79], a[0:3], v[208:211]
ds_read_b64_tr_b16 a[72:73], v14 offset:36864
v_mfma_f32_16x16x32_bf16 v[212:215], a[76:79], a[4:7], v[212:215]
ds_read_b64_tr_b16 a[74:75], v14 offset:37376
v_add_u32 v235, 18432, v232
v_mfma_f32_16x16x32_bf16 v[216:219], a[76:79], a[8:11], v[216:219]
v_mfma_f32_16x16x32_bf16 v[220:223], a[76:79], a[12:15], v[220:223]
s_waitcnt lgkmcnt(10)
v_mfma_f32_16x16x32_bf16 v[64:67], a[40:43], a[20:23], v[64:67]
s_waitcnt vmcnt(8)
s_barrier
v_mfma_f32_16x16x32_bf16 v[68:71], a[40:43], a[24:27], v[68:71]
ds_read_b64_tr_b16 a[76:77], v15 offset:36864
v_mfma_f32_16x16x32_bf16 v[72:75], a[40:43], a[28:31], v[72:75]
ds_read_b64_tr_b16 a[78:79], v15 offset:37376
s_add_u32 m0, s58, 21504
v_mfma_f32_16x16x32_bf16 v[76:79], a[40:43], a[32:35], v[76:79]
buffer_load_dwordx4 v10, s[8:11], s50 offen lds
v_mfma_f32_16x16x32_bf16 v[80:83], a[44:47], a[20:23], v[80:83]
ds_read_b128 a[0:3], v20 offset:0
v_mfma_f32_16x16x32_bf16 v[84:87], a[44:47], a[24:27], v[84:87]
ds_read_b64_tr_b16 a[40:41], v16 offset:0
v_mfma_f32_16x16x32_bf16 v[88:91], a[44:47], a[28:31], v[88:91]
ds_read_b64_tr_b16 a[42:43], v16 offset:1536
s_add_u32 m0, s59, 18432
v_mfma_f32_16x16x32_bf16 v[92:95], a[44:47], a[32:35], v[92:95]
buffer_load_dwordx4 v11, s[8:11], s50 offen lds
v_mfma_f32_16x16x32_bf16 v[96:99], a[48:51], a[20:23], v[96:99]
ds_read_b128 a[4:7], v20 offset:2048
v_lshrrev_b32 v60, 4, v1
v_mfma_f32_16x16x32_bf16 v[100:103], a[48:51], a[24:27], v[100:103]
v_bfe_u32 v61, v1, 2, 2
v_lshrrev_b32 v62, 1, v61
v_mfma_f32_16x16x32_bf16 v[104:107], a[48:51], a[28:31], v[104:107]
ds_read_b64_tr_b16 a[44:45], v17 offset:0
v_mfma_f32_16x16x32_bf16 v[108:111], a[48:51], a[32:35], v[108:111]
ds_read_b64_tr_b16 a[46:47], v17 offset:1536
s_mul_i32 s52, s53, 114688
s_mul_i32 s51, s53, 86016
s_add_u32 s53, s53, 1
s_cmp_eq_u32 s53, 14
s_cselect_b32 s53, 0, s53
s_add_u32 m0, s55, 0
v_mfma_f32_16x16x32_bf16 v[224:227], a[48:51], a[36:39], v[224:227]
buffer_load_dwordx4 v2, s[12:15], s51 offen lds
v_mfma_f32_16x16x32_bf16 v[112:115], a[52:55], a[20:23], v[112:115]
ds_read_b128 a[8:11], v22 offset:0
v_lshl_add_u32 v62, v60, 1, v62
v_mfma_f32_16x16x32_bf16 v[116:119], a[52:55], a[24:27], v[116:119]
v_and_b32 v62, 3, v62
v_lshl_add_u32 v61, v60, 2, v61
v_mfma_f32_16x16x32_bf16 v[120:123], a[52:55], a[28:31], v[120:123]
ds_read_b64_tr_b16 a[48:49], v16 offset:128
v_mfma_f32_16x16x32_bf16 v[124:127], a[52:55], a[32:35], v[124:127]
ds_read_b64_tr_b16 a[50:51], v16 offset:1664
v_mfma_f32_16x16x32_bf16 v[228:231], a[52:55], a[36:39], v[228:231]
ds_read_b128 a[12:15], v22 offset:2048
v_lshlrev_b32 v61, 7, v61
s_waitcnt lgkmcnt(15)
v_mfma_f32_16x16x32_bf16 v[128:131], a[20:23], a[56:59], v[128:131]
v_and_b32 v63, 3, v1
v_lshl_add_u32 v61, v63, 3, v61
v_mfma_f32_16x16x32_bf16 v[132:135], a[24:27], a[56:59], v[132:135]
ds_read_b64_tr_b16 a[52:53], v17 offset:128
v_mfma_f32_16x16x32_bf16 v[136:139], a[28:31], a[56:59], v[136:139]
ds_read_b64_tr_b16 a[54:55], v17 offset:1664
s_add_u32 m0, s55, 1024
v_mfma_f32_16x16x32_bf16 v[140:143], a[32:35], a[56:59], v[140:143]
buffer_load_dwordx4 v3, s[12:15], s51 offen lds
v_mfma_f32_16x16x32_bf16 v[144:147], a[20:23], a[60:63], v[144:147]
ds_read_b128 a[16:19], v24 offset:0
v_add_u32 v61, s74, v61
v_mfma_f32_16x16x32_bf16 v[148:151], a[24:27], a[60:63], v[148:151]
v_xor_b32 v63, 0, v62
v_lshl_add_u32 v236, v63, 5, v61
v_mfma_f32_16x16x32_bf16 v[152:155], a[28:31], a[60:63], v[152:155]
ds_read_b64_tr_b16 a[56:57], v16 offset:256
s_add_u32 m0, s55, 2048
v_mfma_f32_16x16x32_bf16 v[156:159], a[32:35], a[60:63], v[156:159]
buffer_load_dwordx4 v4, s[12:15], s51 offen lds
s_waitcnt lgkmcnt(15)
v_mfma_f32_16x16x32_bf16 v[160:163], a[64:67], a[20:23], v[160:163]
ds_read_b64_tr_b16 a[58:59], v16 offset:1792
v_add_u32 v250, 0x10000, v236
v_mfma_f32_16x16x32_bf16 v[164:167], a[64:67], a[24:27], v[164:167]
v_xor_b32 v63, 1, v62
ds_read_b64_tr_b16 a[60:61], v17 offset:256
v_mfma_f32_16x16x32_bf16 v[168:171], a[64:67], a[28:31], v[168:171]
ds_read_b64_tr_b16 a[62:63], v17 offset:1792
v_lshl_add_u32 v237, v63, 5, v61
v_mfma_f32_16x16x32_bf16 v[172:175], a[64:67], a[32:35], v[172:175]
v_add_u32 v251, 0x10000, v237
v_mfma_f32_16x16x32_bf16 v[176:179], a[68:71], a[20:23], v[176:179]
ds_read_b64_tr_b16 a[64:65], v18 offset:12288
v_mfma_f32_16x16x32_bf16 v[180:183], a[68:71], a[24:27], v[180:183]
ds_read_b64_tr_b16 a[66:67], v18 offset:12800
v_xor_b32 v63, 2, v62
v_mfma_f32_16x16x32_bf16 v[184:187], a[68:71], a[28:31], v[184:187]
v_lshl_add_u32 v238, v63, 5, v61
s_add_u32 m0, s56, 0
v_mfma_f32_16x16x32_bf16 v[188:191], a[68:71], a[32:35], v[188:191]
buffer_load_dwordx4 v5, s[16:19], s52 offen lds
s_waitcnt lgkmcnt(15)
v_mfma_f32_16x16x32_bf16 v[192:195], a[72:75], a[20:23], v[192:195]
ds_read_b64_tr_b16 a[68:69], v19 offset:12288
v_mfma_f32_16x16x32_bf16 v[196:199], a[72:75], a[24:27], v[196:199]
ds_read_b64_tr_b16 a[70:71], v19 offset:12800
v_add_u32 v252, 0x10000, v238
v_mfma_f32_16x16x32_bf16 v[200:203], a[72:75], a[28:31], v[200:203]
v_xor_b32 v63, 3, v62
s_add_u32 m0, s57, 0
v_mfma_f32_16x16x32_bf16 v[204:207], a[72:75], a[32:35], v[204:207]
buffer_load_dwordx4 v5, s[20:23], s52 offen lds
v_mfma_f32_16x16x32_bf16 v[208:211], a[76:79], a[20:23], v[208:211]
ds_read_b64_tr_b16 a[72:73], v18 offset:16384
v_mfma_f32_16x16x32_bf16 v[212:215], a[76:79], a[24:27], v[212:215]
ds_read_b64_tr_b16 a[74:75], v18 offset:16896
v_lshl_add_u32 v239, v63, 5, v61
v_mfma_f32_16x16x32_bf16 v[216:219], a[76:79], a[28:31], v[216:219]
v_add_u32 v253, 0x10000, v239
v_mfma_f32_16x16x32_bf16 v[220:223], a[76:79], a[32:35], v[220:223]
s_waitcnt lgkmcnt(10)
v_mfma_f32_16x16x32_bf16 v[64:67], a[40:43], a[0:3], v[64:67]
s_waitcnt vmcnt(7)
s_barrier
v_mfma_f32_16x16x32_bf16 v[68:71], a[40:43], a[4:7], v[68:71]
ds_read_b64_tr_b16 a[76:77], v19 offset:16384
v_mfma_f32_16x16x32_bf16 v[72:75], a[40:43], a[8:11], v[72:75]
ds_read_b64_tr_b16 a[78:79], v19 offset:16896
s_lshl_b32 s50, s54, 7
s_add_u32 s54, s54, 1
s_cmp_eq_u32 s54, 7
s_cselect_b32 s54, 0, s54
s_add_u32 m0, s58, 36864
v_mfma_f32_16x16x32_bf16 v[76:79], a[40:43], a[12:15], v[76:79]
buffer_load_dwordx4 v7, s[8:11], s50 offen lds
v_mfma_f32_16x16x32_bf16 v[80:83], a[44:47], a[0:3], v[80:83]
ds_read_b128 a[20:23], v21 offset:0
v_mfma_f32_16x16x32_bf16 v[84:87], a[44:47], a[4:7], v[84:87]
ds_read_b64_tr_b16 a[40:41], v16 offset:20480
v_mfma_f32_16x16x32_bf16 v[88:91], a[44:47], a[8:11], v[88:91]
ds_read_b64_tr_b16 a[42:43], v16 offset:22016
s_add_u32 m0, s58, 37888
v_mfma_f32_16x16x32_bf16 v[92:95], a[44:47], a[12:15], v[92:95]
buffer_load_dwordx4 v8, s[8:11], s50 offen lds
v_mfma_f32_16x16x32_bf16 v[96:99], a[48:51], a[0:3], v[96:99]
ds_read_b128 a[24:27], v21 offset:2048
v_mfma_f32_16x16x32_bf16 v[100:103], a[48:51], a[4:7], v[100:103]
ds_read_b64_tr_b16 a[44:45], v17 offset:20480
v_mfma_f32_16x16x32_bf16 v[104:107], a[48:51], a[8:11], v[104:107]
ds_read_b64_tr_b16 a[46:47], v17 offset:22016
v_mfma_f32_16x16x32_bf16 v[108:111], a[48:51], a[12:15], v[108:111]
ds_read_b128 a[28:31], v23 offset:0
s_add_u32 m0, s58, 38912
v_mfma_f32_16x16x32_bf16 v[224:227], a[48:51], a[16:19], v[224:227]
buffer_load_dwordx4 v9, s[8:11], s50 offen lds
v_mfma_f32_16x16x32_bf16 v[112:115], a[52:55], a[0:3], v[112:115]
ds_read_b64_tr_b16 a[48:49], v16 offset:20608
v_mfma_f32_16x16x32_bf16 v[116:119], a[52:55], a[4:7], v[116:119]
ds_read_b64_tr_b16 a[50:51], v16 offset:22144
v_mfma_f32_16x16x32_bf16 v[120:123], a[52:55], a[8:11], v[120:123]
ds_read_b128 a[32:35], v23 offset:2048
v_mfma_f32_16x16x32_bf16 v[124:127], a[52:55], a[12:15], v[124:127]
s_mul_i32 s52, s53, 114688
s_mul_i32 s51, s53, 86016
s_add_u32 s53, s53, 1
s_cmp_eq_u32 s53, 14
s_cselect_b32 s53, 0, s53
s_add_u32 m0, s55, 20480
v_mfma_f32_16x16x32_bf16 v[228:231], a[52:55], a[16:19], v[228:231]
buffer_load_dwordx4 v2, s[12:15], s51 offen lds
s_waitcnt lgkmcnt(15)
v_mfma_f32_16x16x32_bf16 v[128:131], a[0:3], a[56:59], v[128:131]
ds_read_b64_tr_b16 a[52:53], v17 offset:20608
v_mfma_f32_16x16x32_bf16 v[132:135], a[4:7], a[56:59], v[132:135]
ds_read_b64_tr_b16 a[54:55], v17 offset:22144
v_mfma_f32_16x16x32_bf16 v[136:139], a[8:11], a[56:59], v[136:139]
ds_read_b128 a[36:39], v25 offset:0
v_mfma_f32_16x16x32_bf16 v[140:143], a[12:15], a[56:59], v[140:143]
v_mfma_f32_16x16x32_bf16 v[144:147], a[0:3], a[60:63], v[144:147]
ds_read_b64_tr_b16 a[56:57], v16 offset:20736
v_mfma_f32_16x16x32_bf16 v[148:151], a[4:7], a[60:63], v[148:151]
ds_read_b64_tr_b16 a[58:59], v16 offset:22272
v_mfma_f32_16x16x32_bf16 v[152:155], a[8:11], a[60:63], v[152:155]
s_add_u32 m0, s55, 21504
v_mfma_f32_16x16x32_bf16 v[156:159], a[12:15], a[60:63], v[156:159]
buffer_load_dwordx4 v3, s[12:15], s51 offen lds
s_waitcnt lgkmcnt(15)
v_mfma_f32_16x16x32_bf16 v[160:163], a[64:67], a[0:3], v[160:163]
ds_read_b64_tr_b16 a[60:61], v17 offset:20736
v_mfma_f32_16x16x32_bf16 v[164:167], a[64:67], a[4:7], v[164:167]
ds_read_b64_tr_b16 a[62:63], v17 offset:22272
v_mfma_f32_16x16x32_bf16 v[168:171], a[64:67], a[8:11], v[168:171]
s_add_u32 m0, s55, 22528
v_mfma_f32_16x16x32_bf16 v[172:175], a[64:67], a[12:15], v[172:175]
buffer_load_dwordx4 v4, s[12:15], s51 offen lds
v_mfma_f32_16x16x32_bf16 v[176:179], a[68:71], a[0:3], v[176:179]
ds_read_b64_tr_b16 a[64:65], v18 offset:32768
v_mfma_f32_16x16x32_bf16 v[180:183], a[68:71], a[4:7], v[180:183]
ds_read_b64_tr_b16 a[66:67], v18 offset:33280
v_mfma_f32_16x16x32_bf16 v[184:187], a[68:71], a[8:11], v[184:187]
s_add_u32 m0, s56, 20480
v_mfma_f32_16x16x32_bf16 v[188:191], a[68:71], a[12:15], v[188:191]
buffer_load_dwordx4 v5, s[16:19], s52 offen lds
v_mfma_f32_16x16x32_bf16 v[192:195], a[72:75], a[0:3], v[192:195]
ds_read_b64_tr_b16 a[68:69], v19 offset:32768
v_mfma_f32_16x16x32_bf16 v[196:199], a[72:75], a[4:7], v[196:199]
ds_read_b64_tr_b16 a[70:71], v19 offset:33280
v_mfma_f32_16x16x32_bf16 v[200:203], a[72:75], a[8:11], v[200:203]
s_add_u32 m0, s57, 20480
v_mfma_f32_16x16x32_bf16 v[204:207], a[72:75], a[12:15], v[204:207]
buffer_load_dwordx4 v5, s[20:23], s52 offen lds
v_mfma_f32_16x16x32_bf16 v[208:211], a[76:79], a[0:3], v[208:211]
ds_read_b64_tr_b16 a[72:73], v18 offset:36864
v_mfma_f32_16x16x32_bf16 v[212:215], a[76:79], a[4:7], v[212:215]
ds_read_b64_tr_b16 a[74:75], v18 offset:37376
v_mfma_f32_16x16x32_bf16 v[216:219], a[76:79], a[8:11], v[216:219]
v_mfma_f32_16x16x32_bf16 v[220:223], a[76:79], a[12:15], v[220:223]
s_waitcnt lgkmcnt(10)
v_mfma_f32_16x16x32_bf16 v[64:67], a[40:43], a[20:23], v[64:67]
s_waitcnt vmcnt(8)
s_barrier
v_mfma_f32_16x16x32_bf16 v[68:71], a[40:43], a[24:27], v[68:71]
ds_read_b64_tr_b16 a[76:77], v19 offset:36864
v_mfma_f32_16x16x32_bf16 v[72:75], a[40:43], a[28:31], v[72:75]
ds_read_b64_tr_b16 a[78:79], v19 offset:37376
s_add_u32 m0, s58, 39936
v_mfma_f32_16x16x32_bf16 v[76:79], a[40:43], a[32:35], v[76:79]
buffer_load_dwordx4 v10, s[8:11], s50 offen lds
v_mfma_f32_16x16x32_bf16 v[80:83], a[44:47], a[20:23], v[80:83]
ds_read_b128 a[0:3], v20 offset:18432
v_mfma_f32_16x16x32_bf16 v[84:87], a[44:47], a[24:27], v[84:87]
ds_read_b64_tr_b16 a[40:41], v12 offset:0
v_mfma_f32_16x16x32_bf16 v[88:91], a[44:47], a[28:31], v[88:91]
ds_read_b64_tr_b16 a[42:43], v12 offset:1536
s_add_u32 m0, s59, 36864
v_mfma_f32_16x16x32_bf16 v[92:95], a[44:47], a[32:35], v[92:95]
buffer_load_dwordx4 v11, s[8:11], s50 offen lds
v_mfma_f32_16x16x32_bf16 v[96:99], a[48:51], a[20:23], v[96:99]
ds_read_b128 a[4:7], v20 offset:20480
v_mfma_f32_16x16x32_bf16 v[100:103], a[48:51], a[24:27], v[100:103]
buffer_load_dword v60, v35, s[4:7], 0 offen sc1
v_mfma_f32_16x16x32_bf16 v[104:107], a[48:51], a[28:31], v[104:107]
ds_read_b64_tr_b16 a[44:45], v13 offset:0
v_mfma_f32_16x16x32_bf16 v[108:111], a[48:51], a[32:35], v[108:111]
ds_read_b64_tr_b16 a[46:47], v13 offset:1536
s_mul_i32 s52, s53, 114688
s_mul_i32 s51, s53, 86016
s_add_u32 s53, s53, 1
s_cmp_eq_u32 s53, 14
s_cselect_b32 s53, 0, s53
s_add_u32 m0, s55, 40960
v_mfma_f32_16x16x32_bf16 v[224:227], a[48:51], a[36:39], v[224:227]
buffer_load_dwordx4 v2, s[12:15], s51 offen lds
v_mfma_f32_16x16x32_bf16 v[112:115], a[52:55], a[20:23], v[112:115]
ds_read_b128 a[8:11], v22 offset:18432
v_mfma_f32_16x16x32_bf16 v[116:119], a[52:55], a[24:27], v[116:119]
ds_read_b64_tr_b16 a[48:49], v12 offset:128
v_mfma_f32_16x16x32_bf16 v[120:123], a[52:55], a[28:31], v[120:123]
ds_read_b64_tr_b16 a[50:51], v12 offset:1664
v_mfma_f32_16x16x32_bf16 v[124:127], a[52:55], a[32:35], v[124:127]
ds_read_b128 a[12:15], v22 offset:20480
v_mfma_f32_16x16x32_bf16 v[228:231], a[52:55], a[36:39], v[228:231]
s_waitcnt lgkmcnt(15)
v_mfma_f32_16x16x32_bf16 v[128:131], a[20:23], a[56:59], v[128:131]
ds_read_b64_tr_b16 a[52:53], v13 offset:128
v_mfma_f32_16x16x32_bf16 v[132:135], a[24:27], a[56:59], v[132:135]
ds_read_b64_tr_b16 a[54:55], v13 offset:1664
v_mfma_f32_16x16x32_bf16 v[136:139], a[28:31], a[56:59], v[136:139]
ds_read_b128 a[16:19], v24 offset:18432
s_add_u32 m0, s55, 41984
v_mfma_f32_16x16x32_bf16 v[140:143], a[32:35], a[56:59], v[140:143]
buffer_load_dwordx4 v3, s[12:15], s51 offen lds
v_mfma_f32_16x16x32_bf16 v[144:147], a[20:23], a[60:63], v[144:147]
ds_read_b64_tr_b16 a[56:57], v12 offset:256
v_mfma_f32_16x16x32_bf16 v[148:151], a[24:27], a[60:63], v[148:151]
ds_read_b64_tr_b16 a[58:59], v12 offset:1792
v_mfma_f32_16x16x32_bf16 v[152:155], a[28:31], a[60:63], v[152:155]
s_add_u32 m0, s55, 43008
v_mfma_f32_16x16x32_bf16 v[156:159], a[32:35], a[60:63], v[156:159]
buffer_load_dwordx4 v4, s[12:15], s51 offen lds
s_waitcnt lgkmcnt(15)
v_mfma_f32_16x16x32_bf16 v[160:163], a[64:67], a[20:23], v[160:163]
ds_read_b64_tr_b16 a[60:61], v13 offset:256
v_mfma_f32_16x16x32_bf16 v[164:167], a[64:67], a[24:27], v[164:167]
ds_read_b64_tr_b16 a[62:63], v13 offset:1792
v_mfma_f32_16x16x32_bf16 v[168:171], a[64:67], a[28:31], v[168:171]
v_mfma_f32_16x16x32_bf16 v[172:175], a[64:67], a[32:35], v[172:175]
v_mfma_f32_16x16x32_bf16 v[176:179], a[68:71], a[20:23], v[176:179]
ds_read_b64_tr_b16 a[64:65], v14 offset:12288
v_mfma_f32_16x16x32_bf16 v[180:183], a[68:71], a[24:27], v[180:183]
ds_read_b64_tr_b16 a[66:67], v14 offset:12800
v_mfma_f32_16x16x32_bf16 v[184:187], a[68:71], a[28:31], v[184:187]
s_add_u32 m0, s56, 40960
v_mfma_f32_16x16x32_bf16 v[188:191], a[68:71], a[32:35], v[188:191]
buffer_load_dwordx4 v5, s[16:19], s52 offen lds
v_mfma_f32_16x16x32_bf16 v[192:195], a[72:75], a[20:23], v[192:195]
ds_read_b64_tr_b16 a[68:69], v15 offset:12288
v_mfma_f32_16x16x32_bf16 v[196:199], a[72:75], a[24:27], v[196:199]
ds_read_b64_tr_b16 a[70:71], v15 offset:12800
v_mfma_f32_16x16x32_bf16 v[200:203], a[72:75], a[28:31], v[200:203]
s_add_u32 m0, s57, 40960
v_mfma_f32_16x16x32_bf16 v[204:207], a[72:75], a[32:35], v[204:207]
buffer_load_dwordx4 v5, s[20:23], s52 offen lds
v_mfma_f32_16x16x32_bf16 v[208:211], a[76:79], a[20:23], v[208:211]
ds_read_b64_tr_b16 a[72:73], v14 offset:16384
v_mfma_f32_16x16x32_bf16 v[212:215], a[76:79], a[24:27], v[212:215]
ds_read_b64_tr_b16 a[74:75], v14 offset:16896
v_mfma_f32_16x16x32_bf16 v[216:219], a[76:79], a[28:31], v[216:219]
v_mfma_f32_16x16x32_bf16 v[220:223], a[76:79], a[32:35], v[220:223]
s_waitcnt lgkmcnt(10)
v_mfma_f32_16x16x32_bf16 v[64:67], a[40:43], a[0:3], v[64:67]
s_waitcnt vmcnt(8)
s_barrier
v_mfma_f32_16x16x32_bf16 v[68:71], a[40:43], a[4:7], v[68:71]
ds_read_b64_tr_b16 a[76:77], v15 offset:16384
v_mfma_f32_16x16x32_bf16 v[72:75], a[40:43], a[8:11], v[72:75]
ds_read_b64_tr_b16 a[78:79], v15 offset:16896
s_lshl_b32 s50, s54, 7
s_add_u32 s54, s54, 1
s_cmp_eq_u32 s54, 7
s_cselect_b32 s54, 0, s54
s_add_u32 m0, s58, 0
v_mfma_f32_16x16x32_bf16 v[76:79], a[40:43], a[12:15], v[76:79]
buffer_load_dwordx4 v7, s[8:11], s50 offen lds
v_mfma_f32_16x16x32_bf16 v[80:83], a[44:47], a[0:3], v[80:83]
ds_read_b128 a[20:23], v21 offset:18432
v_mfma_f32_16x16x32_bf16 v[84:87], a[44:47], a[4:7], v[84:87]
ds_read_b64_tr_b16 a[40:41], v12 offset:20480
v_mfma_f32_16x16x32_bf16 v[88:91], a[44:47], a[8:11], v[88:91]
ds_read_b64_tr_b16 a[42:43], v12 offset:22016
s_add_u32 m0, s58, 1024
v_mfma_f32_16x16x32_bf16 v[92:95], a[44:47], a[12:15], v[92:95]
buffer_load_dwordx4 v8, s[8:11], s50 offen lds
v_mfma_f32_16x16x32_bf16 v[96:99], a[48:51], a[0:3], v[96:99]
ds_read_b128 a[24:27], v21 offset:20480
s_waitcnt vmcnt(7)
v_mfma_f32_16x16x32_bf16 v[100:103], a[48:51], a[4:7], v[100:103]
ds_read_b64_tr_b16 a[44:45], v13 offset:20480
v_mfma_f32_16x16x32_bf16 v[104:107], a[48:51], a[8:11], v[104:107]
ds_read_b64_tr_b16 a[46:47], v13 offset:22016
v_mfma_f32_16x16x32_bf16 v[108:111], a[48:51], a[12:15], v[108:111]
ds_read_b128 a[28:31], v23 offset:18432
s_add_u32 m0, s58, 2048
v_mfma_f32_16x16x32_bf16 v[224:227], a[48:51], a[16:19], v[224:227]
buffer_load_dwordx4 v9, s[8:11], s50 offen lds
v_mfma_f32_16x16x32_bf16 v[112:115], a[52:55], a[0:3], v[112:115]
v_readlane_b32 s60, v60, 0
v_readlane_b32 s61, v60, 1
v_readlane_b32 s62, v60, 2
v_readlane_b32 s63, v60, 3
s_nop 0
s_add_u32 s60, s60, s61
s_add_u32 s62, s62, s63
s_add_u32 s60, s60, s62
s_cmp_ge_u32 s60, 256
s_cbranch_scc0 L_cnt_slow_3
L_cnt_back_4:
v_mfma_f32_16x16x32_bf16 v[116:119], a[52:55], a[4:7], v[116:119]
ds_read_b64_tr_b16 a[48:49], v12 offset:20608
v_mfma_f32_16x16x32_bf16 v[120:123], a[52:55], a[8:11], v[120:123]
ds_read_b64_tr_b16 a[50:51], v12 offset:22144
v_mfma_f32_16x16x32_bf16 v[124:127], a[52:55], a[12:15], v[124:127]
ds_read_b128 a[32:35], v23 offset:20480
s_mov_b32 s62, 9437184
s_mul_i32 s52, s53, 114688
s_mul_i32 s51, s53, 86016
s_add_u32 s53, s53, 1
s_cmp_eq_u32 s53, 14
s_cselect_b32 s53, 0, s53
s_add_u32 m0, s55, 61440
v_mfma_f32_16x16x32_bf16 v[228:231], a[52:55], a[16:19], v[228:231]
buffer_load_dwordx4 v2, s[12:15], s51 offen lds
s_waitcnt lgkmcnt(15)
v_mfma_f32_16x16x32_bf16 v[128:131], a[0:3], a[56:59], v[128:131]
ds_read_b64_tr_b16 a[52:53], v13 offset:20608
v_mfma_f32_16x16x32_bf16 v[132:135], a[4:7], a[56:59], v[132:135]
ds_read_b64_tr_b16 a[54:55], v13 offset:22144
v_mfma_f32_16x16x32_bf16 v[136:139], a[8:11], a[56:59], v[136:139]
ds_read_b128 a[36:39], v25 offset:18432
v_mfma_f32_16x16x32_bf16 v[140:143], a[12:15], a[56:59], v[140:143]
buffer_load_dwordx2 v[40:41], v26, s[24:27], s62 offen sc1
v_mfma_f32_16x16x32_bf16 v[144:147], a[0:3], a[60:63], v[144:147]
ds_read_b64_tr_b16 a[56:57], v12 offset:20736
v_mfma_f32_16x16x32_bf16 v[148:151], a[4:7], a[60:63], v[148:151]
ds_read_b64_tr_b16 a[58:59], v12 offset:22272
v_mfma_f32_16x16x32_bf16 v[152:155], a[8:11], a[60:63], v[152:155]
buffer_load_dwordx4 v[44:47], v27, s[24:27], s80 offen sc1
s_add_u32 m0, s55, 62464
v_mfma_f32_16x16x32_bf16 v[156:159], a[12:15], a[60:63], v[156:159]
buffer_load_dwordx4 v3, s[12:15], s51 offen lds
s_waitcnt lgkmcnt(15)
v_mfma_f32_16x16x32_bf16 v[160:163], a[64:67], a[0:3], v[160:163]
ds_read_b64_tr_b16 a[60:61], v13 offset:20736
v_mfma_f32_16x16x32_bf16 v[164:167], a[64:67], a[4:7], v[164:167]
ds_read_b64_tr_b16 a[62:63], v13 offset:22272
v_mfma_f32_16x16x32_bf16 v[168:171], a[64:67], a[8:11], v[168:171]
buffer_load_dwordx4 v[48:51], v27, s[24:27], s81 offen sc1
s_add_u32 m0, s55, 63488
v_mfma_f32_16x16x32_bf16 v[172:175], a[64:67], a[12:15], v[172:175]
buffer_load_dwordx4 v4, s[12:15], s51 offen lds
v_mfma_f32_16x16x32_bf16 v[176:179], a[68:71], a[0:3], v[176:179]
ds_read_b64_tr_b16 a[64:65], v14 offset:32768
v_mfma_f32_16x16x32_bf16 v[180:183], a[68:71], a[4:7], v[180:183]
ds_read_b64_tr_b16 a[66:67], v14 offset:33280
v_mfma_f32_16x16x32_bf16 v[184:187], a[68:71], a[8:11], v[184:187]
buffer_load_dwordx4 v[52:55], v27, s[24:27], s82 offen sc1
s_add_u32 m0, s56, 61440
v_mfma_f32_16x16x32_bf16 v[188:191], a[68:71], a[12:15], v[188:191]
buffer_load_dwordx4 v5, s[16:19], s52 offen lds
v_mfma_f32_16x16x32_bf16 v[192:195], a[72:75], a[0:3], v[192:195]
ds_read_b64_tr_b16 a[68:69], v15 offset:32768
v_mfma_f32_16x16x32_bf16 v[196:199], a[72:75], a[4:7], v[196:199]
ds_read_b64_tr_b16 a[70:71], v15 offset:33280
v_mfma_f32_16x16x32_bf16 v[200:203], a[72:75], a[8:11], v[200:203]
buffer_load_dwordx4 v[56:59], v27, s[24:27], s83 offen sc1
s_add_u32 m0, s57, 61440
v_mfma_f32_16x16x32_bf16 v[204:207], a[72:75], a[12:15], v[204:207]
buffer_load_dwordx4 v5, s[20:23], s52 offen lds
v_mfma_f32_16x16x32_bf16 v[208:211], a[76:79], a[0:3], v[208:211]
ds_read_b64_tr_b16 a[72:73], v14 offset:36864
v_mfma_f32_16x16x32_bf16 v[212:215], a[76:79], a[4:7], v[212:215]
ds_read_b64_tr_b16 a[74:75], v14 offset:37376
v_mfma_f32_16x16x32_bf16 v[216:219], a[76:79], a[8:11], v[216:219]
v_mfma_f32_16x16x32_bf16 v[220:223], a[76:79], a[12:15], v[220:223]
s_waitcnt lgkmcnt(10)
v_mfma_f32_16x16x32_bf16 v[64:67], a[40:43], a[20:23], v[64:67]
s_waitcnt vmcnt(13)
s_barrier
v_mfma_f32_16x16x32_bf16 v[68:71], a[40:43], a[24:27], v[68:71]
ds_read_b64_tr_b16 a[76:77], v15 offset:36864
v_mfma_f32_16x16x32_bf16 v[72:75], a[40:43], a[28:31], v[72:75]
ds_read_b64_tr_b16 a[78:79], v15 offset:37376
s_add_u32 m0, s58, 3072
v_mfma_f32_16x16x32_bf16 v[76:79], a[40:43], a[32:35], v[76:79]
buffer_load_dwordx4 v10, s[8:11], s50 offen lds
v_mfma_f32_16x16x32_bf16 v[80:83], a[44:47], a[20:23], v[80:83]
ds_read_b128 a[0:3], v20 offset:36864
v_mfma_f32_16x16x32_bf16 v[84:87], a[44:47], a[24:27], v[84:87]
ds_read_b64_tr_b16 a[40:41], v16 offset:0
v_mfma_f32_16x16x32_bf16 v[88:91], a[44:47], a[28:31], v[88:91]
ds_read_b64_tr_b16 a[42:43], v16 offset:1536
s_add_u32 m0, s59, 0
v_mfma_f32_16x16x32_bf16 v[92:95], a[44:47], a[32:35], v[92:95]
buffer_load_dwordx4 v11, s[8:11], s50 offen lds
v_mfma_f32_16x16x32_bf16 v[96:99], a[48:51], a[20:23], v[96:99]
ds_read_b128 a[4:7], v20 offset:38912
v_mfma_f32_16x16x32_bf16 v[100:103], a[48:51], a[24:27], v[100:103]
ds_read_b64_tr_b16 a[44:45], v17 offset:0
v_mfma_f32_16x16x32_bf16 v[104:107], a[48:51], a[28:31], v[104:107]
ds_read_b64_tr_b16 a[46:47], v17 offset:1536
v_mfma_f32_16x16x32_bf16 v[108:111], a[48:51], a[32:35], v[108:111]
ds_read_b128 a[8:11], v22 offset:36864
s_mul_i32 s52, s53, 114688
s_mul_i32 s51, s53, 86016
s_add_u32 s53, s53, 1
s_cmp_eq_u32 s53, 14
s_cselect_b32 s53, 0, s53
s_add_u32 m0, s55, 0
v_mfma_f32_16x16x32_bf16 v[224:227], a[48:51], a[36:39], v[224:227]
buffer_load_dwordx4 v2, s[12:15], s51 offen lds
v_mfma_f32_16x16x32_bf16 v[112:115], a[52:55], a[20:23], v[112:115]
ds_read_b64_tr_b16 a[48:49], v16 offset:128
v_mfma_f32_16x16x32_bf16 v[116:119], a[52:55], a[24:27], v[116:119]
ds_read_b64_tr_b16 a[50:51], v16 offset:1664
v_mfma_f32_16x16x32_bf16 v[120:123], a[52:55], a[28:31], v[120:123]
ds_read_b128 a[12:15], v22 offset:38912
v_mfma_f32_16x16x32_bf16 v[124:127], a[52:55], a[32:35], v[124:127]
v_mfma_f32_16x16x32_bf16 v[228:231], a[52:55], a[36:39], v[228:231]
s_waitcnt lgkmcnt(15)
v_mfma_f32_16x16x32_bf16 v[128:131], a[20:23], a[56:59], v[128:131]
ds_read_b64_tr_b16 a[52:53], v17 offset:128
v_mfma_f32_16x16x32_bf16 v[132:135], a[24:27], a[56:59], v[132:135]
ds_read_b64_tr_b16 a[54:55], v17 offset:1664
v_mfma_f32_16x16x32_bf16 v[136:139], a[28:31], a[56:59], v[136:139]
ds_read_b128 a[16:19], v24 offset:36864
s_add_u32 m0, s55, 1024
v_mfma_f32_16x16x32_bf16 v[140:143], a[32:35], a[56:59], v[140:143]
buffer_load_dwordx4 v3, s[12:15], s51 offen lds
v_mfma_f32_16x16x32_bf16 v[144:147], a[20:23], a[60:63], v[144:147]
ds_read_b64_tr_b16 a[56:57], v16 offset:256
v_mfma_f32_16x16x32_bf16 v[148:151], a[24:27], a[60:63], v[148:151]
ds_read_b64_tr_b16 a[58:59], v16 offset:1792
v_mfma_f32_16x16x32_bf16 v[152:155], a[28:31], a[60:63], v[152:155]
s_add_u32 m0, s55, 2048
v_mfma_f32_16x16x32_bf16 v[156:159], a[32:35], a[60:63], v[156:159]
buffer_load_dwordx4 v4, s[12:15], s51 offen lds
s_waitcnt lgkmcnt(15)
v_mfma_f32_16x16x32_bf16 v[160:163], a[64:67], a[20:23], v[160:163]
ds_read_b64_tr_b16 a[60:61], v17 offset:256
v_mfma_f32_16x16x32_bf16 v[164:167], a[64:67], a[24:27], v[164:167]
ds_read_b64_tr_b16 a[62:63], v17 offset:1792
v_mfma_f32_16x16x32_bf16 v[168:171], a[64:67], a[28:31], v[168:171]
v_mfma_f32_16x16x32_bf16 v[172:175], a[64:67], a[32:35], v[172:175]
v_mfma_f32_16x16x32_bf16 v[176:179], a[68:71], a[20:23], v[176:179]
ds_read_b64_tr_b16 a[64:65], v18 offset:12288
v_mfma_f32_16x16x32_bf16 v[180:183], a[68:71], a[24:27], v[180:183]
ds_read_b64_tr_b16 a[66:67], v18 offset:12800
v_mfma_f32_16x16x32_bf16 v[184:187], a[68:71], a[28:31], v[184:187]
s_add_u32 m0, s56, 0
v_mfma_f32_16x16x32_bf16 v[188:191], a[68:71], a[32:35], v[188:191]
buffer_load_dwordx4 v5, s[16:19], s52 offen lds
v_mfma_f32_16x16x32_bf16 v[192:195], a[72:75], a[20:23], v[192:195]
ds_read_b64_tr_b16 a[68:69], v19 offset:12288
v_mfma_f32_16x16x32_bf16 v[196:199], a[72:75], a[24:27], v[196:199]
ds_read_b64_tr_b16 a[70:71], v19 offset:12800
v_mfma_f32_16x16x32_bf16 v[200:203], a[72:75], a[28:31], v[200:203]
s_add_u32 m0, s57, 0
v_mfma_f32_16x16x32_bf16 v[204:207], a[72:75], a[32:35], v[204:207]
buffer_load_dwordx4 v5, s[20:23], s52 offen lds
v_mfma_f32_16x16x32_bf16 v[208:211], a[76:79], a[20:23], v[208:211]
ds_read_b64_tr_b16 a[72:73], v18 offset:16384
v_mfma_f32_16x16x32_bf16 v[212:215], a[76:79], a[24:27], v[212:215]
ds_read_b64_tr_b16 a[74:75], v18 offset:16896
v_mfma_f32_16x16x32_bf16 v[216:219], a[76:79], a[28:31], v[216:219]
v_mfma_f32_16x16x32_bf16 v[220:223], a[76:79], a[32:35], v[220:223]
s_waitcnt lgkmcnt(10)
v_mfma_f32_16x16x32_bf16 v[64:67], a[40:43], a[0:3], v[64:67]
s_waitcnt vmcnt(7)
s_barrier
v_mfma_f32_16x16x32_bf16 v[68:71], a[40:43], a[4:7], v[68:71]
ds_read_b64_tr_b16 a[76:77], v19 offset:16384
v_mfma_f32_16x16x32_bf16 v[72:75], a[40:43], a[8:11], v[72:75]
ds_read_b64_tr_b16 a[78:79], v19 offset:16896
s_mul_i32 s52, s53, 114688
s_mul_i32 s51, s53, 86016
s_add_u32 s53, s53, 1
s_cmp_eq_u32 s53, 14
s_cselect_b32 s53, 0, s53
s_add_u32 m0, s55, 20480
v_mfma_f32_16x16x32_bf16 v[76:79], a[40:43], a[12:15], v[76:79]
buffer_load_dwordx4 v2, s[12:15], s51 offen lds
v_mfma_f32_16x16x32_bf16 v[80:83], a[44:47], a[0:3], v[80:83]
ds_read_b128 a[20:23], v21 offset:36864
v_mfma_f32_16x16x32_bf16 v[84:87], a[44:47], a[4:7], v[84:87]
ds_read_b64_tr_b16 a[40:41], v16 offset:20480
v_mfma_f32_16x16x32_bf16 v[88:91], a[44:47], a[8:11], v[88:91]
ds_read_b64_tr_b16 a[42:43], v16 offset:22016
v_mfma_f32_16x16x32_bf16 v[92:95], a[44:47], a[12:15], v[92:95]
ds_read_b128 a[24:27], v21 offset:38912
v_bitop3_b32 v43, v44, v45, v46 bitop3:0x80
v_mfma_f32_16x16x32_bf16 v[96:99], a[48:51], a[0:3], v[96:99]
v_bitop3_b32 v43, v43, v47, v48 bitop3:0x80
v_bitop3_b32 v43, v43, v49, v50 bitop3:0x80
v_mfma_f32_16x16x32_bf16 v[100:103], a[48:51], a[4:7], v[100:103]
ds_read_b64_tr_b16 a[44:45], v17 offset:20480
v_mfma_f32_16x16x32_bf16 v[104:107], a[48:51], a[8:11], v[104:107]
ds_read_b64_tr_b16 a[46:47], v17 offset:22016
v_mfma_f32_16x16x32_bf16 v[108:111], a[48:51], a[12:15], v[108:111]
ds_read_b128 a[28:31], v23 offset:36864
v_bitop3_b32 v43, v43, v51, v52 bitop3:0x80
s_add_u32 m0, s55, 21504
v_mfma_f32_16x16x32_bf16 v[224:227], a[48:51], a[16:19], v[224:227]
buffer_load_dwordx4 v3, s[12:15], s51 offen lds
v_bitop3_b32 v43, v43, v53, v54 bitop3:0x80
v_mfma_f32_16x16x32_bf16 v[112:115], a[52:55], a[0:3], v[112:115]
v_bitop3_b32 v42, v56, v57, v58 bitop3:0x80
ds_read_b64_tr_b16 a[48:49], v16 offset:20608
v_mfma_f32_16x16x32_bf16 v[116:119], a[52:55], a[4:7], v[116:119]
ds_read_b64_tr_b16 a[50:51], v16 offset:22144
v_mfma_f32_16x16x32_bf16 v[120:123], a[52:55], a[8:11], v[120:123]
ds_read_b128 a[32:35], v23 offset:38912
v_and_b32 v42, v42, v59
v_mfma_f32_16x16x32_bf16 v[124:127], a[52:55], a[12:15], v[124:127]
v_or_b32 v42, s47, v42
v_bitop3_b32 v43, v43, v55, v42 bitop3:0x80
v_mfma_f32_16x16x32_bf16 v[228:231], a[52:55], a[16:19], v[228:231]
s_waitcnt lgkmcnt(15)
v_mfma_f32_16x16x32_bf16 v[128:131], a[0:3], a[56:59], v[128:131]
ds_read_b64_tr_b16 a[52:53], v17 offset:20608
v_mfma_f32_16x16x32_bf16 v[132:135], a[4:7], a[56:59], v[132:135]
ds_read_b64_tr_b16 a[54:55], v17 offset:22144
v_mfma_f32_16x16x32_bf16 v[136:139], a[8:11], a[56:59], v[136:139]
ds_read_b128 a[36:39], v25 offset:36864
v_and_b32 v43, 1, v43
s_add_u32 m0, s55, 22528
v_mfma_f32_16x16x32_bf16 v[140:143], a[12:15], a[56:59], v[140:143]
buffer_load_dwordx4 v4, s[12:15], s51 offen lds
v_mfma_f32_16x16x32_bf16 v[144:147], a[0:3], a[60:63], v[144:147]
v_cmp_eq_u32 vcc, 0, v41
v_cmp_eq_u32 s[60:61], 0, v43
s_nop 1
s_or_b64 vcc, vcc, s[60:61]
s_cmp_eq_u64 vcc, 0
s_cbranch_scc0 L_gat_slow_6
L_gat_back_7:
v_mfma_f32_16x16x32_bf16 v[148:151], a[4:7], a[60:63], v[148:151]
v_add_f32 v44, v44, v48
ds_read_b64_tr_b16 a[56:57], v16 offset:20736
v_mfma_f32_16x16x32_bf16 v[152:155], a[8:11], a[60:63], v[152:155]
ds_read_b64_tr_b16 a[58:59], v16 offset:22272
v_add_f32 v52, v52, v56
v_mfma_f32_16x16x32_bf16 v[156:159], a[12:15], a[60:63], v[156:159]
v_add_f32 v45, v45, v49
v_add_f32 v53, v53, v57
s_waitcnt lgkmcnt(15)
v_mfma_f32_16x16x32_bf16 v[160:163], a[64:67], a[0:3], v[160:163]
ds_read_b64_tr_b16 a[60:61], v17 offset:20736
v_mfma_f32_16x16x32_bf16 v[164:167], a[64:67], a[4:7], v[164:167]
ds_read_b64_tr_b16 a[62:63], v17 offset:22272
v_add_f32 v46, v46, v50
v_mfma_f32_16x16x32_bf16 v[168:171], a[64:67], a[8:11], v[168:171]
v_add_f32 v54, v54, v58
v_add_f32 v47, v47, v51
s_add_u32 m0, s56, 20480
v_mfma_f32_16x16x32_bf16 v[172:175], a[64:67], a[12:15], v[172:175]
buffer_load_dwordx4 v5, s[16:19], s52 offen lds
v_mfma_f32_16x16x32_bf16 v[176:179], a[68:71], a[0:3], v[176:179]
ds_read_b64_tr_b16 a[64:65], v18 offset:32768
v_mfma_f32_16x16x32_bf16 v[180:183], a[68:71], a[4:7], v[180:183]
ds_read_b64_tr_b16 a[66:67], v18 offset:33280
v_add_f32 v55, v55, v59
v_mfma_f32_16x16x32_bf16 v[184:187], a[68:71], a[8:11], v[184:187]
v_add_f32 v44, v44, v52
v_add_f32 v45, v45, v53
v_mfma_f32_16x16x32_bf16 v[188:191], a[68:71], a[12:15], v[188:191]
v_mfma_f32_16x16x32_bf16 v[192:195], a[72:75], a[0:3], v[192:195]
ds_read_b64_tr_b16 a[68:69], v19 offset:32768
v_mfma_f32_16x16x32_bf16 v[196:199], a[72:75], a[4:7], v[196:199]
ds_read_b64_tr_b16 a[70:71], v19 offset:33280
v_add_f32 v46, v46, v54
v_mfma_f32_16x16x32_bf16 v[200:203], a[72:75], a[8:11], v[200:203]
v_add_f32 v47, v47, v55
ds_write_b32 v28, v40
s_add_u32 m0, s57, 20480
v_mfma_f32_16x16x32_bf16 v[204:207], a[72:75], a[12:15], v[204:207]
buffer_load_dwordx4 v5, s[20:23], s52 offen lds
v_mfma_f32_16x16x32_bf16 v[208:211], a[76:79], a[0:3], v[208:211]
ds_read_b64_tr_b16 a[72:73], v18 offset:36864
v_mfma_f32_16x16x32_bf16 v[212:215], a[76:79], a[4:7], v[212:215]
ds_read_b64_tr_b16 a[74:75], v18 offset:37376
v_mfma_f32_16x16x32_bf16 v[216:219], a[76:79], a[8:11], v[216:219]
ds_write_b32 v28, v41 offset:960
v_mfma_f32_16x16x32_bf16 v[220:223], a[76:79], a[12:15], v[220:223]
ds_write_b128 v33, v[44:47]
s_waitcnt lgkmcnt(0)
v_mfma_f32_16x16x32_bf16 v[64:67], a[40:43], a[20:23], v[64:67]
s_waitcnt vmcnt(5)
s_barrier
v_mfma_f32_16x16x32_bf16 v[68:71], a[40:43], a[24:27], v[68:71]
ds_read_b64_tr_b16 a[76:77], v19 offset:36864
v_mfma_f32_16x16x32_bf16 v[72:75], a[40:43], a[28:31], v[72:75]
ds_read_b64_tr_b16 a[78:79], v19 offset:37376
v_mfma_f32_16x16x32_bf16 v[76:79], a[40:43], a[32:35], v[76:79]
ds_read_b128 a[0:3], v20 offset:0
v_mfma_f32_16x16x32_bf16 v[80:83], a[44:47], a[20:23], v[80:83]
ds_read_b64_tr_b16 a[40:41], v12 offset:0
v_mfma_f32_16x16x32_bf16 v[84:87], a[44:47], a[24:27], v[84:87]
ds_read_b64_tr_b16 a[42:43], v12 offset:1536
v_mfma_f32_16x16x32_bf16 v[88:91], a[44:47], a[28:31], v[88:91]
ds_read_b128 a[4:7], v20 offset:2048
v_mfma_f32_16x16x32_bf16 v[92:95], a[44:47], a[32:35], v[92:95]
ds_read_b128 v[48:51], v34
s_waitcnt lgkmcnt(0)
v_add_f32 v44, v44, v48
v_mfma_f32_16x16x32_bf16 v[96:99], a[48:51], a[20:23], v[96:99]
ds_read_b64_tr_b16 a[44:45], v13 offset:0
v_mfma_f32_16x16x32_bf16 v[100:103], a[48:51], a[24:27], v[100:103]
ds_read_b64_tr_b16 a[46:47], v13 offset:1536
v_mfma_f32_16x16x32_bf16 v[104:107], a[48:51], a[28:31], v[104:107]
ds_read_b128 a[8:11], v22 offset:0
v_add_f32 v45, v45, v49
v_mfma_f32_16x16x32_bf16 v[108:111], a[48:51], a[32:35], v[108:111]
v_add_f32 v46, v46, v50
v_add_f32 v47, v47, v51
v_mfma_f32_16x16x32_bf16 v[224:227], a[48:51], a[36:39], v[224:227]
v_mfma_f32_16x16x32_bf16 v[112:115], a[52:55], a[20:23], v[112:115]
ds_read_b64_tr_b16 a[48:49], v12 offset:128
v_mfma_f32_16x16x32_bf16 v[116:119], a[52:55], a[24:27], v[116:119]
ds_read_b64_tr_b16 a[50:51], v12 offset:1664
v_mfma_f32_16x16x32_bf16 v[120:123], a[52:55], a[28:31], v[120:123]
ds_read_b128 a[12:15], v22 offset:2048
v_mfma_f32_16x16x32_bf16 v[124:127], a[52:55], a[32:35], v[124:127]
ds_write_b128 v29, v[44:47]
s_waitcnt lgkmcnt(0)
v_mfma_f32_16x16x32_bf16 v[228:231], a[52:55], a[36:39], v[228:231]
v_mfma_f32_16x16x32_bf16 v[128:131], a[20:23], a[56:59], v[128:131]
ds_read_b64_tr_b16 a[52:53], v13 offset:128
v_mfma_f32_16x16x32_bf16 v[132:135], a[24:27], a[56:59], v[132:135]
ds_read_b64_tr_b16 a[54:55], v13 offset:1664
v_mfma_f32_16x16x32_bf16 v[136:139], a[28:31], a[56:59], v[136:139]
ds_read_b128 a[16:19], v24 offset:0
s_add_u32 s3, s70, 0
s_add_u32 m0, s74, 40960
v_mfma_f32_16x16x32_bf16 v[140:143], a[32:35], a[56:59], v[140:143]
v_mfma_f32_16x16x32_bf16 v[144:147], a[20:23], a[60:63], v[144:147]
ds_read_b64_tr_b16 a[56:57], v12 offset:256
v_mfma_f32_16x16x32_bf16 v[148:151], a[24:27], a[60:63], v[148:151]
ds_read_b64_tr_b16 a[58:59], v12 offset:1792
v_mfma_f32_16x16x32_bf16 v[152:155], a[28:31], a[60:63], v[152:155]
buffer_load_dwordx4 v232, s[36:39], s3 offen offset:0 lds
v_mfma_f32_16x16x32_bf16 v[156:159], a[32:35], a[60:63], v[156:159]
buffer_load_dwordx4 v233, s[36:39], s3 offen offset:1024 lds
v_mfma_f32_16x16x32_bf16 v[160:163], a[64:67], a[20:23], v[160:163]
ds_read_b64_tr_b16 a[60:61], v13 offset:256
v_mfma_f32_16x16x32_bf16 v[164:167], a[64:67], a[24:27], v[164:167]
ds_read_b64_tr_b16 a[62:63], v13 offset:1792
v_mfma_f32_16x16x32_bf16 v[168:171], a[64:67], a[28:31], v[168:171]
buffer_load_dwordx4 v234, s[36:39], s3 offen offset:2048 lds
v_mfma_f32_16x16x32_bf16 v[172:175], a[64:67], a[32:35], v[172:175]
buffer_load_dwordx4 v235, s[36:39], s3 offen offset:3072 lds
v_mfma_f32_16x16x32_bf16 v[176:179], a[68:71], a[20:23], v[176:179]
ds_read_b64_tr_b16 a[64:65], v14 offset:12288
v_mfma_f32_16x16x32_bf16 v[180:183], a[68:71], a[24:27], v[180:183]
ds_read_b64_tr_b16 a[66:67], v14 offset:12800
s_add_u32 s3, s70, 28672
s_add_u32 m0, s74, 100352
v_mfma_f32_16x16x32_bf16 v[184:187], a[68:71], a[28:31], v[184:187]
v_mfma_f32_16x16x32_bf16 v[188:191], a[68:71], a[32:35], v[188:191]
v_mfma_f32_16x16x32_bf16 v[192:195], a[72:75], a[20:23], v[192:195]
ds_read_b64_tr_b16 a[68:69], v15 offset:12288
v_mfma_f32_16x16x32_bf16 v[196:199], a[72:75], a[24:27], v[196:199]
ds_read_b64_tr_b16 a[70:71], v15 offset:12800
v_mfma_f32_16x16x32_bf16 v[200:203], a[72:75], a[28:31], v[200:203]
buffer_load_dwordx4 v232, s[36:39], s3 offen offset:0 lds
v_mfma_f32_16x16x32_bf16 v[204:207], a[72:75], a[32:35], v[204:207]
buffer_load_dwordx4 v233, s[36:39], s3 offen offset:1024 lds
v_mfma_f32_16x16x32_bf16 v[208:211], a[76:79], a[20:23], v[208:211]
ds_read_b64_tr_b16 a[72:73], v14 offset:16384
v_mfma_f32_16x16x32_bf16 v[212:215], a[76:79], a[24:27], v[212:215]
ds_read_b64_tr_b16 a[74:75], v14 offset:16896
v_mfma_f32_16x16x32_bf16 v[216:219], a[76:79], a[28:31], v[216:219]
buffer_load_dwordx4 v234, s[36:39], s3 offen offset:2048 lds
v_mfma_f32_16x16x32_bf16 v[220:223], a[76:79], a[32:35], v[220:223]
buffer_load_dwordx4 v235, s[36:39], s3 offen offset:3072 lds
s_waitcnt lgkmcnt(10)
v_mfma_f32_16x16x32_bf16 v[64:67], a[40:43], a[0:3], v[64:67]
s_waitcnt vmcnt(8)
s_barrier
v_mfma_f32_16x16x32_bf16 v[68:71], a[40:43], a[4:7], v[68:71]
ds_read_b64_tr_b16 a[76:77], v15 offset:16384
v_mfma_f32_16x16x32_bf16 v[72:75], a[40:43], a[8:11], v[72:75]
ds_read_b64_tr_b16 a[78:79], v15 offset:16896
v_mfma_f32_16x16x32_bf16 v[76:79], a[40:43], a[12:15], v[76:79]
ds_read_b128 a[20:23], v21 offset:0
v_mfma_f32_16x16x32_bf16 v[80:83], a[44:47], a[0:3], v[80:83]
ds_read_b64_tr_b16 a[40:41], v12 offset:20480
v_mfma_f32_16x16x32_bf16 v[84:87], a[44:47], a[4:7], v[84:87]
ds_read_b64_tr_b16 a[42:43], v12 offset:22016
v_mfma_f32_16x16x32_bf16 v[88:91], a[44:47], a[8:11], v[88:91]
ds_read_b128 a[24:27], v21 offset:2048
v_and_b32 v34, 15, v1
v_mfma_f32_16x16x32_bf16 v[92:95], a[44:47], a[12:15], v[92:95]
v_lshlrev_b32 v34, 2, v34
s_lshl_b32 s60, s47, 8
s_add_u32 s60, s60, 139392
v_mfma_f32_16x16x32_bf16 v[96:99], a[48:51], a[0:3], v[96:99]
s_add_u32 s61, s60, 128
ds_read_b64_tr_b16 a[44:45], v13 offset:20480
v_mfma_f32_16x16x32_bf16 v[100:103], a[48:51], a[4:7], v[100:103]
ds_read_b64_tr_b16 a[46:47], v13 offset:22016
v_mfma_f32_16x16x32_bf16 v[104:107], a[48:51], a[8:11], v[104:107]
ds_read_b128 a[28:31], v23 offset:0
v_add_u32 v35, s60, v34
v_mfma_f32_16x16x32_bf16 v[108:111], a[48:51], a[12:15], v[108:111]
v_add_u32 v58, s61, v34
ds_read_b32 v26, v35 offset:0
v_mfma_f32_16x16x32_bf16 v[224:227], a[48:51], a[16:19], v[224:227]
ds_read_b32 v27, v35 offset:960
v_mfma_f32_16x16x32_bf16 v[112:115], a[52:55], a[0:3], v[112:115]
ds_read_b32 v28, v35 offset:64
v_mfma_f32_16x16x32_bf16 v[116:119], a[52:55], a[4:7], v[116:119]
ds_read_b64_tr_b16 a[48:49], v12 offset:20608
v_mfma_f32_16x16x32_bf16 v[120:123], a[52:55], a[8:11], v[120:123]
ds_read_b64_tr_b16 a[50:51], v12 offset:22144
v_mfma_f32_16x16x32_bf16 v[124:127], a[52:55], a[12:15], v[124:127]
ds_read_b128 a[32:35], v23 offset:2048
v_mfma_f32_16x16x32_bf16 v[228:231], a[52:55], a[16:19], v[228:231]
ds_read_b32 v29, v35 offset:1024
s_waitcnt lgkmcnt(15)
v_mfma_f32_16x16x32_bf16 v[128:131], a[0:3], a[56:59], v[128:131]
ds_read_b32 v30, v58 offset:0
v_mfma_f32_16x16x32_bf16 v[132:135], a[4:7], a[56:59], v[132:135]
ds_read_b32 v31, v58 offset:960
v_mfma_f32_16x16x32_bf16 v[136:139], a[8:11], a[56:59], v[136:139]
ds_read_b32 v32, v58 offset:64
v_mfma_f32_16x16x32_bf16 v[140:143], a[12:15], a[56:59], v[140:143]
ds_read_b32 v33, v58 offset:1024
v_mfma_f32_16x16x32_bf16 v[144:147], a[0:3], a[60:63], v[144:147]
ds_read_b64_tr_b16 a[52:53], v13 offset:20608
v_mfma_f32_16x16x32_bf16 v[148:151], a[4:7], a[60:63], v[148:151]
ds_read_b64_tr_b16 a[54:55], v13 offset:22144
v_mfma_f32_16x16x32_bf16 v[152:155], a[8:11], a[60:63], v[152:155]
ds_read_b128 a[36:39], v25 offset:0
v_lshrrev_b32 v240, 4, v1
v_mfma_f32_16x16x32_bf16 v[156:159], a[12:15], a[60:63], v[156:159]
v_mul_u32_u24 v240, 0x110, v240
s_mul_i32 s60, s48, 1088
s_add_u32 s60, s60, 137216
v_add_u32 v240, s60, v240
v_mfma_f32_16x16x32_bf16 v[160:163], a[64:67], a[0:3], v[160:163]
ds_read_b64_tr_b16 a[56:57], v12 offset:20736
v_mfma_f32_16x16x32_bf16 v[164:167], a[64:67], a[4:7], v[164:167]
ds_read_b64_tr_b16 a[58:59], v12 offset:22272
v_lshlrev_b32 v241, 4, v1
s_lshl_b32 s60, s44, 3
s_lshl_b32 s61, s47, 2
v_mfma_f32_16x16x32_bf16 v[168:171], a[64:67], a[8:11], v[168:171]
s_add_u32 s60, s60, s61
ds_read_b64_tr_b16 a[60:61], v13 offset:20736
v_mfma_f32_16x16x32_bf16 v[172:175], a[64:67], a[12:15], v[172:175]
ds_read_b64_tr_b16 a[62:63], v13 offset:22272
s_mul_i32 s60, s60, 72
s_mul_i32 s61, s49, 9
v_mfma_f32_16x16x32_bf16 v[176:179], a[68:71], a[0:3], v[176:179]
s_and_b32 s62, s45, 1
s_lshl_b32 s62, s62, 2
ds_read_b64_tr_b16 a[64:65], v14 offset:32768
v_mfma_f32_16x16x32_bf16 v[180:183], a[68:71], a[4:7], v[180:183]
ds_read_b64_tr_b16 a[66:67], v14 offset:33280
s_add_u32 s61, s61, s62
s_add_u32 s60, s60, s61
v_mfma_f32_16x16x32_bf16 v[184:187], a[68:71], a[8:11], v[184:187]
s_lshl_b32 s60, s60, 10
s_lshl_b32 s61, s48, 11
v_mfma_f32_16x16x32_bf16 v[188:191], a[68:71], a[12:15], v[188:191]
s_waitcnt lgkmcnt(15)
v_mfma_f32_16x16x32_bf16 v[192:195], a[72:75], a[0:3], v[192:195]
ds_read_b64_tr_b16 a[68:69], v15 offset:32768
v_mfma_f32_16x16x32_bf16 v[196:199], a[72:75], a[4:7], v[196:199]
ds_read_b64_tr_b16 a[70:71], v15 offset:33280
s_add_u32 s64, s60, s61
s_add_u32 s65, s64, 147456
v_mfma_f32_16x16x32_bf16 v[200:203], a[72:75], a[8:11], v[200:203]
s_add_u32 s3, s70, 57344
s_add_u32 m0, s74, 61440
v_mfma_f32_16x16x32_bf16 v[204:207], a[72:75], a[12:15], v[204:207]
v_mfma_f32_16x16x32_bf16 v[208:211], a[76:79], a[0:3], v[208:211]
ds_read_b64_tr_b16 a[72:73], v14 offset:36864
v_mfma_f32_16x16x32_bf16 v[212:215], a[76:79], a[4:7], v[212:215]
ds_read_b64_tr_b16 a[74:75], v14 offset:37376
v_mfma_f32_16x16x32_bf16 v[216:219], a[76:79], a[8:11], v[216:219]
buffer_load_dwordx4 v232, s[36:39], s3 offen offset:0 lds
v_mfma_f32_16x16x32_bf16 v[220:223], a[76:79], a[12:15], v[220:223]
buffer_load_dwordx4 v233, s[36:39], s3 offen offset:1024 lds
buffer_load_dwordx4 v234, s[36:39], s3 offen offset:2048 lds
buffer_load_dwordx4 v235, s[36:39], s3 offen offset:3072 lds
s_waitcnt lgkmcnt(10)
v_mfma_f32_16x16x32_bf16 v[64:67], a[40:43], a[20:23], v[64:67]
s_barrier
v_mfma_f32_16x16x32_bf16 v[68:71], a[40:43], a[24:27], v[68:71]
ds_read_b64_tr_b16 a[76:77], v15 offset:36864
v_mfma_f32_16x16x32_bf16 v[72:75], a[40:43], a[28:31], v[72:75]
ds_read_b64_tr_b16 a[78:79], v15 offset:37376
v_mfma_f32_16x16x32_bf16 v[76:79], a[40:43], a[32:35], v[76:79]
v_mfma_f32_16x16x32_bf16 v[80:83], a[44:47], a[20:23], v[80:83]
s_add_u32 s3, s70, 86016
s_add_u32 m0, s74, 118784
v_mfma_f32_16x16x32_bf16 v[84:87], a[44:47], a[24:27], v[84:87]
buffer_load_dwordx4 v232, s[36:39], s3 offen offset:0 lds
v_mfma_f32_16x16x32_bf16 v[88:91], a[44:47], a[28:31], v[88:91]
buffer_load_dwordx4 v233, s[36:39], s3 offen offset:1024 lds
v_mfma_f32_16x16x32_bf16 v[92:95], a[44:47], a[32:35], v[92:95]
buffer_load_dwordx4 v234, s[36:39], s3 offen offset:2048 lds
v_mfma_f32_16x16x32_bf16 v[96:99], a[48:51], a[20:23], v[96:99]
buffer_load_dwordx4 v235, s[36:39], s3 offen offset:3072 lds
s_add_u32 s3, s70, 114688
s_add_u32 m0, s74, 0
v_mfma_f32_16x16x32_bf16 v[100:103], a[48:51], a[24:27], v[100:103]
buffer_load_dwordx4 v232, s[36:39], s3 offen offset:0 lds
v_mfma_f32_16x16x32_bf16 v[104:107], a[48:51], a[28:31], v[104:107]
buffer_load_dwordx4 v233, s[36:39], s3 offen offset:1024 lds
v_mfma_f32_16x16x32_bf16 v[108:111], a[48:51], a[32:35], v[108:111]
buffer_load_dwordx4 v234, s[36:39], s3 offen offset:2048 lds
v_mfma_f32_16x16x32_bf16 v[224:227], a[48:51], a[36:39], v[224:227]
buffer_load_dwordx4 v235, s[36:39], s3 offen offset:3072 lds
v_sub_f32 v242, 0, v26
v_mfma_f32_16x16x32_bf16 v[112:115], a[52:55], a[20:23], v[112:115]
v_mul_f32 v243, v27, v27
v_sub_f32 v244, 0, v28
v_mfma_f32_16x16x32_bf16 v[116:119], a[52:55], a[24:27], v[116:119]
v_mul_f32 v245, v29, v29
v_sub_f32 v246, 0, v30
v_mfma_f32_16x16x32_bf16 v[120:123], a[52:55], a[28:31], v[120:123]
v_mul_f32 v247, v31, v31
v_sub_f32 v248, 0, v32
v_mfma_f32_16x16x32_bf16 v[124:127], a[52:55], a[32:35], v[124:127]
v_mul_f32 v249, v33, v33
v_and_b32 v58, 15, v1
v_mfma_f32_16x16x32_bf16 v[228:231], a[52:55], a[36:39], v[228:231]
v_lshrrev_b32 v59, 4, v1
v_lshlrev_b32 v59, 2, v59
s_waitcnt lgkmcnt(8)
v_mfma_f32_16x16x32_bf16 v[128:131], a[20:23], a[56:59], v[128:131]
v_mov_b32 v62, 0xf149f2ca
v_add_u32 v60, 0, v59
v_mfma_f32_16x16x32_bf16 v[132:135], a[24:27], a[56:59], v[132:135]
v_sub_u32 v60, v58, v60
v_and_b32 v60, 0x80000001, v60
v_mfma_f32_16x16x32_bf16 v[136:139], a[28:31], a[56:59], v[136:139]
v_cmp_eq_u32 vcc, 0, v60
s_nop 1
v_cndmask_b32_e64 v38, v62, 0, vcc
v_mfma_f32_16x16x32_bf16 v[140:143], a[32:35], a[56:59], v[140:143]
v_cmp_eq_u32 vcc, 0x80000000, v60
s_nop 1
v_cndmask_b32_e64 v34, v62, 0, vcc
v_mfma_f32_16x16x32_bf16 v[144:147], a[20:23], a[60:63], v[144:147]
v_add_u32 v60, 1, v59
v_sub_u32 v60, v58, v60
v_mfma_f32_16x16x32_bf16 v[148:151], a[24:27], a[60:63], v[148:151]
v_and_b32 v60, 0x80000001, v60
v_mfma_f32_16x16x32_bf16 v[152:155], a[28:31], a[60:63], v[152:155]
v_cmp_eq_u32 vcc, 0, v60
s_nop 1
v_cndmask_b32_e64 v39, v62, 0, vcc
v_mfma_f32_16x16x32_bf16 v[156:159], a[32:35], a[60:63], v[156:159]
v_cmp_eq_u32 vcc, 0x80000000, v60
s_nop 1
v_cndmask_b32_e64 v35, v62, 0, vcc
s_waitcnt lgkmcnt(4)
v_mfma_f32_16x16x32_bf16 v[160:163], a[64:67], a[20:23], v[160:163]
v_add_u32 v60, 2, v59
v_sub_u32 v60, v58, v60
v_mfma_f32_16x16x32_bf16 v[164:167], a[64:67], a[24:27], v[164:167]
v_and_b32 v60, 0x80000001, v60
v_mfma_f32_16x16x32_bf16 v[168:171], a[64:67], a[28:31], v[168:171]
v_cmp_eq_u32 vcc, 0, v60
s_nop 1
v_cndmask_b32_e64 v40, v62, 0, vcc
v_mfma_f32_16x16x32_bf16 v[172:175], a[64:67], a[32:35], v[172:175]
v_cmp_eq_u32 vcc, 0x80000000, v60
s_nop 1
v_cndmask_b32_e64 v36, v62, 0, vcc
v_mfma_f32_16x16x32_bf16 v[176:179], a[68:71], a[20:23], v[176:179]
v_add_u32 v60, 3, v59
v_sub_u32 v60, v58, v60
v_mfma_f32_16x16x32_bf16 v[180:183], a[68:71], a[24:27], v[180:183]
v_and_b32 v60, 0x80000001, v60
v_mfma_f32_16x16x32_bf16 v[184:187], a[68:71], a[28:31], v[184:187]
v_cmp_eq_u32 vcc, 0, v60
s_nop 1
v_cndmask_b32_e64 v41, v62, 0, vcc
v_mfma_f32_16x16x32_bf16 v[188:191], a[68:71], a[32:35], v[188:191]
v_cmp_eq_u32 vcc, 0x80000000, v60
s_nop 1
v_cndmask_b32_e64 v37, v62, 0, vcc
s_waitcnt lgkmcnt(0)
v_mfma_f32_16x16x32_bf16 v[192:195], a[72:75], a[20:23], v[192:195]
s_cmp_eq_u32 s44, 0
s_cselect_b32 s60, 0xf149f2ca, 0
v_mfma_f32_16x16x32_bf16 v[196:199], a[72:75], a[24:27], v[196:199]
v_add_f32 v42, s60, v34
v_add_f32 v43, s60, v35
v_mfma_f32_16x16x32_bf16 v[200:203], a[72:75], a[28:31], v[200:203]
v_add_f32 v44, s60, v36
v_add_f32 v45, s60, v37
v_mfma_f32_16x16x32_bf16 v[204:207], a[72:75], a[32:35], v[204:207]
v_mov_b32 v46, 0x3f803f80
v_mov_b32 v47, 0x3f803f80
v_mfma_f32_16x16x32_bf16 v[208:211], a[76:79], a[20:23], v[208:211]
v_mov_b32 v48, 0x3f803f80
v_mov_b32 v49, 0x3f803f80
v_mfma_f32_16x16x32_bf16 v[212:215], a[76:79], a[24:27], v[212:215]
v_subrev_u32 v50, 48, v1
v_ashrrev_i32 v50, 31, v50
v_mfma_f32_16x16x32_bf16 v[216:219], a[76:79], a[28:31], v[216:219]
v_and_b32 v51, 1.0, v50
ds_read_b128 v[52:55], v240 offset:96
v_mfma_f32_16x16x32_bf16 v[220:223], a[76:79], a[32:35], v[220:223]
ds_read_b128 v[56:59], v240 offset:128
ds_read_b128 v[4:7], v240 offset:112
ds_read_b128 v[8:11], v240 offset:144
ds_read_b128 v[12:15], v240 offset:32
ds_read_b128 v[16:19], v240 offset:48
v_bfe_u32 v60, v1, 2, 2
v_mul_u32_u24 v60, 0x110, v60
v_and_b32 v61, 3, v1
v_lshl_add_u32 v61, v61, 2, v60
s_mul_i32 s61, s48, 1088
s_add_u32 s61, s61, 137280
v_add_u32 v61, s61, v61
ds_read_b32 v20, v61
ds_read_b32 v22, v61 offset:16
v_and_b32 v60, 15, v1
v_lshlrev_b32 v60, 2, v60
v_add_u32 v60, 139904, v60
ds_read_b32 v24, v60
ds_read_b32 v25, v60 offset:960
ds_read_b128 v[60:63], v240 offset:0
ds_read_b64 v[2:3], v240 offset:16
ds_read_b64 v[254:255], v240 offset:24
s_waitcnt lgkmcnt(0)
s_barrier
v_pk_fma_f32 v[160:161], v[52:53], v[242:243], v[160:161] op_sel_hi:[1,0,1]
v_pk_fma_f32 v[164:165], v[52:53], v[244:245], v[164:165] op_sel_hi:[1,0,1]
v_pk_fma_f32 v[176:177], v[4:5], v[242:243], v[176:177] op_sel_hi:[1,0,1]
v_pk_fma_f32 v[180:181], v[4:5], v[244:245], v[180:181] op_sel_hi:[1,0,1]
v_pk_fma_f32 v[162:163], v[54:55], v[242:243], v[162:163] op_sel_hi:[1,0,1]
v_pk_fma_f32 v[166:167], v[54:55], v[244:245], v[166:167] op_sel_hi:[1,0,1]
v_pk_fma_f32 v[178:179], v[6:7], v[242:243], v[178:179] op_sel_hi:[1,0,1]
v_pk_fma_f32 v[182:183], v[6:7], v[244:245], v[182:183] op_sel_hi:[1,0,1]
v_pk_fma_f32 v[192:193], v[56:57], v[242:243], v[192:193] op_sel_hi:[1,0,1]
v_pk_fma_f32 v[196:197], v[56:57], v[244:245], v[196:197] op_sel_hi:[1,0,1]
v_pk_fma_f32 v[208:209], v[8:9], v[242:243], v[208:209] op_sel_hi:[1,0,1]
v_pk_fma_f32 v[212:213], v[8:9], v[244:245], v[212:213] op_sel_hi:[1,0,1]
v_pk_fma_f32 v[194:195], v[58:59], v[242:243], v[194:195] op_sel_hi:[1,0,1]
v_pk_fma_f32 v[198:199], v[58:59], v[244:245], v[198:199] op_sel_hi:[1,0,1]
v_pk_fma_f32 v[210:211], v[10:11], v[242:243], v[210:211] op_sel_hi:[1,0,1]
v_pk_fma_f32 v[214:215], v[10:11], v[244:245], v[214:215] op_sel_hi:[1,0,1]
v_pk_mul_f32 v[160:161], v[160:161], v[192:193]
v_pk_mul_f32 v[164:165], v[164:165], v[196:197]
v_pk_mul_f32 v[176:177], v[176:177], v[208:209]
v_pk_mul_f32 v[180:181], v[180:181], v[212:213]
v_pk_mul_f32 v[162:163], v[162:163], v[194:195]
v_pk_mul_f32 v[166:167], v[166:167], v[198:199]
v_pk_mul_f32 v[178:179], v[178:179], v[210:211]
v_pk_mul_f32 v[182:183], v[182:183], v[214:215]
v_pk_mul_f32 v[160:161], v[160:161], v[242:243] op_sel:[0,1] op_sel_hi:[1,1]
v_pk_mul_f32 v[164:165], v[164:165], v[244:245] op_sel:[0,1] op_sel_hi:[1,1]
v_pk_mul_f32 v[176:177], v[176:177], v[242:243] op_sel:[0,1] op_sel_hi:[1,1]
v_pk_mul_f32 v[180:181], v[180:181], v[244:245] op_sel:[0,1] op_sel_hi:[1,1]
v_pk_mul_f32 v[162:163], v[162:163], v[242:243] op_sel:[0,1] op_sel_hi:[1,1]
v_pk_mul_f32 v[166:167], v[166:167], v[244:245] op_sel:[0,1] op_sel_hi:[1,1]
v_pk_mul_f32 v[178:179], v[178:179], v[242:243] op_sel:[0,1] op_sel_hi:[1,1]
v_pk_mul_f32 v[182:183], v[182:183], v[244:245] op_sel:[0,1] op_sel_hi:[1,1]
v_cvt_pk_bf16_f32 v192, v160, v161
v_cvt_pk_bf16_f32 v196, v164, v165
v_cvt_pk_bf16_f32 v194, v176, v177
v_cvt_pk_bf16_f32 v198, v180, v181
v_cvt_pk_bf16_f32 v193, v162, v163
v_cvt_pk_bf16_f32 v197, v166, v167
v_cvt_pk_bf16_f32 v195, v178, v179
v_cvt_pk_bf16_f32 v199, v182, v183
s_add_u32 s60, s64, 1024
buffer_store_dwordx4 v[192:195], v241, s[24:27], s60 offen sc1
s_add_u32 s60, s64, 74752
buffer_store_dwordx4 v[196:199], v241, s[24:27], s60 offen sc1
v_pk_fma_f32 v[168:169], v[52:53], v[246:247], v[168:169] op_sel_hi:[1,0,1]
v_pk_fma_f32 v[172:173], v[52:53], v[248:249], v[172:173] op_sel_hi:[1,0,1]
v_pk_fma_f32 v[184:185], v[4:5], v[246:247], v[184:185] op_sel_hi:[1,0,1]
v_pk_fma_f32 v[188:189], v[4:5], v[248:249], v[188:189] op_sel_hi:[1,0,1]
v_pk_fma_f32 v[170:171], v[54:55], v[246:247], v[170:171] op_sel_hi:[1,0,1]
v_pk_fma_f32 v[174:175], v[54:55], v[248:249], v[174:175] op_sel_hi:[1,0,1]
v_pk_fma_f32 v[186:187], v[6:7], v[246:247], v[186:187] op_sel_hi:[1,0,1]
v_pk_fma_f32 v[190:191], v[6:7], v[248:249], v[190:191] op_sel_hi:[1,0,1]
v_pk_fma_f32 v[200:201], v[56:57], v[246:247], v[200:201] op_sel_hi:[1,0,1]
v_pk_fma_f32 v[204:205], v[56:57], v[248:249], v[204:205] op_sel_hi:[1,0,1]
v_pk_fma_f32 v[216:217], v[8:9], v[246:247], v[216:217] op_sel_hi:[1,0,1]
v_pk_fma_f32 v[220:221], v[8:9], v[248:249], v[220:221] op_sel_hi:[1,0,1]
v_pk_fma_f32 v[202:203], v[58:59], v[246:247], v[202:203] op_sel_hi:[1,0,1]
v_pk_fma_f32 v[206:207], v[58:59], v[248:249], v[206:207] op_sel_hi:[1,0,1]
v_pk_fma_f32 v[218:219], v[10:11], v[246:247], v[218:219] op_sel_hi:[1,0,1]
v_pk_fma_f32 v[222:223], v[10:11], v[248:249], v[222:223] op_sel_hi:[1,0,1]
v_pk_mul_f32 v[168:169], v[168:169], v[200:201]
v_pk_mul_f32 v[172:173], v[172:173], v[204:205]
v_pk_mul_f32 v[184:185], v[184:185], v[216:217]
v_pk_mul_f32 v[188:189], v[188:189], v[220:221]
v_pk_mul_f32 v[170:171], v[170:171], v[202:203]
v_pk_mul_f32 v[174:175], v[174:175], v[206:207]
v_pk_mul_f32 v[186:187], v[186:187], v[218:219]
v_pk_mul_f32 v[190:191], v[190:191], v[222:223]
v_pk_mul_f32 v[168:169], v[168:169], v[246:247] op_sel:[0,1] op_sel_hi:[1,1]
v_pk_mul_f32 v[172:173], v[172:173], v[248:249] op_sel:[0,1] op_sel_hi:[1,1]
v_pk_mul_f32 v[184:185], v[184:185], v[246:247] op_sel:[0,1] op_sel_hi:[1,1]
v_pk_mul_f32 v[188:189], v[188:189], v[248:249] op_sel:[0,1] op_sel_hi:[1,1]
v_pk_mul_f32 v[170:171], v[170:171], v[246:247] op_sel:[0,1] op_sel_hi:[1,1]
v_pk_mul_f32 v[174:175], v[174:175], v[248:249] op_sel:[0,1] op_sel_hi:[1,1]
v_pk_mul_f32 v[186:187], v[186:187], v[246:247] op_sel:[0,1] op_sel_hi:[1,1]
v_pk_mul_f32 v[190:191], v[190:191], v[248:249] op_sel:[0,1] op_sel_hi:[1,1]
v_cvt_pk_bf16_f32 v200, v168, v169
v_cvt_pk_bf16_f32 v204, v172, v173
v_cvt_pk_bf16_f32 v202, v184, v185
v_cvt_pk_bf16_f32 v206, v188, v189
v_cvt_pk_bf16_f32 v201, v170, v171
v_cvt_pk_bf16_f32 v205, v174, v175
v_cvt_pk_bf16_f32 v203, v186, v187
v_cvt_pk_bf16_f32 v207, v190, v191
s_add_u32 s60, s65, 1024
buffer_store_dwordx4 v[200:203], v241, s[24:27], s60 offen sc1
s_add_u32 s60, s65, 74752
buffer_store_dwordx4 v[204:207], v241, s[24:27], s60 offen sc1
v_pk_fma_f32 v[64:65], v[60:61], v[242:243], v[64:65] op_sel_hi:[1,0,1]
v_pk_fma_f32 v[68:69], v[60:61], v[244:245], v[68:69] op_sel_hi:[1,0,1]
v_pk_fma_f32 v[72:73], v[60:61], v[246:247], v[72:73] op_sel_hi:[1,0,1]
v_pk_fma_f32 v[76:77], v[60:61], v[248:249], v[76:77] op_sel_hi:[1,0,1]
v_pk_fma_f32 v[66:67], v[62:63], v[242:243], v[66:67] op_sel_hi:[1,0,1]
v_pk_fma_f32 v[70:71], v[62:63], v[244:245], v[70:71] op_sel_hi:[1,0,1]
v_pk_fma_f32 v[74:75], v[62:63], v[246:247], v[74:75] op_sel_hi:[1,0,1]
v_pk_fma_f32 v[78:79], v[62:63], v[248:249], v[78:79] op_sel_hi:[1,0,1]
v_pk_fma_f32 v[80:81], v[2:3], v[242:243], v[80:81] op_sel_hi:[1,0,1]
v_pk_fma_f32 v[84:85], v[2:3], v[244:245], v[84:85] op_sel_hi:[1,0,1]
v_pk_fma_f32 v[88:89], v[2:3], v[246:247], v[88:89] op_sel_hi:[1,0,1]
v_pk_fma_f32 v[92:93], v[2:3], v[248:249], v[92:93] op_sel_hi:[1,0,1]
v_pk_fma_f32 v[82:83], v[254:255], v[242:243], v[82:83] op_sel_hi:[1,0,1]
v_pk_fma_f32 v[86:87], v[254:255], v[244:245], v[86:87] op_sel_hi:[1,0,1]
v_pk_fma_f32 v[90:91], v[254:255], v[246:247], v[90:91] op_sel_hi:[1,0,1]
v_pk_fma_f32 v[94:95], v[254:255], v[248:249], v[94:95] op_sel_hi:[1,0,1]
v_cvt_pk_bf16_f32 v176, v64, v65
v_cvt_pk_bf16_f32 v180, v68, v69
v_cvt_pk_bf16_f32 v184, v72, v73
v_cvt_pk_bf16_f32 v188, v76, v77
v_cvt_pk_bf16_f32 v177, v66, v67
v_cvt_pk_bf16_f32 v181, v70, v71
v_cvt_pk_bf16_f32 v185, v74, v75
v_cvt_pk_bf16_f32 v189, v78, v79
v_cvt_pk_bf16_f32 v178, v80, v81
v_cvt_pk_bf16_f32 v182, v84, v85
v_cvt_pk_bf16_f32 v186, v88, v89
v_cvt_pk_bf16_f32 v190, v92, v93
v_cvt_pk_bf16_f32 v179, v82, v83
v_cvt_pk_bf16_f32 v183, v86, v87
v_cvt_pk_bf16_f32 v187, v90, v91
v_cvt_pk_bf16_f32 v191, v94, v95
v_lshrrev_b32 v61, 4, v1
v_lshlrev_b32 v61, 4, v61
v_add_u32 v61, 139392, v61
ds_read_b128 v[88:91], v61 offset:192
ds_read_b128 v[92:95], v61 offset:1152
ds_read_b128 v[64:67], v61 offset:0
ds_read_b128 v[68:71], v61 offset:960
ds_read_b128 v[72:75], v61 offset:64
ds_read_b128 v[76:79], v61 offset:1024
ds_read_b128 v[80:83], v61 offset:128
ds_read_b128 v[84:87], v61 offset:1088
v_sub_f32 v24, 0, v24
v_pk_fma_f32 v[96:97], v[12:13], v[242:243], v[96:97] op_sel_hi:[1,0,1]
v_pk_fma_f32 v[100:101], v[12:13], v[244:245], v[100:101] op_sel_hi:[1,0,1]
v_pk_fma_f32 v[104:105], v[12:13], v[246:247], v[104:105] op_sel_hi:[1,0,1]
v_pk_fma_f32 v[108:109], v[12:13], v[248:249], v[108:109] op_sel_hi:[1,0,1]
v_pk_fma_f32 v[224:225], v[12:13], v[24:25], v[224:225] op_sel_hi:[1,0,1]
v_pk_fma_f32 v[98:99], v[14:15], v[242:243], v[98:99] op_sel_hi:[1,0,1]
v_pk_fma_f32 v[102:103], v[14:15], v[244:245], v[102:103] op_sel_hi:[1,0,1]
v_pk_fma_f32 v[106:107], v[14:15], v[246:247], v[106:107] op_sel_hi:[1,0,1]
v_pk_fma_f32 v[110:111], v[14:15], v[248:249], v[110:111] op_sel_hi:[1,0,1]
v_pk_fma_f32 v[226:227], v[14:15], v[24:25], v[226:227] op_sel_hi:[1,0,1]
v_pk_fma_f32 v[112:113], v[16:17], v[242:243], v[112:113] op_sel_hi:[1,0,1]
v_pk_fma_f32 v[116:117], v[16:17], v[244:245], v[116:117] op_sel_hi:[1,0,1]
v_pk_fma_f32 v[120:121], v[16:17], v[246:247], v[120:121] op_sel_hi:[1,0,1]
v_pk_fma_f32 v[124:125], v[16:17], v[248:249], v[124:125] op_sel_hi:[1,0,1]
v_pk_fma_f32 v[228:229], v[16:17], v[24:25], v[228:229] op_sel_hi:[1,0,1]
v_pk_fma_f32 v[114:115], v[18:19], v[242:243], v[114:115] op_sel_hi:[1,0,1]
v_pk_fma_f32 v[118:119], v[18:19], v[244:245], v[118:119] op_sel_hi:[1,0,1]
v_pk_fma_f32 v[122:123], v[18:19], v[246:247], v[122:123] op_sel_hi:[1,0,1]
v_pk_fma_f32 v[126:127], v[18:19], v[248:249], v[126:127] op_sel_hi:[1,0,1]
v_pk_fma_f32 v[230:231], v[18:19], v[24:25], v[230:231] op_sel_hi:[1,0,1]
v_pk_mul_f32 v[96:97], v[96:97], v[26:27] op_sel:[0,1] op_sel_hi:[1,1]
v_pk_mul_f32 v[100:101], v[100:101], v[28:29] op_sel:[0,1] op_sel_hi:[1,1]
v_pk_mul_f32 v[104:105], v[104:105], v[30:31] op_sel:[0,1] op_sel_hi:[1,1]
v_pk_mul_f32 v[108:109], v[108:109], v[32:33] op_sel:[0,1] op_sel_hi:[1,1]
v_pk_mul_f32 v[224:225], v[224:225], v[24:25] op_sel:[0,1] op_sel_hi:[1,1]
v_pk_mul_f32 v[98:99], v[98:99], v[26:27] op_sel:[0,1] op_sel_hi:[1,1]
v_pk_mul_f32 v[102:103], v[102:103], v[28:29] op_sel:[0,1] op_sel_hi:[1,1]
v_pk_mul_f32 v[106:107], v[106:107], v[30:31] op_sel:[0,1] op_sel_hi:[1,1]
v_pk_mul_f32 v[110:111], v[110:111], v[32:33] op_sel:[0,1] op_sel_hi:[1,1]
v_pk_mul_f32 v[226:227], v[226:227], v[24:25] op_sel:[0,1] op_sel_hi:[1,1]
v_pk_mul_f32 v[112:113], v[112:113], v[26:27] op_sel:[0,1] op_sel_hi:[1,1]
v_pk_mul_f32 v[116:117], v[116:117], v[28:29] op_sel:[0,1] op_sel_hi:[1,1]
v_pk_mul_f32 v[120:121], v[120:121], v[30:31] op_sel:[0,1] op_sel_hi:[1,1]
v_pk_mul_f32 v[124:125], v[124:125], v[32:33] op_sel:[0,1] op_sel_hi:[1,1]
v_pk_mul_f32 v[228:229], v[228:229], v[24:25] op_sel:[0,1] op_sel_hi:[1,1]
v_pk_mul_f32 v[114:115], v[114:115], v[26:27] op_sel:[0,1] op_sel_hi:[1,1]
v_pk_mul_f32 v[118:119], v[118:119], v[28:29] op_sel:[0,1] op_sel_hi:[1,1]
v_pk_mul_f32 v[122:123], v[122:123], v[30:31] op_sel:[0,1] op_sel_hi:[1,1]
v_pk_mul_f32 v[126:127], v[126:127], v[32:33] op_sel:[0,1] op_sel_hi:[1,1]
v_pk_mul_f32 v[230:231], v[230:231], v[24:25] op_sel:[0,1] op_sel_hi:[1,1]
v_cvt_pk_bf16_f32 v196, v96, v97
v_cvt_pk_bf16_f32 v200, v100, v101
v_cvt_pk_bf16_f32 v204, v104, v105
v_cvt_pk_bf16_f32 v208, v108, v109
v_cvt_pk_bf16_f32 v192, v224, v225
v_cvt_pk_bf16_f32 v197, v98, v99
v_cvt_pk_bf16_f32 v201, v102, v103
v_cvt_pk_bf16_f32 v205, v106, v107
v_cvt_pk_bf16_f32 v209, v110, v111
v_cvt_pk_bf16_f32 v193, v226, v227
v_cvt_pk_bf16_f32 v198, v112, v113
v_cvt_pk_bf16_f32 v202, v116, v117
v_cvt_pk_bf16_f32 v206, v120, v121
v_cvt_pk_bf16_f32 v210, v124, v125
v_cvt_pk_bf16_f32 v194, v228, v229
v_cvt_pk_bf16_f32 v199, v114, v115
v_cvt_pk_bf16_f32 v203, v118, v119
v_cvt_pk_bf16_f32 v207, v122, v123
v_cvt_pk_bf16_f32 v211, v126, v127
v_cvt_pk_bf16_f32 v195, v230, v231
v_and_b32 v198, v50, v198
v_and_b32 v202, v50, v202
v_and_b32 v206, v50, v206
v_and_b32 v210, v50, v210
v_and_b32 v194, v50, v194
v_and_b32 v199, v50, v199
v_and_b32 v203, v50, v203
v_and_b32 v207, v50, v207
v_and_b32 v211, v50, v211
v_and_b32 v195, v50, v195
v_sub_f32 v20, 0, v20
v_sub_f32 v22, 0, v22
s_lshl_b32 s60, s48, 10
s_add_u32 s60, s60, 141312
v_add_u32 v21, s60, v241
s_waitcnt lgkmcnt(0)
v_pk_fma_f32 v[140:141], v[88:89], v[20:21], v[140:141] op_sel_hi:[1,0,1]
v_pk_fma_f32 v[142:143], v[90:91], v[20:21], v[142:143] op_sel_hi:[1,0,1]
v_pk_fma_f32 v[156:157], v[88:89], v[22:23], v[156:157] op_sel_hi:[1,0,1]
v_pk_fma_f32 v[158:159], v[90:91], v[22:23], v[158:159] op_sel_hi:[1,0,1]
v_pk_mul_f32 v[140:141], v[140:141], v[92:93]
v_pk_mul_f32 v[142:143], v[142:143], v[94:95]
v_pk_mul_f32 v[156:157], v[156:157], v[92:93]
v_pk_mul_f32 v[158:159], v[158:159], v[94:95]
v_cvt_pk_bf16_f32 v220, v140, v141
v_cvt_pk_bf16_f32 v221, v142, v143
v_cvt_pk_bf16_f32 v168, v156, v157
v_cvt_pk_bf16_f32 v169, v158, v159
ds_write_b128 v21, v[208:211]
ds_write_b64 v21, v[220:221] offset:2048
ds_write_b64 v21, v[168:169] offset:2056
v_pk_fma_f32 v[128:129], v[64:65], v[20:21], v[128:129] op_sel_hi:[1,0,1]
v_pk_fma_f32 v[132:133], v[72:73], v[20:21], v[132:133] op_sel_hi:[1,0,1]
v_pk_fma_f32 v[136:137], v[80:81], v[20:21], v[136:137] op_sel_hi:[1,0,1]
v_pk_fma_f32 v[130:131], v[66:67], v[20:21], v[130:131] op_sel_hi:[1,0,1]
v_pk_fma_f32 v[134:135], v[74:75], v[20:21], v[134:135] op_sel_hi:[1,0,1]
v_pk_fma_f32 v[138:139], v[82:83], v[20:21], v[138:139] op_sel_hi:[1,0,1]
v_pk_fma_f32 v[144:145], v[64:65], v[22:23], v[144:145] op_sel_hi:[1,0,1]
v_pk_fma_f32 v[148:149], v[72:73], v[22:23], v[148:149] op_sel_hi:[1,0,1]
v_pk_fma_f32 v[152:153], v[80:81], v[22:23], v[152:153] op_sel_hi:[1,0,1]
v_pk_fma_f32 v[146:147], v[66:67], v[22:23], v[146:147] op_sel_hi:[1,0,1]
v_pk_fma_f32 v[150:151], v[74:75], v[22:23], v[150:151] op_sel_hi:[1,0,1]
v_pk_fma_f32 v[154:155], v[82:83], v[22:23], v[154:155] op_sel_hi:[1,0,1]
v_pk_mul_f32 v[128:129], v[128:129], v[68:69]
v_pk_mul_f32 v[132:133], v[132:133], v[76:77]
v_pk_mul_f32 v[136:137], v[136:137], v[84:85]
v_pk_mul_f32 v[130:131], v[130:131], v[70:71]
v_pk_mul_f32 v[134:135], v[134:135], v[78:79]
v_pk_mul_f32 v[138:139], v[138:139], v[86:87]
v_pk_mul_f32 v[144:145], v[144:145], v[68:69]
v_pk_mul_f32 v[148:149], v[148:149], v[76:77]
v_pk_mul_f32 v[152:153], v[152:153], v[84:85]
v_pk_mul_f32 v[146:147], v[146:147], v[70:71]
v_pk_mul_f32 v[150:151], v[150:151], v[78:79]
v_pk_mul_f32 v[154:155], v[154:155], v[86:87]
v_cvt_pk_bf16_f32 v214, v128, v129
v_cvt_pk_bf16_f32 v216, v132, v133
v_cvt_pk_bf16_f32 v218, v136, v137
v_cvt_pk_bf16_f32 v215, v130, v131
v_cvt_pk_bf16_f32 v217, v134, v135
v_cvt_pk_bf16_f32 v219, v138, v139
v_cvt_pk_bf16_f32 v162, v144, v145
v_cvt_pk_bf16_f32 v164, v148, v149
v_cvt_pk_bf16_f32 v166, v152, v153
v_cvt_pk_bf16_f32 v163, v146, v147
v_cvt_pk_bf16_f32 v165, v150, v151
v_cvt_pk_bf16_f32 v167, v154, v155
s_waitcnt lgkmcnt(0)
s_barrier
ds_read_b64 v[212:213], v21 offset:4096
ds_read_b64 v[160:161], v21 offset:4104
s_mov_b32 s62, 0x3e8b97f6
v_mul_f32 v80, s62, v27
v_mul_f32 v81, s62, v29
v_mul_f32 v82, s62, v31
v_mul_f32 v83, s62, v33
v_mfma_f32_16x16x32_bf16 v[116:119], v[200:203], v[180:183], v[38:41]
v_mfma_f32_16x16x32_bf16 v[112:115], v[196:199], v[180:183], v[34:37]
v_mfma_f32_16x16x32_bf16 v[132:135], v[204:207], v[184:187], v[38:41]
v_mfma_f32_16x16x32_bf16 v[128:131], v[200:203], v[184:187], v[34:37]
v_mfma_f32_16x16x32_bf16 v[148:151], v[208:211], v[188:191], v[38:41]
v_mfma_f32_16x16x32_bf16 v[144:147], v[204:207], v[188:191], v[34:37]
v_mfma_f32_16x16x32_bf16 v[100:103], v[196:199], v[176:179], v[38:41]
v_mfma_f32_16x16x32_bf16 v[96:99], v[192:195], v[176:179], v[42:45]
s_nop 1
v_max3_f32 v124, v112, v113, v114
s_nop 0
v_max3_f32 v140, v128, v129, v130
s_nop 0
v_max3_f32 v156, v144, v145, v146
s_nop 0
v_max3_f32 v108, v96, v97, v98
v_max3_f32 v125, v115, v116, v117
v_max3_f32 v141, v131, v132, v133
v_max3_f32 v157, v147, v148, v149
v_max3_f32 v109, v99, v100, v101
v_max3_f32 v124, v124, v118, v119
v_max3_f32 v140, v140, v134, v135
v_max3_f32 v156, v156, v150, v151
v_max3_f32 v108, v108, v102, v103
v_max_f32 v124, v124, v125
v_max_f32 v140, v140, v141
v_max_f32 v156, v156, v157
v_max_f32 v108, v108, v109
v_mov_b32 v125, v124
v_mov_b32 v141, v140
v_mov_b32 v157, v156
v_mov_b32 v109, v108
v_permlane32_swap_b32 v124, v125
v_permlane32_swap_b32 v140, v141
v_permlane32_swap_b32 v156, v157
v_permlane32_swap_b32 v108, v109
v_max_f32 v124, v124, v125
v_max_f32 v140, v140, v141
v_max_f32 v156, v156, v157
v_max_f32 v108, v108, v109
v_mov_b32 v125, v124
v_mov_b32 v141, v140
v_mov_b32 v157, v156
v_mov_b32 v109, v108
v_permlane16_swap_b32 v124, v125
v_permlane16_swap_b32 v140, v141
v_permlane16_swap_b32 v156, v157
v_permlane16_swap_b32 v108, v109
v_max_f32 v124, v124, v125
v_max_f32 v140, v140, v141
v_max_f32 v156, v156, v157
v_max_f32 v108, v108, v109
v_mul_f32 v126, v124, v81
v_mul_f32 v142, v140, v82
v_mul_f32 v158, v156, v83
v_mul_f32 v110, v108, v80
v_fma_f32 v112, v112, v81, -v126
v_fma_f32 v128, v128, v82, -v142
v_fma_f32 v144, v144, v83, -v158
v_fma_f32 v96, v96, v80, -v110
v_fma_f32 v113, v113, v81, -v126
v_fma_f32 v129, v129, v82, -v142
v_fma_f32 v145, v145, v83, -v158
v_fma_f32 v97, v97, v80, -v110
v_fma_f32 v114, v114, v81, -v126
v_fma_f32 v130, v130, v82, -v142
v_fma_f32 v146, v146, v83, -v158
v_fma_f32 v98, v98, v80, -v110
v_fma_f32 v115, v115, v81, -v126
v_fma_f32 v131, v131, v82, -v142
v_fma_f32 v147, v147, v83, -v158
v_fma_f32 v99, v99, v80, -v110
v_fma_f32 v116, v116, v81, -v126
v_fma_f32 v132, v132, v82, -v142
v_fma_f32 v148, v148, v83, -v158
v_fma_f32 v100, v100, v80, -v110
v_fma_f32 v117, v117, v81, -v126
v_fma_f32 v133, v133, v82, -v142
v_fma_f32 v149, v149, v83, -v158
v_fma_f32 v101, v101, v80, -v110
v_fma_f32 v118, v118, v81, -v126
v_fma_f32 v134, v134, v82, -v142
v_fma_f32 v150, v150, v83, -v158
v_fma_f32 v102, v102, v80, -v110
v_fma_f32 v119, v119, v81, -v126
v_fma_f32 v135, v135, v82, -v142
v_fma_f32 v151, v151, v83, -v158
v_fma_f32 v103, v103, v80, -v110
v_exp_f32 v112, v112
v_exp_f32 v128, v128
v_exp_f32 v144, v144
v_exp_f32 v96, v96
v_exp_f32 v113, v113
v_exp_f32 v129, v129
v_exp_f32 v145, v145
v_exp_f32 v97, v97
v_exp_f32 v114, v114
v_exp_f32 v130, v130
v_exp_f32 v146, v146
v_exp_f32 v98, v98
v_exp_f32 v115, v115
v_exp_f32 v131, v131
v_exp_f32 v147, v147
v_exp_f32 v99, v99
v_exp_f32 v116, v116
v_exp_f32 v132, v132
v_exp_f32 v148, v148
v_exp_f32 v100, v100
v_exp_f32 v117, v117
v_exp_f32 v133, v133
v_exp_f32 v149, v149
v_exp_f32 v101, v101
v_exp_f32 v118, v118
v_exp_f32 v134, v134
v_exp_f32 v150, v150
v_exp_f32 v102, v102
v_exp_f32 v119, v119
v_exp_f32 v135, v135
v_exp_f32 v151, v151
v_exp_f32 v103, v103
v_cvt_pk_bf16_f32 v120, v112, v113
v_cvt_pk_bf16_f32 v136, v128, v129
v_cvt_pk_bf16_f32 v152, v144, v145
v_cvt_pk_bf16_f32 v104, v96, v97
v_cvt_pk_bf16_f32 v121, v114, v115
v_cvt_pk_bf16_f32 v137, v130, v131
v_cvt_pk_bf16_f32 v153, v146, v147
v_cvt_pk_bf16_f32 v105, v98, v99
v_cvt_pk_bf16_f32 v122, v116, v117
v_cvt_pk_bf16_f32 v138, v132, v133
v_cvt_pk_bf16_f32 v154, v148, v149
v_cvt_pk_bf16_f32 v106, v100, v101
v_cvt_pk_bf16_f32 v123, v118, v119
v_cvt_pk_bf16_f32 v139, v134, v135
v_cvt_pk_bf16_f32 v155, v150, v151
v_cvt_pk_bf16_f32 v107, v102, v103
s_waitcnt lgkmcnt(0)
v_mfma_f32_16x16x32_bf16 v[124:127], v[46:49], v[120:123], 0
v_mfma_f32_16x16x32_bf16 v[112:115], v[214:217], v[120:123], 0
v_mfma_f32_16x16x32_bf16 v[116:119], v[162:165], v[120:123], 0
v_mfma_f32_16x16x32_bf16 v[140:143], v[46:49], v[136:139], 0
v_mfma_f32_16x16x32_bf16 v[128:131], v[216:219], v[136:139], 0
v_mfma_f32_16x16x32_bf16 v[132:135], v[164:167], v[136:139], 0
v_mfma_f32_16x16x32_bf16 v[156:159], v[46:49], v[152:155], 0
v_mfma_f32_16x16x32_bf16 v[144:147], v[218:221], v[152:155], 0
v_mfma_f32_16x16x32_bf16 v[148:151], v[166:169], v[152:155], 0
v_mfma_f32_16x16x32_bf16 v[108:111], v[46:49], v[104:107], 0
v_mfma_f32_16x16x32_bf16 v[96:99], v[212:215], v[104:107], 0
v_mfma_f32_16x16x32_bf16 v[100:103], v[160:163], v[104:107], 0
v_rcp_f32 v124, v124
v_rcp_f32 v140, v140
s_nop 0
v_rcp_f32 v156, v156
s_nop 1
v_rcp_f32 v108, v108
v_mul_f32 v125, v124, v51
v_mul_f32 v141, v140, v51
v_mul_f32 v157, v156, v51
v_mul_f32 v109, v108, v51
v_mul_f32 v112, v112, v124
v_mul_f32 v128, v128, v140
v_mul_f32 v144, v144, v156
v_mul_f32 v96, v96, v108
v_mul_f32 v113, v113, v124
v_mul_f32 v129, v129, v140
v_mul_f32 v145, v145, v156
v_mul_f32 v97, v97, v108
v_mul_f32 v114, v114, v124
v_mul_f32 v130, v130, v140
v_mul_f32 v146, v146, v156
v_mul_f32 v98, v98, v108
v_mul_f32 v115, v115, v124
v_mul_f32 v131, v131, v140
v_mul_f32 v147, v147, v156
v_mul_f32 v99, v99, v108
v_mul_f32 v116, v116, v125
v_mul_f32 v132, v132, v141
v_mul_f32 v148, v148, v157
v_mul_f32 v100, v100, v109
v_mul_f32 v117, v117, v125
v_mul_f32 v133, v133, v141
v_mul_f32 v149, v149, v157
v_mul_f32 v101, v101, v109
v_mul_f32 v118, v118, v125
v_mul_f32 v134, v134, v141
v_mul_f32 v150, v150, v157
v_mul_f32 v102, v102, v109
v_mul_f32 v119, v119, v125
v_mul_f32 v135, v135, v141
v_mul_f32 v151, v151, v157
v_mul_f32 v103, v103, v109
v_cvt_pk_bf16_f32 v120, v112, v113
v_cvt_pk_bf16_f32 v136, v128, v129
v_cvt_pk_bf16_f32 v152, v144, v145
v_cvt_pk_bf16_f32 v104, v96, v97
v_cvt_pk_bf16_f32 v121, v114, v115
v_cvt_pk_bf16_f32 v137, v130, v131
v_cvt_pk_bf16_f32 v153, v146, v147
v_cvt_pk_bf16_f32 v105, v98, v99
v_cvt_pk_bf16_f32 v122, v116, v117
v_cvt_pk_bf16_f32 v138, v132, v133
v_cvt_pk_bf16_f32 v154, v148, v149
v_cvt_pk_bf16_f32 v106, v100, v101
v_cvt_pk_bf16_f32 v123, v118, v119
v_cvt_pk_bf16_f32 v139, v134, v135
v_cvt_pk_bf16_f32 v155, v150, v151
v_cvt_pk_bf16_f32 v107, v102, v103
s_add_u32 s60, s64, 73728
buffer_store_dwordx4 v[120:123], v241, s[24:27], s60 offen sc1
s_add_u32 s60, s65, 0
buffer_store_dwordx4 v[136:139], v241, s[24:27], s60 offen sc1
s_add_u32 s60, s65, 73728
buffer_store_dwordx4 v[152:155], v241, s[24:27], s60 offen sc1
s_add_u32 s60, s64, 0
buffer_store_dwordx4 v[104:107], v241, s[24:27], s60 offen sc1
s_lshr_b32 s60, s68, 2
s_add_u32 s61, s68, 2
s_lshr_b32 s61, s61, 2
v_mov_b32 v60, s60
v_mov_b32 v61, s61
v_cmp_gt_u32 vcc, 8, v1
s_nop 0
s_nop 0
v_cndmask_b32 v60, v61, v60, vcc
v_and_b32 v61, 3, v1
v_lshlrev_b32 v61, 2, v61
v_lshl_add_u32 v61, v60, 7, v61
v_bfe_u32 v60, v1, 2, 1
v_lshl_add_u32 v11, v60, 6, v61
v_cmp_gt_u32 vcc, 16, v1
v_mov_b32 v61, 2146435072
s_nop 0
v_cndmask_b32 v11, v61, v11, vcc
v_bfe_u32 v60, v1, 1, 2
v_cndmask_b32 v60, 7, v60, vcc
v_cmp_eq_u32 vcc, 1, v60
s_nop 1
v_cndmask_b32_e64 v12, 0, 1, vcc
v_cmp_eq_u32 vcc, 3, v60
s_nop 1
v_cndmask_b32_e64 v13, 0, 1, vcc
v_cmp_eq_u32 vcc, 0, v60
s_nop 1
v_cndmask_b32_e64 v14, 0, 1, vcc
v_cmp_eq_u32 vcc, 2, v60
s_nop 1
v_cndmask_b32_e64 v15, 0, 1, vcc
s_add_u32 s3, s70, 802816
s_add_u32 m0, s74, 20480
s_nop 0
buffer_load_dwordx4 v232, s[36:39], s3 offen lds
buffer_load_dwordx4 v233, s[36:39], s3 offen offset:1024 lds
buffer_load_dwordx4 v234, s[36:39], s3 offen offset:2048 lds
buffer_load_dwordx4 v235, s[36:39], s3 offen offset:3072 lds
s_add_u32 s3, s70, 831488
s_add_u32 m0, s74, 81920
s_nop 0
buffer_load_dwordx4 v232, s[36:39], s3 offen lds
buffer_load_dwordx4 v233, s[36:39], s3 offen offset:1024 lds
buffer_load_dwordx4 v234, s[36:39], s3 offen offset:2048 lds
buffer_load_dwordx4 v235, s[36:39], s3 offen offset:3072 lds
s_waitcnt vmcnt(8)
v_mov_b32 v62, 1
v_mov_b32 v63, 0
buffer_store_dword v62, v63, s[24:27], s77 offen sc1
ds_read_b64_tr_b16 a[0:1], v236 offset:40960
ds_read_b64_tr_b16 a[2:3], v236 offset:43008
ds_read_b64_tr_b16 a[4:5], v237 offset:40960
ds_read_b64_tr_b16 a[6:7], v237 offset:43008
ds_read_b64_tr_b16 a[8:9], v238 offset:40960
ds_read_b64_tr_b16 a[10:11], v238 offset:43008
ds_read_b64_tr_b16 a[12:13], v239 offset:40960
ds_read_b64_tr_b16 a[14:15], v239 offset:43008
ds_read_b64_tr_b16 a[16:17], v250 offset:34816
ds_read_b64_tr_b16 a[18:19], v250 offset:36864
ds_read_b64_tr_b16 a[20:21], v251 offset:34816
ds_read_b64_tr_b16 a[22:23], v251 offset:36864
ds_read_b64_tr_b16 a[24:25], v252 offset:34816
ds_read_b64_tr_b16 a[26:27], v252 offset:36864
ds_read_b64_tr_b16 a[28:29], v253 offset:34816
ds_read_b64_tr_b16 a[30:31], v253 offset:36864
s_waitcnt lgkmcnt(8)
s_add_u32 s3, s70, 860160
s_add_u32 m0, s74, 40960
s_nop 0
buffer_load_dwordx4 v232, s[36:39], s3 offen lds
buffer_load_dwordx4 v233, s[36:39], s3 offen offset:1024 lds
buffer_load_dwordx4 v234, s[36:39], s3 offen offset:2048 lds
buffer_load_dwordx4 v235, s[36:39], s3 offen offset:3072 lds
ds_read_b64_tr_b16 a[32:33], v236 offset:61440
ds_read_b64_tr_b16 a[34:35], v236 offset:63488
ds_read_b64_tr_b16 a[36:37], v237 offset:61440
ds_read_b64_tr_b16 a[38:39], v237 offset:63488
ds_read_b64_tr_b16 a[40:41], v238 offset:61440
ds_read_b64_tr_b16 a[42:43], v238 offset:63488
ds_read_b64_tr_b16 a[44:45], v239 offset:61440
ds_read_b64_tr_b16 a[46:47], v239 offset:63488
s_waitcnt lgkmcnt(8)
s_add_u32 s3, s70, 888832
s_add_u32 m0, s74, 100352
s_nop 0
buffer_load_dwordx4 v232, s[36:39], s3 offen lds
buffer_load_dwordx4 v233, s[36:39], s3 offen offset:1024 lds
buffer_load_dwordx4 v234, s[36:39], s3 offen offset:2048 lds
buffer_load_dwordx4 v235, s[36:39], s3 offen offset:3072 lds
ds_read_b64_tr_b16 a[48:49], v250 offset:53248
ds_read_b64_tr_b16 a[50:51], v250 offset:55296
ds_read_b64_tr_b16 a[52:53], v251 offset:53248
ds_read_b64_tr_b16 a[54:55], v251 offset:55296
ds_read_b64_tr_b16 a[56:57], v252 offset:53248
ds_read_b64_tr_b16 a[58:59], v252 offset:55296
ds_read_b64_tr_b16 a[60:61], v253 offset:53248
ds_read_b64_tr_b16 a[62:63], v253 offset:55296
s_waitcnt lgkmcnt(8)
s_add_u32 s3, s70, 917504
s_add_u32 m0, s74, 61440
s_nop 0
buffer_load_dwordx4 v232, s[36:39], s3 offen lds
buffer_load_dwordx4 v233, s[36:39], s3 offen offset:1024 lds
buffer_load_dwordx4 v234, s[36:39], s3 offen offset:2048 lds
buffer_load_dwordx4 v235, s[36:39], s3 offen offset:3072 lds
ds_read_b64_tr_b16 a[64:65], v236 offset:0
ds_read_b64_tr_b16 a[66:67], v236 offset:2048
ds_read_b64_tr_b16 a[68:69], v237 offset:0
ds_read_b64_tr_b16 a[70:71], v237 offset:2048
ds_read_b64_tr_b16 a[72:73], v238 offset:0
ds_read_b64_tr_b16 a[74:75], v238 offset:2048
ds_read_b64_tr_b16 a[76:77], v239 offset:0
ds_read_b64_tr_b16 a[78:79], v239 offset:2048
s_waitcnt lgkmcnt(8)
s_add_u32 s3, s71, 0
s_add_u32 m0, s74, 118784
s_nop 0
buffer_load_dwordx4 v232, s[36:39], s3 offen lds
buffer_load_dwordx4 v233, s[36:39], s3 offen offset:1024 lds
buffer_load_dwordx4 v234, s[36:39], s3 offen offset:2048 lds
buffer_load_dwordx4 v235, s[36:39], s3 offen offset:3072 lds
s_waitcnt vmcnt(21)
ds_read_b64_tr_b16 a[80:81], v236 offset:20480
ds_read_b64_tr_b16 a[82:83], v236 offset:22528
ds_read_b64_tr_b16 a[84:85], v237 offset:20480
ds_read_b64_tr_b16 a[86:87], v237 offset:22528
ds_read_b64_tr_b16 a[88:89], v238 offset:20480
ds_read_b64_tr_b16 a[90:91], v238 offset:22528
ds_read_b64_tr_b16 a[92:93], v239 offset:20480
ds_read_b64_tr_b16 a[94:95], v239 offset:22528
s_waitcnt lgkmcnt(8)
s_add_u32 s3, s71, 28672
s_add_u32 m0, s74, 0
s_nop 0
buffer_load_dwordx4 v232, s[36:39], s3 offen lds
buffer_load_dwordx4 v233, s[36:39], s3 offen offset:1024 lds
buffer_load_dwordx4 v234, s[36:39], s3 offen offset:2048 lds
buffer_load_dwordx4 v235, s[36:39], s3 offen offset:3072 lds
s_waitcnt vmcnt(21)
ds_read_b64_tr_b16 a[96:97], v250 offset:16384
ds_read_b64_tr_b16 a[98:99], v250 offset:18432
ds_read_b64_tr_b16 a[100:101], v251 offset:16384
ds_read_b64_tr_b16 a[102:103], v251 offset:18432
ds_read_b64_tr_b16 a[104:105], v252 offset:16384
ds_read_b64_tr_b16 a[106:107], v252 offset:18432
ds_read_b64_tr_b16 a[108:109], v253 offset:16384
ds_read_b64_tr_b16 a[110:111], v253 offset:18432
s_waitcnt lgkmcnt(8)
s_add_u32 s3, s72, 0
s_add_u32 m0, s74, 20480
s_nop 0
buffer_load_dwordx4 v232, s[32:35], s3 offen lds
buffer_load_dwordx4 v233, s[32:35], s3 offen offset:1024 lds
buffer_load_dwordx4 v234, s[32:35], s3 offen offset:2048 lds
buffer_load_dwordx4 v235, s[32:35], s3 offen offset:3072 lds
s_waitcnt vmcnt(20)
ds_read_b64_tr_b16 a[112:113], v236 offset:40960
ds_read_b64_tr_b16 a[114:115], v236 offset:43008
ds_read_b64_tr_b16 a[116:117], v237 offset:40960
ds_read_b64_tr_b16 a[118:119], v237 offset:43008
ds_read_b64_tr_b16 a[120:121], v238 offset:40960
ds_read_b64_tr_b16 a[122:123], v238 offset:43008
ds_read_b64_tr_b16 a[124:125], v239 offset:40960
ds_read_b64_tr_b16 a[126:127], v239 offset:43008
s_waitcnt lgkmcnt(8)
s_add_u32 s3, s72, 25088
s_add_u32 m0, s74, 81920
s_nop 0
buffer_load_dwordx4 v232, s[32:35], s3 offen lds
buffer_load_dwordx4 v233, s[32:35], s3 offen offset:1024 lds
buffer_load_dwordx4 v234, s[32:35], s3 offen offset:2048 lds
buffer_load_dwordx4 v235, s[32:35], s3 offen offset:3072 lds
s_waitcnt vmcnt(20)
ds_read_b64_tr_b16 a[128:129], v250 offset:34816
ds_read_b64_tr_b16 a[130:131], v250 offset:36864
ds_read_b64_tr_b16 a[132:133], v251 offset:34816
ds_read_b64_tr_b16 a[134:135], v251 offset:36864
ds_read_b64_tr_b16 a[136:137], v252 offset:34816
ds_read_b64_tr_b16 a[138:139], v252 offset:36864
ds_read_b64_tr_b16 a[140:141], v253 offset:34816
ds_read_b64_tr_b16 a[142:143], v253 offset:36864
s_waitcnt lgkmcnt(8)
s_add_u32 s3, s71, 802816
s_add_u32 m0, s74, 40960
s_nop 0
buffer_load_dwordx4 v232, s[36:39], s3 offen lds
buffer_load_dwordx4 v233, s[36:39], s3 offen offset:1024 lds
buffer_load_dwordx4 v234, s[36:39], s3 offen offset:2048 lds
buffer_load_dwordx4 v235, s[36:39], s3 offen offset:3072 lds
s_waitcnt vmcnt(20)
ds_read_b64_tr_b16 a[144:145], v236 offset:61440
ds_read_b64_tr_b16 a[146:147], v236 offset:63488
ds_read_b64_tr_b16 a[148:149], v237 offset:61440
ds_read_b64_tr_b16 a[150:151], v237 offset:63488
ds_read_b64_tr_b16 a[152:153], v238 offset:61440
ds_read_b64_tr_b16 a[154:155], v238 offset:63488
ds_read_b64_tr_b16 a[156:157], v239 offset:61440
ds_read_b64_tr_b16 a[158:159], v239 offset:63488
s_waitcnt lgkmcnt(8)
s_add_u32 s3, s71, 831488
s_add_u32 m0, s74, 100352
s_nop 0
buffer_load_dwordx4 v232, s[36:39], s3 offen lds
buffer_load_dwordx4 v233, s[36:39], s3 offen offset:1024 lds
buffer_load_dwordx4 v234, s[36:39], s3 offen offset:2048 lds
buffer_load_dwordx4 v235, s[36:39], s3 offen offset:3072 lds
s_waitcnt vmcnt(20)
ds_read_b64_tr_b16 a[160:161], v250 offset:53248
ds_read_b64_tr_b16 a[162:163], v250 offset:55296
ds_read_b64_tr_b16 a[164:165], v251 offset:53248
ds_read_b64_tr_b16 a[166:167], v251 offset:55296
ds_read_b64_tr_b16 a[168:169], v252 offset:53248
ds_read_b64_tr_b16 a[170:171], v252 offset:55296
ds_read_b64_tr_b16 a[172:173], v253 offset:53248
ds_read_b64_tr_b16 a[174:175], v253 offset:55296
s_waitcnt lgkmcnt(8)
s_add_u32 s3, s72, 200704
s_add_u32 m0, s74, 61440
s_nop 0
buffer_load_dwordx4 v232, s[32:35], s3 offen lds
buffer_load_dwordx4 v233, s[32:35], s3 offen offset:1024 lds
buffer_load_dwordx4 v234, s[32:35], s3 offen offset:2048 lds
buffer_load_dwordx4 v235, s[32:35], s3 offen offset:3072 lds
s_waitcnt vmcnt(20)
ds_read_b64_tr_b16 a[176:177], v236 offset:0
ds_read_b64_tr_b16 a[178:179], v236 offset:2048
ds_read_b64_tr_b16 a[180:181], v237 offset:0
ds_read_b64_tr_b16 a[182:183], v237 offset:2048
ds_read_b64_tr_b16 a[184:185], v238 offset:0
buffer_load_dword v10, v11, s[24:27], s79 offen sc1
ds_read_b64_tr_b16 a[186:187], v238 offset:2048
ds_read_b64_tr_b16 a[188:189], v239 offset:0
ds_read_b64_tr_b16 a[190:191], v239 offset:2048
s_waitcnt lgkmcnt(8)
s_add_u32 s3, s72, 225792
s_add_u32 m0, s74, 118784
s_nop 0
buffer_load_dwordx4 v232, s[32:35], s3 offen lds
buffer_load_dwordx4 v233, s[32:35], s3 offen offset:1024 lds
buffer_load_dwordx4 v234, s[32:35], s3 offen offset:2048 lds
buffer_load_dwordx4 v235, s[32:35], s3 offen offset:3072 lds
s_waitcnt vmcnt(4)
v_cmp_lt_u32 vcc, v10, v12
s_nop 0
s_cmp_eq_u64 vcc, 0
s_cbranch_scc0 L_flg_slow_13
L_flg_back_14:
s_add_u32 s60, s73, 4096
buffer_load_dwordx4 v[128:131], v241, s[24:27], s60 offen sc1
s_add_u32 s60, s73, 77824
buffer_load_dwordx4 v[132:135], v241, s[24:27], s60 offen sc1
s_add_u32 s60, s73, 151552
buffer_load_dwordx4 v[136:139], v241, s[24:27], s60 offen sc1
s_add_u32 s60, s73, 5120
buffer_load_dwordx4 v[140:143], v241, s[24:27], s60 offen sc1
s_add_u32 s60, s73, 78848
buffer_load_dwordx4 v[144:147], v241, s[24:27], s60 offen sc1
s_add_u32 s60, s73, 152576
buffer_load_dwordx4 v[148:151], v241, s[24:27], s60 offen sc1
buffer_load_dword v10, v11, s[24:27], s79 offen sc1
s_add_u32 s60, s73, 6144
buffer_load_dwordx4 v[152:155], v241, s[24:27], s60 offen sc1
s_add_u32 s60, s73, 79872
buffer_load_dwordx4 v[156:159], v241, s[24:27], s60 offen sc1
s_add_u32 s60, s73, 153600
buffer_load_dwordx4 v[160:163], v241, s[24:27], s60 offen sc1
s_add_u32 s60, s73, 7168
buffer_load_dwordx4 v[164:167], v241, s[24:27], s60 offen sc1
s_add_u32 s60, s73, 80896
buffer_load_dwordx4 v[168:171], v241, s[24:27], s60 offen sc1
s_add_u32 s60, s73, 154624
buffer_load_dwordx4 v[172:175], v241, s[24:27], s60 offen sc1
s_add_u32 s60, s73, 8192
buffer_load_dwordx4 v[176:179], v241, s[24:27], s60 offen sc1
s_add_u32 s60, s73, 81920
buffer_load_dwordx4 v[180:183], v241, s[24:27], s60 offen sc1
s_add_u32 s60, s73, 155648
buffer_load_dwordx4 v[184:187], v241, s[24:27], s60 offen sc1
ds_read_b64_tr_b16 a[192:193], v236 offset:20480
ds_read_b64_tr_b16 a[194:195], v236 offset:22528
ds_read_b64_tr_b16 a[196:197], v237 offset:20480
ds_read_b64_tr_b16 a[198:199], v237 offset:22528
ds_read_b64_tr_b16 a[200:201], v238 offset:20480
ds_read_b64_tr_b16 a[202:203], v238 offset:22528
ds_read_b64_tr_b16 a[204:205], v239 offset:20480
ds_read_b64_tr_b16 a[206:207], v239 offset:22528
ds_read_b64_tr_b16 a[208:209], v250 offset:16384
ds_read_b64_tr_b16 a[210:211], v250 offset:18432
ds_read_b64_tr_b16 a[212:213], v251 offset:16384
ds_read_b64_tr_b16 a[214:215], v251 offset:18432
ds_read_b64_tr_b16 a[216:217], v252 offset:16384
ds_read_b64_tr_b16 a[218:219], v252 offset:18432
ds_read_b64_tr_b16 a[220:221], v253 offset:16384
ds_read_b64_tr_b16 a[222:223], v253 offset:18432
ds_read_b64_tr_b16 a[224:225], v236 offset:40960
ds_read_b64_tr_b16 a[226:227], v236 offset:43008
ds_read_b64_tr_b16 a[228:229], v237 offset:40960
ds_read_b64_tr_b16 a[230:231], v237 offset:43008
ds_read_b64_tr_b16 a[232:233], v238 offset:40960
ds_read_b64_tr_b16 a[234:235], v238 offset:43008
ds_read_b64_tr_b16 a[236:237], v239 offset:40960
ds_read_b64_tr_b16 a[238:239], v239 offset:43008
ds_read_b64_tr_b16 a[240:241], v250 offset:34816
ds_read_b64_tr_b16 a[242:243], v250 offset:36864
ds_read_b64_tr_b16 a[244:245], v251 offset:34816
ds_read_b64_tr_b16 a[246:247], v251 offset:36864
ds_read_b64_tr_b16 a[248:249], v252 offset:34816
ds_read_b64_tr_b16 a[250:251], v252 offset:36864
ds_read_b64_tr_b16 a[252:253], v253 offset:34816
ds_read_b64_tr_b16 a[254:255], v253 offset:36864
ds_read_b64_tr_b16 v[192:193], v236 offset:61440
ds_read_b64_tr_b16 v[194:195], v236 offset:63488
ds_read_b64_tr_b16 v[196:197], v237 offset:61440
ds_read_b64_tr_b16 v[198:199], v237 offset:63488
ds_read_b64_tr_b16 v[200:201], v238 offset:61440
ds_read_b64_tr_b16 v[202:203], v238 offset:63488
ds_read_b64_tr_b16 v[204:205], v239 offset:61440
ds_read_b64_tr_b16 v[206:207], v239 offset:63488
s_waitcnt vmcnt(16)
ds_read_b64_tr_b16 v[208:209], v250 offset:53248
ds_read_b64_tr_b16 v[210:211], v250 offset:55296
ds_read_b64_tr_b16 v[212:213], v251 offset:53248
ds_read_b64_tr_b16 v[214:215], v251 offset:55296
ds_read_b64_tr_b16 v[216:217], v252 offset:53248
ds_read_b64_tr_b16 v[218:219], v252 offset:55296
ds_read_b64_tr_b16 v[220:221], v253 offset:53248
ds_read_b64_tr_b16 v[222:223], v253 offset:55296
s_waitcnt vmcnt(9)
v_cmp_lt_u32 vcc, v10, v13
s_nop 0
s_cmp_eq_u64 vcc, 0
s_cbranch_scc0 L_flg_slow_16
L_flg_back_17:
s_add_u32 s60, s73, 40960
buffer_load_dwordx4 v[188:191], v241, s[24:27], s60 offen sc1
v_and_b32 v34, 15, v1
v_mul_u32_u24 v35, 0x110, v34
v_lshrrev_b32 v36, 4, v1
v_lshl_add_u32 v35, v36, 4, v35
s_mul_i32 s61, s46, 17408
v_add_u32 v38, s61, v35
s_mul_i32 s61, s46, 4352
v_add_u32 v39, s61, v35
s_add_u32 s61, s68, s46
s_lshl_b32 s61, s61, 4
v_add_u32 v34, s61, v34
v_mul_u32_u24 v34, 0x380, v34
v_and_b32 v37, 1, v36
v_lshlrev_b32 v37, 1, v37
v_lshrrev_b32 v36, 1, v36
v_or_b32 v36, v36, v37
v_lshl_add_u32 v34, v36, 4, v34
s_lshl_b32 s61, s69, 7
v_add_u32 v40, s61, v34
v_mfma_f32_16x16x32_bf16 v[64:67], a[0:3], v[128:131], 0
v_mfma_f32_16x16x32_bf16 v[80:83], a[4:7], v[128:131], 0
v_mfma_f32_16x16x32_bf16 v[96:99], a[8:11], v[128:131], 0
v_mfma_f32_16x16x32_bf16 v[112:115], a[12:15], v[128:131], 0
s_add_u32 s60, s73, 114688
buffer_load_dwordx4 v[128:131], v241, s[24:27], s60 offen sc1
v_mfma_f32_16x16x32_bf16 v[68:71], a[0:3], v[132:135], 0
v_mfma_f32_16x16x32_bf16 v[84:87], a[4:7], v[132:135], 0
v_mfma_f32_16x16x32_bf16 v[100:103], a[8:11], v[132:135], 0
v_mfma_f32_16x16x32_bf16 v[116:119], a[12:15], v[132:135], 0
s_add_u32 s60, s73, 188416
buffer_load_dwordx4 v[132:135], v241, s[24:27], s60 offen sc1
v_mfma_f32_16x16x32_bf16 v[72:75], a[0:3], v[136:139], 0
v_mfma_f32_16x16x32_bf16 v[88:91], a[4:7], v[136:139], 0
v_mfma_f32_16x16x32_bf16 v[104:107], a[8:11], v[136:139], 0
v_mfma_f32_16x16x32_bf16 v[120:123], a[12:15], v[136:139], 0
s_add_u32 s60, s73, 41984
buffer_load_dwordx4 v[136:139], v241, s[24:27], s60 offen sc1
v_mfma_f32_16x16x32_bf16 v[64:67], a[16:19], v[140:143], v[64:67]
v_mfma_f32_16x16x32_bf16 v[80:83], a[20:23], v[140:143], v[80:83]
v_mfma_f32_16x16x32_bf16 v[96:99], a[24:27], v[140:143], v[96:99]
v_mfma_f32_16x16x32_bf16 v[112:115], a[28:31], v[140:143], v[112:115]
s_add_u32 s60, s73, 115712
buffer_load_dwordx4 v[140:143], v241, s[24:27], s60 offen sc1
v_mfma_f32_16x16x32_bf16 v[68:71], a[16:19], v[144:147], v[68:71]
v_mfma_f32_16x16x32_bf16 v[84:87], a[20:23], v[144:147], v[84:87]
v_mfma_f32_16x16x32_bf16 v[100:103], a[24:27], v[144:147], v[100:103]
v_mfma_f32_16x16x32_bf16 v[116:119], a[28:31], v[144:147], v[116:119]
s_add_u32 s60, s73, 189440
buffer_load_dwordx4 v[144:147], v241, s[24:27], s60 offen sc1
buffer_load_dword v10, v11, s[24:27], s79 offen sc1
v_mfma_f32_16x16x32_bf16 v[72:75], a[16:19], v[148:151], v[72:75]
v_mfma_f32_16x16x32_bf16 v[88:91], a[20:23], v[148:151], v[88:91]
v_mfma_f32_16x16x32_bf16 v[104:107], a[24:27], v[148:151], v[104:107]
v_mfma_f32_16x16x32_bf16 v[120:123], a[28:31], v[148:151], v[120:123]
s_add_u32 s60, s73, 43008
buffer_load_dwordx4 v[148:151], v241, s[24:27], s60 offen sc1
s_waitcnt vmcnt(16)
v_mfma_f32_16x16x32_bf16 v[64:67], a[32:35], v[152:155], v[64:67]
v_mfma_f32_16x16x32_bf16 v[80:83], a[36:39], v[152:155], v[80:83]
v_mfma_f32_16x16x32_bf16 v[96:99], a[40:43], v[152:155], v[96:99]
v_mfma_f32_16x16x32_bf16 v[112:115], a[44:47], v[152:155], v[112:115]
s_add_u32 s60, s73, 116736
buffer_load_dwordx4 v[152:155], v241, s[24:27], s60 offen sc1
s_waitcnt vmcnt(16)
v_mfma_f32_16x16x32_bf16 v[68:71], a[32:35], v[156:159], v[68:71]
v_mfma_f32_16x16x32_bf16 v[84:87], a[36:39], v[156:159], v[84:87]
v_mfma_f32_16x16x32_bf16 v[100:103], a[40:43], v[156:159], v[100:103]
v_mfma_f32_16x16x32_bf16 v[116:119], a[44:47], v[156:159], v[116:119]
s_add_u32 s60, s73, 190464
buffer_load_dwordx4 v[156:159], v241, s[24:27], s60 offen sc1
s_waitcnt vmcnt(16)
v_mfma_f32_16x16x32_bf16 v[72:75], a[32:35], v[160:163], v[72:75]
v_mfma_f32_16x16x32_bf16 v[88:91], a[36:39], v[160:163], v[88:91]
v_mfma_f32_16x16x32_bf16 v[104:107], a[40:43], v[160:163], v[104:107]
v_mfma_f32_16x16x32_bf16 v[120:123], a[44:47], v[160:163], v[120:123]
s_add_u32 s60, s73, 44032
buffer_load_dwordx4 v[160:163], v241, s[24:27], s60 offen sc1
s_waitcnt vmcnt(16)
v_mfma_f32_16x16x32_bf16 v[64:67], a[48:51], v[164:167], v[64:67]
v_mfma_f32_16x16x32_bf16 v[80:83], a[52:55], v[164:167], v[80:83]
v_mfma_f32_16x16x32_bf16 v[96:99], a[56:59], v[164:167], v[96:99]
v_mfma_f32_16x16x32_bf16 v[112:115], a[60:63], v[164:167], v[112:115]
s_add_u32 s60, s73, 117760
buffer_load_dwordx4 v[164:167], v241, s[24:27], s60 offen sc1
s_waitcnt vmcnt(16)
v_mfma_f32_16x16x32_bf16 v[68:71], a[48:51], v[168:171], v[68:71]
v_mfma_f32_16x16x32_bf16 v[84:87], a[52:55], v[168:171], v[84:87]
v_mfma_f32_16x16x32_bf16 v[100:103], a[56:59], v[168:171], v[100:103]
v_mfma_f32_16x16x32_bf16 v[116:119], a[60:63], v[168:171], v[116:119]
s_add_u32 s60, s73, 191488
buffer_load_dwordx4 v[168:171], v241, s[24:27], s60 offen sc1
s_waitcnt vmcnt(16)
v_mfma_f32_16x16x32_bf16 v[72:75], a[48:51], v[172:175], v[72:75]
v_mfma_f32_16x16x32_bf16 v[88:91], a[52:55], v[172:175], v[88:91]
v_mfma_f32_16x16x32_bf16 v[104:107], a[56:59], v[172:175], v[104:107]
v_mfma_f32_16x16x32_bf16 v[120:123], a[60:63], v[172:175], v[120:123]
s_add_u32 s60, s73, 45056
buffer_load_dwordx4 v[172:175], v241, s[24:27], s60 offen sc1
s_waitcnt vmcnt(16)
v_mfma_f32_16x16x32_bf16 v[64:67], a[64:67], v[176:179], v[64:67]
v_mfma_f32_16x16x32_bf16 v[80:83], a[68:71], v[176:179], v[80:83]
v_mfma_f32_16x16x32_bf16 v[96:99], a[72:75], v[176:179], v[96:99]
v_mfma_f32_16x16x32_bf16 v[112:115], a[76:79], v[176:179], v[112:115]
s_add_u32 s60, s73, 118784
buffer_load_dwordx4 v[176:179], v241, s[24:27], s60 offen sc1
s_waitcnt vmcnt(16)
v_mfma_f32_16x16x32_bf16 v[68:71], a[64:67], v[180:183], v[68:71]
v_mfma_f32_16x16x32_bf16 v[84:87], a[68:71], v[180:183], v[84:87]
v_mfma_f32_16x16x32_bf16 v[100:103], a[72:75], v[180:183], v[100:103]
v_mfma_f32_16x16x32_bf16 v[116:119], a[76:79], v[180:183], v[116:119]
s_add_u32 s60, s73, 192512
buffer_load_dwordx4 v[180:183], v241, s[24:27], s60 offen sc1
s_waitcnt vmcnt(16)
v_mfma_f32_16x16x32_bf16 v[72:75], a[64:67], v[184:187], v[72:75]
v_mfma_f32_16x16x32_bf16 v[88:91], a[68:71], v[184:187], v[88:91]
v_mfma_f32_16x16x32_bf16 v[104:107], a[72:75], v[184:187], v[104:107]
v_mfma_f32_16x16x32_bf16 v[120:123], a[76:79], v[184:187], v[120:123]
s_waitcnt vmcnt(9)
v_cmp_lt_u32 vcc, v10, v14
s_nop 0
s_cmp_eq_u64 vcc, 0
s_cbranch_scc0 L_flg_slow_19
L_flg_back_20:
s_add_u32 s60, s73, 1024
buffer_load_dwordx4 v[184:187], v241, s[24:27], s60 offen sc1
v_mfma_f32_16x16x32_bf16 v[64:67], a[80:83], v[188:191], v[64:67]
v_mfma_f32_16x16x32_bf16 v[80:83], a[84:87], v[188:191], v[80:83]
v_mfma_f32_16x16x32_bf16 v[96:99], a[88:91], v[188:191], v[96:99]
v_mfma_f32_16x16x32_bf16 v[112:115], a[92:95], v[188:191], v[112:115]
s_add_u32 s60, s73, 74752
buffer_load_dwordx4 v[188:191], v241, s[24:27], s60 offen sc1
v_mfma_f32_16x16x32_bf16 v[68:71], a[80:83], v[128:131], v[68:71]
v_mfma_f32_16x16x32_bf16 v[84:87], a[84:87], v[128:131], v[84:87]
v_mfma_f32_16x16x32_bf16 v[100:103], a[88:91], v[128:131], v[100:103]
v_mfma_f32_16x16x32_bf16 v[116:119], a[92:95], v[128:131], v[116:119]
s_add_u32 s60, s73, 148480
buffer_load_dwordx4 v[128:131], v241, s[24:27], s60 offen sc1
buffer_load_dword v10, v11, s[24:27], s79 offen sc1
v_mfma_f32_16x16x32_bf16 v[72:75], a[80:83], v[132:135], v[72:75]
v_mfma_f32_16x16x32_bf16 v[88:91], a[84:87], v[132:135], v[88:91]
v_mfma_f32_16x16x32_bf16 v[104:107], a[88:91], v[132:135], v[104:107]
v_mfma_f32_16x16x32_bf16 v[120:123], a[92:95], v[132:135], v[120:123]
s_add_u32 s60, s73, 3072
buffer_load_dwordx4 v[132:135], v241, s[24:27], s60 offen sc1
v_mfma_f32_16x16x32_bf16 v[64:67], a[96:99], v[136:139], v[64:67]
v_mfma_f32_16x16x32_bf16 v[80:83], a[100:103], v[136:139], v[80:83]
v_mfma_f32_16x16x32_bf16 v[96:99], a[104:107], v[136:139], v[96:99]
v_mfma_f32_16x16x32_bf16 v[112:115], a[108:111], v[136:139], v[112:115]
s_add_u32 s60, s73, 76800
buffer_load_dwordx4 v[136:139], v241, s[24:27], s60 offen sc1
v_mfma_f32_16x16x32_bf16 v[68:71], a[96:99], v[140:143], v[68:71]
v_mfma_f32_16x16x32_bf16 v[84:87], a[100:103], v[140:143], v[84:87]
v_mfma_f32_16x16x32_bf16 v[100:103], a[104:107], v[140:143], v[100:103]
v_mfma_f32_16x16x32_bf16 v[116:119], a[108:111], v[140:143], v[116:119]
s_add_u32 s60, s73, 150528
buffer_load_dwordx4 v[140:143], v241, s[24:27], s60 offen sc1
v_mfma_f32_16x16x32_bf16 v[72:75], a[96:99], v[144:147], v[72:75]
v_mfma_f32_16x16x32_bf16 v[88:91], a[100:103], v[144:147], v[88:91]
v_mfma_f32_16x16x32_bf16 v[104:107], a[104:107], v[144:147], v[104:107]
v_mfma_f32_16x16x32_bf16 v[120:123], a[108:111], v[144:147], v[120:123]
s_add_u32 s60, s73, 0
buffer_load_dwordx4 v[144:147], v241, s[24:27], s60 offen sc1
s_waitcnt vmcnt(16)
v_mfma_f32_16x16x32_bf16 v[64:67], a[112:115], v[148:151], v[64:67]
v_mfma_f32_16x16x32_bf16 v[80:83], a[116:119], v[148:151], v[80:83]
v_mfma_f32_16x16x32_bf16 v[96:99], a[120:123], v[148:151], v[96:99]
v_mfma_f32_16x16x32_bf16 v[112:115], a[124:127], v[148:151], v[112:115]
s_add_u32 s60, s73, 73728
buffer_load_dwordx4 v[148:151], v241, s[24:27], s60 offen sc1
s_waitcnt vmcnt(16)
v_mfma_f32_16x16x32_bf16 v[68:71], a[112:115], v[152:155], v[68:71]
v_mfma_f32_16x16x32_bf16 v[84:87], a[116:119], v[152:155], v[84:87]
v_mfma_f32_16x16x32_bf16 v[100:103], a[120:123], v[152:155], v[100:103]
v_mfma_f32_16x16x32_bf16 v[116:119], a[124:127], v[152:155], v[116:119]
s_add_u32 s60, s73, 147456
buffer_load_dwordx4 v[152:155], v241, s[24:27], s60 offen sc1
s_waitcnt vmcnt(16)
v_mfma_f32_16x16x32_bf16 v[72:75], a[112:115], v[156:159], v[72:75]
v_mfma_f32_16x16x32_bf16 v[88:91], a[116:119], v[156:159], v[88:91]
v_mfma_f32_16x16x32_bf16 v[104:107], a[120:123], v[156:159], v[104:107]
v_mfma_f32_16x16x32_bf16 v[120:123], a[124:127], v[156:159], v[120:123]
s_add_u32 s60, s73, 2048
buffer_load_dwordx4 v[156:159], v241, s[24:27], s60 offen sc1
s_waitcnt vmcnt(16)
v_mfma_f32_16x16x32_bf16 v[64:67], a[128:131], v[160:163], v[64:67]
v_mfma_f32_16x16x32_bf16 v[80:83], a[132:135], v[160:163], v[80:83]
v_mfma_f32_16x16x32_bf16 v[96:99], a[136:139], v[160:163], v[96:99]
v_mfma_f32_16x16x32_bf16 v[112:115], a[140:143], v[160:163], v[112:115]
s_add_u32 s60, s73, 75776
buffer_load_dwordx4 v[160:163], v241, s[24:27], s60 offen sc1
s_waitcnt vmcnt(16)
v_mfma_f32_16x16x32_bf16 v[68:71], a[128:131], v[164:167], v[68:71]
v_mfma_f32_16x16x32_bf16 v[84:87], a[132:135], v[164:167], v[84:87]
v_mfma_f32_16x16x32_bf16 v[100:103], a[136:139], v[164:167], v[100:103]
v_mfma_f32_16x16x32_bf16 v[116:119], a[140:143], v[164:167], v[116:119]
s_add_u32 s60, s73, 149504
buffer_load_dwordx4 v[164:167], v241, s[24:27], s60 offen sc1
s_waitcnt vmcnt(16)
v_mfma_f32_16x16x32_bf16 v[72:75], a[128:131], v[168:171], v[72:75]
v_mfma_f32_16x16x32_bf16 v[88:91], a[132:135], v[168:171], v[88:91]
v_mfma_f32_16x16x32_bf16 v[104:107], a[136:139], v[168:171], v[104:107]
v_mfma_f32_16x16x32_bf16 v[120:123], a[140:143], v[168:171], v[120:123]
s_waitcnt vmcnt(9)
v_cmp_lt_u32 vcc, v10, v15
s_nop 0
s_cmp_eq_u64 vcc, 0
s_cbranch_scc0 L_flg_slow_22
L_flg_back_23:
s_add_u32 s60, s73, 37888
buffer_load_dwordx4 v[168:171], v241, s[24:27], s60 offen sc1
v_mfma_f32_16x16x32_bf16 v[64:67], a[144:147], v[172:175], v[64:67]
v_mfma_f32_16x16x32_bf16 v[80:83], a[148:151], v[172:175], v[80:83]
v_mfma_f32_16x16x32_bf16 v[96:99], a[152:155], v[172:175], v[96:99]
v_mfma_f32_16x16x32_bf16 v[112:115], a[156:159], v[172:175], v[112:115]
s_add_u32 s60, s73, 39936
buffer_load_dwordx4 v[172:175], v241, s[24:27], s60 offen sc1
v_mfma_f32_16x16x32_bf16 v[68:71], a[144:147], v[176:179], v[68:71]
v_mfma_f32_16x16x32_bf16 v[84:87], a[148:151], v[176:179], v[84:87]
v_mfma_f32_16x16x32_bf16 v[100:103], a[152:155], v[176:179], v[100:103]
v_mfma_f32_16x16x32_bf16 v[116:119], a[156:159], v[176:179], v[116:119]
s_add_u32 s60, s73, 36864
buffer_load_dwordx4 v[176:179], v241, s[24:27], s60 offen sc1
v_mfma_f32_16x16x32_bf16 v[72:75], a[144:147], v[180:183], v[72:75]
v_mfma_f32_16x16x32_bf16 v[88:91], a[148:151], v[180:183], v[88:91]
v_mfma_f32_16x16x32_bf16 v[104:107], a[152:155], v[180:183], v[104:107]
v_mfma_f32_16x16x32_bf16 v[120:123], a[156:159], v[180:183], v[120:123]
s_add_u32 s60, s73, 38912
buffer_load_dwordx4 v[180:183], v241, s[24:27], s60 offen sc1
v_mfma_f32_16x16x32_bf16 v[64:67], a[160:163], v[184:187], v[64:67]
v_mfma_f32_16x16x32_bf16 v[80:83], a[164:167], v[184:187], v[80:83]
v_mfma_f32_16x16x32_bf16 v[96:99], a[168:171], v[184:187], v[96:99]
v_mfma_f32_16x16x32_bf16 v[112:115], a[172:175], v[184:187], v[112:115]
s_add_u32 s60, s73, 111616
buffer_load_dwordx4 v[184:187], v241, s[24:27], s60 offen sc1
v_mfma_f32_16x16x32_bf16 v[68:71], a[160:163], v[188:191], v[68:71]
v_mfma_f32_16x16x32_bf16 v[84:87], a[164:167], v[188:191], v[84:87]
v_mfma_f32_16x16x32_bf16 v[100:103], a[168:171], v[188:191], v[100:103]
v_mfma_f32_16x16x32_bf16 v[116:119], a[172:175], v[188:191], v[116:119]
s_add_u32 s60, s73, 113664
buffer_load_dwordx4 v[188:191], v241, s[24:27], s60 offen sc1
v_mfma_f32_16x16x32_bf16 v[72:75], a[160:163], v[128:131], v[72:75]
v_mfma_f32_16x16x32_bf16 v[88:91], a[164:167], v[128:131], v[88:91]
v_mfma_f32_16x16x32_bf16 v[104:107], a[168:171], v[128:131], v[104:107]
v_mfma_f32_16x16x32_bf16 v[120:123], a[172:175], v[128:131], v[120:123]
s_add_u32 s60, s73, 110592
buffer_load_dwordx4 v[128:131], v241, s[24:27], s60 offen sc1
s_waitcnt vmcnt(15)
v_mfma_f32_16x16x32_bf16 v[64:67], a[176:179], v[132:135], v[64:67]
v_mfma_f32_16x16x32_bf16 v[80:83], a[180:183], v[132:135], v[80:83]
v_mfma_f32_16x16x32_bf16 v[96:99], a[184:187], v[132:135], v[96:99]
v_mfma_f32_16x16x32_bf16 v[112:115], a[188:191], v[132:135], v[112:115]
s_add_u32 s60, s73, 112640
buffer_load_dwordx4 v[132:135], v241, s[24:27], s60 offen sc1
s_waitcnt vmcnt(15)
v_mfma_f32_16x16x32_bf16 v[68:71], a[176:179], v[136:139], v[68:71]
v_mfma_f32_16x16x32_bf16 v[84:87], a[180:183], v[136:139], v[84:87]
v_mfma_f32_16x16x32_bf16 v[100:103], a[184:187], v[136:139], v[100:103]
v_mfma_f32_16x16x32_bf16 v[116:119], a[188:191], v[136:139], v[116:119]
s_add_u32 s60, s73, 185344
buffer_load_dwordx4 v[136:139], v241, s[24:27], s60 offen sc1
s_waitcnt vmcnt(15)
v_mfma_f32_16x16x32_bf16 v[72:75], a[176:179], v[140:143], v[72:75]
v_mfma_f32_16x16x32_bf16 v[88:91], a[180:183], v[140:143], v[88:91]
v_mfma_f32_16x16x32_bf16 v[104:107], a[184:187], v[140:143], v[104:107]
v_mfma_f32_16x16x32_bf16 v[120:123], a[188:191], v[140:143], v[120:123]
s_add_u32 s60, s73, 187392
buffer_load_dwordx4 v[140:143], v241, s[24:27], s60 offen sc1
s_waitcnt vmcnt(15)
v_mfma_f32_16x16x32_bf16 v[64:67], a[192:195], v[144:147], v[64:67]
v_mfma_f32_16x16x32_bf16 v[80:83], a[196:199], v[144:147], v[80:83]
v_mfma_f32_16x16x32_bf16 v[96:99], a[200:203], v[144:147], v[96:99]
v_mfma_f32_16x16x32_bf16 v[112:115], a[204:207], v[144:147], v[112:115]
s_add_u32 s60, s73, 184320
buffer_load_dwordx4 v[144:147], v241, s[24:27], s60 offen sc1
s_waitcnt vmcnt(15)
v_mfma_f32_16x16x32_bf16 v[68:71], a[192:195], v[148:151], v[68:71]
v_mfma_f32_16x16x32_bf16 v[84:87], a[196:199], v[148:151], v[84:87]
v_mfma_f32_16x16x32_bf16 v[100:103], a[200:203], v[148:151], v[100:103]
v_mfma_f32_16x16x32_bf16 v[116:119], a[204:207], v[148:151], v[116:119]
s_add_u32 s60, s73, 186368
buffer_load_dwordx4 v[148:151], v241, s[24:27], s60 offen sc1
buffer_load_dwordx4 v[44:47], v40, s[8:11], 0 offen
buffer_load_dwordx4 v[48:51], v40, s[8:11], 0 offen offset:64
s_waitcnt vmcnt(17)
v_mfma_f32_16x16x32_bf16 v[72:75], a[192:195], v[152:155], v[72:75]
v_mfma_f32_16x16x32_bf16 v[88:91], a[196:199], v[152:155], v[88:91]
v_mfma_f32_16x16x32_bf16 v[104:107], a[200:203], v[152:155], v[104:107]
v_mfma_f32_16x16x32_bf16 v[120:123], a[204:207], v[152:155], v[120:123]
s_waitcnt vmcnt(16)
v_mfma_f32_16x16x32_bf16 v[64:67], a[208:211], v[156:159], v[64:67]
v_mfma_f32_16x16x32_bf16 v[80:83], a[212:215], v[156:159], v[80:83]
v_mfma_f32_16x16x32_bf16 v[96:99], a[216:219], v[156:159], v[96:99]
v_mfma_f32_16x16x32_bf16 v[112:115], a[220:223], v[156:159], v[112:115]
s_waitcnt vmcnt(15)
v_mfma_f32_16x16x32_bf16 v[68:71], a[208:211], v[160:163], v[68:71]
v_mfma_f32_16x16x32_bf16 v[84:87], a[212:215], v[160:163], v[84:87]
v_mfma_f32_16x16x32_bf16 v[100:103], a[216:219], v[160:163], v[100:103]
v_mfma_f32_16x16x32_bf16 v[116:119], a[220:223], v[160:163], v[116:119]
s_waitcnt vmcnt(14)
v_mfma_f32_16x16x32_bf16 v[72:75], a[208:211], v[164:167], v[72:75]
v_mfma_f32_16x16x32_bf16 v[88:91], a[212:215], v[164:167], v[88:91]
v_mfma_f32_16x16x32_bf16 v[104:107], a[216:219], v[164:167], v[104:107]
v_mfma_f32_16x16x32_bf16 v[120:123], a[220:223], v[164:167], v[120:123]
s_barrier
s_waitcnt vmcnt(13)
v_mfma_f32_16x16x32_bf16 v[64:67], a[224:227], v[168:171], v[64:67]
v_mfma_f32_16x16x32_bf16 v[80:83], a[228:231], v[168:171], v[80:83]
v_mfma_f32_16x16x32_bf16 v[96:99], a[232:235], v[168:171], v[96:99]
v_mfma_f32_16x16x32_bf16 v[112:115], a[236:239], v[168:171], v[112:115]
s_waitcnt vmcnt(12)
v_mfma_f32_16x16x32_bf16 v[64:67], a[240:243], v[172:175], v[64:67]
v_mfma_f32_16x16x32_bf16 v[80:83], a[244:247], v[172:175], v[80:83]
v_mfma_f32_16x16x32_bf16 v[96:99], a[248:251], v[172:175], v[96:99]
v_mfma_f32_16x16x32_bf16 v[112:115], a[252:255], v[172:175], v[112:115]
s_waitcnt vmcnt(11)
v_mfma_f32_16x16x32_bf16 v[64:67], v[192:195], v[176:179], v[64:67]
v_mfma_f32_16x16x32_bf16 v[80:83], v[196:199], v[176:179], v[80:83]
v_mfma_f32_16x16x32_bf16 v[96:99], v[200:203], v[176:179], v[96:99]
v_mfma_f32_16x16x32_bf16 v[112:115], v[204:207], v[176:179], v[112:115]
s_waitcnt vmcnt(10)
v_mfma_f32_16x16x32_bf16 v[64:67], v[208:211], v[180:183], v[64:67]
v_mfma_f32_16x16x32_bf16 v[80:83], v[212:215], v[180:183], v[80:83]
v_mfma_f32_16x16x32_bf16 v[96:99], v[216:219], v[180:183], v[96:99]
v_mfma_f32_16x16x32_bf16 v[112:115], v[220:223], v[180:183], v[112:115]
s_waitcnt vmcnt(9)
v_mfma_f32_16x16x32_bf16 v[68:71], a[224:227], v[184:187], v[68:71]
v_mfma_f32_16x16x32_bf16 v[84:87], a[228:231], v[184:187], v[84:87]
v_mfma_f32_16x16x32_bf16 v[100:103], a[232:235], v[184:187], v[100:103]
v_mfma_f32_16x16x32_bf16 v[116:119], a[236:239], v[184:187], v[116:119]
ds_write_b128 v38, v[64:67] offset:0
s_waitcnt vmcnt(8)
v_mfma_f32_16x16x32_bf16 v[68:71], a[240:243], v[188:191], v[68:71]
v_mfma_f32_16x16x32_bf16 v[84:87], a[244:247], v[188:191], v[84:87]
v_mfma_f32_16x16x32_bf16 v[100:103], a[248:251], v[188:191], v[100:103]
v_mfma_f32_16x16x32_bf16 v[116:119], a[252:255], v[188:191], v[116:119]
ds_write_b128 v38, v[80:83] offset:64
s_waitcnt vmcnt(7)
v_mfma_f32_16x16x32_bf16 v[68:71], v[192:195], v[128:131], v[68:71]
v_mfma_f32_16x16x32_bf16 v[84:87], v[196:199], v[128:131], v[84:87]
v_mfma_f32_16x16x32_bf16 v[100:103], v[200:203], v[128:131], v[100:103]
v_mfma_f32_16x16x32_bf16 v[116:119], v[204:207], v[128:131], v[116:119]
ds_write_b128 v38, v[96:99] offset:128
s_waitcnt vmcnt(6)
v_mfma_f32_16x16x32_bf16 v[68:71], v[208:211], v[132:135], v[68:71]
v_mfma_f32_16x16x32_bf16 v[84:87], v[212:215], v[132:135], v[84:87]
v_mfma_f32_16x16x32_bf16 v[100:103], v[216:219], v[132:135], v[100:103]
v_mfma_f32_16x16x32_bf16 v[116:119], v[220:223], v[132:135], v[116:119]
ds_write_b128 v38, v[112:115] offset:192
s_waitcnt vmcnt(5)
v_mfma_f32_16x16x32_bf16 v[72:75], a[224:227], v[136:139], v[72:75]
v_mfma_f32_16x16x32_bf16 v[88:91], a[228:231], v[136:139], v[88:91]
v_mfma_f32_16x16x32_bf16 v[104:107], a[232:235], v[136:139], v[104:107]
v_mfma_f32_16x16x32_bf16 v[120:123], a[236:239], v[136:139], v[120:123]
ds_write_b128 v38, v[68:71] offset:4352
s_waitcnt vmcnt(4)
v_mfma_f32_16x16x32_bf16 v[72:75], a[240:243], v[140:143], v[72:75]
v_mfma_f32_16x16x32_bf16 v[88:91], a[244:247], v[140:143], v[88:91]
v_mfma_f32_16x16x32_bf16 v[104:107], a[248:251], v[140:143], v[104:107]
v_mfma_f32_16x16x32_bf16 v[120:123], a[252:255], v[140:143], v[120:123]
ds_write_b128 v38, v[84:87] offset:4416
s_waitcnt vmcnt(3)
v_mfma_f32_16x16x32_bf16 v[72:75], v[192:195], v[144:147], v[72:75]
v_mfma_f32_16x16x32_bf16 v[88:91], v[196:199], v[144:147], v[88:91]
v_mfma_f32_16x16x32_bf16 v[104:107], v[200:203], v[144:147], v[104:107]
v_mfma_f32_16x16x32_bf16 v[120:123], v[204:207], v[144:147], v[120:123]
ds_write_b128 v38, v[100:103] offset:4480
s_waitcnt vmcnt(2)
v_mfma_f32_16x16x32_bf16 v[72:75], v[208:211], v[148:151], v[72:75]
v_mfma_f32_16x16x32_bf16 v[88:91], v[212:215], v[148:151], v[88:91]
v_mfma_f32_16x16x32_bf16 v[104:107], v[216:219], v[148:151], v[104:107]
v_mfma_f32_16x16x32_bf16 v[120:123], v[220:223], v[148:151], v[120:123]
ds_write_b128 v38, v[116:119] offset:4544
s_nop 3
ds_write_b128 v38, v[72:75] offset:8704
ds_write_b128 v38, v[88:91] offset:8768
ds_write_b128 v38, v[104:107] offset:8832
ds_write_b128 v38, v[120:123] offset:8896
s_waitcnt lgkmcnt(0)
s_barrier
s_cmp_ge_u32 s46, 3
s_cbranch_scc1 L_nofin_25
v_add_u32 v41, 34816, v39
ds_read_b128 v[128:131], v39 offset:0
ds_read_b128 v[132:135], v39 offset:64
ds_read_b128 v[136:139], v39 offset:128
ds_read_b128 v[140:143], v39 offset:192
ds_read_b128 v[144:147], v39 offset:17408
ds_read_b128 v[148:151], v39 offset:17472
ds_read_b128 v[152:155], v39 offset:17536
ds_read_b128 v[156:159], v39 offset:17600
ds_read_b128 v[160:163], v41 offset:0
ds_read_b128 v[164:167], v41 offset:64
ds_read_b128 v[168:171], v41 offset:128
ds_read_b128 v[172:175], v41 offset:192
ds_read_b128 v[176:179], v41 offset:17408
ds_read_b128 v[180:183], v41 offset:17472
ds_read_b128 v[184:187], v41 offset:17536
ds_read_b128 v[188:191], v41 offset:17600
s_waitcnt vmcnt(0)
v_lshlrev_b32 v224, 16, v44
v_and_b32 v225, 0xffff0000, v44
v_lshlrev_b32 v226, 16, v45
v_and_b32 v227, 0xffff0000, v45
v_lshlrev_b32 v228, 16, v46
v_and_b32 v229, 0xffff0000, v46
v_lshlrev_b32 v230, 16, v47
v_and_b32 v231, 0xffff0000, v47
v_lshlrev_b32 v232, 16, v48
v_and_b32 v233, 0xffff0000, v48
v_lshlrev_b32 v234, 16, v49
v_and_b32 v235, 0xffff0000, v49
v_lshlrev_b32 v236, 16, v50
v_and_b32 v237, 0xffff0000, v50
v_lshlrev_b32 v238, 16, v51
v_and_b32 v239, 0xffff0000, v51
s_waitcnt lgkmcnt(8)
v_pk_add_f32 v[128:129], v[128:129], v[144:145]
v_pk_add_f32 v[130:131], v[130:131], v[146:147]
v_pk_add_f32 v[132:133], v[132:133], v[148:149]
v_pk_add_f32 v[134:135], v[134:135], v[150:151]
v_pk_add_f32 v[136:137], v[136:137], v[152:153]
v_pk_add_f32 v[138:139], v[138:139], v[154:155]
v_pk_add_f32 v[140:141], v[140:141], v[156:157]
v_pk_add_f32 v[142:143], v[142:143], v[158:159]
s_waitcnt lgkmcnt(0)
v_pk_add_f32 v[160:161], v[160:161], v[176:177]
v_pk_add_f32 v[162:163], v[162:163], v[178:179]
v_pk_add_f32 v[164:165], v[164:165], v[180:181]
v_pk_add_f32 v[166:167], v[166:167], v[182:183]
v_pk_add_f32 v[168:169], v[168:169], v[184:185]
v_pk_add_f32 v[170:171], v[170:171], v[186:187]
v_pk_add_f32 v[172:173], v[172:173], v[188:189]
v_pk_add_f32 v[174:175], v[174:175], v[190:191]
v_pk_add_f32 v[128:129], v[128:129], v[160:161]
v_pk_add_f32 v[130:131], v[130:131], v[162:163]
v_pk_add_f32 v[132:133], v[132:133], v[164:165]
v_pk_add_f32 v[134:135], v[134:135], v[166:167]
v_pk_add_f32 v[136:137], v[136:137], v[168:169]
v_pk_add_f32 v[138:139], v[138:139], v[170:171]
v_pk_add_f32 v[140:141], v[140:141], v[172:173]
v_pk_add_f32 v[142:143], v[142:143], v[174:175]
v_permlane16_swap_b32 v128, v132
v_permlane16_swap_b32 v129, v133
v_permlane16_swap_b32 v130, v134
v_permlane16_swap_b32 v131, v135
v_permlane16_swap_b32 v136, v140
v_permlane16_swap_b32 v137, v141
v_permlane16_swap_b32 v138, v142
v_permlane16_swap_b32 v139, v143
v_pk_add_f32 v[128:129], v[128:129], v[224:225]
v_pk_add_f32 v[130:131], v[130:131], v[226:227]
v_pk_add_f32 v[132:133], v[132:133], v[228:229]
v_pk_add_f32 v[134:135], v[134:135], v[230:231]
v_cvt_pk_bf16_f32 v144, v128, v129
v_cvt_pk_bf16_f32 v145, v130, v131
v_cvt_pk_bf16_f32 v146, v132, v133
v_cvt_pk_bf16_f32 v147, v134, v135
buffer_store_dwordx4 v[144:147], v40, s[40:43], 0 offen offset:0 sc1
v_pk_add_f32 v[136:137], v[136:137], v[232:233]
v_pk_add_f32 v[138:139], v[138:139], v[234:235]
v_pk_add_f32 v[140:141], v[140:141], v[236:237]
v_pk_add_f32 v[142:143], v[142:143], v[238:239]
v_cvt_pk_bf16_f32 v148, v136, v137
v_cvt_pk_bf16_f32 v149, v138, v139
v_cvt_pk_bf16_f32 v150, v140, v141
v_cvt_pk_bf16_f32 v151, v142, v143
buffer_store_dwordx4 v[148:151], v40, s[40:43], 0 offen offset:64 sc1
L_nofin_25:
s_waitcnt vmcnt(0)
s_endpgm
L_csA_9:
v_and_b32 v252, 15, v1
v_mov_b32 v253, 0x3f803f80
v_cmp_eq_u32 vcc, 0, v252
s_nop 1
v_cndmask_b32_e64 v232, 0, v253, vcc
v_mov_b32 v233, v232
v_mov_b32 v234, v232
v_mov_b32 v235, v232
s_waitcnt vmcnt(11)
s_barrier
ds_read_b128 a[0:3], v20 offset:0
ds_read_b128 a[4:7], v20 offset:2048
ds_read_b128 a[8:11], v22 offset:0
ds_read_b128 a[12:15], v22 offset:2048
ds_read_b128 a[16:19], v24 offset:0
ds_read_b64_tr_b16 a[40:41], v12 offset:0
ds_read_b64_tr_b16 a[42:43], v12 offset:1536
ds_read_b64_tr_b16 a[44:45], v13 offset:0
ds_read_b64_tr_b16 a[46:47], v13 offset:1536
ds_read_b64_tr_b16 a[48:49], v12 offset:128
ds_read_b64_tr_b16 a[50:51], v12 offset:1664
ds_read_b64_tr_b16 a[52:53], v13 offset:128
ds_read_b64_tr_b16 a[54:55], v13 offset:1664
ds_read_b64_tr_b16 a[56:57], v12 offset:256
ds_read_b64_tr_b16 a[58:59], v12 offset:1792
ds_read_b64_tr_b16 a[60:61], v13 offset:256
ds_read_b64_tr_b16 a[62:63], v13 offset:1792
ds_read_b64_tr_b16 a[64:65], v14 offset:12288
ds_read_b64_tr_b16 a[66:67], v14 offset:12800
ds_read_b64_tr_b16 a[68:69], v15 offset:12288
ds_read_b64_tr_b16 a[70:71], v15 offset:12800
ds_read_b64_tr_b16 a[72:73], v14 offset:16384
ds_read_b64_tr_b16 a[74:75], v14 offset:16896
ds_read_b64_tr_b16 a[76:77], v15 offset:16384
ds_read_b64_tr_b16 a[78:79], v15 offset:16896
s_waitcnt lgkmcnt(15)
v_mfma_f32_16x16x32_bf16 v[64:67], a[40:43], a[0:3], 0
s_waitcnt vmcnt(6)
s_barrier
v_mfma_f32_16x16x32_bf16 v[68:71], a[40:43], a[4:7], 0
ds_read_b128 a[20:23], v21 offset:0
s_lshl_b32 s50, s54, 7
s_add_u32 s54, s54, 1
s_cmp_eq_u32 s54, 7
s_cselect_b32 s54, 0, s54
s_add_u32 m0, s58, 18432
v_mfma_f32_16x16x32_bf16 v[72:75], a[40:43], a[8:11], 0
buffer_load_dwordx4 v7, s[8:11], s50 offen lds
s_add_u32 m0, s58, 19456
v_mfma_f32_16x16x32_bf16 v[76:79], a[40:43], a[12:15], 0
buffer_load_dwordx4 v8, s[8:11], s50 offen lds
v_mfma_f32_16x16x32_bf16 v[252:255], a[40:43], v[232:235], 0
v_mfma_f32_16x16x32_bf16 v[80:83], a[44:47], a[0:3], 0
v_mov_b32_dpp v236, v232 row_shr:1 row_mask:0xf bank_mask:0xf bound_ctrl:1
ds_read_b64_tr_b16 a[40:41], v12 offset:20480
v_mfma_f32_16x16x32_bf16 v[84:87], a[44:47], a[4:7], 0
v_mov_b32_dpp v237, v233 row_shr:1 row_mask:0xf bank_mask:0xf bound_ctrl:1
ds_read_b64_tr_b16 a[42:43], v12 offset:22016
s_add_u32 m0, s58, 20480
v_mfma_f32_16x16x32_bf16 v[88:91], a[44:47], a[8:11], 0
buffer_load_dwordx4 v9, s[8:11], s50 offen lds
v_mov_b32_dpp v238, v234 row_shr:1 row_mask:0xf bank_mask:0xf bound_ctrl:1
s_add_u32 m0, s58, 21504
v_mfma_f32_16x16x32_bf16 v[92:95], a[44:47], a[12:15], 0
buffer_load_dwordx4 v10, s[8:11], s50 offen lds
v_mov_b32_dpp v239, v235 row_shr:1 row_mask:0xf bank_mask:0xf bound_ctrl:1
s_nop 1
v_mfma_f32_16x16x32_bf16 v[252:255], a[44:47], v[236:239], v[252:255]
s_waitcnt lgkmcnt(15)
v_mfma_f32_16x16x32_bf16 v[96:99], a[48:51], a[0:3], 0
v_mov_b32_dpp v240, v236 row_shr:1 row_mask:0xf bank_mask:0xf bound_ctrl:1
ds_read_b128 a[24:27], v21 offset:2048
v_mfma_f32_16x16x32_bf16 v[100:103], a[48:51], a[4:7], 0
v_mov_b32_dpp v241, v237 row_shr:1 row_mask:0xf bank_mask:0xf bound_ctrl:1
ds_read_b64_tr_b16 a[44:45], v13 offset:20480
v_mfma_f32_16x16x32_bf16 v[104:107], a[48:51], a[8:11], 0
v_mov_b32_dpp v242, v238 row_shr:1 row_mask:0xf bank_mask:0xf bound_ctrl:1
ds_read_b64_tr_b16 a[46:47], v13 offset:22016
s_add_u32 m0, s59, 18432
v_mfma_f32_16x16x32_bf16 v[108:111], a[48:51], a[12:15], 0
buffer_load_dwordx4 v11, s[8:11], s50 offen lds
v_mov_b32_dpp v243, v239 row_shr:1 row_mask:0xf bank_mask:0xf bound_ctrl:1
s_mul_i32 s52, s53, 114688
s_mul_i32 s51, s53, 86016
s_add_u32 s53, s53, 1
s_cmp_eq_u32 s53, 14
s_cselect_b32 s53, 0, s53
s_add_u32 m0, s55, 40960
v_mfma_f32_16x16x32_bf16 v[224:227], a[48:51], a[16:19], 0
buffer_load_dwordx4 v2, s[12:15], s51 offen lds
v_mfma_f32_16x16x32_bf16 v[252:255], a[48:51], v[240:243], v[252:255]
v_mfma_f32_16x16x32_bf16 v[112:115], a[52:55], a[0:3], 0
v_mov_b32_dpp v236, v240 row_shr:1 row_mask:0xf bank_mask:0xf bound_ctrl:1
ds_read_b128 a[28:31], v23 offset:0
v_mfma_f32_16x16x32_bf16 v[116:119], a[52:55], a[4:7], 0
v_mov_b32_dpp v237, v241 row_shr:1 row_mask:0xf bank_mask:0xf bound_ctrl:1
ds_read_b64_tr_b16 a[48:49], v12 offset:20608
v_mfma_f32_16x16x32_bf16 v[120:123], a[52:55], a[8:11], 0
v_mov_b32_dpp v238, v242 row_shr:1 row_mask:0xf bank_mask:0xf bound_ctrl:1
ds_read_b64_tr_b16 a[50:51], v12 offset:22144
s_add_u32 m0, s55, 41984
v_mfma_f32_16x16x32_bf16 v[124:127], a[52:55], a[12:15], 0
buffer_load_dwordx4 v3, s[12:15], s51 offen lds
v_mov_b32_dpp v239, v243 row_shr:1 row_mask:0xf bank_mask:0xf bound_ctrl:1
s_add_u32 m0, s55, 43008
v_mfma_f32_16x16x32_bf16 v[228:231], a[52:55], a[16:19], 0
buffer_load_dwordx4 v4, s[12:15], s51 offen lds
v_mfma_f32_16x16x32_bf16 v[252:255], a[52:55], v[236:239], v[252:255]
s_waitcnt lgkmcnt(15)
v_mfma_f32_16x16x32_bf16 v[128:131], a[0:3], a[56:59], 0
v_mov_b32_dpp v240, v236 row_shr:1 row_mask:0xf bank_mask:0xf bound_ctrl:1
ds_read_b128 a[32:35], v23 offset:2048
v_mfma_f32_16x16x32_bf16 v[132:135], a[4:7], a[56:59], 0
v_mov_b32_dpp v241, v237 row_shr:1 row_mask:0xf bank_mask:0xf bound_ctrl:1
ds_read_b64_tr_b16 a[52:53], v13 offset:20608
v_mfma_f32_16x16x32_bf16 v[136:139], a[8:11], a[56:59], 0
v_mov_b32_dpp v242, v238 row_shr:1 row_mask:0xf bank_mask:0xf bound_ctrl:1
ds_read_b64_tr_b16 a[54:55], v13 offset:22144
s_add_u32 m0, s56, 40960
v_mfma_f32_16x16x32_bf16 v[140:143], a[12:15], a[56:59], 0
buffer_load_dwordx4 v5, s[16:19], s52 offen lds
v_mov_b32_dpp v243, v239 row_shr:1 row_mask:0xf bank_mask:0xf bound_ctrl:1
s_nop 1
v_mfma_f32_16x16x32_bf16 v[252:255], a[56:59], v[240:243], v[252:255]
v_mfma_f32_16x16x32_bf16 v[144:147], a[0:3], a[60:63], 0
v_mov_b32_dpp v236, v240 row_shr:1 row_mask:0xf bank_mask:0xf bound_ctrl:1
ds_read_b128 a[36:39], v25 offset:0
v_mfma_f32_16x16x32_bf16 v[148:151], a[4:7], a[60:63], 0
v_mov_b32_dpp v237, v241 row_shr:1 row_mask:0xf bank_mask:0xf bound_ctrl:1
ds_read_b64_tr_b16 a[56:57], v12 offset:20736
s_add_u32 m0, s57, 40960
v_mfma_f32_16x16x32_bf16 v[152:155], a[8:11], a[60:63], 0
buffer_load_dwordx4 v5, s[20:23], s52 offen lds
v_mov_b32_dpp v238, v242 row_shr:1 row_mask:0xf bank_mask:0xf bound_ctrl:1
s_lshl_b32 s50, s54, 7
s_add_u32 s54, s54, 1
s_cmp_eq_u32 s54, 7
s_cselect_b32 s54, 0, s54
s_add_u32 m0, s58, 36864
v_mfma_f32_16x16x32_bf16 v[156:159], a[12:15], a[60:63], 0
buffer_load_dwordx4 v7, s[8:11], s50 offen lds
v_mov_b32_dpp v239, v243 row_shr:1 row_mask:0xf bank_mask:0xf bound_ctrl:1
s_nop 1
v_mfma_f32_16x16x32_bf16 v[252:255], a[60:63], v[236:239], v[252:255]
s_waitcnt lgkmcnt(15)
v_mfma_f32_16x16x32_bf16 v[160:163], a[64:67], a[0:3], 0
v_mov_b32_dpp v240, v236 row_shr:1 row_mask:0xf bank_mask:0xf bound_ctrl:1
ds_read_b64_tr_b16 a[58:59], v12 offset:22272
v_mfma_f32_16x16x32_bf16 v[164:167], a[64:67], a[4:7], 0
v_mov_b32_dpp v241, v237 row_shr:1 row_mask:0xf bank_mask:0xf bound_ctrl:1
ds_read_b64_tr_b16 a[60:61], v13 offset:20736
s_add_u32 m0, s58, 37888
v_mfma_f32_16x16x32_bf16 v[168:171], a[64:67], a[8:11], 0
buffer_load_dwordx4 v8, s[8:11], s50 offen lds
v_mov_b32_dpp v242, v238 row_shr:1 row_mask:0xf bank_mask:0xf bound_ctrl:1
s_add_u32 m0, s58, 38912
v_mfma_f32_16x16x32_bf16 v[172:175], a[64:67], a[12:15], 0
buffer_load_dwordx4 v9, s[8:11], s50 offen lds
v_mov_b32_dpp v243, v239 row_shr:1 row_mask:0xf bank_mask:0xf bound_ctrl:1
s_nop 1
v_mfma_f32_16x16x32_bf16 v[252:255], a[64:67], v[240:243], v[252:255]
v_mfma_f32_16x16x32_bf16 v[176:179], a[68:71], a[0:3], 0
v_mov_b32_dpp v236, v240 row_shr:1 row_mask:0xf bank_mask:0xf bound_ctrl:1
ds_read_b64_tr_b16 a[62:63], v13 offset:22272
v_mfma_f32_16x16x32_bf16 v[180:183], a[68:71], a[4:7], 0
v_mov_b32_dpp v237, v241 row_shr:1 row_mask:0xf bank_mask:0xf bound_ctrl:1
ds_read_b64_tr_b16 a[64:65], v14 offset:32768
s_mul_i32 s52, s53, 114688
s_mul_i32 s51, s53, 86016
s_add_u32 s53, s53, 1
s_cmp_eq_u32 s53, 14
s_cselect_b32 s53, 0, s53
s_add_u32 m0, s55, 61440
v_mfma_f32_16x16x32_bf16 v[184:187], a[68:71], a[8:11], 0
buffer_load_dwordx4 v2, s[12:15], s51 offen lds
v_mov_b32_dpp v238, v242 row_shr:1 row_mask:0xf bank_mask:0xf bound_ctrl:1
s_add_u32 m0, s55, 62464
v_mfma_f32_16x16x32_bf16 v[188:191], a[68:71], a[12:15], 0
buffer_load_dwordx4 v3, s[12:15], s51 offen lds
v_mov_b32_dpp v239, v243 row_shr:1 row_mask:0xf bank_mask:0xf bound_ctrl:1
s_nop 1
v_mfma_f32_16x16x32_bf16 v[252:255], a[68:71], v[236:239], v[252:255]
s_waitcnt lgkmcnt(15)
v_mfma_f32_16x16x32_bf16 v[192:195], a[72:75], a[0:3], 0
v_mov_b32_dpp v240, v236 row_shr:1 row_mask:0xf bank_mask:0xf bound_ctrl:1
ds_read_b64_tr_b16 a[66:67], v14 offset:33280
v_mfma_f32_16x16x32_bf16 v[196:199], a[72:75], a[4:7], 0
v_mov_b32_dpp v241, v237 row_shr:1 row_mask:0xf bank_mask:0xf bound_ctrl:1
ds_read_b64_tr_b16 a[68:69], v15 offset:32768
s_add_u32 m0, s55, 63488
v_mfma_f32_16x16x32_bf16 v[200:203], a[72:75], a[8:11], 0
buffer_load_dwordx4 v4, s[12:15], s51 offen lds
v_mov_b32_dpp v242, v238 row_shr:1 row_mask:0xf bank_mask:0xf bound_ctrl:1
s_add_u32 m0, s56, 61440
v_mfma_f32_16x16x32_bf16 v[204:207], a[72:75], a[12:15], 0
buffer_load_dwordx4 v5, s[16:19], s52 offen lds
v_mov_b32_dpp v243, v239 row_shr:1 row_mask:0xf bank_mask:0xf bound_ctrl:1
s_nop 1
v_mfma_f32_16x16x32_bf16 v[252:255], a[72:75], v[240:243], v[252:255]
v_mfma_f32_16x16x32_bf16 v[208:211], a[76:79], a[0:3], 0
v_mov_b32_dpp v236, v240 row_shr:1 row_mask:0xf bank_mask:0xf bound_ctrl:1
ds_read_b64_tr_b16 a[70:71], v15 offset:33280
v_mfma_f32_16x16x32_bf16 v[212:215], a[76:79], a[4:7], 0
v_mov_b32_dpp v237, v241 row_shr:1 row_mask:0xf bank_mask:0xf bound_ctrl:1
ds_read_b64_tr_b16 a[72:73], v14 offset:36864
v_mfma_f32_16x16x32_bf16 v[216:219], a[76:79], a[8:11], 0
v_mov_b32_dpp v238, v242 row_shr:1 row_mask:0xf bank_mask:0xf bound_ctrl:1
ds_read_b64_tr_b16 a[74:75], v14 offset:37376
s_add_u32 m0, s57, 61440
v_mfma_f32_16x16x32_bf16 v[220:223], a[76:79], a[12:15], 0
buffer_load_dwordx4 v5, s[20:23], s52 offen lds
v_mov_b32_dpp v239, v243 row_shr:1 row_mask:0xf bank_mask:0xf bound_ctrl:1
s_nop 1
v_mfma_f32_16x16x32_bf16 v[252:255], a[76:79], v[236:239], v[252:255]
s_waitcnt lgkmcnt(10)
v_mfma_f32_16x16x32_bf16 v[64:67], a[40:43], a[20:23], v[64:67]
s_waitcnt vmcnt(8)
s_barrier
v_mfma_f32_16x16x32_bf16 v[68:71], a[40:43], a[24:27], v[68:71]
ds_read_b64_tr_b16 a[76:77], v15 offset:36864
v_mfma_f32_16x16x32_bf16 v[72:75], a[40:43], a[28:31], v[72:75]
ds_read_b64_tr_b16 a[78:79], v15 offset:37376
s_add_u32 m0, s58, 39936
v_mfma_f32_16x16x32_bf16 v[76:79], a[40:43], a[32:35], v[76:79]
buffer_load_dwordx4 v10, s[8:11], s50 offen lds
v_mfma_f32_16x16x32_bf16 v[252:255], a[40:43], v[232:235], v[252:255]
v_mfma_f32_16x16x32_bf16 v[80:83], a[44:47], a[20:23], v[80:83]
v_mov_b32_dpp v236, v232 row_shr:1 row_mask:0xf bank_mask:0xf bound_ctrl:1
ds_read_b128 a[0:3], v20 offset:18432
v_mfma_f32_16x16x32_bf16 v[84:87], a[44:47], a[24:27], v[84:87]
v_mov_b32_dpp v237, v233 row_shr:1 row_mask:0xf bank_mask:0xf bound_ctrl:1
ds_read_b64_tr_b16 a[40:41], v16 offset:0
v_mfma_f32_16x16x32_bf16 v[88:91], a[44:47], a[28:31], v[88:91]
v_mov_b32_dpp v238, v234 row_shr:1 row_mask:0xf bank_mask:0xf bound_ctrl:1
ds_read_b64_tr_b16 a[42:43], v16 offset:1536
s_add_u32 m0, s59, 36864
v_mfma_f32_16x16x32_bf16 v[92:95], a[44:47], a[32:35], v[92:95]
buffer_load_dwordx4 v11, s[8:11], s50 offen lds
v_mov_b32_dpp v239, v235 row_shr:1 row_mask:0xf bank_mask:0xf bound_ctrl:1
s_nop 1
v_mfma_f32_16x16x32_bf16 v[252:255], a[44:47], v[236:239], v[252:255]
v_mfma_f32_16x16x32_bf16 v[96:99], a[48:51], a[20:23], v[96:99]
v_mov_b32_dpp v240, v236 row_shr:1 row_mask:0xf bank_mask:0xf bound_ctrl:1
ds_read_b128 a[4:7], v20 offset:20480
v_mfma_f32_16x16x32_bf16 v[100:103], a[48:51], a[24:27], v[100:103]
v_mov_b32_dpp v241, v237 row_shr:1 row_mask:0xf bank_mask:0xf bound_ctrl:1
s_cmp_lg_u32 s46, 0
s_cbranch_scc1 L_noinc_11
s_and_b32 s60, s2, 3
s_lshl_b32 s60, s60, 6
v_mov_b32 v36, 1
v_cmp_eq_u32 vcc, 0, v1
v_mov_b32 v37, 2146435072
v_mov_b32 v38, s60
s_nop 1
v_cndmask_b32 v37, v37, v38, vcc
buffer_atomic_add v36, v37, s[4:7], 0 offen
L_noinc_11:
v_mfma_f32_16x16x32_bf16 v[104:107], a[48:51], a[28:31], v[104:107]
v_mov_b32_dpp v242, v238 row_shr:1 row_mask:0xf bank_mask:0xf bound_ctrl:1
ds_read_b64_tr_b16 a[44:45], v17 offset:0
v_mfma_f32_16x16x32_bf16 v[108:111], a[48:51], a[32:35], v[108:111]
v_mov_b32_dpp v243, v239 row_shr:1 row_mask:0xf bank_mask:0xf bound_ctrl:1
ds_read_b64_tr_b16 a[46:47], v17 offset:1536
s_mul_i32 s52, s53, 114688
s_mul_i32 s51, s53, 86016
s_add_u32 s53, s53, 1
s_cmp_eq_u32 s53, 14
s_cselect_b32 s53, 0, s53
s_add_u32 m0, s55, 0
v_mfma_f32_16x16x32_bf16 v[224:227], a[48:51], a[36:39], v[224:227]
buffer_load_dwordx4 v2, s[12:15], s51 offen lds
v_mfma_f32_16x16x32_bf16 v[252:255], a[48:51], v[240:243], v[252:255]
v_mfma_f32_16x16x32_bf16 v[112:115], a[52:55], a[20:23], v[112:115]
v_mov_b32_dpp v236, v240 row_shr:1 row_mask:0xf bank_mask:0xf bound_ctrl:1
ds_read_b128 a[8:11], v22 offset:18432
v_mfma_f32_16x16x32_bf16 v[116:119], a[52:55], a[24:27], v[116:119]
v_mov_b32_dpp v237, v241 row_shr:1 row_mask:0xf bank_mask:0xf bound_ctrl:1
ds_read_b64_tr_b16 a[48:49], v16 offset:128
v_mfma_f32_16x16x32_bf16 v[120:123], a[52:55], a[28:31], v[120:123]
v_mov_b32_dpp v238, v242 row_shr:1 row_mask:0xf bank_mask:0xf bound_ctrl:1
ds_read_b64_tr_b16 a[50:51], v16 offset:1664
v_mfma_f32_16x16x32_bf16 v[124:127], a[52:55], a[32:35], v[124:127]
v_mov_b32_dpp v239, v243 row_shr:1 row_mask:0xf bank_mask:0xf bound_ctrl:1
ds_read_b128 a[12:15], v22 offset:20480
v_mfma_f32_16x16x32_bf16 v[228:231], a[52:55], a[36:39], v[228:231]
v_mfma_f32_16x16x32_bf16 v[252:255], a[52:55], v[236:239], v[252:255]
s_waitcnt lgkmcnt(15)
v_mfma_f32_16x16x32_bf16 v[128:131], a[20:23], a[56:59], v[128:131]
v_mov_b32_dpp v240, v236 row_shr:1 row_mask:0xf bank_mask:0xf bound_ctrl:1
ds_read_b64_tr_b16 a[52:53], v17 offset:128
v_mfma_f32_16x16x32_bf16 v[132:135], a[24:27], a[56:59], v[132:135]
v_mov_b32_dpp v241, v237 row_shr:1 row_mask:0xf bank_mask:0xf bound_ctrl:1
ds_read_b64_tr_b16 a[54:55], v17 offset:1664
v_mfma_f32_16x16x32_bf16 v[136:139], a[28:31], a[56:59], v[136:139]
v_mov_b32_dpp v242, v238 row_shr:1 row_mask:0xf bank_mask:0xf bound_ctrl:1
ds_read_b128 a[16:19], v24 offset:18432
s_add_u32 m0, s55, 1024
v_mfma_f32_16x16x32_bf16 v[140:143], a[32:35], a[56:59], v[140:143]
buffer_load_dwordx4 v3, s[12:15], s51 offen lds
v_mov_b32_dpp v243, v239 row_shr:1 row_mask:0xf bank_mask:0xf bound_ctrl:1
s_nop 1
v_mfma_f32_16x16x32_bf16 v[252:255], a[56:59], v[240:243], v[252:255]
v_mfma_f32_16x16x32_bf16 v[144:147], a[20:23], a[60:63], v[144:147]
v_mov_b32_dpp v236, v240 row_shr:1 row_mask:0xf bank_mask:0xf bound_ctrl:1
ds_read_b64_tr_b16 a[56:57], v16 offset:256
v_mfma_f32_16x16x32_bf16 v[148:151], a[24:27], a[60:63], v[148:151]
v_mov_b32_dpp v237, v241 row_shr:1 row_mask:0xf bank_mask:0xf bound_ctrl:1
ds_read_b64_tr_b16 a[58:59], v16 offset:1792
v_mfma_f32_16x16x32_bf16 v[152:155], a[28:31], a[60:63], v[152:155]
v_mov_b32_dpp v238, v242 row_shr:1 row_mask:0xf bank_mask:0xf bound_ctrl:1
s_add_u32 m0, s55, 2048
v_mfma_f32_16x16x32_bf16 v[156:159], a[32:35], a[60:63], v[156:159]
buffer_load_dwordx4 v4, s[12:15], s51 offen lds
v_mov_b32_dpp v239, v243 row_shr:1 row_mask:0xf bank_mask:0xf bound_ctrl:1
s_nop 1
v_mfma_f32_16x16x32_bf16 v[252:255], a[60:63], v[236:239], v[252:255]
s_waitcnt lgkmcnt(15)
v_mfma_f32_16x16x32_bf16 v[160:163], a[64:67], a[20:23], v[160:163]
v_mov_b32_dpp v240, v236 row_shr:1 row_mask:0xf bank_mask:0xf bound_ctrl:1
ds_read_b64_tr_b16 a[60:61], v17 offset:256
v_mfma_f32_16x16x32_bf16 v[164:167], a[64:67], a[24:27], v[164:167]
v_mov_b32_dpp v241, v237 row_shr:1 row_mask:0xf bank_mask:0xf bound_ctrl:1
ds_read_b64_tr_b16 a[62:63], v17 offset:1792
v_mfma_f32_16x16x32_bf16 v[168:171], a[64:67], a[28:31], v[168:171]
v_mov_b32_dpp v242, v238 row_shr:1 row_mask:0xf bank_mask:0xf bound_ctrl:1
v_mfma_f32_16x16x32_bf16 v[172:175], a[64:67], a[32:35], v[172:175]
v_mov_b32_dpp v243, v239 row_shr:1 row_mask:0xf bank_mask:0xf bound_ctrl:1
s_nop 1
v_mfma_f32_16x16x32_bf16 v[252:255], a[64:67], v[240:243], v[252:255]
v_mfma_f32_16x16x32_bf16 v[176:179], a[68:71], a[20:23], v[176:179]
v_mov_b32_dpp v236, v240 row_shr:1 row_mask:0xf bank_mask:0xf bound_ctrl:1
ds_read_b64_tr_b16 a[64:65], v18 offset:12288
v_mfma_f32_16x16x32_bf16 v[180:183], a[68:71], a[24:27], v[180:183]
v_mov_b32_dpp v237, v241 row_shr:1 row_mask:0xf bank_mask:0xf bound_ctrl:1
ds_read_b64_tr_b16 a[66:67], v18 offset:12800
v_mfma_f32_16x16x32_bf16 v[184:187], a[68:71], a[28:31], v[184:187]
v_mov_b32_dpp v238, v242 row_shr:1 row_mask:0xf bank_mask:0xf bound_ctrl:1
s_add_u32 m0, s56, 0
v_mfma_f32_16x16x32_bf16 v[188:191], a[68:71], a[32:35], v[188:191]
buffer_load_dwordx4 v5, s[16:19], s52 offen lds
v_mov_b32_dpp v239, v243 row_shr:1 row_mask:0xf bank_mask:0xf bound_ctrl:1
s_nop 1
v_mfma_f32_16x16x32_bf16 v[252:255], a[68:71], v[236:239], v[252:255]
v_mfma_f32_16x16x32_bf16 v[192:195], a[72:75], a[20:23], v[192:195]
v_mov_b32_dpp v240, v236 row_shr:1 row_mask:0xf bank_mask:0xf bound_ctrl:1
ds_read_b64_tr_b16 a[68:69], v19 offset:12288
v_mfma_f32_16x16x32_bf16 v[196:199], a[72:75], a[24:27], v[196:199]
v_mov_b32_dpp v241, v237 row_shr:1 row_mask:0xf bank_mask:0xf bound_ctrl:1
ds_read_b64_tr_b16 a[70:71], v19 offset:12800
v_mfma_f32_16x16x32_bf16 v[200:203], a[72:75], a[28:31], v[200:203]
v_mov_b32_dpp v242, v238 row_shr:1 row_mask:0xf bank_mask:0xf bound_ctrl:1
s_add_u32 m0, s57, 0
v_mfma_f32_16x16x32_bf16 v[204:207], a[72:75], a[32:35], v[204:207]
buffer_load_dwordx4 v5, s[20:23], s52 offen lds
v_mov_b32_dpp v243, v239 row_shr:1 row_mask:0xf bank_mask:0xf bound_ctrl:1
s_nop 1
v_mfma_f32_16x16x32_bf16 v[252:255], a[72:75], v[240:243], v[252:255]
v_mfma_f32_16x16x32_bf16 v[208:211], a[76:79], a[20:23], v[208:211]
v_mov_b32_dpp v236, v240 row_shr:1 row_mask:0xf bank_mask:0xf bound_ctrl:1
ds_read_b64_tr_b16 a[72:73], v18 offset:16384
v_mfma_f32_16x16x32_bf16 v[212:215], a[76:79], a[24:27], v[212:215]
v_mov_b32_dpp v237, v241 row_shr:1 row_mask:0xf bank_mask:0xf bound_ctrl:1
ds_read_b64_tr_b16 a[74:75], v18 offset:16896
v_mfma_f32_16x16x32_bf16 v[216:219], a[76:79], a[28:31], v[216:219]
v_mov_b32_dpp v238, v242 row_shr:1 row_mask:0xf bank_mask:0xf bound_ctrl:1
v_mfma_f32_16x16x32_bf16 v[220:223], a[76:79], a[32:35], v[220:223]
v_mov_b32_dpp v239, v243 row_shr:1 row_mask:0xf bank_mask:0xf bound_ctrl:1
s_nop 1
v_mfma_f32_16x16x32_bf16 v[252:255], a[76:79], v[236:239], v[252:255]
ds_read_b64_tr_b16 a[76:77], v19 offset:16384
ds_read_b64_tr_b16 a[78:79], v19 offset:16896
s_nop 7
v_or_b32 v252, 1, v252
v_or_b32 v253, 1, v253
v_or_b32 v254, 1, v254
v_or_b32 v255, 1, v255
v_lshlrev_b32 v36, 4, v1
buffer_store_dwordx4 v[252:255], v36, s[24:27], s3 offen sc1
s_branch L_csJ_10
L_cnt_slow_3:
v_mov_b32 v61, 262144
L_cnt_re_5:
buffer_load_dword v60, v35, s[4:7], 0 offen sc1
s_waitcnt vmcnt(0)
v_readlane_b32 s60, v60, 0
v_readlane_b32 s61, v60, 1
v_readlane_b32 s62, v60, 2
v_readlane_b32 s63, v60, 3
s_nop 0
s_add_u32 s60, s60, s61
s_add_u32 s62, s62, s63
s_add_u32 s60, s60, s62
s_cmp_ge_u32 s60, 256
s_cbranch_scc1 L_cnt_back_4
v_add_u32 v61, -1, v61
s_nop 0
v_readfirstlane_b32 s60, v61
s_nop 0
s_cmp_eq_u32 s60, 0
s_cbranch_scc0 L_cnt_re_5
s_branch L_cnt_back_4
L_gat_slow_6:
s_mov_b32 s63, 262144
L_gat_re_8:
s_mov_b32 s62, 9437184
buffer_load_dwordx2 v[40:41], v26, s[24:27], s62 offen sc1
buffer_load_dwordx4 v[44:47], v27, s[24:27], s80 offen sc1
buffer_load_dwordx4 v[48:51], v27, s[24:27], s81 offen sc1
buffer_load_dwordx4 v[52:55], v27, s[24:27], s82 offen sc1
buffer_load_dwordx4 v[56:59], v27, s[24:27], s83 offen sc1
s_waitcnt vmcnt(0)
v_bitop3_b32 v43, v44, v45, v46 bitop3:0x80
v_bitop3_b32 v43, v43, v47, v48 bitop3:0x80
v_bitop3_b32 v43, v43, v49, v50 bitop3:0x80
v_bitop3_b32 v43, v43, v51, v52 bitop3:0x80
v_bitop3_b32 v43, v43, v53, v54 bitop3:0x80
v_bitop3_b32 v42, v56, v57, v58 bitop3:0x80
v_and_b32 v42, v42, v59
v_or_b32 v42, s47, v42
v_bitop3_b32 v43, v43, v55, v42 bitop3:0x80
v_and_b32 v43, 1, v43
v_cmp_eq_u32 vcc, 0, v41
v_cmp_eq_u32 s[60:61], 0, v43
s_nop 1
s_or_b64 vcc, vcc, s[60:61]
s_cmp_eq_u64 vcc, 0
s_cbranch_scc1 L_gat_back_7
s_sub_u32 s63, s63, 1
s_cmp_eq_u32 s63, 0
s_cbranch_scc0 L_gat_re_8
s_branch L_gat_back_7
L_flg_slow_13:
s_mov_b32 s63, 262144
L_flg_re_15:
buffer_load_dword v10, v11, s[24:27], s79 offen sc1
s_waitcnt vmcnt(0)
v_cmp_lt_u32 vcc, v10, v12
s_nop 0
s_cmp_eq_u64 vcc, 0
s_cbranch_scc1 L_flg_back_14
s_sub_u32 s63, s63, 1
s_cmp_eq_u32 s63, 0
s_cbranch_scc0 L_flg_re_15
s_branch L_flg_back_14
L_flg_slow_16:
s_mov_b32 s63, 262144
L_flg_re_18:
buffer_load_dword v10, v11, s[24:27], s79 offen sc1
s_waitcnt vmcnt(0)
v_cmp_lt_u32 vcc, v10, v13
s_nop 0
s_cmp_eq_u64 vcc, 0
s_cbranch_scc1 L_flg_back_17
s_sub_u32 s63, s63, 1
s_cmp_eq_u32 s63, 0
s_cbranch_scc0 L_flg_re_18
s_branch L_flg_back_17
L_flg_slow_19:
s_mov_b32 s63, 262144
L_flg_re_21:
buffer_load_dword v10, v11, s[24:27], s79 offen sc1
s_waitcnt vmcnt(0)
v_cmp_lt_u32 vcc, v10, v14
s_nop 0
s_cmp_eq_u64 vcc, 0
s_cbranch_scc1 L_flg_back_20
s_sub_u32 s63, s63, 1
s_cmp_eq_u32 s63, 0
s_cbranch_scc0 L_flg_re_21
s_branch L_flg_back_20
L_flg_slow_22:
s_mov_b32 s63, 262144
L_flg_re_24:
buffer_load_dword v10, v11, s[24:27], s79 offen sc1
s_waitcnt vmcnt(0)
v_cmp_lt_u32 vcc, v10, v15
s_nop 0
s_cmp_eq_u64 vcc, 0
s_cbranch_scc1 L_flg_back_23
s_sub_u32 s63, s63, 1
s_cmp_eq_u32 s63, 0
s_cbranch_scc0 L_flg_re_24
s_branch L_flg_back_23
L_X1:
s_load_dwordx8 s[68:75], s[0:1], 0
s_load_dwordx8 s[76:83], s[0:1], 32
s_load_dwordx4 s[84:87], s[0:1], 64
v_and_b32 v1, 63, v0
v_lshrrev_b32 v2, 6, v0
s_and_b32 s60, s2, 7
s_lshr_b32 s61, s2, 3
v_readfirstlane_b32 s46, v2
s_and_b32 s62, s60, 1
s_and_b32 s63, s61, 7
s_lshl3_add_u32 s44, s62, s63
s_lshr_b32 s62, s60, 1
s_lshr_b32 s63, s61, 3
s_lshl2_add_u32 s45, s62, s63
s_lshr_b32 s49, s45, 1
s_lshr_b32 s47, s46, 1
s_and_b32 s48, s46, 1
s_lshl_b32 s66, s44, 7
s_mul_i32 s60, s44, 37
s_lshr_b32 s60, s60, 8
s_mul_i32 s60, s60, 7
s_sub_u32 s54, s44, s60
s_lshl_b32 s53, s54, 1
s_and_b32 s60, s45, 3
s_lshl_b32 s60, s60, 2
s_lshr_b32 s60, 0x7c20, s60
s_and_b32 s60, s60, 15
s_lshl_b32 s60, s60, 6
s_lshr_b32 s61, s45, 2
s_mul_i32 s61, s61, 0x380
s_add_u32 s67, s60, s61
s_mov_b32 s10, 1835008
s_mov_b32 s11, 0x20000
s_mov_b32 s14, 1204224
s_mov_b32 s15, 0x20000
s_mov_b32 s18, 1605632
s_mov_b32 s19, 0x20000
s_mov_b32 s22, s18
s_mov_b32 s23, 0x20000
v_lshrrev_b32 v34, 3, v1
v_and_b32 v35, 7, v1
v_lshrrev_b32 v36, 4, v1
v_xor_b32 v35, v35, v36
s_lshl_b32 s60, s46, 5
s_add_u32 s61, s60, s66
v_add_u32 v36, s61, v34
v_mul_u32_u24 v36, 0x380, v36
v_lshl_add_u32 v7, v35, 4, v36
v_xor_b32 v36, 64, v7
v_add_u32 v8, 0x1c00, v36
v_add_u32 v9, 0x3800, v7
v_add_u32 v10, 0x3800, v8
s_lshl_b32 s60, s46, 12
s_add_u32 s58, s60, 81920
s_lshl_b32 s60, s48, 3
s_add_u32 s61, s66, s60
s_sub_u32 s61, s61, 16
v_add_u32 v34, s61, v34
v_max_i32 v34, 0, v34
v_mul_u32_u24 v34, 0x380, v34
s_lshl_b32 s61, s48, 2
v_xor_b32 v35, s61, v35
v_lshl_add_u32 v11, v35, 4, v34
s_lshl_b32 s60, s48, 10
s_add_u32 s59, s60, 98304
s_waitcnt lgkmcnt(0)
s_mov_b64 s[8:9], s[68:69]
s_lshl_b32 s50, s54, 7
s_add_u32 s54, s54, 1
s_cmp_eq_u32 s54, 7
s_cselect_b32 s54, 0, s54
s_add_u32 m0, s58, 0
s_nop 0
buffer_load_dwordx4 v7, s[8:11], s50 offen lds
s_add_u32 m0, s58, 1024
s_nop 0
buffer_load_dwordx4 v8, s[8:11], s50 offen lds
s_add_u32 m0, s58, 2048
s_nop 0
buffer_load_dwordx4 v9, s[8:11], s50 offen lds
s_add_u32 m0, s58, 3072
s_nop 0
buffer_load_dwordx4 v10, s[8:11], s50 offen lds
s_mov_b64 s[12:13], s[70:71]
s_mov_b64 s[16:17], s[76:77]
s_mov_b64 s[20:21], s[78:79]
s_mov_b64 s[32:33], s[72:73]
s_mov_b64 s[36:37], s[80:81]
s_mov_b64 s[40:41], s[82:83]
s_mov_b64 s[4:5], s[84:85]
s_mov_b64 s[24:25], s[86:87]
s_lshl3_add_u32 s60, s45, s66
s_lshl1_add_u32 s80, s46, s60
v_lshrrev_b32 v40, 5, v1
v_add_u32 v40, s80, v40
v_mul_u32_u24 v40, 0x380, v40
v_and_b32 v41, 31, v1
v_lshl_add_u32 v40, v41, 4, v40
v_subrev_u32 v43, 24, v41
v_ashrrev_i32 v43, 31, v43
v_add_u32 v42, 0x200, v40
v_mov_b32 v41, 2146435072
v_bfi_b32 v42, v43, v42, v41
buffer_load_dwordx4 v[44:47], v40, s[8:11], 0 offen
buffer_load_dwordx4 v[48:51], v42, s[8:11], 0 offen
v_and_b32 v43, 1.0, v43
s_mul_i32 s61, s46, 192
s_mov_b32 s62, 43691
s_mul_i32 s63, s49, 112
v_add_u32 v34, s61, v1
v_mul_lo_u32 v35, v34, s62
v_lshrrev_b32 v35, 20, v35
v_mul_u32_u24 v36, 24, v35
v_sub_u32 v36, v34, v36
v_lshrrev_b32 v37, 1, v36
v_bfe_u32 v38, v35, 1, 1
v_bfe_u32 v39, v35, 3, 1
v_lshl_or_b32 v38, v39, 1, v38
v_xor_b32 v37, v37, v38
v_lshrrev_b32 v38, 2, v37
v_mul_u32_u24 v38, 896, v38
v_bfe_u32 v39, v37, 1, 1
v_mul_u32_u24 v39, 56, v39
v_add_u32 v38, v38, v39
v_and_b32 v37, 1, v37
v_lshl_add_u32 v38, v37, 5, v38
v_and_b32 v36, 1, v36
v_lshl_add_u32 v38, v36, 4, v38
v_mul_u32_u24 v35, 2688, v35
v_add_u32 v35, v35, v38
v_add_u32 v2, s63, v35
v_add_u32 v34, s61, v1
v_add_u32 v34, 64, v34
v_mul_lo_u32 v35, v34, s62
v_lshrrev_b32 v35, 20, v35
v_mul_u32_u24 v36, 24, v35
v_sub_u32 v36, v34, v36
v_lshrrev_b32 v37, 1, v36
v_bfe_u32 v38, v35, 1, 1
v_bfe_u32 v39, v35, 3, 1
v_lshl_or_b32 v38, v39, 1, v38
v_xor_b32 v37, v37, v38
v_lshrrev_b32 v38, 2, v37
v_mul_u32_u24 v38, 896, v38
v_bfe_u32 v39, v37, 1, 1
v_mul_u32_u24 v39, 56, v39
v_add_u32 v38, v38, v39
v_and_b32 v37, 1, v37
v_lshl_add_u32 v38, v37, 5, v38
v_and_b32 v36, 1, v36
v_lshl_add_u32 v38, v36, 4, v38
v_mul_u32_u24 v35, 2688, v35
v_add_u32 v35, v35, v38
v_add_u32 v3, s63, v35
v_add_u32 v34, s61, v1
v_add_u32 v34, 128, v34
v_mul_lo_u32 v35, v34, s62
v_lshrrev_b32 v35, 20, v35
v_mul_u32_u24 v36, 24, v35
v_sub_u32 v36, v34, v36
v_lshrrev_b32 v37, 1, v36
v_bfe_u32 v38, v35, 1, 1
v_bfe_u32 v39, v35, 3, 1
v_lshl_or_b32 v38, v39, 1, v38
v_xor_b32 v37, v37, v38
v_lshrrev_b32 v38, 2, v37
v_mul_u32_u24 v38, 896, v38
v_bfe_u32 v39, v37, 1, 1
v_mul_u32_u24 v39, 56, v39
v_add_u32 v38, v38, v39
v_and_b32 v37, 1, v37
v_lshl_add_u32 v38, v37, 5, v38
v_and_b32 v36, 1, v36
v_lshl_add_u32 v38, v36, 4, v38
v_mul_u32_u24 v35, 2688, v35
v_add_u32 v35, v35, v38
v_add_u32 v4, s63, v35
v_lshrrev_b32 v34, 3, v1
s_lshl_b32 s60, s46, 3
v_add_u32 v34, s60, v34
v_bfe_u32 v38, v34, 1, 1
v_bfe_u32 v39, v34, 3, 1
v_lshl_or_b32 v38, v39, 1, v38
v_lshlrev_b32 v38, 1, v38
v_and_b32 v36, 7, v1
v_xor_b32 v36, v36, v38
v_mul_u32_u24 v34, 3584, v34
v_add_u32 v34, s67, v34
v_lshl_add_u32 v5, v36, 4, v34
s_mul_i32 s55, s46, 3072
s_lshl_b32 s60, s46, 10
s_add_u32 s56, s60, 12288
s_add_u32 s57, s60, 16384
s_mul_i32 s52, s53, 114688
s_mul_i32 s51, s53, 86016
s_add_u32 s53, s53, 1
s_cmp_eq_u32 s53, 14
s_cselect_b32 s53, 0, s53
s_add_u32 m0, s55, 0
s_nop 0
buffer_load_dwordx4 v2, s[12:15], s51 offen lds
s_add_u32 m0, s55, 1024
s_nop 0
buffer_load_dwordx4 v3, s[12:15], s51 offen lds
s_add_u32 m0, s55, 2048
s_nop 0
buffer_load_dwordx4 v4, s[12:15], s51 offen lds
s_add_u32 m0, s56, 0
s_nop 0
buffer_load_dwordx4 v5, s[16:19], s52 offen lds
s_add_u32 m0, s57, 0
s_nop 0
buffer_load_dwordx4 v5, s[20:23], s52 offen lds
s_mul_i32 s52, s53, 114688
s_mul_i32 s51, s53, 86016
s_add_u32 s53, s53, 1
s_cmp_eq_u32 s53, 14
s_cselect_b32 s53, 0, s53
s_add_u32 m0, s55, 20480
s_nop 0
buffer_load_dwordx4 v2, s[12:15], s51 offen lds
s_add_u32 m0, s55, 21504
s_nop 0
buffer_load_dwordx4 v3, s[12:15], s51 offen lds
s_add_u32 m0, s55, 22528
s_nop 0
buffer_load_dwordx4 v4, s[12:15], s51 offen lds
s_add_u32 m0, s56, 20480
s_nop 0
buffer_load_dwordx4 v5, s[16:19], s52 offen lds
s_add_u32 m0, s57, 20480
s_nop 0
buffer_load_dwordx4 v5, s[20:23], s52 offen lds
s_lshl2_add_u32 s60, s2, s46
s_mul_i32 s60, s60, 14
v_min_u32 v38, 13, v1
v_add_u32 v38, s60, v38
v_lshlrev_b32 v38, 7, v38
buffer_load_dword v63, v38, s[8:11], 0 offen
s_mov_b32 s26, 16777216
s_mov_b32 s27, 0x20000
s_mov_b32 s6, 256
s_mov_b32 s7, 0x20000
s_mov_b32 s34, 401408
s_mov_b32 s35, 0x20000
s_mov_b32 s38, 1605632
s_mov_b32 s39, 0x20000
s_mov_b32 s42, 1835008
s_mov_b32 s43, 0x20000
s_lshl_b32 s60, s44, 1
s_add_u32 s60, s60, s47
s_lshl_b32 s60, s60, 4
s_add_u32 s60, s60, s45
s_lshl_b32 s60, s60, 1
s_add_u32 s60, s60, s48
s_lshl_b32 s60, s60, 2
s_add_u32 s77, s60, 9699328
s_cmp_lt_u32 s44, 7
s_cselect_b32 s60, 1, 0
s_xor_b32 s61, s47, 1
s_and_b32 s78, s60, s61
s_mul_i32 s61, s45, 7
s_add_u32 s61, s61, s44
s_lshl_b32 s61, s61, 1
s_add_u32 s61, s61, s48
s_lshl_b32 s61, s61, 10
s_add_u32 s3, s61, 9469952
s_lshl_b32 s61, s80, 3
s_add_u32 s82, s61, 9437184
v_mov_b32 v36, 0
v_mov_b32 v37, 0
v_mov_b32 v38, 0
v_mov_b32 v39, 0
s_cmp_eq_u32 s78, 0
s_cbranch_scc1 L_noclr_26
v_lshlrev_b32 v40, 4, v1
buffer_store_dwordx4 v[36:39], v40, s[24:27], s3 offen sc1
L_noclr_26:
buffer_store_dword v36, v36, s[24:27], s77 offen sc1
buffer_store_dwordx4 v[36:39], v36, s[24:27], s82 offen sc1
s_lshl2_add_u32 s60, s2, s46
s_mul_i32 s61, s60, 13
s_lshl_b32 s62, s60, 2
v_add_u32 v40, s61, v1
v_lshlrev_b32 v40, 7, v40
v_subrev_u32 v42, 13, v1
v_ashrrev_i32 v42, 31, v42
v_bfi_b32 v40, v42, v40, v41
buffer_load_dword v60, v40, s[36:39], 0 offen
v_add_u32 v40, s62, v1
v_lshlrev_b32 v40, 7, v40
v_subrev_u32 v42, 4, v1
v_ashrrev_i32 v42, 31, v42
v_bfi_b32 v40, v42, v40, v41
buffer_load_dword v61, v40, s[32:35], 0 offen
v_and_b32 v34, 15, v1
v_bfe_u32 v35, v34, 1, 3
v_lshrrev_b32 v36, 4, v1
v_lshlrev_b32 v37, 7, v34
s_lshl_b32 s60, s47, 13
s_add_u32 s60, s60, 81920
s_add_u32 s61, s60, 4096
v_or_b32 v38, 0, v36
v_xor_b32 v38, v38, v35
v_lshl_add_u32 v38, v38, 4, v37
v_add_u32 v20, s60, v38
v_add_u32 v22, s61, v38
v_add_u32 v24, 98304, v38
v_or_b32 v38, 4, v36
v_xor_b32 v38, v38, v35
v_lshl_add_u32 v38, v38, 4, v37
v_add_u32 v21, s60, v38
v_add_u32 v23, s61, v38
v_add_u32 v25, 98304, v38
v_lshrrev_b32 v34, 4, v1
v_bfe_u32 v35, v1, 2, 2
v_lshrrev_b32 v36, 1, v35
v_and_b32 v37, 1, v34
v_lshl_or_b32 v36, v37, 1, v36
v_lshl_add_u32 v35, v34, 3, v35
v_and_b32 v37, 3, v1
v_lshlrev_b32 v37, 3, v37
s_lshl_b32 s60, s48, 1
v_xor_b32 v38, s60, v36
v_lshl_add_u32 v38, v38, 5, v37
v_mul_u32_u24 v39, 384, v35
v_add_u32 v12, v39, v38
v_lshl_add_u32 v14, v35, 7, v38
s_lshl_b32 s60, s48, 1
s_add_u32 s60, s60, 1
v_xor_b32 v38, s60, v36
v_lshl_add_u32 v38, v38, 5, v37
v_mul_u32_u24 v39, 384, v35
v_add_u32 v13, v39, v38
v_lshl_add_u32 v15, v35, 7, v38
v_add_u32 v16, 40960, v12
v_add_u32 v17, 40960, v13
v_add_u32 v18, 40960, v14
v_add_u32 v19, 40960, v15
s_waitcnt vmcnt(15)
v_lshlrev_b32 v200, 16, v44
v_and_b32 v201, 0xffff0000, v44
v_lshlrev_b32 v202, 16, v45
v_and_b32 v203, 0xffff0000, v45
v_lshlrev_b32 v204, 16, v46
v_and_b32 v205, 0xffff0000, v46
v_lshlrev_b32 v206, 16, v47
v_and_b32 v207, 0xffff0000, v47
v_lshlrev_b32 v208, 16, v48
v_and_b32 v209, 0xffff0000, v48
v_lshlrev_b32 v210, 16, v49
v_and_b32 v211, 0xffff0000, v49
v_lshlrev_b32 v212, 16, v50
v_and_b32 v213, 0xffff0000, v50
v_lshlrev_b32 v214, 16, v51
v_and_b32 v215, 0xffff0000, v51
v_pk_add_f32 v[216:217], v[200:201], v[202:203]
v_pk_add_f32 v[218:219], v[204:205], v[206:207]
v_pk_add_f32 v[220:221], v[208:209], v[210:211]
v_pk_add_f32 v[222:223], v[212:213], v[214:215]
v_pk_add_f32 v[216:217], v[216:217], v[218:219]
v_pk_add_f32 v[220:221], v[220:221], v[222:223]
v_pk_add_f32 v[216:217], v[216:217], v[220:221]
v_add_f32 v216, v216, v217
s_nop 1
v_add_f32_dpp v216, v216, v216 row_ror:8 row_mask:0xf bank_mask:0xf
s_nop 1
v_add_f32_dpp v216, v216, v216 row_ror:4 row_mask:0xf bank_mask:0xf
s_nop 1
v_add_f32_dpp v216, v216, v216 row_ror:2 row_mask:0xf bank_mask:0xf
s_nop 1
v_add_f32_dpp v216, v216, v216 row_ror:1 row_mask:0xf bank_mask:0xf
v_mov_b32 v217, v216
s_nop 1
v_permlane16_swap_b32 v216, v217
v_add_f32 v216, v216, v217
v_mul_f32 v216, 0x3b124925, v216
v_sub_f32 v218, 0, v216
v_pk_add_f32 v[200:201], v[200:201], v[218:219] op_sel_hi:[1,0]
v_pk_add_f32 v[202:203], v[202:203], v[218:219] op_sel_hi:[1,0]
v_pk_add_f32 v[204:205], v[204:205], v[218:219] op_sel_hi:[1,0]
v_pk_add_f32 v[206:207], v[206:207], v[218:219] op_sel_hi:[1,0]
v_pk_add_f32 v[208:209], v[208:209], v[218:219] op_sel_hi:[1,0]
v_pk_add_f32 v[210:211], v[210:211], v[218:219] op_sel_hi:[1,0]
v_pk_add_f32 v[212:213], v[212:213], v[218:219] op_sel_hi:[1,0]
v_pk_add_f32 v[214:215], v[214:215], v[218:219] op_sel_hi:[1,0]
v_pk_mul_f32 v[220:221], v[200:201], v[200:201]
v_pk_mul_f32 v[222:223], v[208:209], v[208:209]
v_pk_fma_f32 v[220:221], v[202:203], v[202:203], v[220:221]
v_pk_fma_f32 v[222:223], v[210:211], v[210:211], v[222:223]
v_pk_fma_f32 v[220:221], v[204:205], v[204:205], v[220:221]
v_pk_fma_f32 v[222:223], v[212:213], v[212:213], v[222:223]
v_pk_fma_f32 v[220:221], v[206:207], v[206:207], v[220:221]
v_pk_fma_f32 v[222:223], v[214:215], v[214:215], v[222:223]
v_add_f32 v220, v220, v221
v_add_f32 v222, v222, v223
v_fma_f32 v220, v222, v43, v220
s_nop 1
v_add_f32_dpp v220, v220, v220 row_ror:8 row_mask:0xf bank_mask:0xf
s_nop 1
v_add_f32_dpp v220, v220, v220 row_ror:4 row_mask:0xf bank_mask:0xf
s_nop 1
v_add_f32_dpp v220, v220, v220 row_ror:2 row_mask:0xf bank_mask:0xf
s_nop 1
v_add_f32_dpp v220, v220, v220 row_ror:1 row_mask:0xf bank_mask:0xf
v_mov_b32 v221, v220
s_nop 1
v_permlane16_swap_b32 v220, v221
v_add_f32 v220, v220, v221
v_mov_b32 v221, 0x3727c5ac
v_fmac_f32 v221, 0x3b124925, v220
v_rsq_f32 v217, v221
s_nop 0
v_or_b32 v217, 1, v217
v_lshrrev_b32 v193, 5, v1
v_lshlrev_b32 v193, 3, v193
buffer_store_dwordx2 v[216:217], v193, s[24:27], s82 offen sc1
s_waitcnt vmcnt(11)
s_barrier
ds_read_b128 a[0:3], v20 offset:0
ds_read_b128 a[4:7], v20 offset:2048
ds_read_b128 a[8:11], v22 offset:0
ds_read_b128 a[12:15], v22 offset:2048
ds_read_b128 a[16:19], v24 offset:0
ds_read_b64_tr_b16 a[40:41], v12 offset:0
ds_read_b64_tr_b16 a[42:43], v12 offset:1536
ds_read_b64_tr_b16 a[44:45], v13 offset:0
ds_read_b64_tr_b16 a[46:47], v13 offset:1536
ds_read_b64_tr_b16 a[48:49], v12 offset:128
ds_read_b64_tr_b16 a[50:51], v12 offset:1664
ds_read_b64_tr_b16 a[52:53], v13 offset:128
ds_read_b64_tr_b16 a[54:55], v13 offset:1664
ds_read_b64_tr_b16 a[56:57], v12 offset:256
ds_read_b64_tr_b16 a[58:59], v12 offset:1792
ds_read_b64_tr_b16 a[60:61], v13 offset:256
ds_read_b64_tr_b16 a[62:63], v13 offset:1792
ds_read_b64_tr_b16 a[64:65], v14 offset:12288
ds_read_b64_tr_b16 a[66:67], v14 offset:12800
ds_read_b64_tr_b16 a[68:69], v15 offset:12288
ds_read_b64_tr_b16 a[70:71], v15 offset:12800
ds_read_b64_tr_b16 a[72:73], v14 offset:16384
ds_read_b64_tr_b16 a[74:75], v14 offset:16896
ds_read_b64_tr_b16 a[76:77], v15 offset:16384
ds_read_b64_tr_b16 a[78:79], v15 offset:16896
s_waitcnt lgkmcnt(15)
v_mfma_f32_16x16x32_bf16 v[64:67], a[40:43], a[0:3], 0
s_waitcnt vmcnt(6)
s_barrier
v_mfma_f32_16x16x32_bf16 v[68:71], a[40:43], a[4:7], 0
ds_read_b128 a[20:23], v21 offset:0
s_lshl_b32 s50, s54, 7
s_add_u32 s54, s54, 1
s_cmp_eq_u32 s54, 7
s_cselect_b32 s54, 0, s54
s_add_u32 m0, s58, 18432
v_mfma_f32_16x16x32_bf16 v[72:75], a[40:43], a[8:11], 0
buffer_load_dwordx4 v7, s[8:11], s50 offen lds
s_add_u32 m0, s58, 19456
v_mfma_f32_16x16x32_bf16 v[76:79], a[40:43], a[12:15], 0
buffer_load_dwordx4 v8, s[8:11], s50 offen lds
v_mfma_f32_16x16x32_bf16 v[80:83], a[44:47], a[0:3], 0
ds_read_b64_tr_b16 a[40:41], v12 offset:20480
v_mfma_f32_16x16x32_bf16 v[84:87], a[44:47], a[4:7], 0
ds_read_b64_tr_b16 a[42:43], v12 offset:22016
s_add_u32 m0, s58, 20480
v_mfma_f32_16x16x32_bf16 v[88:91], a[44:47], a[8:11], 0
buffer_load_dwordx4 v9, s[8:11], s50 offen lds
s_add_u32 m0, s58, 21504
v_mfma_f32_16x16x32_bf16 v[92:95], a[44:47], a[12:15], 0
buffer_load_dwordx4 v10, s[8:11], s50 offen lds
s_waitcnt lgkmcnt(15)
v_mfma_f32_16x16x32_bf16 v[96:99], a[48:51], a[0:3], 0
ds_read_b128 a[24:27], v21 offset:2048
v_mfma_f32_16x16x32_bf16 v[100:103], a[48:51], a[4:7], 0
ds_read_b64_tr_b16 a[44:45], v13 offset:20480
v_mfma_f32_16x16x32_bf16 v[104:107], a[48:51], a[8:11], 0
ds_read_b64_tr_b16 a[46:47], v13 offset:22016
s_mul_i32 s52, s53, 114688
s_mul_i32 s51, s53, 86016
s_add_u32 s53, s53, 1
s_cmp_eq_u32 s53, 14
s_cselect_b32 s53, 0, s53
s_add_u32 m0, s55, 40960
v_mfma_f32_16x16x32_bf16 v[108:111], a[48:51], a[12:15], 0
buffer_load_dwordx4 v2, s[12:15], s51 offen lds
v_mfma_f32_16x16x32_bf16 v[112:115], a[52:55], a[0:3], 0
ds_read_b128 a[28:31], v23 offset:0
v_mfma_f32_16x16x32_bf16 v[116:119], a[52:55], a[4:7], 0
ds_read_b64_tr_b16 a[48:49], v12 offset:20608
s_add_u32 m0, s55, 41984
v_mfma_f32_16x16x32_bf16 v[120:123], a[52:55], a[8:11], 0
buffer_load_dwordx4 v3, s[12:15], s51 offen lds
s_add_u32 m0, s55, 43008
v_mfma_f32_16x16x32_bf16 v[124:127], a[52:55], a[12:15], 0
buffer_load_dwordx4 v4, s[12:15], s51 offen lds
s_waitcnt lgkmcnt(15)
v_mfma_f32_16x16x32_bf16 v[128:131], a[0:3], a[56:59], 0
ds_read_b64_tr_b16 a[50:51], v12 offset:22144
v_mfma_f32_16x16x32_bf16 v[132:135], a[4:7], a[56:59], 0
ds_read_b128 a[32:35], v23 offset:2048
v_mfma_f32_16x16x32_bf16 v[136:139], a[8:11], a[56:59], 0
ds_read_b64_tr_b16 a[52:53], v13 offset:20608
v_mfma_f32_16x16x32_bf16 v[140:143], a[12:15], a[56:59], 0
ds_read_b64_tr_b16 a[54:55], v13 offset:22144
s_add_u32 m0, s56, 40960
v_mfma_f32_16x16x32_bf16 v[224:227], a[16:19], a[56:59], 0
buffer_load_dwordx4 v5, s[16:19], s52 offen lds
v_mfma_f32_16x16x32_bf16 v[144:147], a[0:3], a[60:63], 0
ds_read_b128 a[36:39], v25 offset:0
v_mfma_f32_16x16x32_bf16 v[148:151], a[4:7], a[60:63], 0
ds_read_b64_tr_b16 a[56:57], v12 offset:20736
v_mfma_f32_16x16x32_bf16 v[152:155], a[8:11], a[60:63], 0
ds_read_b64_tr_b16 a[58:59], v12 offset:22272
s_add_u32 m0, s57, 40960
v_mfma_f32_16x16x32_bf16 v[156:159], a[12:15], a[60:63], 0
buffer_load_dwordx4 v5, s[20:23], s52 offen lds
s_lshl_b32 s50, s54, 7
s_add_u32 s54, s54, 1
s_cmp_eq_u32 s54, 7
s_cselect_b32 s54, 0, s54
s_add_u32 m0, s58, 36864
v_mfma_f32_16x16x32_bf16 v[228:231], a[16:19], a[60:63], 0
buffer_load_dwordx4 v7, s[8:11], s50 offen lds
s_waitcnt lgkmcnt(15)
v_mfma_f32_16x16x32_bf16 v[160:163], a[64:67], a[0:3], 0
ds_read_b64_tr_b16 a[60:61], v13 offset:20736
v_mfma_f32_16x16x32_bf16 v[164:167], a[64:67], a[4:7], 0
ds_read_b64_tr_b16 a[62:63], v13 offset:22272
s_add_u32 m0, s58, 37888
v_mfma_f32_16x16x32_bf16 v[168:171], a[64:67], a[8:11], 0
buffer_load_dwordx4 v8, s[8:11], s50 offen lds
s_mul_i32 s52, s53, 114688
s_mul_i32 s51, s53, 86016
s_add_u32 s53, s53, 1
s_cmp_eq_u32 s53, 14
s_cselect_b32 s53, 0, s53
s_add_u32 m0, s55, 61440
v_mfma_f32_16x16x32_bf16 v[172:175], a[64:67], a[12:15], 0
buffer_load_dwordx4 v2, s[12:15], s51 offen lds
v_mfma_f32_16x16x32_bf16 v[176:179], a[68:71], a[0:3], 0
ds_read_b64_tr_b16 a[64:65], v14 offset:32768
v_mfma_f32_16x16x32_bf16 v[180:183], a[68:71], a[4:7], 0
ds_read_b64_tr_b16 a[66:67], v14 offset:33280
v_mfma_f32_16x16x32_bf16 v[184:187], a[68:71], a[8:11], 0
s_add_u32 m0, s55, 62464
v_mfma_f32_16x16x32_bf16 v[188:191], a[68:71], a[12:15], 0
buffer_load_dwordx4 v3, s[12:15], s51 offen lds
v_mfma_f32_16x16x32_bf16 v[192:195], a[72:75], a[0:3], 0
ds_read_b64_tr_b16 a[68:69], v15 offset:32768
v_mfma_f32_16x16x32_bf16 v[196:199], a[72:75], a[4:7], 0
ds_read_b64_tr_b16 a[70:71], v15 offset:33280
s_add_u32 m0, s55, 63488
v_mfma_f32_16x16x32_bf16 v[200:203], a[72:75], a[8:11], 0
buffer_load_dwordx4 v4, s[12:15], s51 offen lds
s_add_u32 m0, s56, 61440
v_mfma_f32_16x16x32_bf16 v[204:207], a[72:75], a[12:15], 0
buffer_load_dwordx4 v5, s[16:19], s52 offen lds
v_mfma_f32_16x16x32_bf16 v[208:211], a[76:79], a[0:3], 0
ds_read_b64_tr_b16 a[72:73], v14 offset:36864
v_mfma_f32_16x16x32_bf16 v[212:215], a[76:79], a[4:7], 0
ds_read_b64_tr_b16 a[74:75], v14 offset:37376
v_mfma_f32_16x16x32_bf16 v[216:219], a[76:79], a[8:11], 0
s_add_u32 m0, s57, 61440
v_mfma_f32_16x16x32_bf16 v[220:223], a[76:79], a[12:15], 0
buffer_load_dwordx4 v5, s[20:23], s52 offen lds
s_waitcnt lgkmcnt(10)
v_mfma_f32_16x16x32_bf16 v[64:67], a[40:43], a[20:23], v[64:67]
s_waitcnt vmcnt(7)
s_barrier
v_mfma_f32_16x16x32_bf16 v[68:71], a[40:43], a[24:27], v[68:71]
ds_read_b64_tr_b16 a[76:77], v15 offset:36864
v_mfma_f32_16x16x32_bf16 v[72:75], a[40:43], a[28:31], v[72:75]
ds_read_b64_tr_b16 a[78:79], v15 offset:37376
s_add_u32 m0, s58, 38912
v_mfma_f32_16x16x32_bf16 v[76:79], a[40:43], a[32:35], v[76:79]
buffer_load_dwordx4 v9, s[8:11], s50 offen lds
v_mfma_f32_16x16x32_bf16 v[80:83], a[44:47], a[20:23], v[80:83]
ds_read_b128 a[0:3], v20 offset:18432
v_mfma_f32_16x16x32_bf16 v[84:87], a[44:47], a[24:27], v[84:87]
ds_read_b64_tr_b16 a[40:41], v16 offset:0
v_mfma_f32_16x16x32_bf16 v[88:91], a[44:47], a[28:31], v[88:91]
ds_read_b64_tr_b16 a[42:43], v16 offset:1536
s_add_u32 m0, s58, 39936
v_mfma_f32_16x16x32_bf16 v[92:95], a[44:47], a[32:35], v[92:95]
buffer_load_dwordx4 v10, s[8:11], s50 offen lds
v_mfma_f32_16x16x32_bf16 v[96:99], a[48:51], a[20:23], v[96:99]
ds_read_b128 a[4:7], v20 offset:20480
v_mfma_f32_16x16x32_bf16 v[100:103], a[48:51], a[24:27], v[100:103]
s_cmp_lg_u32 s46, 0
s_cbranch_scc1 L_noinc_33
s_and_b32 s60, s2, 3
s_lshl_b32 s60, s60, 6
v_mov_b32 v36, 1
v_cmp_eq_u32 vcc, 0, v1
v_mov_b32 v37, 2146435072
v_mov_b32 v38, s60
s_nop 1
v_cndmask_b32 v37, v37, v38, vcc
buffer_atomic_add v36, v37, s[4:7], 0 offen
L_noinc_33:
v_mfma_f32_16x16x32_bf16 v[104:107], a[48:51], a[28:31], v[104:107]
ds_read_b64_tr_b16 a[44:45], v17 offset:0
s_mul_i32 s52, s53, 114688
s_mul_i32 s51, s53, 86016
s_add_u32 s53, s53, 1
s_cmp_eq_u32 s53, 14
s_cselect_b32 s53, 0, s53
s_add_u32 m0, s55, 0
v_mfma_f32_16x16x32_bf16 v[108:111], a[48:51], a[32:35], v[108:111]
buffer_load_dwordx4 v2, s[12:15], s51 offen lds
v_mfma_f32_16x16x32_bf16 v[112:115], a[52:55], a[20:23], v[112:115]
ds_read_b64_tr_b16 a[46:47], v17 offset:1536
v_mfma_f32_16x16x32_bf16 v[116:119], a[52:55], a[24:27], v[116:119]
ds_read_b128 a[8:11], v22 offset:18432
v_mfma_f32_16x16x32_bf16 v[120:123], a[52:55], a[28:31], v[120:123]
ds_read_b64_tr_b16 a[48:49], v16 offset:128
v_mfma_f32_16x16x32_bf16 v[124:127], a[52:55], a[32:35], v[124:127]
ds_read_b64_tr_b16 a[50:51], v16 offset:1664
s_waitcnt lgkmcnt(15)
v_mfma_f32_16x16x32_bf16 v[128:131], a[20:23], a[56:59], v[128:131]
ds_read_b128 a[12:15], v22 offset:20480
v_mfma_f32_16x16x32_bf16 v[132:135], a[24:27], a[56:59], v[132:135]
ds_read_b64_tr_b16 a[52:53], v17 offset:128
v_mfma_f32_16x16x32_bf16 v[136:139], a[28:31], a[56:59], v[136:139]
ds_read_b64_tr_b16 a[54:55], v17 offset:1664
v_mfma_f32_16x16x32_bf16 v[140:143], a[32:35], a[56:59], v[140:143]
ds_read_b128 a[16:19], v24 offset:18432
s_add_u32 m0, s55, 1024
v_mfma_f32_16x16x32_bf16 v[224:227], a[36:39], a[56:59], v[224:227]
buffer_load_dwordx4 v3, s[12:15], s51 offen lds
v_mfma_f32_16x16x32_bf16 v[144:147], a[20:23], a[60:63], v[144:147]
ds_read_b64_tr_b16 a[56:57], v16 offset:256
v_mfma_f32_16x16x32_bf16 v[148:151], a[24:27], a[60:63], v[148:151]
ds_read_b64_tr_b16 a[58:59], v16 offset:1792
v_mfma_f32_16x16x32_bf16 v[152:155], a[28:31], a[60:63], v[152:155]
v_mfma_f32_16x16x32_bf16 v[156:159], a[32:35], a[60:63], v[156:159]
s_add_u32 m0, s55, 2048
v_mfma_f32_16x16x32_bf16 v[228:231], a[36:39], a[60:63], v[228:231]
buffer_load_dwordx4 v4, s[12:15], s51 offen lds
s_waitcnt lgkmcnt(15)
v_mfma_f32_16x16x32_bf16 v[160:163], a[64:67], a[20:23], v[160:163]
ds_read_b64_tr_b16 a[60:61], v17 offset:256
v_mfma_f32_16x16x32_bf16 v[164:167], a[64:67], a[24:27], v[164:167]
ds_read_b64_tr_b16 a[62:63], v17 offset:1792
v_mfma_f32_16x16x32_bf16 v[168:171], a[64:67], a[28:31], v[168:171]
v_mfma_f32_16x16x32_bf16 v[172:175], a[64:67], a[32:35], v[172:175]
v_mfma_f32_16x16x32_bf16 v[176:179], a[68:71], a[20:23], v[176:179]
ds_read_b64_tr_b16 a[64:65], v18 offset:12288
v_mfma_f32_16x16x32_bf16 v[180:183], a[68:71], a[24:27], v[180:183]
ds_read_b64_tr_b16 a[66:67], v18 offset:12800
v_mfma_f32_16x16x32_bf16 v[184:187], a[68:71], a[28:31], v[184:187]
s_add_u32 m0, s56, 0
v_mfma_f32_16x16x32_bf16 v[188:191], a[68:71], a[32:35], v[188:191]
buffer_load_dwordx4 v5, s[16:19], s52 offen lds
v_mfma_f32_16x16x32_bf16 v[192:195], a[72:75], a[20:23], v[192:195]
ds_read_b64_tr_b16 a[68:69], v19 offset:12288
v_mfma_f32_16x16x32_bf16 v[196:199], a[72:75], a[24:27], v[196:199]
ds_read_b64_tr_b16 a[70:71], v19 offset:12800
v_mfma_f32_16x16x32_bf16 v[200:203], a[72:75], a[28:31], v[200:203]
s_add_u32 m0, s57, 0
v_mfma_f32_16x16x32_bf16 v[204:207], a[72:75], a[32:35], v[204:207]
buffer_load_dwordx4 v5, s[20:23], s52 offen lds
v_mfma_f32_16x16x32_bf16 v[208:211], a[76:79], a[20:23], v[208:211]
ds_read_b64_tr_b16 a[72:73], v18 offset:16384
v_mfma_f32_16x16x32_bf16 v[212:215], a[76:79], a[24:27], v[212:215]
ds_read_b64_tr_b16 a[74:75], v18 offset:16896
v_mfma_f32_16x16x32_bf16 v[216:219], a[76:79], a[28:31], v[216:219]
v_mfma_f32_16x16x32_bf16 v[220:223], a[76:79], a[32:35], v[220:223]
ds_read_b64_tr_b16 a[76:77], v19 offset:16384
ds_read_b64_tr_b16 a[78:79], v19 offset:16896
s_waitcnt lgkmcnt(12)
v_mfma_f32_16x16x32_bf16 v[64:67], a[40:43], a[0:3], v[64:67]
s_waitcnt vmcnt(7)
s_barrier
v_mfma_f32_16x16x32_bf16 v[68:71], a[40:43], a[4:7], v[68:71]
ds_read_b128 a[20:23], v21 offset:18432
v_mfma_f32_16x16x32_bf16 v[72:75], a[40:43], a[8:11], v[72:75]
s_lshl_b32 s50, s54, 7
s_add_u32 s54, s54, 1
s_cmp_eq_u32 s54, 7
s_cselect_b32 s54, 0, s54
s_add_u32 m0, s58, 0
v_mfma_f32_16x16x32_bf16 v[76:79], a[40:43], a[12:15], v[76:79]
buffer_load_dwordx4 v7, s[8:11], s50 offen lds
v_mfma_f32_16x16x32_bf16 v[80:83], a[44:47], a[0:3], v[80:83]
ds_read_b64_tr_b16 a[40:41], v16 offset:20480
v_mfma_f32_16x16x32_bf16 v[84:87], a[44:47], a[4:7], v[84:87]
ds_read_b64_tr_b16 a[42:43], v16 offset:22016
v_mfma_f32_16x16x32_bf16 v[88:91], a[44:47], a[8:11], v[88:91]
ds_read_b128 a[24:27], v21 offset:20480
s_and_b32 s60, s2, 7
s_lshr_b32 s61, s2, 3
s_add_u32 m0, s58, 1024
v_mfma_f32_16x16x32_bf16 v[92:95], a[44:47], a[12:15], v[92:95]
buffer_load_dwordx4 v8, s[8:11], s50 offen lds
s_and_b32 s62, s61, 7
v_mfma_f32_16x16x32_bf16 v[96:99], a[48:51], a[0:3], v[96:99]
ds_read_b64_tr_b16 a[44:45], v17 offset:20480
v_mfma_f32_16x16x32_bf16 v[100:103], a[48:51], a[4:7], v[100:103]
ds_read_b64_tr_b16 a[46:47], v17 offset:22016
v_mfma_f32_16x16x32_bf16 v[104:107], a[48:51], a[8:11], v[104:107]
ds_read_b128 a[28:31], v23 offset:18432
s_lshr_b32 s63, s61, 4
s_lshl3_add_u32 s62, s63, s62
s_mul_i32 s52, s53, 114688
s_mul_i32 s51, s53, 86016
s_add_u32 s53, s53, 1
s_cmp_eq_u32 s53, 14
s_cselect_b32 s53, 0, s53
s_add_u32 m0, s55, 20480
v_mfma_f32_16x16x32_bf16 v[108:111], a[48:51], a[12:15], v[108:111]
buffer_load_dwordx4 v2, s[12:15], s51 offen lds
s_lshr_b32 s69, s62, 2
v_mfma_f32_16x16x32_bf16 v[112:115], a[52:55], a[0:3], v[112:115]
ds_read_b64_tr_b16 a[48:49], v16 offset:20608
v_mfma_f32_16x16x32_bf16 v[116:119], a[52:55], a[4:7], v[116:119]
ds_read_b64_tr_b16 a[50:51], v16 offset:22144
v_mfma_f32_16x16x32_bf16 v[120:123], a[52:55], a[8:11], v[120:123]
ds_read_b128 a[32:35], v23 offset:20480
s_and_b32 s63, s62, 3
s_mul_i32 s63, s63, 3
v_mfma_f32_16x16x32_bf16 v[124:127], a[52:55], a[12:15], v[124:127]
s_lshl4_add_u32 s68, s60, s63
s_waitcnt lgkmcnt(15)
v_mfma_f32_16x16x32_bf16 v[128:131], a[0:3], a[56:59], v[128:131]
ds_read_b64_tr_b16 a[52:53], v17 offset:20608
v_mfma_f32_16x16x32_bf16 v[132:135], a[4:7], a[56:59], v[132:135]
ds_read_b64_tr_b16 a[54:55], v17 offset:22144
v_mfma_f32_16x16x32_bf16 v[136:139], a[8:11], a[56:59], v[136:139]
ds_read_b128 a[36:39], v25 offset:18432
s_lshr_b32 s60, s46, 1
s_mul_i32 s60, s60, 448
v_mfma_f32_16x16x32_bf16 v[140:143], a[12:15], a[56:59], v[140:143]
s_and_b32 s61, s46, 1
s_add_u32 m0, s55, 21504
v_mfma_f32_16x16x32_bf16 v[224:227], a[16:19], a[56:59], v[224:227]
buffer_load_dwordx4 v3, s[12:15], s51 offen lds
v_mfma_f32_16x16x32_bf16 v[144:147], a[0:3], a[60:63], v[144:147]
ds_read_b64_tr_b16 a[56:57], v16 offset:20736
v_mfma_f32_16x16x32_bf16 v[148:151], a[4:7], a[60:63], v[148:151]
ds_read_b64_tr_b16 a[58:59], v16 offset:22272
s_mul_i32 s63, s61, 384
s_add_u32 s63, s63, s60
v_mfma_f32_16x16x32_bf16 v[152:155], a[8:11], a[60:63], v[152:155]
s_mul_i32 s71, s63, 0x380
v_mfma_f32_16x16x32_bf16 v[156:159], a[12:15], a[60:63], v[156:159]
s_add_u32 m0, s55, 22528
v_mfma_f32_16x16x32_bf16 v[228:231], a[16:19], a[60:63], v[228:231]
buffer_load_dwordx4 v4, s[12:15], s51 offen lds
s_waitcnt lgkmcnt(15)
v_mfma_f32_16x16x32_bf16 v[160:163], a[64:67], a[0:3], v[160:163]
ds_read_b64_tr_b16 a[60:61], v17 offset:20736
v_mfma_f32_16x16x32_bf16 v[164:167], a[64:67], a[4:7], v[164:167]
ds_read_b64_tr_b16 a[62:63], v17 offset:22272
s_mul_i32 s63, s61, 160
s_add_u32 s63, s63, s60
v_mfma_f32_16x16x32_bf16 v[168:171], a[64:67], a[8:11], v[168:171]
s_add_u32 s63, s63, 64
v_mfma_f32_16x16x32_bf16 v[172:175], a[64:67], a[12:15], v[172:175]
v_mfma_f32_16x16x32_bf16 v[176:179], a[68:71], a[0:3], v[176:179]
ds_read_b64_tr_b16 a[64:65], v18 offset:32768
v_mfma_f32_16x16x32_bf16 v[180:183], a[68:71], a[4:7], v[180:183]
ds_read_b64_tr_b16 a[66:67], v18 offset:33280
s_mul_i32 s70, s63, 0x380
s_mul_i32 s72, s46, 50176
v_mfma_f32_16x16x32_bf16 v[184:187], a[68:71], a[8:11], v[184:187]
s_lshl_b32 s74, s46, 12
s_add_u32 m0, s56, 20480
v_mfma_f32_16x16x32_bf16 v[188:191], a[68:71], a[12:15], v[188:191]
buffer_load_dwordx4 v5, s[16:19], s52 offen lds
v_mfma_f32_16x16x32_bf16 v[192:195], a[72:75], a[0:3], v[192:195]
ds_read_b64_tr_b16 a[68:69], v19 offset:32768
v_mfma_f32_16x16x32_bf16 v[196:199], a[72:75], a[4:7], v[196:199]
ds_read_b64_tr_b16 a[70:71], v19 offset:33280
s_mul_i32 s60, s68, 72
s_mul_i32 s61, s46, 9
v_mfma_f32_16x16x32_bf16 v[200:203], a[72:75], a[8:11], v[200:203]
s_add_u32 s60, s60, s61
s_add_u32 m0, s57, 20480
v_mfma_f32_16x16x32_bf16 v[204:207], a[72:75], a[12:15], v[204:207]
buffer_load_dwordx4 v5, s[20:23], s52 offen lds
v_mfma_f32_16x16x32_bf16 v[208:211], a[76:79], a[0:3], v[208:211]
ds_read_b64_tr_b16 a[72:73], v18 offset:36864
v_mfma_f32_16x16x32_bf16 v[212:215], a[76:79], a[4:7], v[212:215]
ds_read_b64_tr_b16 a[74:75], v18 offset:37376
s_lshl_b32 s73, s60, 10
s_lshl_b32 s60, s46, 4
v_mfma_f32_16x16x32_bf16 v[216:219], a[76:79], a[8:11], v[216:219]
s_add_u32 s79, s60, 9699328
v_mfma_f32_16x16x32_bf16 v[220:223], a[76:79], a[12:15], v[220:223]
s_waitcnt lgkmcnt(10)
v_mfma_f32_16x16x32_bf16 v[64:67], a[40:43], a[20:23], v[64:67]
s_waitcnt vmcnt(7)
s_barrier
v_mfma_f32_16x16x32_bf16 v[68:71], a[40:43], a[24:27], v[68:71]
ds_read_b64_tr_b16 a[76:77], v19 offset:36864
v_mfma_f32_16x16x32_bf16 v[72:75], a[40:43], a[28:31], v[72:75]
ds_read_b64_tr_b16 a[78:79], v19 offset:37376
s_add_u32 m0, s58, 2048
v_mfma_f32_16x16x32_bf16 v[76:79], a[40:43], a[32:35], v[76:79]
buffer_load_dwordx4 v9, s[8:11], s50 offen lds
v_mfma_f32_16x16x32_bf16 v[80:83], a[44:47], a[20:23], v[80:83]
ds_read_b128 a[0:3], v20 offset:36864
v_mfma_f32_16x16x32_bf16 v[84:87], a[44:47], a[24:27], v[84:87]
ds_read_b64_tr_b16 a[40:41], v12 offset:0
v_mfma_f32_16x16x32_bf16 v[88:91], a[44:47], a[28:31], v[88:91]
ds_read_b64_tr_b16 a[42:43], v12 offset:1536
s_add_u32 m0, s58, 3072
v_mfma_f32_16x16x32_bf16 v[92:95], a[44:47], a[32:35], v[92:95]
buffer_load_dwordx4 v10, s[8:11], s50 offen lds
v_mfma_f32_16x16x32_bf16 v[96:99], a[48:51], a[20:23], v[96:99]
ds_read_b128 a[4:7], v20 offset:38912
v_min_u32 v36, 143, v0
v_mfma_f32_16x16x32_bf16 v[100:103], a[48:51], a[24:27], v[100:103]
v_sub_u32 v37, 127, v36
v_ashrrev_i32 v37, 31, v37
v_mfma_f32_16x16x32_bf16 v[104:107], a[48:51], a[28:31], v[104:107]
v_and_b32 v37, 0xffffff70, v37
ds_read_b64_tr_b16 a[44:45], v13 offset:0
s_mul_i32 s52, s53, 114688
s_mul_i32 s51, s53, 86016
s_add_u32 s53, s53, 1
s_cmp_eq_u32 s53, 14
s_cselect_b32 s53, 0, s53
s_add_u32 m0, s55, 40960
v_mfma_f32_16x16x32_bf16 v[108:111], a[48:51], a[32:35], v[108:111]
buffer_load_dwordx4 v2, s[12:15], s51 offen lds
v_mfma_f32_16x16x32_bf16 v[112:115], a[52:55], a[20:23], v[112:115]
ds_read_b64_tr_b16 a[46:47], v13 offset:1536
v_mfma_f32_16x16x32_bf16 v[116:119], a[52:55], a[24:27], v[116:119]
ds_read_b128 a[8:11], v22 offset:36864
v_add_u32 v36, v36, v37
v_mfma_f32_16x16x32_bf16 v[120:123], a[52:55], a[28:31], v[120:123]
v_add_u32 v36, s66, v36
v_max_i32 v36, 0, v36
v_mfma_f32_16x16x32_bf16 v[124:127], a[52:55], a[32:35], v[124:127]
v_lshlrev_b32 v26, 3, v36
ds_read_b64_tr_b16 a[48:49], v12 offset:128
s_waitcnt lgkmcnt(15)
v_mfma_f32_16x16x32_bf16 v[128:131], a[20:23], a[56:59], v[128:131]
ds_read_b64_tr_b16 a[50:51], v12 offset:1664
v_mfma_f32_16x16x32_bf16 v[132:135], a[24:27], a[56:59], v[132:135]
ds_read_b128 a[12:15], v22 offset:38912
v_min_u32 v28, 0xef, v0
v_mfma_f32_16x16x32_bf16 v[136:139], a[28:31], a[56:59], v[136:139]
v_lshlrev_b32 v28, 2, v28
v_add_u32 v28, 139392, v28
v_mfma_f32_16x16x32_bf16 v[140:143], a[32:35], a[56:59], v[140:143]
v_lshlrev_b32 v27, 4, v1
ds_read_b64_tr_b16 a[52:53], v13 offset:128
s_add_u32 m0, s55, 41984
v_mfma_f32_16x16x32_bf16 v[224:227], a[36:39], a[56:59], v[224:227]
buffer_load_dwordx4 v3, s[12:15], s51 offen lds
v_mfma_f32_16x16x32_bf16 v[144:147], a[20:23], a[60:63], v[144:147]
ds_read_b64_tr_b16 a[54:55], v13 offset:1664
v_mfma_f32_16x16x32_bf16 v[148:151], a[24:27], a[60:63], v[148:151]
ds_read_b128 a[16:19], v24 offset:36864
v_lshlrev_b32 v35, 6, v1
s_lshl_b32 s60, s46, 10
s_add_u32 s60, s60, 141312
v_mfma_f32_16x16x32_bf16 v[152:155], a[28:31], a[60:63], v[152:155]
v_add_u32 v33, s60, v27
ds_read_b64_tr_b16 a[56:57], v12 offset:256
v_mfma_f32_16x16x32_bf16 v[156:159], a[32:35], a[60:63], v[156:159]
ds_read_b64_tr_b16 a[58:59], v12 offset:1792
s_xor_b32 s61, s46, 2
s_lshl_b32 s61, s61, 10
s_add_u32 m0, s55, 43008
v_mfma_f32_16x16x32_bf16 v[228:231], a[36:39], a[60:63], v[228:231]
buffer_load_dwordx4 v4, s[12:15], s51 offen lds
s_add_u32 s61, s61, 141312
v_add_u32 v34, s61, v27
s_waitcnt lgkmcnt(15)
v_mfma_f32_16x16x32_bf16 v[160:163], a[64:67], a[20:23], v[160:163]
ds_read_b64_tr_b16 a[60:61], v13 offset:256
v_mfma_f32_16x16x32_bf16 v[164:167], a[64:67], a[24:27], v[164:167]
ds_read_b64_tr_b16 a[62:63], v13 offset:1792
s_mul_i32 s60, s48, 1088
s_add_u32 s60, s60, 137216
v_lshrrev_b32 v36, 4, v1
v_mfma_f32_16x16x32_bf16 v[168:171], a[64:67], a[28:31], v[168:171]
v_lshl_add_u32 v36, v36, 4, v27
v_mfma_f32_16x16x32_bf16 v[172:175], a[64:67], a[32:35], v[172:175]
v_mfma_f32_16x16x32_bf16 v[176:179], a[68:71], a[20:23], v[176:179]
ds_read_b64_tr_b16 a[64:65], v14 offset:12288
v_mfma_f32_16x16x32_bf16 v[180:183], a[68:71], a[24:27], v[180:183]
ds_read_b64_tr_b16 a[66:67], v14 offset:12800
v_add_u32 v29, s60, v36
s_mul_i32 s60, s45, 7
s_lshl_b32 s61, s47, 2
v_mfma_f32_16x16x32_bf16 v[184:187], a[68:71], a[28:31], v[184:187]
s_add_u32 s60, s60, s61
s_add_u32 m0, s56, 40960
v_mfma_f32_16x16x32_bf16 v[188:191], a[68:71], a[32:35], v[188:191]
buffer_load_dwordx4 v5, s[16:19], s52 offen lds
v_mfma_f32_16x16x32_bf16 v[192:195], a[72:75], a[20:23], v[192:195]
ds_read_b64_tr_b16 a[68:69], v15 offset:12288
v_mfma_f32_16x16x32_bf16 v[196:199], a[72:75], a[24:27], v[196:199]
ds_read_b64_tr_b16 a[70:71], v15 offset:12800
s_lshl_b32 s60, s60, 1
s_add_u32 s60, s60, s48
v_mfma_f32_16x16x32_bf16 v[200:203], a[72:75], a[28:31], v[200:203]
s_lshl_b32 s60, s60, 10
s_add_u32 s80, s60, 9469952
s_add_u32 m0, s57, 40960
v_mfma_f32_16x16x32_bf16 v[204:207], a[72:75], a[32:35], v[204:207]
buffer_load_dwordx4 v5, s[20:23], s52 offen lds
v_mfma_f32_16x16x32_bf16 v[208:211], a[76:79], a[20:23], v[208:211]
ds_read_b64_tr_b16 a[72:73], v14 offset:16384
v_mfma_f32_16x16x32_bf16 v[212:215], a[76:79], a[24:27], v[212:215]
ds_read_b64_tr_b16 a[74:75], v14 offset:16896
s_add_u32 s81, s80, 2048
s_add_u32 s82, s80, 4096
v_mfma_f32_16x16x32_bf16 v[216:219], a[76:79], a[28:31], v[216:219]
s_add_u32 s83, s80, 6144
v_mfma_f32_16x16x32_bf16 v[220:223], a[76:79], a[32:35], v[220:223]
s_cmp_eq_u32 s47, 1
s_cselect_b32 s83, 0xf0000000, s83
s_waitcnt lgkmcnt(10)
v_mfma_f32_16x16x32_bf16 v[64:67], a[40:43], a[0:3], v[64:67]
s_waitcnt vmcnt(7)
s_barrier
v_mfma_f32_16x16x32_bf16 v[68:71], a[40:43], a[4:7], v[68:71]
ds_read_b64_tr_b16 a[76:77], v15 offset:16384
v_mfma_f32_16x16x32_bf16 v[72:75], a[40:43], a[8:11], v[72:75]
ds_read_b64_tr_b16 a[78:79], v15 offset:16896
s_lshl_b32 s50, s54, 7
s_add_u32 s54, s54, 1
s_cmp_eq_u32 s54, 7
s_cselect_b32 s54, 0, s54
s_add_u32 m0, s58, 18432
v_mfma_f32_16x16x32_bf16 v[76:79], a[40:43], a[12:15], v[76:79]
buffer_load_dwordx4 v7, s[8:11], s50 offen lds
v_mfma_f32_16x16x32_bf16 v[80:83], a[44:47], a[0:3], v[80:83]
ds_read_b128 a[20:23], v21 offset:36864
v_mfma_f32_16x16x32_bf16 v[84:87], a[44:47], a[4:7], v[84:87]
ds_read_b64_tr_b16 a[40:41], v12 offset:20480
v_mfma_f32_16x16x32_bf16 v[88:91], a[44:47], a[8:11], v[88:91]
ds_read_b64_tr_b16 a[42:43], v12 offset:22016
s_add_u32 m0, s58, 19456
v_mfma_f32_16x16x32_bf16 v[92:95], a[44:47], a[12:15], v[92:95]
buffer_load_dwordx4 v8, s[8:11], s50 offen lds
v_mfma_f32_16x16x32_bf16 v[96:99], a[48:51], a[0:3], v[96:99]
ds_read_b128 a[24:27], v21 offset:38912
v_lshrrev_b32 v60, 3, v1
v_mfma_f32_16x16x32_bf16 v[100:103], a[48:51], a[4:7], v[100:103]
v_and_b32 v61, 7, v1
ds_read_b64_tr_b16 a[44:45], v13 offset:20480
v_mfma_f32_16x16x32_bf16 v[104:107], a[48:51], a[8:11], v[104:107]
ds_read_b64_tr_b16 a[46:47], v13 offset:22016
s_mul_i32 s52, s53, 114688
s_mul_i32 s51, s53, 86016
s_add_u32 s53, s53, 1
s_cmp_eq_u32 s53, 14
s_cselect_b32 s53, 0, s53
s_add_u32 m0, s55, 61440
v_mfma_f32_16x16x32_bf16 v[108:111], a[48:51], a[12:15], v[108:111]
buffer_load_dwordx4 v2, s[12:15], s51 offen lds
v_mfma_f32_16x16x32_bf16 v[112:115], a[52:55], a[0:3], v[112:115]
ds_read_b128 a[28:31], v23 offset:36864
v_bfe_u32 v62, v60, 1, 2
v_mfma_f32_16x16x32_bf16 v[116:119], a[52:55], a[4:7], v[116:119]
v_lshlrev_b32 v62, 1, v62
ds_read_b64_tr_b16 a[48:49], v12 offset:20608
v_mfma_f32_16x16x32_bf16 v[120:123], a[52:55], a[8:11], v[120:123]
ds_read_b64_tr_b16 a[50:51], v12 offset:22144
v_mfma_f32_16x16x32_bf16 v[124:127], a[52:55], a[12:15], v[124:127]
ds_read_b128 a[32:35], v23 offset:38912
v_xor_b32 v61, v61, v62
s_waitcnt lgkmcnt(15)
v_mfma_f32_16x16x32_bf16 v[128:131], a[0:3], a[56:59], v[128:131]
v_mul_u32_u24 v60, 896, v60
ds_read_b64_tr_b16 a[52:53], v13 offset:20608
v_mfma_f32_16x16x32_bf16 v[132:135], a[4:7], a[56:59], v[132:135]
ds_read_b64_tr_b16 a[54:55], v13 offset:22144
v_mfma_f32_16x16x32_bf16 v[136:139], a[8:11], a[56:59], v[136:139]
ds_read_b128 a[36:39], v25 offset:36864
v_lshl_add_u32 v60, v61, 4, v60
v_mfma_f32_16x16x32_bf16 v[140:143], a[12:15], a[56:59], v[140:143]
s_add_u32 m0, s55, 62464
v_mfma_f32_16x16x32_bf16 v[224:227], a[16:19], a[56:59], v[224:227]
buffer_load_dwordx4 v3, s[12:15], s51 offen lds
v_mfma_f32_16x16x32_bf16 v[144:147], a[0:3], a[60:63], v[144:147]
ds_read_b64_tr_b16 a[56:57], v12 offset:20736
v_mfma_f32_16x16x32_bf16 v[148:151], a[4:7], a[60:63], v[148:151]
ds_read_b64_tr_b16 a[58:59], v12 offset:22272
s_lshl_b32 s60, s69, 7
v_mfma_f32_16x16x32_bf16 v[152:155], a[8:11], a[60:63], v[152:155]
v_mfma_f32_16x16x32_bf16 v[156:159], a[12:15], a[60:63], v[156:159]
s_add_u32 m0, s55, 63488
v_mfma_f32_16x16x32_bf16 v[228:231], a[16:19], a[60:63], v[228:231]
buffer_load_dwordx4 v4, s[12:15], s51 offen lds
s_waitcnt lgkmcnt(15)
v_mfma_f32_16x16x32_bf16 v[160:163], a[64:67], a[0:3], v[160:163]
ds_read_b64_tr_b16 a[60:61], v13 offset:20736
v_mfma_f32_16x16x32_bf16 v[164:167], a[64:67], a[4:7], v[164:167]
ds_read_b64_tr_b16 a[62:63], v13 offset:22272
v_add_u32 v232, s60, v60
v_mfma_f32_16x16x32_bf16 v[168:171], a[64:67], a[8:11], v[168:171]
v_mfma_f32_16x16x32_bf16 v[172:175], a[64:67], a[12:15], v[172:175]
v_mfma_f32_16x16x32_bf16 v[176:179], a[68:71], a[0:3], v[176:179]
ds_read_b64_tr_b16 a[64:65], v14 offset:32768
v_mfma_f32_16x16x32_bf16 v[180:183], a[68:71], a[4:7], v[180:183]
ds_read_b64_tr_b16 a[66:67], v14 offset:33280
v_add_u32 v233, 6144, v232
v_mfma_f32_16x16x32_bf16 v[184:187], a[68:71], a[8:11], v[184:187]
s_add_u32 m0, s56, 61440
v_mfma_f32_16x16x32_bf16 v[188:191], a[68:71], a[12:15], v[188:191]
buffer_load_dwordx4 v5, s[16:19], s52 offen lds
v_mfma_f32_16x16x32_bf16 v[192:195], a[72:75], a[0:3], v[192:195]
ds_read_b64_tr_b16 a[68:69], v15 offset:32768
v_mfma_f32_16x16x32_bf16 v[196:199], a[72:75], a[4:7], v[196:199]
ds_read_b64_tr_b16 a[70:71], v15 offset:33280
v_add_u32 v234, 12288, v232
v_mfma_f32_16x16x32_bf16 v[200:203], a[72:75], a[8:11], v[200:203]
s_add_u32 m0, s57, 61440
v_mfma_f32_16x16x32_bf16 v[204:207], a[72:75], a[12:15], v[204:207]
buffer_load_dwordx4 v5, s[20:23], s52 offen lds
v_mfma_f32_16x16x32_bf16 v[208:211], a[76:79], a[0:3], v[208:211]
ds_read_b64_tr_b16 a[72:73], v14 offset:36864
v_mfma_f32_16x16x32_bf16 v[212:215], a[76:79], a[4:7], v[212:215]
ds_read_b64_tr_b16 a[74:75], v14 offset:37376
v_add_u32 v235, 18432, v232
v_mfma_f32_16x16x32_bf16 v[216:219], a[76:79], a[8:11], v[216:219]
v_mfma_f32_16x16x32_bf16 v[220:223], a[76:79], a[12:15], v[220:223]
s_waitcnt lgkmcnt(10)
v_mfma_f32_16x16x32_bf16 v[64:67], a[40:43], a[20:23], v[64:67]
s_waitcnt vmcnt(7)
s_barrier
v_mfma_f32_16x16x32_bf16 v[68:71], a[40:43], a[24:27], v[68:71]
ds_read_b64_tr_b16 a[76:77], v15 offset:36864
v_mfma_f32_16x16x32_bf16 v[72:75], a[40:43], a[28:31], v[72:75]
ds_read_b64_tr_b16 a[78:79], v15 offset:37376
s_add_u32 m0, s58, 20480
v_mfma_f32_16x16x32_bf16 v[76:79], a[40:43], a[32:35], v[76:79]
buffer_load_dwordx4 v9, s[8:11], s50 offen lds
v_mfma_f32_16x16x32_bf16 v[80:83], a[44:47], a[20:23], v[80:83]
ds_read_b128 a[0:3], v20 offset:0
v_mfma_f32_16x16x32_bf16 v[84:87], a[44:47], a[24:27], v[84:87]
ds_read_b64_tr_b16 a[40:41], v16 offset:0
v_mfma_f32_16x16x32_bf16 v[88:91], a[44:47], a[28:31], v[88:91]
ds_read_b64_tr_b16 a[42:43], v16 offset:1536
s_add_u32 m0, s58, 21504
v_mfma_f32_16x16x32_bf16 v[92:95], a[44:47], a[32:35], v[92:95]
buffer_load_dwordx4 v10, s[8:11], s50 offen lds
v_mfma_f32_16x16x32_bf16 v[96:99], a[48:51], a[20:23], v[96:99]
ds_read_b128 a[4:7], v20 offset:2048
v_lshrrev_b32 v60, 4, v1
v_mfma_f32_16x16x32_bf16 v[100:103], a[48:51], a[24:27], v[100:103]
v_bfe_u32 v61, v1, 2, 2
v_lshrrev_b32 v62, 1, v61
v_mfma_f32_16x16x32_bf16 v[104:107], a[48:51], a[28:31], v[104:107]
ds_read_b64_tr_b16 a[44:45], v17 offset:0
s_mul_i32 s52, s53, 114688
s_mul_i32 s51, s53, 86016
s_add_u32 s53, s53, 1
s_cmp_eq_u32 s53, 14
s_cselect_b32 s53, 0, s53
s_add_u32 m0, s55, 0
v_mfma_f32_16x16x32_bf16 v[108:111], a[48:51], a[32:35], v[108:111]
buffer_load_dwordx4 v2, s[12:15], s51 offen lds
v_mfma_f32_16x16x32_bf16 v[112:115], a[52:55], a[20:23], v[112:115]
ds_read_b64_tr_b16 a[46:47], v17 offset:1536
v_mfma_f32_16x16x32_bf16 v[116:119], a[52:55], a[24:27], v[116:119]
ds_read_b128 a[8:11], v22 offset:0
v_lshl_add_u32 v62, v60, 1, v62
v_mfma_f32_16x16x32_bf16 v[120:123], a[52:55], a[28:31], v[120:123]
v_and_b32 v62, 3, v62
v_lshl_add_u32 v61, v60, 2, v61
v_mfma_f32_16x16x32_bf16 v[124:127], a[52:55], a[32:35], v[124:127]
ds_read_b64_tr_b16 a[48:49], v16 offset:128
s_waitcnt lgkmcnt(15)
v_mfma_f32_16x16x32_bf16 v[128:131], a[20:23], a[56:59], v[128:131]
ds_read_b64_tr_b16 a[50:51], v16 offset:1664
v_mfma_f32_16x16x32_bf16 v[132:135], a[24:27], a[56:59], v[132:135]
ds_read_b128 a[12:15], v22 offset:2048
v_lshlrev_b32 v61, 7, v61
v_mfma_f32_16x16x32_bf16 v[136:139], a[28:31], a[56:59], v[136:139]
v_and_b32 v63, 3, v1
v_lshl_add_u32 v61, v63, 3, v61
v_mfma_f32_16x16x32_bf16 v[140:143], a[32:35], a[56:59], v[140:143]
ds_read_b64_tr_b16 a[52:53], v17 offset:128
s_add_u32 m0, s55, 1024
v_mfma_f32_16x16x32_bf16 v[224:227], a[36:39], a[56:59], v[224:227]
buffer_load_dwordx4 v3, s[12:15], s51 offen lds
v_mfma_f32_16x16x32_bf16 v[144:147], a[20:23], a[60:63], v[144:147]
ds_read_b64_tr_b16 a[54:55], v17 offset:1664
v_mfma_f32_16x16x32_bf16 v[148:151], a[24:27], a[60:63], v[148:151]
ds_read_b128 a[16:19], v24 offset:0
v_add_u32 v61, s74, v61
v_mfma_f32_16x16x32_bf16 v[152:155], a[28:31], a[60:63], v[152:155]
v_xor_b32 v63, 0, v62
v_lshl_add_u32 v236, v63, 5, v61
v_mfma_f32_16x16x32_bf16 v[156:159], a[32:35], a[60:63], v[156:159]
ds_read_b64_tr_b16 a[56:57], v16 offset:256
s_add_u32 m0, s55, 2048
v_mfma_f32_16x16x32_bf16 v[228:231], a[36:39], a[60:63], v[228:231]
buffer_load_dwordx4 v4, s[12:15], s51 offen lds
s_waitcnt lgkmcnt(15)
v_mfma_f32_16x16x32_bf16 v[160:163], a[64:67], a[20:23], v[160:163]
ds_read_b64_tr_b16 a[58:59], v16 offset:1792
v_add_u32 v250, 0x10000, v236
v_mfma_f32_16x16x32_bf16 v[164:167], a[64:67], a[24:27], v[164:167]
v_xor_b32 v63, 1, v62
ds_read_b64_tr_b16 a[60:61], v17 offset:256
v_mfma_f32_16x16x32_bf16 v[168:171], a[64:67], a[28:31], v[168:171]
ds_read_b64_tr_b16 a[62:63], v17 offset:1792
v_lshl_add_u32 v237, v63, 5, v61
v_mfma_f32_16x16x32_bf16 v[172:175], a[64:67], a[32:35], v[172:175]
v_add_u32 v251, 0x10000, v237
v_mfma_f32_16x16x32_bf16 v[176:179], a[68:71], a[20:23], v[176:179]
ds_read_b64_tr_b16 a[64:65], v18 offset:12288
v_mfma_f32_16x16x32_bf16 v[180:183], a[68:71], a[24:27], v[180:183]
ds_read_b64_tr_b16 a[66:67], v18 offset:12800
v_xor_b32 v63, 2, v62
v_mfma_f32_16x16x32_bf16 v[184:187], a[68:71], a[28:31], v[184:187]
v_lshl_add_u32 v238, v63, 5, v61
s_add_u32 m0, s56, 0
v_mfma_f32_16x16x32_bf16 v[188:191], a[68:71], a[32:35], v[188:191]
buffer_load_dwordx4 v5, s[16:19], s52 offen lds
s_waitcnt lgkmcnt(15)
v_mfma_f32_16x16x32_bf16 v[192:195], a[72:75], a[20:23], v[192:195]
ds_read_b64_tr_b16 a[68:69], v19 offset:12288
v_mfma_f32_16x16x32_bf16 v[196:199], a[72:75], a[24:27], v[196:199]
ds_read_b64_tr_b16 a[70:71], v19 offset:12800
v_add_u32 v252, 0x10000, v238
v_mfma_f32_16x16x32_bf16 v[200:203], a[72:75], a[28:31], v[200:203]
v_xor_b32 v63, 3, v62
s_add_u32 m0, s57, 0
v_mfma_f32_16x16x32_bf16 v[204:207], a[72:75], a[32:35], v[204:207]
buffer_load_dwordx4 v5, s[20:23], s52 offen lds
v_mfma_f32_16x16x32_bf16 v[208:211], a[76:79], a[20:23], v[208:211]
ds_read_b64_tr_b16 a[72:73], v18 offset:16384
v_mfma_f32_16x16x32_bf16 v[212:215], a[76:79], a[24:27], v[212:215]
ds_read_b64_tr_b16 a[74:75], v18 offset:16896
v_lshl_add_u32 v239, v63, 5, v61
v_mfma_f32_16x16x32_bf16 v[216:219], a[76:79], a[28:31], v[216:219]
v_add_u32 v253, 0x10000, v239
v_mfma_f32_16x16x32_bf16 v[220:223], a[76:79], a[32:35], v[220:223]
s_waitcnt lgkmcnt(10)
v_mfma_f32_16x16x32_bf16 v[64:67], a[40:43], a[0:3], v[64:67]
s_waitcnt vmcnt(7)
s_barrier
v_mfma_f32_16x16x32_bf16 v[68:71], a[40:43], a[4:7], v[68:71]
ds_read_b64_tr_b16 a[76:77], v19 offset:16384
v_mfma_f32_16x16x32_bf16 v[72:75], a[40:43], a[8:11], v[72:75]
ds_read_b64_tr_b16 a[78:79], v19 offset:16896
s_lshl_b32 s50, s54, 7
s_add_u32 s54, s54, 1
s_cmp_eq_u32 s54, 7
s_cselect_b32 s54, 0, s54
s_add_u32 m0, s58, 36864
v_mfma_f32_16x16x32_bf16 v[76:79], a[40:43], a[12:15], v[76:79]
buffer_load_dwordx4 v7, s[8:11], s50 offen lds
v_mfma_f32_16x16x32_bf16 v[80:83], a[44:47], a[0:3], v[80:83]
ds_read_b128 a[20:23], v21 offset:0
v_mfma_f32_16x16x32_bf16 v[84:87], a[44:47], a[4:7], v[84:87]
ds_read_b64_tr_b16 a[40:41], v16 offset:20480
v_mfma_f32_16x16x32_bf16 v[88:91], a[44:47], a[8:11], v[88:91]
ds_read_b64_tr_b16 a[42:43], v16 offset:22016
s_add_u32 m0, s58, 37888
v_mfma_f32_16x16x32_bf16 v[92:95], a[44:47], a[12:15], v[92:95]
buffer_load_dwordx4 v8, s[8:11], s50 offen lds
v_mfma_f32_16x16x32_bf16 v[96:99], a[48:51], a[0:3], v[96:99]
ds_read_b128 a[24:27], v21 offset:2048
v_mfma_f32_16x16x32_bf16 v[100:103], a[48:51], a[4:7], v[100:103]
ds_read_b64_tr_b16 a[44:45], v17 offset:20480
v_mfma_f32_16x16x32_bf16 v[104:107], a[48:51], a[8:11], v[104:107]
ds_read_b64_tr_b16 a[46:47], v17 offset:22016
s_mul_i32 s52, s53, 114688
s_mul_i32 s51, s53, 86016
s_add_u32 s53, s53, 1
s_cmp_eq_u32 s53, 14
s_cselect_b32 s53, 0, s53
s_add_u32 m0, s55, 20480
v_mfma_f32_16x16x32_bf16 v[108:111], a[48:51], a[12:15], v[108:111]
buffer_load_dwordx4 v2, s[12:15], s51 offen lds
v_mfma_f32_16x16x32_bf16 v[112:115], a[52:55], a[0:3], v[112:115]
ds_read_b128 a[28:31], v23 offset:0
v_mfma_f32_16x16x32_bf16 v[116:119], a[52:55], a[4:7], v[116:119]
ds_read_b64_tr_b16 a[48:49], v16 offset:20608
v_mfma_f32_16x16x32_bf16 v[120:123], a[52:55], a[8:11], v[120:123]
ds_read_b64_tr_b16 a[50:51], v16 offset:22144
v_mfma_f32_16x16x32_bf16 v[124:127], a[52:55], a[12:15], v[124:127]
ds_read_b128 a[32:35], v23 offset:2048
s_waitcnt lgkmcnt(15)
v_mfma_f32_16x16x32_bf16 v[128:131], a[0:3], a[56:59], v[128:131]
ds_read_b64_tr_b16 a[52:53], v17 offset:20608
v_mfma_f32_16x16x32_bf16 v[132:135], a[4:7], a[56:59], v[132:135]
ds_read_b64_tr_b16 a[54:55], v17 offset:22144
v_mfma_f32_16x16x32_bf16 v[136:139], a[8:11], a[56:59], v[136:139]
ds_read_b128 a[36:39], v25 offset:0
v_mfma_f32_16x16x32_bf16 v[140:143], a[12:15], a[56:59], v[140:143]
s_add_u32 m0, s55, 21504
v_mfma_f32_16x16x32_bf16 v[224:227], a[16:19], a[56:59], v[224:227]
buffer_load_dwordx4 v3, s[12:15], s51 offen lds
v_mfma_f32_16x16x32_bf16 v[144:147], a[0:3], a[60:63], v[144:147]
ds_read_b64_tr_b16 a[56:57], v16 offset:20736
v_mfma_f32_16x16x32_bf16 v[148:151], a[4:7], a[60:63], v[148:151]
ds_read_b64_tr_b16 a[58:59], v16 offset:22272
v_mfma_f32_16x16x32_bf16 v[152:155], a[8:11], a[60:63], v[152:155]
v_mfma_f32_16x16x32_bf16 v[156:159], a[12:15], a[60:63], v[156:159]
s_add_u32 m0, s55, 22528
v_mfma_f32_16x16x32_bf16 v[228:231], a[16:19], a[60:63], v[228:231]
buffer_load_dwordx4 v4, s[12:15], s51 offen lds
s_waitcnt lgkmcnt(15)
v_mfma_f32_16x16x32_bf16 v[160:163], a[64:67], a[0:3], v[160:163]
ds_read_b64_tr_b16 a[60:61], v17 offset:20736
v_mfma_f32_16x16x32_bf16 v[164:167], a[64:67], a[4:7], v[164:167]
ds_read_b64_tr_b16 a[62:63], v17 offset:22272
v_mfma_f32_16x16x32_bf16 v[168:171], a[64:67], a[8:11], v[168:171]
v_mfma_f32_16x16x32_bf16 v[172:175], a[64:67], a[12:15], v[172:175]
v_mfma_f32_16x16x32_bf16 v[176:179], a[68:71], a[0:3], v[176:179]
ds_read_b64_tr_b16 a[64:65], v18 offset:32768
v_mfma_f32_16x16x32_bf16 v[180:183], a[68:71], a[4:7], v[180:183]
ds_read_b64_tr_b16 a[66:67], v18 offset:33280
v_mfma_f32_16x16x32_bf16 v[184:187], a[68:71], a[8:11], v[184:187]
s_add_u32 m0, s56, 20480
v_mfma_f32_16x16x32_bf16 v[188:191], a[68:71], a[12:15], v[188:191]
buffer_load_dwordx4 v5, s[16:19], s52 offen lds
v_mfma_f32_16x16x32_bf16 v[192:195], a[72:75], a[0:3], v[192:195]
ds_read_b64_tr_b16 a[68:69], v19 offset:32768
v_mfma_f32_16x16x32_bf16 v[196:199], a[72:75], a[4:7], v[196:199]
ds_read_b64_tr_b16 a[70:71], v19 offset:33280
v_mfma_f32_16x16x32_bf16 v[200:203], a[72:75], a[8:11], v[200:203]
s_add_u32 m0, s57, 20480
v_mfma_f32_16x16x32_bf16 v[204:207], a[72:75], a[12:15], v[204:207]
buffer_load_dwordx4 v5, s[20:23], s52 offen lds
v_mfma_f32_16x16x32_bf16 v[208:211], a[76:79], a[0:3], v[208:211]
ds_read_b64_tr_b16 a[72:73], v18 offset:36864
v_mfma_f32_16x16x32_bf16 v[212:215], a[76:79], a[4:7], v[212:215]
ds_read_b64_tr_b16 a[74:75], v18 offset:37376
v_mfma_f32_16x16x32_bf16 v[216:219], a[76:79], a[8:11], v[216:219]
v_mfma_f32_16x16x32_bf16 v[220:223], a[76:79], a[12:15], v[220:223]
s_waitcnt lgkmcnt(10)
v_mfma_f32_16x16x32_bf16 v[64:67], a[40:43], a[20:23], v[64:67]
s_waitcnt vmcnt(7)
s_barrier
v_mfma_f32_16x16x32_bf16 v[68:71], a[40:43], a[24:27], v[68:71]
ds_read_b64_tr_b16 a[76:77], v19 offset:36864
v_mfma_f32_16x16x32_bf16 v[72:75], a[40:43], a[28:31], v[72:75]
ds_read_b64_tr_b16 a[78:79], v19 offset:37376
s_add_u32 m0, s58, 38912
v_mfma_f32_16x16x32_bf16 v[76:79], a[40:43], a[32:35], v[76:79]
buffer_load_dwordx4 v9, s[8:11], s50 offen lds
v_mfma_f32_16x16x32_bf16 v[80:83], a[44:47], a[20:23], v[80:83]
ds_read_b128 a[0:3], v20 offset:18432
v_mfma_f32_16x16x32_bf16 v[84:87], a[44:47], a[24:27], v[84:87]
ds_read_b64_tr_b16 a[40:41], v12 offset:0
v_mfma_f32_16x16x32_bf16 v[88:91], a[44:47], a[28:31], v[88:91]
ds_read_b64_tr_b16 a[42:43], v12 offset:1536
s_add_u32 m0, s58, 39936
v_mfma_f32_16x16x32_bf16 v[92:95], a[44:47], a[32:35], v[92:95]
buffer_load_dwordx4 v10, s[8:11], s50 offen lds
v_mfma_f32_16x16x32_bf16 v[96:99], a[48:51], a[20:23], v[96:99]
ds_read_b128 a[4:7], v20 offset:20480
v_mfma_f32_16x16x32_bf16 v[100:103], a[48:51], a[24:27], v[100:103]
buffer_load_dword v60, v35, s[4:7], 0 offen sc1
v_mfma_f32_16x16x32_bf16 v[104:107], a[48:51], a[28:31], v[104:107]
ds_read_b64_tr_b16 a[44:45], v13 offset:0
s_mul_i32 s52, s53, 114688
s_mul_i32 s51, s53, 86016
s_add_u32 s53, s53, 1
s_cmp_eq_u32 s53, 14
s_cselect_b32 s53, 0, s53
s_add_u32 m0, s55, 40960
v_mfma_f32_16x16x32_bf16 v[108:111], a[48:51], a[32:35], v[108:111]
buffer_load_dwordx4 v2, s[12:15], s51 offen lds
v_mfma_f32_16x16x32_bf16 v[112:115], a[52:55], a[20:23], v[112:115]
ds_read_b64_tr_b16 a[46:47], v13 offset:1536
v_mfma_f32_16x16x32_bf16 v[116:119], a[52:55], a[24:27], v[116:119]
ds_read_b128 a[8:11], v22 offset:18432
v_mfma_f32_16x16x32_bf16 v[120:123], a[52:55], a[28:31], v[120:123]
ds_read_b64_tr_b16 a[48:49], v12 offset:128
v_mfma_f32_16x16x32_bf16 v[124:127], a[52:55], a[32:35], v[124:127]
ds_read_b64_tr_b16 a[50:51], v12 offset:1664
s_waitcnt lgkmcnt(15)
v_mfma_f32_16x16x32_bf16 v[128:131], a[20:23], a[56:59], v[128:131]
ds_read_b128 a[12:15], v22 offset:20480
v_mfma_f32_16x16x32_bf16 v[132:135], a[24:27], a[56:59], v[132:135]
ds_read_b64_tr_b16 a[52:53], v13 offset:128
v_mfma_f32_16x16x32_bf16 v[136:139], a[28:31], a[56:59], v[136:139]
ds_read_b64_tr_b16 a[54:55], v13 offset:1664
v_mfma_f32_16x16x32_bf16 v[140:143], a[32:35], a[56:59], v[140:143]
ds_read_b128 a[16:19], v24 offset:18432
s_add_u32 m0, s55, 41984
v_mfma_f32_16x16x32_bf16 v[224:227], a[36:39], a[56:59], v[224:227]
buffer_load_dwordx4 v3, s[12:15], s51 offen lds
v_mfma_f32_16x16x32_bf16 v[144:147], a[20:23], a[60:63], v[144:147]
ds_read_b64_tr_b16 a[56:57], v12 offset:256
v_mfma_f32_16x16x32_bf16 v[148:151], a[24:27], a[60:63], v[148:151]
ds_read_b64_tr_b16 a[58:59], v12 offset:1792
v_mfma_f32_16x16x32_bf16 v[152:155], a[28:31], a[60:63], v[152:155]
v_mfma_f32_16x16x32_bf16 v[156:159], a[32:35], a[60:63], v[156:159]
s_add_u32 m0, s55, 43008
v_mfma_f32_16x16x32_bf16 v[228:231], a[36:39], a[60:63], v[228:231]
buffer_load_dwordx4 v4, s[12:15], s51 offen lds
s_waitcnt lgkmcnt(15)
v_mfma_f32_16x16x32_bf16 v[160:163], a[64:67], a[20:23], v[160:163]
ds_read_b64_tr_b16 a[60:61], v13 offset:256
v_mfma_f32_16x16x32_bf16 v[164:167], a[64:67], a[24:27], v[164:167]
ds_read_b64_tr_b16 a[62:63], v13 offset:1792
v_mfma_f32_16x16x32_bf16 v[168:171], a[64:67], a[28:31], v[168:171]
v_mfma_f32_16x16x32_bf16 v[172:175], a[64:67], a[32:35], v[172:175]
v_mfma_f32_16x16x32_bf16 v[176:179], a[68:71], a[20:23], v[176:179]
ds_read_b64_tr_b16 a[64:65], v14 offset:12288
v_mfma_f32_16x16x32_bf16 v[180:183], a[68:71], a[24:27], v[180:183]
ds_read_b64_tr_b16 a[66:67], v14 offset:12800
v_mfma_f32_16x16x32_bf16 v[184:187], a[68:71], a[28:31], v[184:187]
s_add_u32 m0, s56, 40960
v_mfma_f32_16x16x32_bf16 v[188:191], a[68:71], a[32:35], v[188:191]
buffer_load_dwordx4 v5, s[16:19], s52 offen lds
v_mfma_f32_16x16x32_bf16 v[192:195], a[72:75], a[20:23], v[192:195]
ds_read_b64_tr_b16 a[68:69], v15 offset:12288
v_mfma_f32_16x16x32_bf16 v[196:199], a[72:75], a[24:27], v[196:199]
ds_read_b64_tr_b16 a[70:71], v15 offset:12800
v_mfma_f32_16x16x32_bf16 v[200:203], a[72:75], a[28:31], v[200:203]
s_add_u32 m0, s57, 40960
v_mfma_f32_16x16x32_bf16 v[204:207], a[72:75], a[32:35], v[204:207]
buffer_load_dwordx4 v5, s[20:23], s52 offen lds
v_mfma_f32_16x16x32_bf16 v[208:211], a[76:79], a[20:23], v[208:211]
ds_read_b64_tr_b16 a[72:73], v14 offset:16384
v_mfma_f32_16x16x32_bf16 v[212:215], a[76:79], a[24:27], v[212:215]
ds_read_b64_tr_b16 a[74:75], v14 offset:16896
v_mfma_f32_16x16x32_bf16 v[216:219], a[76:79], a[28:31], v[216:219]
v_mfma_f32_16x16x32_bf16 v[220:223], a[76:79], a[32:35], v[220:223]
s_waitcnt lgkmcnt(10)
v_mfma_f32_16x16x32_bf16 v[64:67], a[40:43], a[0:3], v[64:67]
s_waitcnt vmcnt(8)
s_barrier
v_mfma_f32_16x16x32_bf16 v[68:71], a[40:43], a[4:7], v[68:71]
ds_read_b64_tr_b16 a[76:77], v15 offset:16384
v_mfma_f32_16x16x32_bf16 v[72:75], a[40:43], a[8:11], v[72:75]
ds_read_b64_tr_b16 a[78:79], v15 offset:16896
s_lshl_b32 s50, s54, 7
s_add_u32 s54, s54, 1
s_cmp_eq_u32 s54, 7
s_cselect_b32 s54, 0, s54
s_add_u32 m0, s58, 0
v_mfma_f32_16x16x32_bf16 v[76:79], a[40:43], a[12:15], v[76:79]
buffer_load_dwordx4 v7, s[8:11], s50 offen lds
v_mfma_f32_16x16x32_bf16 v[80:83], a[44:47], a[0:3], v[80:83]
ds_read_b128 a[20:23], v21 offset:18432
v_mfma_f32_16x16x32_bf16 v[84:87], a[44:47], a[4:7], v[84:87]
ds_read_b64_tr_b16 a[40:41], v12 offset:20480
v_mfma_f32_16x16x32_bf16 v[88:91], a[44:47], a[8:11], v[88:91]
ds_read_b64_tr_b16 a[42:43], v12 offset:22016
s_add_u32 m0, s58, 1024
v_mfma_f32_16x16x32_bf16 v[92:95], a[44:47], a[12:15], v[92:95]
buffer_load_dwordx4 v8, s[8:11], s50 offen lds
v_mfma_f32_16x16x32_bf16 v[96:99], a[48:51], a[0:3], v[96:99]
ds_read_b128 a[24:27], v21 offset:20480
s_waitcnt vmcnt(7)
v_mfma_f32_16x16x32_bf16 v[100:103], a[48:51], a[4:7], v[100:103]
ds_read_b64_tr_b16 a[44:45], v13 offset:20480
v_mfma_f32_16x16x32_bf16 v[104:107], a[48:51], a[8:11], v[104:107]
ds_read_b64_tr_b16 a[46:47], v13 offset:22016
s_mul_i32 s52, s53, 114688
s_mul_i32 s51, s53, 86016
s_add_u32 s53, s53, 1
s_cmp_eq_u32 s53, 14
s_cselect_b32 s53, 0, s53
s_add_u32 m0, s55, 61440
v_mfma_f32_16x16x32_bf16 v[108:111], a[48:51], a[12:15], v[108:111]
buffer_load_dwordx4 v2, s[12:15], s51 offen lds
v_mfma_f32_16x16x32_bf16 v[112:115], a[52:55], a[0:3], v[112:115]
ds_read_b128 a[28:31], v23 offset:18432
v_mfma_f32_16x16x32_bf16 v[116:119], a[52:55], a[4:7], v[116:119]
v_readlane_b32 s60, v60, 0
v_readlane_b32 s61, v60, 1
v_readlane_b32 s62, v60, 2
v_readlane_b32 s63, v60, 3
s_nop 0
s_add_u32 s60, s60, s61
s_add_u32 s62, s62, s63
s_add_u32 s60, s60, s62
s_cmp_ge_u32 s60, 256
s_cbranch_scc0 L_cnt_slow_27
L_cnt_back_28:
v_mfma_f32_16x16x32_bf16 v[120:123], a[52:55], a[8:11], v[120:123]
ds_read_b64_tr_b16 a[48:49], v12 offset:20608
v_mfma_f32_16x16x32_bf16 v[124:127], a[52:55], a[12:15], v[124:127]
ds_read_b64_tr_b16 a[50:51], v12 offset:22144
s_waitcnt lgkmcnt(15)
v_mfma_f32_16x16x32_bf16 v[128:131], a[0:3], a[56:59], v[128:131]
ds_read_b128 a[32:35], v23 offset:20480
s_mov_b32 s62, 9437184
v_mfma_f32_16x16x32_bf16 v[132:135], a[4:7], a[56:59], v[132:135]
ds_read_b64_tr_b16 a[52:53], v13 offset:20608
v_mfma_f32_16x16x32_bf16 v[136:139], a[8:11], a[56:59], v[136:139]
ds_read_b64_tr_b16 a[54:55], v13 offset:22144
v_mfma_f32_16x16x32_bf16 v[140:143], a[12:15], a[56:59], v[140:143]
ds_read_b128 a[36:39], v25 offset:18432
s_add_u32 m0, s55, 62464
v_mfma_f32_16x16x32_bf16 v[224:227], a[16:19], a[56:59], v[224:227]
buffer_load_dwordx4 v3, s[12:15], s51 offen lds
v_mfma_f32_16x16x32_bf16 v[144:147], a[0:3], a[60:63], v[144:147]
buffer_load_dwordx2 v[40:41], v26, s[24:27], s62 offen sc1
v_mfma_f32_16x16x32_bf16 v[148:151], a[4:7], a[60:63], v[148:151]
ds_read_b64_tr_b16 a[56:57], v12 offset:20736
v_mfma_f32_16x16x32_bf16 v[152:155], a[8:11], a[60:63], v[152:155]
ds_read_b64_tr_b16 a[58:59], v12 offset:22272
v_mfma_f32_16x16x32_bf16 v[156:159], a[12:15], a[60:63], v[156:159]
buffer_load_dwordx4 v[44:47], v27, s[24:27], s80 offen sc1
s_add_u32 m0, s55, 63488
v_mfma_f32_16x16x32_bf16 v[228:231], a[16:19], a[60:63], v[228:231]
buffer_load_dwordx4 v4, s[12:15], s51 offen lds
s_waitcnt lgkmcnt(15)
v_mfma_f32_16x16x32_bf16 v[160:163], a[64:67], a[0:3], v[160:163]
ds_read_b64_tr_b16 a[60:61], v13 offset:20736
v_mfma_f32_16x16x32_bf16 v[164:167], a[64:67], a[4:7], v[164:167]
ds_read_b64_tr_b16 a[62:63], v13 offset:22272
v_mfma_f32_16x16x32_bf16 v[168:171], a[64:67], a[8:11], v[168:171]
buffer_load_dwordx4 v[48:51], v27, s[24:27], s81 offen sc1
v_mfma_f32_16x16x32_bf16 v[172:175], a[64:67], a[12:15], v[172:175]
v_mfma_f32_16x16x32_bf16 v[176:179], a[68:71], a[0:3], v[176:179]
ds_read_b64_tr_b16 a[64:65], v14 offset:32768
v_mfma_f32_16x16x32_bf16 v[180:183], a[68:71], a[4:7], v[180:183]
ds_read_b64_tr_b16 a[66:67], v14 offset:33280
v_mfma_f32_16x16x32_bf16 v[184:187], a[68:71], a[8:11], v[184:187]
buffer_load_dwordx4 v[52:55], v27, s[24:27], s82 offen sc1
s_add_u32 m0, s56, 61440
v_mfma_f32_16x16x32_bf16 v[188:191], a[68:71], a[12:15], v[188:191]
buffer_load_dwordx4 v5, s[16:19], s52 offen lds
v_mfma_f32_16x16x32_bf16 v[192:195], a[72:75], a[0:3], v[192:195]
ds_read_b64_tr_b16 a[68:69], v15 offset:32768
v_mfma_f32_16x16x32_bf16 v[196:199], a[72:75], a[4:7], v[196:199]
ds_read_b64_tr_b16 a[70:71], v15 offset:33280
v_mfma_f32_16x16x32_bf16 v[200:203], a[72:75], a[8:11], v[200:203]
buffer_load_dwordx4 v[56:59], v27, s[24:27], s83 offen sc1
s_add_u32 m0, s57, 61440
v_mfma_f32_16x16x32_bf16 v[204:207], a[72:75], a[12:15], v[204:207]
buffer_load_dwordx4 v5, s[20:23], s52 offen lds
v_mfma_f32_16x16x32_bf16 v[208:211], a[76:79], a[0:3], v[208:211]
ds_read_b64_tr_b16 a[72:73], v14 offset:36864
v_mfma_f32_16x16x32_bf16 v[212:215], a[76:79], a[4:7], v[212:215]
ds_read_b64_tr_b16 a[74:75], v14 offset:37376
v_mfma_f32_16x16x32_bf16 v[216:219], a[76:79], a[8:11], v[216:219]
v_mfma_f32_16x16x32_bf16 v[220:223], a[76:79], a[12:15], v[220:223]
s_waitcnt lgkmcnt(10)
v_mfma_f32_16x16x32_bf16 v[64:67], a[40:43], a[20:23], v[64:67]
s_waitcnt vmcnt(12)
s_barrier
v_mfma_f32_16x16x32_bf16 v[68:71], a[40:43], a[24:27], v[68:71]
ds_read_b64_tr_b16 a[76:77], v15 offset:36864
v_mfma_f32_16x16x32_bf16 v[72:75], a[40:43], a[28:31], v[72:75]
ds_read_b64_tr_b16 a[78:79], v15 offset:37376
s_add_u32 m0, s58, 2048
v_mfma_f32_16x16x32_bf16 v[76:79], a[40:43], a[32:35], v[76:79]
buffer_load_dwordx4 v9, s[8:11], s50 offen lds
v_mfma_f32_16x16x32_bf16 v[80:83], a[44:47], a[20:23], v[80:83]
ds_read_b128 a[0:3], v20 offset:36864
v_mfma_f32_16x16x32_bf16 v[84:87], a[44:47], a[24:27], v[84:87]
ds_read_b64_tr_b16 a[40:41], v16 offset:0
v_mfma_f32_16x16x32_bf16 v[88:91], a[44:47], a[28:31], v[88:91]
ds_read_b64_tr_b16 a[42:43], v16 offset:1536
s_add_u32 m0, s58, 3072
v_mfma_f32_16x16x32_bf16 v[92:95], a[44:47], a[32:35], v[92:95]
buffer_load_dwordx4 v10, s[8:11], s50 offen lds
v_mfma_f32_16x16x32_bf16 v[96:99], a[48:51], a[20:23], v[96:99]
ds_read_b128 a[4:7], v20 offset:38912
v_mfma_f32_16x16x32_bf16 v[100:103], a[48:51], a[24:27], v[100:103]
ds_read_b64_tr_b16 a[44:45], v17 offset:0
v_mfma_f32_16x16x32_bf16 v[104:107], a[48:51], a[28:31], v[104:107]
ds_read_b64_tr_b16 a[46:47], v17 offset:1536
s_mul_i32 s52, s53, 114688
s_mul_i32 s51, s53, 86016
s_add_u32 s53, s53, 1
s_cmp_eq_u32 s53, 14
s_cselect_b32 s53, 0, s53
s_add_u32 m0, s55, 0
v_mfma_f32_16x16x32_bf16 v[108:111], a[48:51], a[32:35], v[108:111]
buffer_load_dwordx4 v2, s[12:15], s51 offen lds
v_mfma_f32_16x16x32_bf16 v[112:115], a[52:55], a[20:23], v[112:115]
ds_read_b128 a[8:11], v22 offset:36864
v_mfma_f32_16x16x32_bf16 v[116:119], a[52:55], a[24:27], v[116:119]
ds_read_b64_tr_b16 a[48:49], v16 offset:128
v_mfma_f32_16x16x32_bf16 v[120:123], a[52:55], a[28:31], v[120:123]
ds_read_b64_tr_b16 a[50:51], v16 offset:1664
v_mfma_f32_16x16x32_bf16 v[124:127], a[52:55], a[32:35], v[124:127]
ds_read_b128 a[12:15], v22 offset:38912
s_waitcnt lgkmcnt(15)
v_mfma_f32_16x16x32_bf16 v[128:131], a[20:23], a[56:59], v[128:131]
ds_read_b64_tr_b16 a[52:53], v17 offset:128
v_mfma_f32_16x16x32_bf16 v[132:135], a[24:27], a[56:59], v[132:135]
ds_read_b64_tr_b16 a[54:55], v17 offset:1664
v_mfma_f32_16x16x32_bf16 v[136:139], a[28:31], a[56:59], v[136:139]
ds_read_b128 a[16:19], v24 offset:36864
v_mfma_f32_16x16x32_bf16 v[140:143], a[32:35], a[56:59], v[140:143]
s_add_u32 m0, s55, 1024
v_mfma_f32_16x16x32_bf16 v[224:227], a[36:39], a[56:59], v[224:227]
buffer_load_dwordx4 v3, s[12:15], s51 offen lds
v_mfma_f32_16x16x32_bf16 v[144:147], a[20:23], a[60:63], v[144:147]
ds_read_b64_tr_b16 a[56:57], v16 offset:256
v_mfma_f32_16x16x32_bf16 v[148:151], a[24:27], a[60:63], v[148:151]
ds_read_b64_tr_b16 a[58:59], v16 offset:1792
v_mfma_f32_16x16x32_bf16 v[152:155], a[28:31], a[60:63], v[152:155]
v_mfma_f32_16x16x32_bf16 v[156:159], a[32:35], a[60:63], v[156:159]
s_add_u32 m0, s55, 2048
v_mfma_f32_16x16x32_bf16 v[228:231], a[36:39], a[60:63], v[228:231]
buffer_load_dwordx4 v4, s[12:15], s51 offen lds
s_waitcnt lgkmcnt(15)
v_mfma_f32_16x16x32_bf16 v[160:163], a[64:67], a[20:23], v[160:163]
ds_read_b64_tr_b16 a[60:61], v17 offset:256
v_mfma_f32_16x16x32_bf16 v[164:167], a[64:67], a[24:27], v[164:167]
ds_read_b64_tr_b16 a[62:63], v17 offset:1792
v_mfma_f32_16x16x32_bf16 v[168:171], a[64:67], a[28:31], v[168:171]
v_mfma_f32_16x16x32_bf16 v[172:175], a[64:67], a[32:35], v[172:175]
v_mfma_f32_16x16x32_bf16 v[176:179], a[68:71], a[20:23], v[176:179]
ds_read_b64_tr_b16 a[64:65], v18 offset:12288
v_mfma_f32_16x16x32_bf16 v[180:183], a[68:71], a[24:27], v[180:183]
ds_read_b64_tr_b16 a[66:67], v18 offset:12800
v_mfma_f32_16x16x32_bf16 v[184:187], a[68:71], a[28:31], v[184:187]
s_add_u32 m0, s56, 0
v_mfma_f32_16x16x32_bf16 v[188:191], a[68:71], a[32:35], v[188:191]
buffer_load_dwordx4 v5, s[16:19], s52 offen lds
v_mfma_f32_16x16x32_bf16 v[192:195], a[72:75], a[20:23], v[192:195]
ds_read_b64_tr_b16 a[68:69], v19 offset:12288
v_mfma_f32_16x16x32_bf16 v[196:199], a[72:75], a[24:27], v[196:199]
ds_read_b64_tr_b16 a[70:71], v19 offset:12800
v_mfma_f32_16x16x32_bf16 v[200:203], a[72:75], a[28:31], v[200:203]
s_add_u32 m0, s57, 0
v_mfma_f32_16x16x32_bf16 v[204:207], a[72:75], a[32:35], v[204:207]
buffer_load_dwordx4 v5, s[20:23], s52 offen lds
v_mfma_f32_16x16x32_bf16 v[208:211], a[76:79], a[20:23], v[208:211]
ds_read_b64_tr_b16 a[72:73], v18 offset:16384
v_mfma_f32_16x16x32_bf16 v[212:215], a[76:79], a[24:27], v[212:215]
ds_read_b64_tr_b16 a[74:75], v18 offset:16896
v_mfma_f32_16x16x32_bf16 v[216:219], a[76:79], a[28:31], v[216:219]
v_mfma_f32_16x16x32_bf16 v[220:223], a[76:79], a[32:35], v[220:223]
s_waitcnt lgkmcnt(10)
v_mfma_f32_16x16x32_bf16 v[64:67], a[40:43], a[0:3], v[64:67]
s_waitcnt vmcnt(7)
s_barrier
v_mfma_f32_16x16x32_bf16 v[68:71], a[40:43], a[4:7], v[68:71]
ds_read_b64_tr_b16 a[76:77], v19 offset:16384
v_mfma_f32_16x16x32_bf16 v[72:75], a[40:43], a[8:11], v[72:75]
ds_read_b64_tr_b16 a[78:79], v19 offset:16896
s_mul_i32 s52, s53, 114688
s_mul_i32 s51, s53, 86016
s_add_u32 s53, s53, 1
s_cmp_eq_u32 s53, 14
s_cselect_b32 s53, 0, s53
s_add_u32 m0, s55, 20480
v_mfma_f32_16x16x32_bf16 v[76:79], a[40:43], a[12:15], v[76:79]
buffer_load_dwordx4 v2, s[12:15], s51 offen lds
v_mfma_f32_16x16x32_bf16 v[80:83], a[44:47], a[0:3], v[80:83]
ds_read_b128 a[20:23], v21 offset:36864
v_mfma_f32_16x16x32_bf16 v[84:87], a[44:47], a[4:7], v[84:87]
ds_read_b64_tr_b16 a[40:41], v16 offset:20480
v_mfma_f32_16x16x32_bf16 v[88:91], a[44:47], a[8:11], v[88:91]
ds_read_b64_tr_b16 a[42:43], v16 offset:22016
v_mfma_f32_16x16x32_bf16 v[92:95], a[44:47], a[12:15], v[92:95]
ds_read_b128 a[24:27], v21 offset:38912
v_bitop3_b32 v43, v44, v45, v46 bitop3:0x80
v_mfma_f32_16x16x32_bf16 v[96:99], a[48:51], a[0:3], v[96:99]
v_bitop3_b32 v43, v43, v47, v48 bitop3:0x80
v_bitop3_b32 v43, v43, v49, v50 bitop3:0x80
v_mfma_f32_16x16x32_bf16 v[100:103], a[48:51], a[4:7], v[100:103]
ds_read_b64_tr_b16 a[44:45], v17 offset:20480
v_mfma_f32_16x16x32_bf16 v[104:107], a[48:51], a[8:11], v[104:107]
ds_read_b64_tr_b16 a[46:47], v17 offset:22016
s_add_u32 m0, s55, 21504
v_mfma_f32_16x16x32_bf16 v[108:111], a[48:51], a[12:15], v[108:111]
buffer_load_dwordx4 v3, s[12:15], s51 offen lds
v_mfma_f32_16x16x32_bf16 v[112:115], a[52:55], a[0:3], v[112:115]
ds_read_b128 a[28:31], v23 offset:36864
v_bitop3_b32 v43, v43, v51, v52 bitop3:0x80
v_mfma_f32_16x16x32_bf16 v[116:119], a[52:55], a[4:7], v[116:119]
v_bitop3_b32 v43, v43, v53, v54 bitop3:0x80
v_bitop3_b32 v42, v56, v57, v58 bitop3:0x80
v_mfma_f32_16x16x32_bf16 v[120:123], a[52:55], a[8:11], v[120:123]
ds_read_b64_tr_b16 a[48:49], v16 offset:20608
v_mfma_f32_16x16x32_bf16 v[124:127], a[52:55], a[12:15], v[124:127]
ds_read_b64_tr_b16 a[50:51], v16 offset:22144
s_waitcnt lgkmcnt(15)
v_mfma_f32_16x16x32_bf16 v[128:131], a[0:3], a[56:59], v[128:131]
ds_read_b128 a[32:35], v23 offset:38912
v_and_b32 v42, v42, v59
v_mfma_f32_16x16x32_bf16 v[132:135], a[4:7], a[56:59], v[132:135]
v_or_b32 v42, s47, v42
v_bitop3_b32 v43, v43, v55, v42 bitop3:0x80
v_mfma_f32_16x16x32_bf16 v[136:139], a[8:11], a[56:59], v[136:139]
ds_read_b64_tr_b16 a[52:53], v17 offset:20608
v_mfma_f32_16x16x32_bf16 v[140:143], a[12:15], a[56:59], v[140:143]
ds_read_b64_tr_b16 a[54:55], v17 offset:22144
s_add_u32 m0, s55, 22528
v_mfma_f32_16x16x32_bf16 v[224:227], a[16:19], a[56:59], v[224:227]
buffer_load_dwordx4 v4, s[12:15], s51 offen lds
v_mfma_f32_16x16x32_bf16 v[144:147], a[0:3], a[60:63], v[144:147]
ds_read_b128 a[36:39], v25 offset:36864
v_and_b32 v43, 1, v43
v_mfma_f32_16x16x32_bf16 v[148:151], a[4:7], a[60:63], v[148:151]
v_cmp_eq_u32 vcc, 0, v41
v_cmp_eq_u32 s[60:61], 0, v43
s_nop 1
s_or_b64 vcc, vcc, s[60:61]
s_cmp_eq_u64 vcc, 0
s_cbranch_scc0 L_gat_slow_30
L_gat_back_31:
v_mfma_f32_16x16x32_bf16 v[152:155], a[8:11], a[60:63], v[152:155]
v_add_f32 v44, v44, v48
ds_read_b64_tr_b16 a[56:57], v16 offset:20736
v_mfma_f32_16x16x32_bf16 v[156:159], a[12:15], a[60:63], v[156:159]
ds_read_b64_tr_b16 a[58:59], v16 offset:22272
v_add_f32 v52, v52, v56
v_mfma_f32_16x16x32_bf16 v[228:231], a[16:19], a[60:63], v[228:231]
v_add_f32 v45, v45, v49
v_add_f32 v53, v53, v57
s_waitcnt lgkmcnt(15)
v_mfma_f32_16x16x32_bf16 v[160:163], a[64:67], a[0:3], v[160:163]
ds_read_b64_tr_b16 a[60:61], v17 offset:20736
v_mfma_f32_16x16x32_bf16 v[164:167], a[64:67], a[4:7], v[164:167]
ds_read_b64_tr_b16 a[62:63], v17 offset:22272
v_add_f32 v46, v46, v50
v_mfma_f32_16x16x32_bf16 v[168:171], a[64:67], a[8:11], v[168:171]
v_add_f32 v54, v54, v58
v_add_f32 v47, v47, v51
s_add_u32 m0, s56, 20480
v_mfma_f32_16x16x32_bf16 v[172:175], a[64:67], a[12:15], v[172:175]
buffer_load_dwordx4 v5, s[16:19], s52 offen lds
v_mfma_f32_16x16x32_bf16 v[176:179], a[68:71], a[0:3], v[176:179]
ds_read_b64_tr_b16 a[64:65], v18 offset:32768
v_mfma_f32_16x16x32_bf16 v[180:183], a[68:71], a[4:7], v[180:183]
ds_read_b64_tr_b16 a[66:67], v18 offset:33280
v_add_f32 v55, v55, v59
v_mfma_f32_16x16x32_bf16 v[184:187], a[68:71], a[8:11], v[184:187]
v_add_f32 v44, v44, v52
v_add_f32 v45, v45, v53
v_mfma_f32_16x16x32_bf16 v[188:191], a[68:71], a[12:15], v[188:191]
v_mfma_f32_16x16x32_bf16 v[192:195], a[72:75], a[0:3], v[192:195]
ds_read_b64_tr_b16 a[68:69], v19 offset:32768
v_mfma_f32_16x16x32_bf16 v[196:199], a[72:75], a[4:7], v[196:199]
ds_read_b64_tr_b16 a[70:71], v19 offset:33280
v_add_f32 v46, v46, v54
v_mfma_f32_16x16x32_bf16 v[200:203], a[72:75], a[8:11], v[200:203]
v_add_f32 v47, v47, v55
ds_write_b32 v28, v40
s_add_u32 m0, s57, 20480
v_mfma_f32_16x16x32_bf16 v[204:207], a[72:75], a[12:15], v[204:207]
buffer_load_dwordx4 v5, s[20:23], s52 offen lds
v_mfma_f32_16x16x32_bf16 v[208:211], a[76:79], a[0:3], v[208:211]
ds_read_b64_tr_b16 a[72:73], v18 offset:36864
v_mfma_f32_16x16x32_bf16 v[212:215], a[76:79], a[4:7], v[212:215]
ds_read_b64_tr_b16 a[74:75], v18 offset:37376
v_mfma_f32_16x16x32_bf16 v[216:219], a[76:79], a[8:11], v[216:219]
ds_write_b32 v28, v41 offset:960
v_mfma_f32_16x16x32_bf16 v[220:223], a[76:79], a[12:15], v[220:223]
ds_write_b128 v33, v[44:47]
s_waitcnt lgkmcnt(0)
v_mfma_f32_16x16x32_bf16 v[64:67], a[40:43], a[20:23], v[64:67]
s_waitcnt vmcnt(5)
s_barrier
v_mfma_f32_16x16x32_bf16 v[68:71], a[40:43], a[24:27], v[68:71]
ds_read_b64_tr_b16 a[76:77], v19 offset:36864
v_mfma_f32_16x16x32_bf16 v[72:75], a[40:43], a[28:31], v[72:75]
ds_read_b64_tr_b16 a[78:79], v19 offset:37376
v_mfma_f32_16x16x32_bf16 v[76:79], a[40:43], a[32:35], v[76:79]
ds_read_b128 a[0:3], v20 offset:0
v_mfma_f32_16x16x32_bf16 v[80:83], a[44:47], a[20:23], v[80:83]
ds_read_b64_tr_b16 a[40:41], v12 offset:0
v_mfma_f32_16x16x32_bf16 v[84:87], a[44:47], a[24:27], v[84:87]
ds_read_b64_tr_b16 a[42:43], v12 offset:1536
v_mfma_f32_16x16x32_bf16 v[88:91], a[44:47], a[28:31], v[88:91]
ds_read_b128 a[4:7], v20 offset:2048
v_mfma_f32_16x16x32_bf16 v[92:95], a[44:47], a[32:35], v[92:95]
ds_read_b128 v[48:51], v34
s_waitcnt lgkmcnt(0)
v_add_f32 v44, v44, v48
v_mfma_f32_16x16x32_bf16 v[96:99], a[48:51], a[20:23], v[96:99]
ds_read_b64_tr_b16 a[44:45], v13 offset:0
v_mfma_f32_16x16x32_bf16 v[100:103], a[48:51], a[24:27], v[100:103]
ds_read_b64_tr_b16 a[46:47], v13 offset:1536
v_mfma_f32_16x16x32_bf16 v[104:107], a[48:51], a[28:31], v[104:107]
ds_read_b128 a[8:11], v22 offset:0
v_add_f32 v45, v45, v49
v_mfma_f32_16x16x32_bf16 v[108:111], a[48:51], a[32:35], v[108:111]
v_add_f32 v46, v46, v50
v_add_f32 v47, v47, v51
v_mfma_f32_16x16x32_bf16 v[112:115], a[52:55], a[20:23], v[112:115]
ds_read_b64_tr_b16 a[48:49], v12 offset:128
v_mfma_f32_16x16x32_bf16 v[116:119], a[52:55], a[24:27], v[116:119]
ds_read_b64_tr_b16 a[50:51], v12 offset:1664
v_mfma_f32_16x16x32_bf16 v[120:123], a[52:55], a[28:31], v[120:123]
ds_read_b128 a[12:15], v22 offset:2048
v_mfma_f32_16x16x32_bf16 v[124:127], a[52:55], a[32:35], v[124:127]
ds_write_b128 v29, v[44:47]
s_waitcnt lgkmcnt(0)
v_mfma_f32_16x16x32_bf16 v[128:131], a[20:23], a[56:59], v[128:131]
ds_read_b64_tr_b16 a[52:53], v13 offset:128
v_mfma_f32_16x16x32_bf16 v[132:135], a[24:27], a[56:59], v[132:135]
ds_read_b64_tr_b16 a[54:55], v13 offset:1664
v_mfma_f32_16x16x32_bf16 v[136:139], a[28:31], a[56:59], v[136:139]
ds_read_b128 a[16:19], v24 offset:0
s_add_u32 s3, s70, 0
s_add_u32 m0, s74, 40960
v_mfma_f32_16x16x32_bf16 v[140:143], a[32:35], a[56:59], v[140:143]
v_mfma_f32_16x16x32_bf16 v[224:227], a[36:39], a[56:59], v[224:227]
v_mfma_f32_16x16x32_bf16 v[144:147], a[20:23], a[60:63], v[144:147]
ds_read_b64_tr_b16 a[56:57], v12 offset:256
v_mfma_f32_16x16x32_bf16 v[148:151], a[24:27], a[60:63], v[148:151]
ds_read_b64_tr_b16 a[58:59], v12 offset:1792
v_mfma_f32_16x16x32_bf16 v[152:155], a[28:31], a[60:63], v[152:155]
buffer_load_dwordx4 v232, s[36:39], s3 offen offset:0 lds
v_mfma_f32_16x16x32_bf16 v[156:159], a[32:35], a[60:63], v[156:159]
buffer_load_dwordx4 v233, s[36:39], s3 offen offset:1024 lds
v_mfma_f32_16x16x32_bf16 v[228:231], a[36:39], a[60:63], v[228:231]
v_mfma_f32_16x16x32_bf16 v[160:163], a[64:67], a[20:23], v[160:163]
ds_read_b64_tr_b16 a[60:61], v13 offset:256
v_mfma_f32_16x16x32_bf16 v[164:167], a[64:67], a[24:27], v[164:167]
ds_read_b64_tr_b16 a[62:63], v13 offset:1792
v_mfma_f32_16x16x32_bf16 v[168:171], a[64:67], a[28:31], v[168:171]
buffer_load_dwordx4 v234, s[36:39], s3 offen offset:2048 lds
v_mfma_f32_16x16x32_bf16 v[172:175], a[64:67], a[32:35], v[172:175]
buffer_load_dwordx4 v235, s[36:39], s3 offen offset:3072 lds
v_mfma_f32_16x16x32_bf16 v[176:179], a[68:71], a[20:23], v[176:179]
ds_read_b64_tr_b16 a[64:65], v14 offset:12288
v_mfma_f32_16x16x32_bf16 v[180:183], a[68:71], a[24:27], v[180:183]
ds_read_b64_tr_b16 a[66:67], v14 offset:12800
s_add_u32 s3, s70, 28672
s_add_u32 m0, s74, 100352
v_mfma_f32_16x16x32_bf16 v[184:187], a[68:71], a[28:31], v[184:187]
v_mfma_f32_16x16x32_bf16 v[188:191], a[68:71], a[32:35], v[188:191]
v_mfma_f32_16x16x32_bf16 v[192:195], a[72:75], a[20:23], v[192:195]
ds_read_b64_tr_b16 a[68:69], v15 offset:12288
v_mfma_f32_16x16x32_bf16 v[196:199], a[72:75], a[24:27], v[196:199]
ds_read_b64_tr_b16 a[70:71], v15 offset:12800
v_mfma_f32_16x16x32_bf16 v[200:203], a[72:75], a[28:31], v[200:203]
buffer_load_dwordx4 v232, s[36:39], s3 offen offset:0 lds
v_mfma_f32_16x16x32_bf16 v[204:207], a[72:75], a[32:35], v[204:207]
buffer_load_dwordx4 v233, s[36:39], s3 offen offset:1024 lds
v_mfma_f32_16x16x32_bf16 v[208:211], a[76:79], a[20:23], v[208:211]
ds_read_b64_tr_b16 a[72:73], v14 offset:16384
v_mfma_f32_16x16x32_bf16 v[212:215], a[76:79], a[24:27], v[212:215]
ds_read_b64_tr_b16 a[74:75], v14 offset:16896
v_mfma_f32_16x16x32_bf16 v[216:219], a[76:79], a[28:31], v[216:219]
buffer_load_dwordx4 v234, s[36:39], s3 offen offset:2048 lds
v_mfma_f32_16x16x32_bf16 v[220:223], a[76:79], a[32:35], v[220:223]
buffer_load_dwordx4 v235, s[36:39], s3 offen offset:3072 lds
s_waitcnt lgkmcnt(10)
v_mfma_f32_16x16x32_bf16 v[64:67], a[40:43], a[0:3], v[64:67]
s_waitcnt vmcnt(8)
s_barrier
v_mfma_f32_16x16x32_bf16 v[68:71], a[40:43], a[4:7], v[68:71]
ds_read_b64_tr_b16 a[76:77], v15 offset:16384
v_mfma_f32_16x16x32_bf16 v[72:75], a[40:43], a[8:11], v[72:75]
ds_read_b64_tr_b16 a[78:79], v15 offset:16896
v_mfma_f32_16x16x32_bf16 v[76:79], a[40:43], a[12:15], v[76:79]
ds_read_b128 a[20:23], v21 offset:0
v_mfma_f32_16x16x32_bf16 v[80:83], a[44:47], a[0:3], v[80:83]
ds_read_b64_tr_b16 a[40:41], v12 offset:20480
v_mfma_f32_16x16x32_bf16 v[84:87], a[44:47], a[4:7], v[84:87]
ds_read_b64_tr_b16 a[42:43], v12 offset:22016
v_mfma_f32_16x16x32_bf16 v[88:91], a[44:47], a[8:11], v[88:91]
ds_read_b128 a[24:27], v21 offset:2048
v_and_b32 v34, 15, v1
v_mfma_f32_16x16x32_bf16 v[92:95], a[44:47], a[12:15], v[92:95]
v_lshlrev_b32 v34, 2, v34
s_lshl_b32 s60, s47, 8
s_add_u32 s60, s60, 139392
v_mfma_f32_16x16x32_bf16 v[96:99], a[48:51], a[0:3], v[96:99]
s_add_u32 s61, s60, 128
ds_read_b64_tr_b16 a[44:45], v13 offset:20480
v_mfma_f32_16x16x32_bf16 v[100:103], a[48:51], a[4:7], v[100:103]
ds_read_b64_tr_b16 a[46:47], v13 offset:22016
v_mfma_f32_16x16x32_bf16 v[104:107], a[48:51], a[8:11], v[104:107]
ds_read_b128 a[28:31], v23 offset:0
v_add_u32 v35, s60, v34
v_mfma_f32_16x16x32_bf16 v[108:111], a[48:51], a[12:15], v[108:111]
v_add_u32 v58, s61, v34
ds_read_b32 v26, v35 offset:0
v_mfma_f32_16x16x32_bf16 v[112:115], a[52:55], a[0:3], v[112:115]
ds_read_b32 v27, v35 offset:960
v_mfma_f32_16x16x32_bf16 v[116:119], a[52:55], a[4:7], v[116:119]
ds_read_b32 v28, v35 offset:64
v_mfma_f32_16x16x32_bf16 v[120:123], a[52:55], a[8:11], v[120:123]
ds_read_b64_tr_b16 a[48:49], v12 offset:20608
v_mfma_f32_16x16x32_bf16 v[124:127], a[52:55], a[12:15], v[124:127]
ds_read_b64_tr_b16 a[50:51], v12 offset:22144
s_waitcnt lgkmcnt(15)
v_mfma_f32_16x16x32_bf16 v[128:131], a[0:3], a[56:59], v[128:131]
ds_read_b128 a[32:35], v23 offset:2048
v_mfma_f32_16x16x32_bf16 v[132:135], a[4:7], a[56:59], v[132:135]
ds_read_b32 v29, v35 offset:1024
v_mfma_f32_16x16x32_bf16 v[136:139], a[8:11], a[56:59], v[136:139]
ds_read_b32 v30, v58 offset:0
v_mfma_f32_16x16x32_bf16 v[140:143], a[12:15], a[56:59], v[140:143]
ds_read_b32 v31, v58 offset:960
v_mfma_f32_16x16x32_bf16 v[224:227], a[16:19], a[56:59], v[224:227]
ds_read_b32 v32, v58 offset:64
v_mfma_f32_16x16x32_bf16 v[144:147], a[0:3], a[60:63], v[144:147]
ds_read_b32 v33, v58 offset:1024
v_mfma_f32_16x16x32_bf16 v[148:151], a[4:7], a[60:63], v[148:151]
ds_read_b64_tr_b16 a[52:53], v13 offset:20608
v_mfma_f32_16x16x32_bf16 v[152:155], a[8:11], a[60:63], v[152:155]
ds_read_b64_tr_b16 a[54:55], v13 offset:22144
v_mfma_f32_16x16x32_bf16 v[156:159], a[12:15], a[60:63], v[156:159]
ds_read_b128 a[36:39], v25 offset:0
v_lshrrev_b32 v240, 4, v1
v_mfma_f32_16x16x32_bf16 v[228:231], a[16:19], a[60:63], v[228:231]
v_mul_u32_u24 v240, 0x110, v240
s_mul_i32 s60, s48, 1088
s_add_u32 s60, s60, 137216
v_add_u32 v240, s60, v240
v_mfma_f32_16x16x32_bf16 v[160:163], a[64:67], a[0:3], v[160:163]
ds_read_b64_tr_b16 a[56:57], v12 offset:20736
v_mfma_f32_16x16x32_bf16 v[164:167], a[64:67], a[4:7], v[164:167]
ds_read_b64_tr_b16 a[58:59], v12 offset:22272
v_lshlrev_b32 v241, 4, v1
s_lshl_b32 s60, s44, 3
s_lshl_b32 s61, s47, 2
v_mfma_f32_16x16x32_bf16 v[168:171], a[64:67], a[8:11], v[168:171]
s_add_u32 s60, s60, s61
ds_read_b64_tr_b16 a[60:61], v13 offset:20736
v_mfma_f32_16x16x32_bf16 v[172:175], a[64:67], a[12:15], v[172:175]
ds_read_b64_tr_b16 a[62:63], v13 offset:22272
s_mul_i32 s60, s60, 72
s_mul_i32 s61, s49, 9
v_mfma_f32_16x16x32_bf16 v[176:179], a[68:71], a[0:3], v[176:179]
s_and_b32 s62, s45, 1
s_lshl_b32 s62, s62, 2
ds_read_b64_tr_b16 a[64:65], v14 offset:32768
v_mfma_f32_16x16x32_bf16 v[180:183], a[68:71], a[4:7], v[180:183]
ds_read_b64_tr_b16 a[66:67], v14 offset:33280
s_add_u32 s61, s61, s62
s_add_u32 s60, s60, s61
v_mfma_f32_16x16x32_bf16 v[184:187], a[68:71], a[8:11], v[184:187]
s_lshl_b32 s60, s60, 10
s_lshl_b32 s61, s48, 11
v_mfma_f32_16x16x32_bf16 v[188:191], a[68:71], a[12:15], v[188:191]
s_waitcnt lgkmcnt(15)
v_mfma_f32_16x16x32_bf16 v[192:195], a[72:75], a[0:3], v[192:195]
ds_read_b64_tr_b16 a[68:69], v15 offset:32768
v_mfma_f32_16x16x32_bf16 v[196:199], a[72:75], a[4:7], v[196:199]
ds_read_b64_tr_b16 a[70:71], v15 offset:33280
s_add_u32 s64, s60, s61
s_add_u32 s65, s64, 147456
v_mfma_f32_16x16x32_bf16 v[200:203], a[72:75], a[8:11], v[200:203]
s_add_u32 s3, s70, 57344
s_add_u32 m0, s74, 61440
v_mfma_f32_16x16x32_bf16 v[204:207], a[72:75], a[12:15], v[204:207]
v_mfma_f32_16x16x32_bf16 v[208:211], a[76:79], a[0:3], v[208:211]
ds_read_b64_tr_b16 a[72:73], v14 offset:36864
v_mfma_f32_16x16x32_bf16 v[212:215], a[76:79], a[4:7], v[212:215]
ds_read_b64_tr_b16 a[74:75], v14 offset:37376
v_mfma_f32_16x16x32_bf16 v[216:219], a[76:79], a[8:11], v[216:219]
buffer_load_dwordx4 v232, s[36:39], s3 offen offset:0 lds
v_mfma_f32_16x16x32_bf16 v[220:223], a[76:79], a[12:15], v[220:223]
buffer_load_dwordx4 v233, s[36:39], s3 offen offset:1024 lds
buffer_load_dwordx4 v234, s[36:39], s3 offen offset:2048 lds
buffer_load_dwordx4 v235, s[36:39], s3 offen offset:3072 lds
s_waitcnt lgkmcnt(10)
v_mfma_f32_16x16x32_bf16 v[64:67], a[40:43], a[20:23], v[64:67]
s_barrier
v_mfma_f32_16x16x32_bf16 v[68:71], a[40:43], a[24:27], v[68:71]
ds_read_b64_tr_b16 a[76:77], v15 offset:36864
v_mfma_f32_16x16x32_bf16 v[72:75], a[40:43], a[28:31], v[72:75]
ds_read_b64_tr_b16 a[78:79], v15 offset:37376
v_mfma_f32_16x16x32_bf16 v[76:79], a[40:43], a[32:35], v[76:79]
v_mfma_f32_16x16x32_bf16 v[80:83], a[44:47], a[20:23], v[80:83]
s_add_u32 s3, s70, 86016
s_add_u32 m0, s74, 118784
v_mfma_f32_16x16x32_bf16 v[84:87], a[44:47], a[24:27], v[84:87]
buffer_load_dwordx4 v232, s[36:39], s3 offen offset:0 lds
v_mfma_f32_16x16x32_bf16 v[88:91], a[44:47], a[28:31], v[88:91]
buffer_load_dwordx4 v233, s[36:39], s3 offen offset:1024 lds
v_mfma_f32_16x16x32_bf16 v[92:95], a[44:47], a[32:35], v[92:95]
buffer_load_dwordx4 v234, s[36:39], s3 offen offset:2048 lds
v_mfma_f32_16x16x32_bf16 v[96:99], a[48:51], a[20:23], v[96:99]
buffer_load_dwordx4 v235, s[36:39], s3 offen offset:3072 lds
s_add_u32 s3, s70, 114688
s_add_u32 m0, s74, 0
v_mfma_f32_16x16x32_bf16 v[100:103], a[48:51], a[24:27], v[100:103]
buffer_load_dwordx4 v232, s[36:39], s3 offen offset:0 lds
v_mfma_f32_16x16x32_bf16 v[104:107], a[48:51], a[28:31], v[104:107]
buffer_load_dwordx4 v233, s[36:39], s3 offen offset:1024 lds
v_mfma_f32_16x16x32_bf16 v[108:111], a[48:51], a[32:35], v[108:111]
buffer_load_dwordx4 v234, s[36:39], s3 offen offset:2048 lds
v_mfma_f32_16x16x32_bf16 v[112:115], a[52:55], a[20:23], v[112:115]
buffer_load_dwordx4 v235, s[36:39], s3 offen offset:3072 lds
v_sub_f32 v242, 0, v26
v_mfma_f32_16x16x32_bf16 v[116:119], a[52:55], a[24:27], v[116:119]
v_mul_f32 v243, v27, v27
v_sub_f32 v244, 0, v28
v_mfma_f32_16x16x32_bf16 v[120:123], a[52:55], a[28:31], v[120:123]
v_mul_f32 v245, v29, v29
v_sub_f32 v246, 0, v30
v_mfma_f32_16x16x32_bf16 v[124:127], a[52:55], a[32:35], v[124:127]
v_mul_f32 v247, v31, v31
v_sub_f32 v248, 0, v32
s_waitcnt lgkmcnt(8)
v_mfma_f32_16x16x32_bf16 v[128:131], a[20:23], a[56:59], v[128:131]
v_mul_f32 v249, v33, v33
v_and_b32 v58, 15, v1
v_mfma_f32_16x16x32_bf16 v[132:135], a[24:27], a[56:59], v[132:135]
v_lshrrev_b32 v59, 4, v1
v_lshlrev_b32 v59, 2, v59
v_mfma_f32_16x16x32_bf16 v[136:139], a[28:31], a[56:59], v[136:139]
v_mov_b32 v62, 0xf149f2ca
v_add_u32 v60, 0, v59
v_mfma_f32_16x16x32_bf16 v[140:143], a[32:35], a[56:59], v[140:143]
v_sub_u32 v60, v58, v60
v_and_b32 v60, 0x80000001, v60
v_mfma_f32_16x16x32_bf16 v[224:227], a[36:39], a[56:59], v[224:227]
v_cmp_eq_u32 vcc, 0, v60
s_nop 1
v_cndmask_b32_e64 v38, v62, 0, vcc
v_mfma_f32_16x16x32_bf16 v[144:147], a[20:23], a[60:63], v[144:147]
v_cmp_eq_u32 vcc, 0x80000000, v60
s_nop 1
v_cndmask_b32_e64 v34, v62, 0, vcc
v_mfma_f32_16x16x32_bf16 v[148:151], a[24:27], a[60:63], v[148:151]
v_add_u32 v60, 1, v59
v_sub_u32 v60, v58, v60
v_mfma_f32_16x16x32_bf16 v[152:155], a[28:31], a[60:63], v[152:155]
v_and_b32 v60, 0x80000001, v60
v_mfma_f32_16x16x32_bf16 v[156:159], a[32:35], a[60:63], v[156:159]
v_cmp_eq_u32 vcc, 0, v60
s_nop 1
v_cndmask_b32_e64 v39, v62, 0, vcc
v_mfma_f32_16x16x32_bf16 v[228:231], a[36:39], a[60:63], v[228:231]
v_cmp_eq_u32 vcc, 0x80000000, v60
s_nop 1
v_cndmask_b32_e64 v35, v62, 0, vcc
s_waitcnt lgkmcnt(4)
v_mfma_f32_16x16x32_bf16 v[160:163], a[64:67], a[20:23], v[160:163]
v_add_u32 v60, 2, v59
v_sub_u32 v60, v58, v60
v_mfma_f32_16x16x32_bf16 v[164:167], a[64:67], a[24:27], v[164:167]
v_and_b32 v60, 0x80000001, v60
v_mfma_f32_16x16x32_bf16 v[168:171], a[64:67], a[28:31], v[168:171]
v_cmp_eq_u32 vcc, 0, v60
s_nop 1
v_cndmask_b32_e64 v40, v62, 0, vcc
v_mfma_f32_16x16x32_bf16 v[172:175], a[64:67], a[32:35], v[172:175]
v_cmp_eq_u32 vcc, 0x80000000, v60
s_nop 1
v_cndmask_b32_e64 v36, v62, 0, vcc
v_mfma_f32_16x16x32_bf16 v[176:179], a[68:71], a[20:23], v[176:179]
v_add_u32 v60, 3, v59
v_sub_u32 v60, v58, v60
v_mfma_f32_16x16x32_bf16 v[180:183], a[68:71], a[24:27], v[180:183]
v_and_b32 v60, 0x80000001, v60
v_mfma_f32_16x16x32_bf16 v[184:187], a[68:71], a[28:31], v[184:187]
v_cmp_eq_u32 vcc, 0, v60
s_nop 1
v_cndmask_b32_e64 v41, v62, 0, vcc
v_mfma_f32_16x16x32_bf16 v[188:191], a[68:71], a[32:35], v[188:191]
v_cmp_eq_u32 vcc, 0x80000000, v60
s_nop 1
v_cndmask_b32_e64 v37, v62, 0, vcc
s_waitcnt lgkmcnt(0)
v_mfma_f32_16x16x32_bf16 v[192:195], a[72:75], a[20:23], v[192:195]
v_mov_b32 v46, 0x3f803f80
v_mov_b32 v47, 0x3f803f80
v_mfma_f32_16x16x32_bf16 v[196:199], a[72:75], a[24:27], v[196:199]
v_mov_b32 v48, 0x3f803f80
v_mov_b32 v49, 0x3f803f80
v_mfma_f32_16x16x32_bf16 v[200:203], a[72:75], a[28:31], v[200:203]
v_subrev_u32 v50, 48, v1
v_ashrrev_i32 v50, 31, v50
v_mfma_f32_16x16x32_bf16 v[204:207], a[72:75], a[32:35], v[204:207]
v_and_b32 v51, 1.0, v50
ds_read_b128 v[52:55], v240 offset:96
v_mfma_f32_16x16x32_bf16 v[208:211], a[76:79], a[20:23], v[208:211]
ds_read_b128 v[56:59], v240 offset:128
v_mfma_f32_16x16x32_bf16 v[212:215], a[76:79], a[24:27], v[212:215]
ds_read_b128 v[4:7], v240 offset:112
v_mfma_f32_16x16x32_bf16 v[216:219], a[76:79], a[28:31], v[216:219]
ds_read_b128 v[8:11], v240 offset:144
v_mfma_f32_16x16x32_bf16 v[220:223], a[76:79], a[32:35], v[220:223]
ds_read_b128 v[12:15], v240 offset:32
ds_read_b128 v[16:19], v240 offset:48
v_bfe_u32 v60, v1, 2, 2
v_mul_u32_u24 v60, 0x110, v60
v_and_b32 v61, 3, v1
v_lshl_add_u32 v61, v61, 2, v60
s_mul_i32 s61, s48, 1088
s_add_u32 s61, s61, 137280
v_add_u32 v61, s61, v61
ds_read_b32 v20, v61
ds_read_b32 v22, v61 offset:16
ds_read_b128 v[60:63], v240 offset:0
ds_read_b64 v[2:3], v240 offset:16
ds_read_b64 v[254:255], v240 offset:24
s_waitcnt lgkmcnt(0)
s_barrier
v_pk_fma_f32 v[160:161], v[52:53], v[242:243], v[160:161] op_sel_hi:[1,0,1]
v_pk_fma_f32 v[164:165], v[52:53], v[244:245], v[164:165] op_sel_hi:[1,0,1]
v_pk_fma_f32 v[176:177], v[4:5], v[242:243], v[176:177] op_sel_hi:[1,0,1]
v_pk_fma_f32 v[180:181], v[4:5], v[244:245], v[180:181] op_sel_hi:[1,0,1]
v_pk_fma_f32 v[162:163], v[54:55], v[242:243], v[162:163] op_sel_hi:[1,0,1]
v_pk_fma_f32 v[166:167], v[54:55], v[244:245], v[166:167] op_sel_hi:[1,0,1]
v_pk_fma_f32 v[178:179], v[6:7], v[242:243], v[178:179] op_sel_hi:[1,0,1]
v_pk_fma_f32 v[182:183], v[6:7], v[244:245], v[182:183] op_sel_hi:[1,0,1]
v_pk_fma_f32 v[192:193], v[56:57], v[242:243], v[192:193] op_sel_hi:[1,0,1]
v_pk_fma_f32 v[196:197], v[56:57], v[244:245], v[196:197] op_sel_hi:[1,0,1]
v_pk_fma_f32 v[208:209], v[8:9], v[242:243], v[208:209] op_sel_hi:[1,0,1]
v_pk_fma_f32 v[212:213], v[8:9], v[244:245], v[212:213] op_sel_hi:[1,0,1]
v_pk_fma_f32 v[194:195], v[58:59], v[242:243], v[194:195] op_sel_hi:[1,0,1]
v_pk_fma_f32 v[198:199], v[58:59], v[244:245], v[198:199] op_sel_hi:[1,0,1]
v_pk_fma_f32 v[210:211], v[10:11], v[242:243], v[210:211] op_sel_hi:[1,0,1]
v_pk_fma_f32 v[214:215], v[10:11], v[244:245], v[214:215] op_sel_hi:[1,0,1]
v_pk_mul_f32 v[160:161], v[160:161], v[192:193]
v_pk_mul_f32 v[164:165], v[164:165], v[196:197]
v_pk_mul_f32 v[176:177], v[176:177], v[208:209]
v_pk_mul_f32 v[180:181], v[180:181], v[212:213]
v_pk_mul_f32 v[162:163], v[162:163], v[194:195]
v_pk_mul_f32 v[166:167], v[166:167], v[198:199]
v_pk_mul_f32 v[178:179], v[178:179], v[210:211]
v_pk_mul_f32 v[182:183], v[182:183], v[214:215]
v_pk_mul_f32 v[160:161], v[160:161], v[242:243] op_sel:[0,1] op_sel_hi:[1,1]
v_pk_mul_f32 v[164:165], v[164:165], v[244:245] op_sel:[0,1] op_sel_hi:[1,1]
v_pk_mul_f32 v[176:177], v[176:177], v[242:243] op_sel:[0,1] op_sel_hi:[1,1]
v_pk_mul_f32 v[180:181], v[180:181], v[244:245] op_sel:[0,1] op_sel_hi:[1,1]
v_pk_mul_f32 v[162:163], v[162:163], v[242:243] op_sel:[0,1] op_sel_hi:[1,1]
v_pk_mul_f32 v[166:167], v[166:167], v[244:245] op_sel:[0,1] op_sel_hi:[1,1]
v_pk_mul_f32 v[178:179], v[178:179], v[242:243] op_sel:[0,1] op_sel_hi:[1,1]
v_pk_mul_f32 v[182:183], v[182:183], v[244:245] op_sel:[0,1] op_sel_hi:[1,1]
v_cvt_pk_bf16_f32 v192, v160, v161
v_cvt_pk_bf16_f32 v196, v164, v165
v_cvt_pk_bf16_f32 v194, v176, v177
v_cvt_pk_bf16_f32 v198, v180, v181
v_cvt_pk_bf16_f32 v193, v162, v163
v_cvt_pk_bf16_f32 v197, v166, v167
v_cvt_pk_bf16_f32 v195, v178, v179
v_cvt_pk_bf16_f32 v199, v182, v183
s_add_u32 s60, s64, 1024
buffer_store_dwordx4 v[192:195], v241, s[24:27], s60 offen sc1
s_add_u32 s60, s64, 74752
buffer_store_dwordx4 v[196:199], v241, s[24:27], s60 offen sc1
v_pk_fma_f32 v[168:169], v[52:53], v[246:247], v[168:169] op_sel_hi:[1,0,1]
v_pk_fma_f32 v[172:173], v[52:53], v[248:249], v[172:173] op_sel_hi:[1,0,1]
v_pk_fma_f32 v[184:185], v[4:5], v[246:247], v[184:185] op_sel_hi:[1,0,1]
v_pk_fma_f32 v[188:189], v[4:5], v[248:249], v[188:189] op_sel_hi:[1,0,1]
v_pk_fma_f32 v[170:171], v[54:55], v[246:247], v[170:171] op_sel_hi:[1,0,1]
v_pk_fma_f32 v[174:175], v[54:55], v[248:249], v[174:175] op_sel_hi:[1,0,1]
v_pk_fma_f32 v[186:187], v[6:7], v[246:247], v[186:187] op_sel_hi:[1,0,1]
v_pk_fma_f32 v[190:191], v[6:7], v[248:249], v[190:191] op_sel_hi:[1,0,1]
v_pk_fma_f32 v[200:201], v[56:57], v[246:247], v[200:201] op_sel_hi:[1,0,1]
v_pk_fma_f32 v[204:205], v[56:57], v[248:249], v[204:205] op_sel_hi:[1,0,1]
v_pk_fma_f32 v[216:217], v[8:9], v[246:247], v[216:217] op_sel_hi:[1,0,1]
v_pk_fma_f32 v[220:221], v[8:9], v[248:249], v[220:221] op_sel_hi:[1,0,1]
v_pk_fma_f32 v[202:203], v[58:59], v[246:247], v[202:203] op_sel_hi:[1,0,1]
v_pk_fma_f32 v[206:207], v[58:59], v[248:249], v[206:207] op_sel_hi:[1,0,1]
v_pk_fma_f32 v[218:219], v[10:11], v[246:247], v[218:219] op_sel_hi:[1,0,1]
v_pk_fma_f32 v[222:223], v[10:11], v[248:249], v[222:223] op_sel_hi:[1,0,1]
v_pk_mul_f32 v[168:169], v[168:169], v[200:201]
v_pk_mul_f32 v[172:173], v[172:173], v[204:205]
v_pk_mul_f32 v[184:185], v[184:185], v[216:217]
v_pk_mul_f32 v[188:189], v[188:189], v[220:221]
v_pk_mul_f32 v[170:171], v[170:171], v[202:203]
v_pk_mul_f32 v[174:175], v[174:175], v[206:207]
v_pk_mul_f32 v[186:187], v[186:187], v[218:219]
v_pk_mul_f32 v[190:191], v[190:191], v[222:223]
v_pk_mul_f32 v[168:169], v[168:169], v[246:247] op_sel:[0,1] op_sel_hi:[1,1]
v_pk_mul_f32 v[172:173], v[172:173], v[248:249] op_sel:[0,1] op_sel_hi:[1,1]
v_pk_mul_f32 v[184:185], v[184:185], v[246:247] op_sel:[0,1] op_sel_hi:[1,1]
v_pk_mul_f32 v[188:189], v[188:189], v[248:249] op_sel:[0,1] op_sel_hi:[1,1]
v_pk_mul_f32 v[170:171], v[170:171], v[246:247] op_sel:[0,1] op_sel_hi:[1,1]
v_pk_mul_f32 v[174:175], v[174:175], v[248:249] op_sel:[0,1] op_sel_hi:[1,1]
v_pk_mul_f32 v[186:187], v[186:187], v[246:247] op_sel:[0,1] op_sel_hi:[1,1]
v_pk_mul_f32 v[190:191], v[190:191], v[248:249] op_sel:[0,1] op_sel_hi:[1,1]
v_cvt_pk_bf16_f32 v200, v168, v169
v_cvt_pk_bf16_f32 v204, v172, v173
v_cvt_pk_bf16_f32 v202, v184, v185
v_cvt_pk_bf16_f32 v206, v188, v189
v_cvt_pk_bf16_f32 v201, v170, v171
v_cvt_pk_bf16_f32 v205, v174, v175
v_cvt_pk_bf16_f32 v203, v186, v187
v_cvt_pk_bf16_f32 v207, v190, v191
s_add_u32 s60, s65, 1024
buffer_store_dwordx4 v[200:203], v241, s[24:27], s60 offen sc1
s_add_u32 s60, s65, 74752
buffer_store_dwordx4 v[204:207], v241, s[24:27], s60 offen sc1
v_pk_fma_f32 v[64:65], v[60:61], v[242:243], v[64:65] op_sel_hi:[1,0,1]
v_pk_fma_f32 v[68:69], v[60:61], v[244:245], v[68:69] op_sel_hi:[1,0,1]
v_pk_fma_f32 v[72:73], v[60:61], v[246:247], v[72:73] op_sel_hi:[1,0,1]
v_pk_fma_f32 v[76:77], v[60:61], v[248:249], v[76:77] op_sel_hi:[1,0,1]
v_pk_fma_f32 v[66:67], v[62:63], v[242:243], v[66:67] op_sel_hi:[1,0,1]
v_pk_fma_f32 v[70:71], v[62:63], v[244:245], v[70:71] op_sel_hi:[1,0,1]
v_pk_fma_f32 v[74:75], v[62:63], v[246:247], v[74:75] op_sel_hi:[1,0,1]
v_pk_fma_f32 v[78:79], v[62:63], v[248:249], v[78:79] op_sel_hi:[1,0,1]
v_pk_fma_f32 v[80:81], v[2:3], v[242:243], v[80:81] op_sel_hi:[1,0,1]
v_pk_fma_f32 v[84:85], v[2:3], v[244:245], v[84:85] op_sel_hi:[1,0,1]
v_pk_fma_f32 v[88:89], v[2:3], v[246:247], v[88:89] op_sel_hi:[1,0,1]
v_pk_fma_f32 v[92:93], v[2:3], v[248:249], v[92:93] op_sel_hi:[1,0,1]
v_pk_fma_f32 v[82:83], v[254:255], v[242:243], v[82:83] op_sel_hi:[1,0,1]
v_pk_fma_f32 v[86:87], v[254:255], v[244:245], v[86:87] op_sel_hi:[1,0,1]
v_pk_fma_f32 v[90:91], v[254:255], v[246:247], v[90:91] op_sel_hi:[1,0,1]
v_pk_fma_f32 v[94:95], v[254:255], v[248:249], v[94:95] op_sel_hi:[1,0,1]
v_cvt_pk_bf16_f32 v176, v64, v65
v_cvt_pk_bf16_f32 v180, v68, v69
v_cvt_pk_bf16_f32 v184, v72, v73
v_cvt_pk_bf16_f32 v188, v76, v77
v_cvt_pk_bf16_f32 v177, v66, v67
v_cvt_pk_bf16_f32 v181, v70, v71
v_cvt_pk_bf16_f32 v185, v74, v75
v_cvt_pk_bf16_f32 v189, v78, v79
v_cvt_pk_bf16_f32 v178, v80, v81
v_cvt_pk_bf16_f32 v182, v84, v85
v_cvt_pk_bf16_f32 v186, v88, v89
v_cvt_pk_bf16_f32 v190, v92, v93
v_cvt_pk_bf16_f32 v179, v82, v83
v_cvt_pk_bf16_f32 v183, v86, v87
v_cvt_pk_bf16_f32 v187, v90, v91
v_cvt_pk_bf16_f32 v191, v94, v95
v_lshrrev_b32 v61, 4, v1
v_lshlrev_b32 v61, 4, v61
v_add_u32 v61, 139648, v61
ds_read_b128 v[52:55], v61 offset:256
ds_read_b128 v[56:59], v61 offset:1216
ds_read_b128 v[64:67], v61 offset:0
ds_read_b128 v[68:71], v61 offset:960
ds_read_b128 v[72:75], v61 offset:64
ds_read_b128 v[76:79], v61 offset:1024
ds_read_b128 v[80:83], v61 offset:128
ds_read_b128 v[84:87], v61 offset:1088
ds_read_b128 v[88:91], v61 offset:192
ds_read_b128 v[92:95], v61 offset:1152
v_pk_fma_f32 v[96:97], v[12:13], v[242:243], v[96:97] op_sel_hi:[1,0,1]
v_pk_fma_f32 v[100:101], v[12:13], v[244:245], v[100:101] op_sel_hi:[1,0,1]
v_pk_fma_f32 v[104:105], v[12:13], v[246:247], v[104:105] op_sel_hi:[1,0,1]
v_pk_fma_f32 v[108:109], v[12:13], v[248:249], v[108:109] op_sel_hi:[1,0,1]
v_pk_fma_f32 v[98:99], v[14:15], v[242:243], v[98:99] op_sel_hi:[1,0,1]
v_pk_fma_f32 v[102:103], v[14:15], v[244:245], v[102:103] op_sel_hi:[1,0,1]
v_pk_fma_f32 v[106:107], v[14:15], v[246:247], v[106:107] op_sel_hi:[1,0,1]
v_pk_fma_f32 v[110:111], v[14:15], v[248:249], v[110:111] op_sel_hi:[1,0,1]
v_pk_fma_f32 v[112:113], v[16:17], v[242:243], v[112:113] op_sel_hi:[1,0,1]
v_pk_fma_f32 v[116:117], v[16:17], v[244:245], v[116:117] op_sel_hi:[1,0,1]
v_pk_fma_f32 v[120:121], v[16:17], v[246:247], v[120:121] op_sel_hi:[1,0,1]
v_pk_fma_f32 v[124:125], v[16:17], v[248:249], v[124:125] op_sel_hi:[1,0,1]
v_pk_fma_f32 v[114:115], v[18:19], v[242:243], v[114:115] op_sel_hi:[1,0,1]
v_pk_fma_f32 v[118:119], v[18:19], v[244:245], v[118:119] op_sel_hi:[1,0,1]
v_pk_fma_f32 v[122:123], v[18:19], v[246:247], v[122:123] op_sel_hi:[1,0,1]
v_pk_fma_f32 v[126:127], v[18:19], v[248:249], v[126:127] op_sel_hi:[1,0,1]
v_pk_mul_f32 v[96:97], v[96:97], v[26:27] op_sel:[0,1] op_sel_hi:[1,1]
v_pk_mul_f32 v[100:101], v[100:101], v[28:29] op_sel:[0,1] op_sel_hi:[1,1]
v_pk_mul_f32 v[104:105], v[104:105], v[30:31] op_sel:[0,1] op_sel_hi:[1,1]
v_pk_mul_f32 v[108:109], v[108:109], v[32:33] op_sel:[0,1] op_sel_hi:[1,1]
v_pk_mul_f32 v[98:99], v[98:99], v[26:27] op_sel:[0,1] op_sel_hi:[1,1]
v_pk_mul_f32 v[102:103], v[102:103], v[28:29] op_sel:[0,1] op_sel_hi:[1,1]
v_pk_mul_f32 v[106:107], v[106:107], v[30:31] op_sel:[0,1] op_sel_hi:[1,1]
v_pk_mul_f32 v[110:111], v[110:111], v[32:33] op_sel:[0,1] op_sel_hi:[1,1]
v_pk_mul_f32 v[112:113], v[112:113], v[26:27] op_sel:[0,1] op_sel_hi:[1,1]
v_pk_mul_f32 v[116:117], v[116:117], v[28:29] op_sel:[0,1] op_sel_hi:[1,1]
v_pk_mul_f32 v[120:121], v[120:121], v[30:31] op_sel:[0,1] op_sel_hi:[1,1]
v_pk_mul_f32 v[124:125], v[124:125], v[32:33] op_sel:[0,1] op_sel_hi:[1,1]
v_pk_mul_f32 v[114:115], v[114:115], v[26:27] op_sel:[0,1] op_sel_hi:[1,1]
v_pk_mul_f32 v[118:119], v[118:119], v[28:29] op_sel:[0,1] op_sel_hi:[1,1]
v_pk_mul_f32 v[122:123], v[122:123], v[30:31] op_sel:[0,1] op_sel_hi:[1,1]
v_pk_mul_f32 v[126:127], v[126:127], v[32:33] op_sel:[0,1] op_sel_hi:[1,1]
v_cvt_pk_bf16_f32 v196, v96, v97
v_cvt_pk_bf16_f32 v200, v100, v101
v_cvt_pk_bf16_f32 v204, v104, v105
v_cvt_pk_bf16_f32 v208, v108, v109
v_cvt_pk_bf16_f32 v197, v98, v99
v_cvt_pk_bf16_f32 v201, v102, v103
v_cvt_pk_bf16_f32 v205, v106, v107
v_cvt_pk_bf16_f32 v209, v110, v111
v_cvt_pk_bf16_f32 v198, v112, v113
v_cvt_pk_bf16_f32 v202, v116, v117
v_cvt_pk_bf16_f32 v206, v120, v121
v_cvt_pk_bf16_f32 v210, v124, v125
v_cvt_pk_bf16_f32 v199, v114, v115
v_cvt_pk_bf16_f32 v203, v118, v119
v_cvt_pk_bf16_f32 v207, v122, v123
v_cvt_pk_bf16_f32 v211, v126, v127
v_and_b32 v198, v50, v198
v_and_b32 v202, v50, v202
v_and_b32 v206, v50, v206
v_and_b32 v210, v50, v210
v_and_b32 v199, v50, v199
v_and_b32 v203, v50, v203
v_and_b32 v207, v50, v207
v_and_b32 v211, v50, v211
v_sub_f32 v20, 0, v20
v_sub_f32 v22, 0, v22
s_lshl_b32 s60, s48, 10
s_add_u32 s60, s60, 141312
v_add_u32 v21, s60, v241
s_waitcnt lgkmcnt(0)
v_pk_fma_f32 v[224:225], v[52:53], v[20:21], v[224:225] op_sel_hi:[1,0,1]
v_pk_fma_f32 v[226:227], v[54:55], v[20:21], v[226:227] op_sel_hi:[1,0,1]
v_pk_fma_f32 v[228:229], v[52:53], v[22:23], v[228:229] op_sel_hi:[1,0,1]
v_pk_fma_f32 v[230:231], v[54:55], v[22:23], v[230:231] op_sel_hi:[1,0,1]
v_pk_mul_f32 v[224:225], v[224:225], v[56:57]
v_pk_mul_f32 v[226:227], v[226:227], v[58:59]
v_pk_mul_f32 v[228:229], v[228:229], v[56:57]
v_pk_mul_f32 v[230:231], v[230:231], v[58:59]
v_cvt_pk_bf16_f32 v60, v224, v225
v_cvt_pk_bf16_f32 v61, v226, v227
v_cvt_pk_bf16_f32 v62, v228, v229
v_cvt_pk_bf16_f32 v63, v230, v231
ds_write_b128 v21, v[60:63] offset:4096
v_pk_fma_f32 v[128:129], v[64:65], v[20:21], v[128:129] op_sel_hi:[1,0,1]
v_pk_fma_f32 v[132:133], v[72:73], v[20:21], v[132:133] op_sel_hi:[1,0,1]
v_pk_fma_f32 v[136:137], v[80:81], v[20:21], v[136:137] op_sel_hi:[1,0,1]
v_pk_fma_f32 v[140:141], v[88:89], v[20:21], v[140:141] op_sel_hi:[1,0,1]
v_pk_fma_f32 v[130:131], v[66:67], v[20:21], v[130:131] op_sel_hi:[1,0,1]
v_pk_fma_f32 v[134:135], v[74:75], v[20:21], v[134:135] op_sel_hi:[1,0,1]
v_pk_fma_f32 v[138:139], v[82:83], v[20:21], v[138:139] op_sel_hi:[1,0,1]
v_pk_fma_f32 v[142:143], v[90:91], v[20:21], v[142:143] op_sel_hi:[1,0,1]
v_pk_fma_f32 v[144:145], v[64:65], v[22:23], v[144:145] op_sel_hi:[1,0,1]
v_pk_fma_f32 v[148:149], v[72:73], v[22:23], v[148:149] op_sel_hi:[1,0,1]
v_pk_fma_f32 v[152:153], v[80:81], v[22:23], v[152:153] op_sel_hi:[1,0,1]
v_pk_fma_f32 v[156:157], v[88:89], v[22:23], v[156:157] op_sel_hi:[1,0,1]
v_pk_fma_f32 v[146:147], v[66:67], v[22:23], v[146:147] op_sel_hi:[1,0,1]
v_pk_fma_f32 v[150:151], v[74:75], v[22:23], v[150:151] op_sel_hi:[1,0,1]
v_pk_fma_f32 v[154:155], v[82:83], v[22:23], v[154:155] op_sel_hi:[1,0,1]
v_pk_fma_f32 v[158:159], v[90:91], v[22:23], v[158:159] op_sel_hi:[1,0,1]
v_pk_mul_f32 v[128:129], v[128:129], v[68:69]
v_pk_mul_f32 v[132:133], v[132:133], v[76:77]
v_pk_mul_f32 v[136:137], v[136:137], v[84:85]
v_pk_mul_f32 v[140:141], v[140:141], v[92:93]
v_pk_mul_f32 v[130:131], v[130:131], v[70:71]
v_pk_mul_f32 v[134:135], v[134:135], v[78:79]
v_pk_mul_f32 v[138:139], v[138:139], v[86:87]
v_pk_mul_f32 v[142:143], v[142:143], v[94:95]
v_pk_mul_f32 v[144:145], v[144:145], v[68:69]
v_pk_mul_f32 v[148:149], v[148:149], v[76:77]
v_pk_mul_f32 v[152:153], v[152:153], v[84:85]
v_pk_mul_f32 v[156:157], v[156:157], v[92:93]
v_pk_mul_f32 v[146:147], v[146:147], v[70:71]
v_pk_mul_f32 v[150:151], v[150:151], v[78:79]
v_pk_mul_f32 v[154:155], v[154:155], v[86:87]
v_pk_mul_f32 v[158:159], v[158:159], v[94:95]
v_cvt_pk_bf16_f32 v214, v128, v129
v_cvt_pk_bf16_f32 v216, v132, v133
v_cvt_pk_bf16_f32 v218, v136, v137
v_cvt_pk_bf16_f32 v220, v140, v141
v_cvt_pk_bf16_f32 v215, v130, v131
v_cvt_pk_bf16_f32 v217, v134, v135
v_cvt_pk_bf16_f32 v219, v138, v139
v_cvt_pk_bf16_f32 v221, v142, v143
v_cvt_pk_bf16_f32 v162, v144, v145
v_cvt_pk_bf16_f32 v164, v148, v149
v_cvt_pk_bf16_f32 v166, v152, v153
v_cvt_pk_bf16_f32 v168, v156, v157
v_cvt_pk_bf16_f32 v163, v146, v147
v_cvt_pk_bf16_f32 v165, v150, v151
v_cvt_pk_bf16_f32 v167, v154, v155
v_cvt_pk_bf16_f32 v169, v158, v159
s_waitcnt lgkmcnt(0)
s_barrier
ds_read_b128 v[192:195], v21
ds_read_b64 v[212:213], v21 offset:2048
ds_read_b64 v[160:161], v21 offset:2056
s_mov_b32 s62, 0x3e8b97f6
v_mul_f32 v80, s62, v27
v_mul_f32 v81, s62, v29
v_mul_f32 v82, s62, v31
v_mul_f32 v83, s62, v33
v_mfma_f32_16x16x32_bf16 v[116:119], v[200:203], v[180:183], v[38:41]
v_mfma_f32_16x16x32_bf16 v[112:115], v[196:199], v[180:183], v[34:37]
v_mfma_f32_16x16x32_bf16 v[132:135], v[204:207], v[184:187], v[38:41]
v_mfma_f32_16x16x32_bf16 v[128:131], v[200:203], v[184:187], v[34:37]
v_mfma_f32_16x16x32_bf16 v[148:151], v[208:211], v[188:191], v[38:41]
v_mfma_f32_16x16x32_bf16 v[144:147], v[204:207], v[188:191], v[34:37]
s_waitcnt lgkmcnt(0)
v_mfma_f32_16x16x32_bf16 v[100:103], v[196:199], v[176:179], v[38:41]
v_mfma_f32_16x16x32_bf16 v[96:99], v[192:195], v[176:179], v[34:37]
s_nop 0
v_max3_f32 v124, v112, v113, v114
s_nop 0
v_max3_f32 v140, v128, v129, v130
s_nop 0
v_max3_f32 v156, v144, v145, v146
s_nop 1
v_max3_f32 v108, v96, v97, v98
v_max3_f32 v125, v115, v116, v117
v_max3_f32 v141, v131, v132, v133
v_max3_f32 v157, v147, v148, v149
v_max3_f32 v109, v99, v100, v101
v_max3_f32 v124, v124, v118, v119
v_max3_f32 v140, v140, v134, v135
v_max3_f32 v156, v156, v150, v151
v_max3_f32 v108, v108, v102, v103
v_max_f32 v124, v124, v125
v_max_f32 v140, v140, v141
v_max_f32 v156, v156, v157
v_max_f32 v108, v108, v109
v_mov_b32 v125, v124
v_mov_b32 v141, v140
v_mov_b32 v157, v156
v_mov_b32 v109, v108
v_permlane32_swap_b32 v124, v125
v_permlane32_swap_b32 v140, v141
v_permlane32_swap_b32 v156, v157
v_permlane32_swap_b32 v108, v109
v_max_f32 v124, v124, v125
v_max_f32 v140, v140, v141
v_max_f32 v156, v156, v157
v_max_f32 v108, v108, v109
v_mov_b32 v125, v124
v_mov_b32 v141, v140
v_mov_b32 v157, v156
v_mov_b32 v109, v108
v_permlane16_swap_b32 v124, v125
v_permlane16_swap_b32 v140, v141
v_permlane16_swap_b32 v156, v157
v_permlane16_swap_b32 v108, v109
v_max_f32 v124, v124, v125
v_max_f32 v140, v140, v141
v_max_f32 v156, v156, v157
v_max_f32 v108, v108, v109
v_mul_f32 v126, v124, v81
v_mul_f32 v142, v140, v82
v_mul_f32 v158, v156, v83
v_mul_f32 v110, v108, v80
v_fma_f32 v112, v112, v81, -v126
v_fma_f32 v128, v128, v82, -v142
v_fma_f32 v144, v144, v83, -v158
v_fma_f32 v96, v96, v80, -v110
v_fma_f32 v113, v113, v81, -v126
v_fma_f32 v129, v129, v82, -v142
v_fma_f32 v145, v145, v83, -v158
v_fma_f32 v97, v97, v80, -v110
v_fma_f32 v114, v114, v81, -v126
v_fma_f32 v130, v130, v82, -v142
v_fma_f32 v146, v146, v83, -v158
v_fma_f32 v98, v98, v80, -v110
v_fma_f32 v115, v115, v81, -v126
v_fma_f32 v131, v131, v82, -v142
v_fma_f32 v147, v147, v83, -v158
v_fma_f32 v99, v99, v80, -v110
v_fma_f32 v116, v116, v81, -v126
v_fma_f32 v132, v132, v82, -v142
v_fma_f32 v148, v148, v83, -v158
v_fma_f32 v100, v100, v80, -v110
v_fma_f32 v117, v117, v81, -v126
v_fma_f32 v133, v133, v82, -v142
v_fma_f32 v149, v149, v83, -v158
v_fma_f32 v101, v101, v80, -v110
v_fma_f32 v118, v118, v81, -v126
v_fma_f32 v134, v134, v82, -v142
v_fma_f32 v150, v150, v83, -v158
v_fma_f32 v102, v102, v80, -v110
v_fma_f32 v119, v119, v81, -v126
v_fma_f32 v135, v135, v82, -v142
v_fma_f32 v151, v151, v83, -v158
v_fma_f32 v103, v103, v80, -v110
v_exp_f32 v112, v112
v_exp_f32 v128, v128
v_exp_f32 v144, v144
v_exp_f32 v96, v96
v_exp_f32 v113, v113
v_exp_f32 v129, v129
v_exp_f32 v145, v145
v_exp_f32 v97, v97
v_exp_f32 v114, v114
v_exp_f32 v130, v130
v_exp_f32 v146, v146
v_exp_f32 v98, v98
v_exp_f32 v115, v115
v_exp_f32 v131, v131
v_exp_f32 v147, v147
v_exp_f32 v99, v99
v_exp_f32 v116, v116
v_exp_f32 v132, v132
v_exp_f32 v148, v148
v_exp_f32 v100, v100
v_exp_f32 v117, v117
v_exp_f32 v133, v133
v_exp_f32 v149, v149
v_exp_f32 v101, v101
v_exp_f32 v118, v118
v_exp_f32 v134, v134
v_exp_f32 v150, v150
v_exp_f32 v102, v102
v_exp_f32 v119, v119
v_exp_f32 v135, v135
v_exp_f32 v151, v151
v_exp_f32 v103, v103
v_cvt_pk_bf16_f32 v120, v112, v113
v_cvt_pk_bf16_f32 v136, v128, v129
v_cvt_pk_bf16_f32 v152, v144, v145
v_cvt_pk_bf16_f32 v104, v96, v97
v_cvt_pk_bf16_f32 v121, v114, v115
v_cvt_pk_bf16_f32 v137, v130, v131
v_cvt_pk_bf16_f32 v153, v146, v147
v_cvt_pk_bf16_f32 v105, v98, v99
v_cvt_pk_bf16_f32 v122, v116, v117
v_cvt_pk_bf16_f32 v138, v132, v133
v_cvt_pk_bf16_f32 v154, v148, v149
v_cvt_pk_bf16_f32 v106, v100, v101
v_cvt_pk_bf16_f32 v123, v118, v119
v_cvt_pk_bf16_f32 v139, v134, v135
v_cvt_pk_bf16_f32 v155, v150, v151
v_cvt_pk_bf16_f32 v107, v102, v103
v_mfma_f32_16x16x32_bf16 v[124:127], v[46:49], v[120:123], 0
v_mfma_f32_16x16x32_bf16 v[112:115], v[214:217], v[120:123], 0
v_mfma_f32_16x16x32_bf16 v[116:119], v[162:165], v[120:123], 0
v_mfma_f32_16x16x32_bf16 v[140:143], v[46:49], v[136:139], 0
v_mfma_f32_16x16x32_bf16 v[128:131], v[216:219], v[136:139], 0
v_mfma_f32_16x16x32_bf16 v[132:135], v[164:167], v[136:139], 0
v_mfma_f32_16x16x32_bf16 v[156:159], v[46:49], v[152:155], 0
v_mfma_f32_16x16x32_bf16 v[144:147], v[218:221], v[152:155], 0
v_mfma_f32_16x16x32_bf16 v[148:151], v[166:169], v[152:155], 0
v_mfma_f32_16x16x32_bf16 v[108:111], v[46:49], v[104:107], 0
v_mfma_f32_16x16x32_bf16 v[96:99], v[212:215], v[104:107], 0
v_mfma_f32_16x16x32_bf16 v[100:103], v[160:163], v[104:107], 0
v_rcp_f32 v124, v124
v_rcp_f32 v140, v140
s_nop 0
v_rcp_f32 v156, v156
s_nop 1
v_rcp_f32 v108, v108
v_mul_f32 v125, v124, v51
v_mul_f32 v141, v140, v51
v_mul_f32 v157, v156, v51
v_mul_f32 v109, v108, v51
v_mul_f32 v112, v112, v124
v_mul_f32 v128, v128, v140
v_mul_f32 v144, v144, v156
v_mul_f32 v96, v96, v108
v_mul_f32 v113, v113, v124
v_mul_f32 v129, v129, v140
v_mul_f32 v145, v145, v156
v_mul_f32 v97, v97, v108
v_mul_f32 v114, v114, v124
v_mul_f32 v130, v130, v140
v_mul_f32 v146, v146, v156
v_mul_f32 v98, v98, v108
v_mul_f32 v115, v115, v124
v_mul_f32 v131, v131, v140
v_mul_f32 v147, v147, v156
v_mul_f32 v99, v99, v108
v_mul_f32 v116, v116, v125
v_mul_f32 v132, v132, v141
v_mul_f32 v148, v148, v157
v_mul_f32 v100, v100, v109
v_mul_f32 v117, v117, v125
v_mul_f32 v133, v133, v141
v_mul_f32 v149, v149, v157
v_mul_f32 v101, v101, v109
v_mul_f32 v118, v118, v125
v_mul_f32 v134, v134, v141
v_mul_f32 v150, v150, v157
v_mul_f32 v102, v102, v109
v_mul_f32 v119, v119, v125
v_mul_f32 v135, v135, v141
v_mul_f32 v151, v151, v157
v_mul_f32 v103, v103, v109
v_cvt_pk_bf16_f32 v120, v112, v113
v_cvt_pk_bf16_f32 v136, v128, v129
v_cvt_pk_bf16_f32 v152, v144, v145
v_cvt_pk_bf16_f32 v104, v96, v97
v_cvt_pk_bf16_f32 v121, v114, v115
v_cvt_pk_bf16_f32 v137, v130, v131
v_cvt_pk_bf16_f32 v153, v146, v147
v_cvt_pk_bf16_f32 v105, v98, v99
v_cvt_pk_bf16_f32 v122, v116, v117
v_cvt_pk_bf16_f32 v138, v132, v133
v_cvt_pk_bf16_f32 v154, v148, v149
v_cvt_pk_bf16_f32 v106, v100, v101
v_cvt_pk_bf16_f32 v123, v118, v119
v_cvt_pk_bf16_f32 v139, v134, v135
v_cvt_pk_bf16_f32 v155, v150, v151
v_cvt_pk_bf16_f32 v107, v102, v103
s_add_u32 s60, s64, 73728
buffer_store_dwordx4 v[120:123], v241, s[24:27], s60 offen sc1
s_add_u32 s60, s65, 0
buffer_store_dwordx4 v[136:139], v241, s[24:27], s60 offen sc1
s_add_u32 s60, s65, 73728
buffer_store_dwordx4 v[152:155], v241, s[24:27], s60 offen sc1
s_add_u32 s60, s64, 0
buffer_store_dwordx4 v[104:107], v241, s[24:27], s60 offen sc1
s_lshr_b32 s60, s68, 2
s_add_u32 s61, s68, 2
s_lshr_b32 s61, s61, 2
v_mov_b32 v60, s60
v_mov_b32 v61, s61
v_cmp_gt_u32 vcc, 8, v1
s_nop 0
s_nop 0
v_cndmask_b32 v60, v61, v60, vcc
v_and_b32 v61, 3, v1
v_lshlrev_b32 v61, 2, v61
v_lshl_add_u32 v61, v60, 7, v61
v_bfe_u32 v60, v1, 2, 1
v_lshl_add_u32 v11, v60, 6, v61
v_cmp_gt_u32 vcc, 16, v1
v_mov_b32 v61, 2146435072
s_nop 0
v_cndmask_b32 v11, v61, v11, vcc
v_bfe_u32 v60, v1, 1, 2
v_cndmask_b32 v60, 7, v60, vcc
v_cmp_eq_u32 vcc, 1, v60
s_nop 1
v_cndmask_b32_e64 v12, 0, 1, vcc
v_cmp_eq_u32 vcc, 3, v60
s_nop 1
v_cndmask_b32_e64 v13, 0, 1, vcc
v_cmp_eq_u32 vcc, 0, v60
s_nop 1
v_cndmask_b32_e64 v14, 0, 1, vcc
v_cmp_eq_u32 vcc, 2, v60
s_nop 1
v_cndmask_b32_e64 v15, 0, 1, vcc
s_add_u32 s3, s70, 802816
s_add_u32 m0, s74, 20480
s_nop 0
buffer_load_dwordx4 v232, s[36:39], s3 offen lds
buffer_load_dwordx4 v233, s[36:39], s3 offen offset:1024 lds
buffer_load_dwordx4 v234, s[36:39], s3 offen offset:2048 lds
buffer_load_dwordx4 v235, s[36:39], s3 offen offset:3072 lds
s_add_u32 s3, s70, 831488
s_add_u32 m0, s74, 81920
s_nop 0
buffer_load_dwordx4 v232, s[36:39], s3 offen lds
buffer_load_dwordx4 v233, s[36:39], s3 offen offset:1024 lds
buffer_load_dwordx4 v234, s[36:39], s3 offen offset:2048 lds
buffer_load_dwordx4 v235, s[36:39], s3 offen offset:3072 lds
s_waitcnt vmcnt(8)
v_mov_b32 v62, 1
v_mov_b32 v63, 0
buffer_store_dword v62, v63, s[24:27], s77 offen sc1
ds_read_b64_tr_b16 a[0:1], v236 offset:40960
ds_read_b64_tr_b16 a[2:3], v236 offset:43008
ds_read_b64_tr_b16 a[4:5], v237 offset:40960
ds_read_b64_tr_b16 a[6:7], v237 offset:43008
ds_read_b64_tr_b16 a[8:9], v238 offset:40960
ds_read_b64_tr_b16 a[10:11], v238 offset:43008
ds_read_b64_tr_b16 a[12:13], v239 offset:40960
ds_read_b64_tr_b16 a[14:15], v239 offset:43008
ds_read_b64_tr_b16 a[16:17], v250 offset:34816
ds_read_b64_tr_b16 a[18:19], v250 offset:36864
ds_read_b64_tr_b16 a[20:21], v251 offset:34816
ds_read_b64_tr_b16 a[22:23], v251 offset:36864
ds_read_b64_tr_b16 a[24:25], v252 offset:34816
ds_read_b64_tr_b16 a[26:27], v252 offset:36864
ds_read_b64_tr_b16 a[28:29], v253 offset:34816
ds_read_b64_tr_b16 a[30:31], v253 offset:36864
s_waitcnt lgkmcnt(8)
s_add_u32 s3, s70, 860160
s_add_u32 m0, s74, 40960
s_nop 0
buffer_load_dwordx4 v232, s[36:39], s3 offen lds
buffer_load_dwordx4 v233, s[36:39], s3 offen offset:1024 lds
buffer_load_dwordx4 v234, s[36:39], s3 offen offset:2048 lds
buffer_load_dwordx4 v235, s[36:39], s3 offen offset:3072 lds
ds_read_b64_tr_b16 a[32:33], v236 offset:61440
ds_read_b64_tr_b16 a[34:35], v236 offset:63488
ds_read_b64_tr_b16 a[36:37], v237 offset:61440
ds_read_b64_tr_b16 a[38:39], v237 offset:63488
ds_read_b64_tr_b16 a[40:41], v238 offset:61440
ds_read_b64_tr_b16 a[42:43], v238 offset:63488
ds_read_b64_tr_b16 a[44:45], v239 offset:61440
ds_read_b64_tr_b16 a[46:47], v239 offset:63488
s_waitcnt lgkmcnt(8)
s_add_u32 s3, s70, 888832
s_add_u32 m0, s74, 100352
s_nop 0
buffer_load_dwordx4 v232, s[36:39], s3 offen lds
buffer_load_dwordx4 v233, s[36:39], s3 offen offset:1024 lds
buffer_load_dwordx4 v234, s[36:39], s3 offen offset:2048 lds
buffer_load_dwordx4 v235, s[36:39], s3 offen offset:3072 lds
ds_read_b64_tr_b16 a[48:49], v250 offset:53248
ds_read_b64_tr_b16 a[50:51], v250 offset:55296
ds_read_b64_tr_b16 a[52:53], v251 offset:53248
ds_read_b64_tr_b16 a[54:55], v251 offset:55296
ds_read_b64_tr_b16 a[56:57], v252 offset:53248
ds_read_b64_tr_b16 a[58:59], v252 offset:55296
ds_read_b64_tr_b16 a[60:61], v253 offset:53248
ds_read_b64_tr_b16 a[62:63], v253 offset:55296
s_waitcnt lgkmcnt(8)
s_add_u32 s3, s70, 917504
s_add_u32 m0, s74, 61440
s_nop 0
buffer_load_dwordx4 v232, s[36:39], s3 offen lds
buffer_load_dwordx4 v233, s[36:39], s3 offen offset:1024 lds
buffer_load_dwordx4 v234, s[36:39], s3 offen offset:2048 lds
buffer_load_dwordx4 v235, s[36:39], s3 offen offset:3072 lds
ds_read_b64_tr_b16 a[64:65], v236 offset:0
ds_read_b64_tr_b16 a[66:67], v236 offset:2048
ds_read_b64_tr_b16 a[68:69], v237 offset:0
ds_read_b64_tr_b16 a[70:71], v237 offset:2048
ds_read_b64_tr_b16 a[72:73], v238 offset:0
ds_read_b64_tr_b16 a[74:75], v238 offset:2048
ds_read_b64_tr_b16 a[76:77], v239 offset:0
ds_read_b64_tr_b16 a[78:79], v239 offset:2048
s_waitcnt lgkmcnt(8)
s_add_u32 s3, s71, 0
s_add_u32 m0, s74, 118784
s_nop 0
buffer_load_dwordx4 v232, s[36:39], s3 offen lds
buffer_load_dwordx4 v233, s[36:39], s3 offen offset:1024 lds
buffer_load_dwordx4 v234, s[36:39], s3 offen offset:2048 lds
buffer_load_dwordx4 v235, s[36:39], s3 offen offset:3072 lds
s_waitcnt vmcnt(21)
ds_read_b64_tr_b16 a[80:81], v236 offset:20480
ds_read_b64_tr_b16 a[82:83], v236 offset:22528
ds_read_b64_tr_b16 a[84:85], v237 offset:20480
ds_read_b64_tr_b16 a[86:87], v237 offset:22528
ds_read_b64_tr_b16 a[88:89], v238 offset:20480
ds_read_b64_tr_b16 a[90:91], v238 offset:22528
ds_read_b64_tr_b16 a[92:93], v239 offset:20480
ds_read_b64_tr_b16 a[94:95], v239 offset:22528
s_waitcnt lgkmcnt(8)
s_add_u32 s3, s71, 28672
s_add_u32 m0, s74, 0
s_nop 0
buffer_load_dwordx4 v232, s[36:39], s3 offen lds
buffer_load_dwordx4 v233, s[36:39], s3 offen offset:1024 lds
buffer_load_dwordx4 v234, s[36:39], s3 offen offset:2048 lds
buffer_load_dwordx4 v235, s[36:39], s3 offen offset:3072 lds
s_waitcnt vmcnt(21)
ds_read_b64_tr_b16 a[96:97], v250 offset:16384
ds_read_b64_tr_b16 a[98:99], v250 offset:18432
ds_read_b64_tr_b16 a[100:101], v251 offset:16384
ds_read_b64_tr_b16 a[102:103], v251 offset:18432
ds_read_b64_tr_b16 a[104:105], v252 offset:16384
ds_read_b64_tr_b16 a[106:107], v252 offset:18432
ds_read_b64_tr_b16 a[108:109], v253 offset:16384
ds_read_b64_tr_b16 a[110:111], v253 offset:18432
s_waitcnt lgkmcnt(8)
s_add_u32 s3, s72, 0
s_add_u32 m0, s74, 20480
s_nop 0
buffer_load_dwordx4 v232, s[32:35], s3 offen lds
buffer_load_dwordx4 v233, s[32:35], s3 offen offset:1024 lds
buffer_load_dwordx4 v234, s[32:35], s3 offen offset:2048 lds
buffer_load_dwordx4 v235, s[32:35], s3 offen offset:3072 lds
s_waitcnt vmcnt(20)
ds_read_b64_tr_b16 a[112:113], v236 offset:40960
ds_read_b64_tr_b16 a[114:115], v236 offset:43008
ds_read_b64_tr_b16 a[116:117], v237 offset:40960
ds_read_b64_tr_b16 a[118:119], v237 offset:43008
ds_read_b64_tr_b16 a[120:121], v238 offset:40960
ds_read_b64_tr_b16 a[122:123], v238 offset:43008
ds_read_b64_tr_b16 a[124:125], v239 offset:40960
ds_read_b64_tr_b16 a[126:127], v239 offset:43008
s_waitcnt lgkmcnt(8)
s_add_u32 s3, s72, 25088
s_add_u32 m0, s74, 81920
s_nop 0
buffer_load_dwordx4 v232, s[32:35], s3 offen lds
buffer_load_dwordx4 v233, s[32:35], s3 offen offset:1024 lds
buffer_load_dwordx4 v234, s[32:35], s3 offen offset:2048 lds
buffer_load_dwordx4 v235, s[32:35], s3 offen offset:3072 lds
s_waitcnt vmcnt(20)
ds_read_b64_tr_b16 a[128:129], v250 offset:34816
ds_read_b64_tr_b16 a[130:131], v250 offset:36864
ds_read_b64_tr_b16 a[132:133], v251 offset:34816
ds_read_b64_tr_b16 a[134:135], v251 offset:36864
ds_read_b64_tr_b16 a[136:137], v252 offset:34816
ds_read_b64_tr_b16 a[138:139], v252 offset:36864
ds_read_b64_tr_b16 a[140:141], v253 offset:34816
ds_read_b64_tr_b16 a[142:143], v253 offset:36864
s_waitcnt lgkmcnt(8)
s_add_u32 s3, s71, 802816
s_add_u32 m0, s74, 40960
s_nop 0
buffer_load_dwordx4 v232, s[36:39], s3 offen lds
buffer_load_dwordx4 v233, s[36:39], s3 offen offset:1024 lds
buffer_load_dwordx4 v234, s[36:39], s3 offen offset:2048 lds
buffer_load_dwordx4 v235, s[36:39], s3 offen offset:3072 lds
s_waitcnt vmcnt(20)
ds_read_b64_tr_b16 a[144:145], v236 offset:61440
ds_read_b64_tr_b16 a[146:147], v236 offset:63488
ds_read_b64_tr_b16 a[148:149], v237 offset:61440
ds_read_b64_tr_b16 a[150:151], v237 offset:63488
ds_read_b64_tr_b16 a[152:153], v238 offset:61440
ds_read_b64_tr_b16 a[154:155], v238 offset:63488
ds_read_b64_tr_b16 a[156:157], v239 offset:61440
ds_read_b64_tr_b16 a[158:159], v239 offset:63488
s_waitcnt lgkmcnt(8)
s_add_u32 s3, s71, 831488
s_add_u32 m0, s74, 100352
s_nop 0
buffer_load_dwordx4 v232, s[36:39], s3 offen lds
buffer_load_dwordx4 v233, s[36:39], s3 offen offset:1024 lds
buffer_load_dwordx4 v234, s[36:39], s3 offen offset:2048 lds
buffer_load_dwordx4 v235, s[36:39], s3 offen offset:3072 lds
s_waitcnt vmcnt(20)
ds_read_b64_tr_b16 a[160:161], v250 offset:53248
ds_read_b64_tr_b16 a[162:163], v250 offset:55296
ds_read_b64_tr_b16 a[164:165], v251 offset:53248
ds_read_b64_tr_b16 a[166:167], v251 offset:55296
ds_read_b64_tr_b16 a[168:169], v252 offset:53248
ds_read_b64_tr_b16 a[170:171], v252 offset:55296
ds_read_b64_tr_b16 a[172:173], v253 offset:53248
ds_read_b64_tr_b16 a[174:175], v253 offset:55296
s_waitcnt lgkmcnt(8)
s_add_u32 s3, s72, 200704
s_add_u32 m0, s74, 61440
s_nop 0
buffer_load_dwordx4 v232, s[32:35], s3 offen lds
buffer_load_dwordx4 v233, s[32:35], s3 offen offset:1024 lds
buffer_load_dwordx4 v234, s[32:35], s3 offen offset:2048 lds
buffer_load_dwordx4 v235, s[32:35], s3 offen offset:3072 lds
s_waitcnt vmcnt(20)
ds_read_b64_tr_b16 a[176:177], v236 offset:0
ds_read_b64_tr_b16 a[178:179], v236 offset:2048
ds_read_b64_tr_b16 a[180:181], v237 offset:0
ds_read_b64_tr_b16 a[182:183], v237 offset:2048
ds_read_b64_tr_b16 a[184:185], v238 offset:0
buffer_load_dword v10, v11, s[24:27], s79 offen sc1
ds_read_b64_tr_b16 a[186:187], v238 offset:2048
ds_read_b64_tr_b16 a[188:189], v239 offset:0
ds_read_b64_tr_b16 a[190:191], v239 offset:2048
s_waitcnt lgkmcnt(8)
s_add_u32 s3, s72, 225792
s_add_u32 m0, s74, 118784
s_nop 0
buffer_load_dwordx4 v232, s[32:35], s3 offen lds
buffer_load_dwordx4 v233, s[32:35], s3 offen offset:1024 lds
buffer_load_dwordx4 v234, s[32:35], s3 offen offset:2048 lds
buffer_load_dwordx4 v235, s[32:35], s3 offen offset:3072 lds
s_waitcnt vmcnt(4)
v_cmp_lt_u32 vcc, v10, v12
s_nop 0
s_cmp_eq_u64 vcc, 0
s_cbranch_scc0 L_flg_slow_34
L_flg_back_35:
s_add_u32 s60, s73, 4096
buffer_load_dwordx4 v[128:131], v241, s[24:27], s60 offen sc1
s_add_u32 s60, s73, 77824
buffer_load_dwordx4 v[132:135], v241, s[24:27], s60 offen sc1
s_add_u32 s60, s73, 151552
buffer_load_dwordx4 v[136:139], v241, s[24:27], s60 offen sc1
s_add_u32 s60, s73, 5120
buffer_load_dwordx4 v[140:143], v241, s[24:27], s60 offen sc1
s_add_u32 s60, s73, 78848
buffer_load_dwordx4 v[144:147], v241, s[24:27], s60 offen sc1
s_add_u32 s60, s73, 152576
buffer_load_dwordx4 v[148:151], v241, s[24:27], s60 offen sc1
buffer_load_dword v10, v11, s[24:27], s79 offen sc1
s_add_u32 s60, s73, 6144
buffer_load_dwordx4 v[152:155], v241, s[24:27], s60 offen sc1
s_add_u32 s60, s73, 79872
buffer_load_dwordx4 v[156:159], v241, s[24:27], s60 offen sc1
s_add_u32 s60, s73, 153600
buffer_load_dwordx4 v[160:163], v241, s[24:27], s60 offen sc1
s_add_u32 s60, s73, 7168
buffer_load_dwordx4 v[164:167], v241, s[24:27], s60 offen sc1
s_add_u32 s60, s73, 80896
buffer_load_dwordx4 v[168:171], v241, s[24:27], s60 offen sc1
s_add_u32 s60, s73, 154624
buffer_load_dwordx4 v[172:175], v241, s[24:27], s60 offen sc1
s_add_u32 s60, s73, 8192
buffer_load_dwordx4 v[176:179], v241, s[24:27], s60 offen sc1
s_add_u32 s60, s73, 81920
buffer_load_dwordx4 v[180:183], v241, s[24:27], s60 offen sc1
s_add_u32 s60, s73, 155648
buffer_load_dwordx4 v[184:187], v241, s[24:27], s60 offen sc1
ds_read_b64_tr_b16 a[192:193], v236 offset:20480
ds_read_b64_tr_b16 a[194:195], v236 offset:22528
ds_read_b64_tr_b16 a[196:197], v237 offset:20480
ds_read_b64_tr_b16 a[198:199], v237 offset:22528
ds_read_b64_tr_b16 a[200:201], v238 offset:20480
ds_read_b64_tr_b16 a[202:203], v238 offset:22528
ds_read_b64_tr_b16 a[204:205], v239 offset:20480
ds_read_b64_tr_b16 a[206:207], v239 offset:22528
ds_read_b64_tr_b16 a[208:209], v250 offset:16384
ds_read_b64_tr_b16 a[210:211], v250 offset:18432
ds_read_b64_tr_b16 a[212:213], v251 offset:16384
ds_read_b64_tr_b16 a[214:215], v251 offset:18432
ds_read_b64_tr_b16 a[216:217], v252 offset:16384
ds_read_b64_tr_b16 a[218:219], v252 offset:18432
ds_read_b64_tr_b16 a[220:221], v253 offset:16384
ds_read_b64_tr_b16 a[222:223], v253 offset:18432
ds_read_b64_tr_b16 a[224:225], v236 offset:40960
ds_read_b64_tr_b16 a[226:227], v236 offset:43008
ds_read_b64_tr_b16 a[228:229], v237 offset:40960
ds_read_b64_tr_b16 a[230:231], v237 offset:43008
ds_read_b64_tr_b16 a[232:233], v238 offset:40960
ds_read_b64_tr_b16 a[234:235], v238 offset:43008
ds_read_b64_tr_b16 a[236:237], v239 offset:40960
ds_read_b64_tr_b16 a[238:239], v239 offset:43008
ds_read_b64_tr_b16 a[240:241], v250 offset:34816
ds_read_b64_tr_b16 a[242:243], v250 offset:36864
ds_read_b64_tr_b16 a[244:245], v251 offset:34816
ds_read_b64_tr_b16 a[246:247], v251 offset:36864
ds_read_b64_tr_b16 a[248:249], v252 offset:34816
ds_read_b64_tr_b16 a[250:251], v252 offset:36864
ds_read_b64_tr_b16 a[252:253], v253 offset:34816
ds_read_b64_tr_b16 a[254:255], v253 offset:36864
ds_read_b64_tr_b16 v[192:193], v236 offset:61440
ds_read_b64_tr_b16 v[194:195], v236 offset:63488
ds_read_b64_tr_b16 v[196:197], v237 offset:61440
ds_read_b64_tr_b16 v[198:199], v237 offset:63488
ds_read_b64_tr_b16 v[200:201], v238 offset:61440
ds_read_b64_tr_b16 v[202:203], v238 offset:63488
ds_read_b64_tr_b16 v[204:205], v239 offset:61440
ds_read_b64_tr_b16 v[206:207], v239 offset:63488
s_waitcnt vmcnt(16)
ds_read_b64_tr_b16 v[208:209], v250 offset:53248
ds_read_b64_tr_b16 v[210:211], v250 offset:55296
ds_read_b64_tr_b16 v[212:213], v251 offset:53248
ds_read_b64_tr_b16 v[214:215], v251 offset:55296
ds_read_b64_tr_b16 v[216:217], v252 offset:53248
ds_read_b64_tr_b16 v[218:219], v252 offset:55296
ds_read_b64_tr_b16 v[220:221], v253 offset:53248
ds_read_b64_tr_b16 v[222:223], v253 offset:55296
s_waitcnt vmcnt(9)
v_cmp_lt_u32 vcc, v10, v13
s_nop 0
s_cmp_eq_u64 vcc, 0
s_cbranch_scc0 L_flg_slow_37
L_flg_back_38:
s_add_u32 s60, s73, 40960
buffer_load_dwordx4 v[188:191], v241, s[24:27], s60 offen sc1
v_and_b32 v34, 15, v1
v_mul_u32_u24 v35, 0x110, v34
v_lshrrev_b32 v36, 4, v1
v_lshl_add_u32 v35, v36, 4, v35
s_mul_i32 s61, s46, 17408
v_add_u32 v38, s61, v35
s_mul_i32 s61, s46, 4352
v_add_u32 v39, s61, v35
s_add_u32 s61, s68, s46
s_lshl_b32 s61, s61, 4
v_add_u32 v34, s61, v34
v_mul_u32_u24 v34, 0x380, v34
v_and_b32 v37, 1, v36
v_lshlrev_b32 v37, 1, v37
v_lshrrev_b32 v36, 1, v36
v_or_b32 v36, v36, v37
v_lshl_add_u32 v34, v36, 4, v34
s_lshl_b32 s61, s69, 7
v_add_u32 v40, s61, v34
v_mfma_f32_16x16x32_bf16 v[64:67], a[0:3], v[128:131], 0
v_mfma_f32_16x16x32_bf16 v[80:83], a[4:7], v[128:131], 0
v_mfma_f32_16x16x32_bf16 v[96:99], a[8:11], v[128:131], 0
v_mfma_f32_16x16x32_bf16 v[112:115], a[12:15], v[128:131], 0
s_add_u32 s60, s73, 114688
buffer_load_dwordx4 v[128:131], v241, s[24:27], s60 offen sc1
v_mfma_f32_16x16x32_bf16 v[68:71], a[0:3], v[132:135], 0
v_mfma_f32_16x16x32_bf16 v[84:87], a[4:7], v[132:135], 0
v_mfma_f32_16x16x32_bf16 v[100:103], a[8:11], v[132:135], 0
v_mfma_f32_16x16x32_bf16 v[116:119], a[12:15], v[132:135], 0
s_add_u32 s60, s73, 188416
buffer_load_dwordx4 v[132:135], v241, s[24:27], s60 offen sc1
v_mfma_f32_16x16x32_bf16 v[72:75], a[0:3], v[136:139], 0
v_mfma_f32_16x16x32_bf16 v[88:91], a[4:7], v[136:139], 0
v_mfma_f32_16x16x32_bf16 v[104:107], a[8:11], v[136:139], 0
v_mfma_f32_16x16x32_bf16 v[120:123], a[12:15], v[136:139], 0
s_add_u32 s60, s73, 41984
buffer_load_dwordx4 v[136:139], v241, s[24:27], s60 offen sc1
v_mfma_f32_16x16x32_bf16 v[64:67], a[16:19], v[140:143], v[64:67]
v_mfma_f32_16x16x32_bf16 v[80:83], a[20:23], v[140:143], v[80:83]
v_mfma_f32_16x16x32_bf16 v[96:99], a[24:27], v[140:143], v[96:99]
v_mfma_f32_16x16x32_bf16 v[112:115], a[28:31], v[140:143], v[112:115]
s_add_u32 s60, s73, 115712
buffer_load_dwordx4 v[140:143], v241, s[24:27], s60 offen sc1
v_mfma_f32_16x16x32_bf16 v[68:71], a[16:19], v[144:147], v[68:71]
v_mfma_f32_16x16x32_bf16 v[84:87], a[20:23], v[144:147], v[84:87]
v_mfma_f32_16x16x32_bf16 v[100:103], a[24:27], v[144:147], v[100:103]
v_mfma_f32_16x16x32_bf16 v[116:119], a[28:31], v[144:147], v[116:119]
s_add_u32 s60, s73, 189440
buffer_load_dwordx4 v[144:147], v241, s[24:27], s60 offen sc1
buffer_load_dword v10, v11, s[24:27], s79 offen sc1
v_mfma_f32_16x16x32_bf16 v[72:75], a[16:19], v[148:151], v[72:75]
v_mfma_f32_16x16x32_bf16 v[88:91], a[20:23], v[148:151], v[88:91]
v_mfma_f32_16x16x32_bf16 v[104:107], a[24:27], v[148:151], v[104:107]
v_mfma_f32_16x16x32_bf16 v[120:123], a[28:31], v[148:151], v[120:123]
s_add_u32 s60, s73, 43008
buffer_load_dwordx4 v[148:151], v241, s[24:27], s60 offen sc1
s_waitcnt vmcnt(16)
v_mfma_f32_16x16x32_bf16 v[64:67], a[32:35], v[152:155], v[64:67]
v_mfma_f32_16x16x32_bf16 v[80:83], a[36:39], v[152:155], v[80:83]
v_mfma_f32_16x16x32_bf16 v[96:99], a[40:43], v[152:155], v[96:99]
v_mfma_f32_16x16x32_bf16 v[112:115], a[44:47], v[152:155], v[112:115]
s_add_u32 s60, s73, 116736
buffer_load_dwordx4 v[152:155], v241, s[24:27], s60 offen sc1
s_waitcnt vmcnt(16)
v_mfma_f32_16x16x32_bf16 v[68:71], a[32:35], v[156:159], v[68:71]
v_mfma_f32_16x16x32_bf16 v[84:87], a[36:39], v[156:159], v[84:87]
v_mfma_f32_16x16x32_bf16 v[100:103], a[40:43], v[156:159], v[100:103]
v_mfma_f32_16x16x32_bf16 v[116:119], a[44:47], v[156:159], v[116:119]
s_add_u32 s60, s73, 190464
buffer_load_dwordx4 v[156:159], v241, s[24:27], s60 offen sc1
s_waitcnt vmcnt(16)
v_mfma_f32_16x16x32_bf16 v[72:75], a[32:35], v[160:163], v[72:75]
v_mfma_f32_16x16x32_bf16 v[88:91], a[36:39], v[160:163], v[88:91]
v_mfma_f32_16x16x32_bf16 v[104:107], a[40:43], v[160:163], v[104:107]
v_mfma_f32_16x16x32_bf16 v[120:123], a[44:47], v[160:163], v[120:123]
s_add_u32 s60, s73, 44032
buffer_load_dwordx4 v[160:163], v241, s[24:27], s60 offen sc1
s_waitcnt vmcnt(16)
v_mfma_f32_16x16x32_bf16 v[64:67], a[48:51], v[164:167], v[64:67]
v_mfma_f32_16x16x32_bf16 v[80:83], a[52:55], v[164:167], v[80:83]
v_mfma_f32_16x16x32_bf16 v[96:99], a[56:59], v[164:167], v[96:99]
v_mfma_f32_16x16x32_bf16 v[112:115], a[60:63], v[164:167], v[112:115]
s_add_u32 s60, s73, 117760
buffer_load_dwordx4 v[164:167], v241, s[24:27], s60 offen sc1
s_waitcnt vmcnt(16)
v_mfma_f32_16x16x32_bf16 v[68:71], a[48:51], v[168:171], v[68:71]
v_mfma_f32_16x16x32_bf16 v[84:87], a[52:55], v[168:171], v[84:87]
v_mfma_f32_16x16x32_bf16 v[100:103], a[56:59], v[168:171], v[100:103]
v_mfma_f32_16x16x32_bf16 v[116:119], a[60:63], v[168:171], v[116:119]
s_add_u32 s60, s73, 191488
buffer_load_dwordx4 v[168:171], v241, s[24:27], s60 offen sc1
s_waitcnt vmcnt(16)
v_mfma_f32_16x16x32_bf16 v[72:75], a[48:51], v[172:175], v[72:75]
v_mfma_f32_16x16x32_bf16 v[88:91], a[52:55], v[172:175], v[88:91]
v_mfma_f32_16x16x32_bf16 v[104:107], a[56:59], v[172:175], v[104:107]
v_mfma_f32_16x16x32_bf16 v[120:123], a[60:63], v[172:175], v[120:123]
s_add_u32 s60, s73, 45056
buffer_load_dwordx4 v[172:175], v241, s[24:27], s60 offen sc1
s_waitcnt vmcnt(16)
v_mfma_f32_16x16x32_bf16 v[64:67], a[64:67], v[176:179], v[64:67]
v_mfma_f32_16x16x32_bf16 v[80:83], a[68:71], v[176:179], v[80:83]
v_mfma_f32_16x16x32_bf16 v[96:99], a[72:75], v[176:179], v[96:99]
v_mfma_f32_16x16x32_bf16 v[112:115], a[76:79], v[176:179], v[112:115]
s_add_u32 s60, s73, 118784
buffer_load_dwordx4 v[176:179], v241, s[24:27], s60 offen sc1
s_waitcnt vmcnt(16)
v_mfma_f32_16x16x32_bf16 v[68:71], a[64:67], v[180:183], v[68:71]
v_mfma_f32_16x16x32_bf16 v[84:87], a[68:71], v[180:183], v[84:87]
v_mfma_f32_16x16x32_bf16 v[100:103], a[72:75], v[180:183], v[100:103]
v_mfma_f32_16x16x32_bf16 v[116:119], a[76:79], v[180:183], v[116:119]
s_add_u32 s60, s73, 192512
buffer_load_dwordx4 v[180:183], v241, s[24:27], s60 offen sc1
s_waitcnt vmcnt(16)
v_mfma_f32_16x16x32_bf16 v[72:75], a[64:67], v[184:187], v[72:75]
v_mfma_f32_16x16x32_bf16 v[88:91], a[68:71], v[184:187], v[88:91]
v_mfma_f32_16x16x32_bf16 v[104:107], a[72:75], v[184:187], v[104:107]
v_mfma_f32_16x16x32_bf16 v[120:123], a[76:79], v[184:187], v[120:123]
s_waitcnt vmcnt(9)
v_cmp_lt_u32 vcc, v10, v14
s_nop 0
s_cmp_eq_u64 vcc, 0
s_cbranch_scc0 L_flg_slow_40
L_flg_back_41:
s_add_u32 s60, s73, 1024
buffer_load_dwordx4 v[184:187], v241, s[24:27], s60 offen sc1
v_mfma_f32_16x16x32_bf16 v[64:67], a[80:83], v[188:191], v[64:67]
v_mfma_f32_16x16x32_bf16 v[80:83], a[84:87], v[188:191], v[80:83]
v_mfma_f32_16x16x32_bf16 v[96:99], a[88:91], v[188:191], v[96:99]
v_mfma_f32_16x16x32_bf16 v[112:115], a[92:95], v[188:191], v[112:115]
s_add_u32 s60, s73, 74752
buffer_load_dwordx4 v[188:191], v241, s[24:27], s60 offen sc1
v_mfma_f32_16x16x32_bf16 v[68:71], a[80:83], v[128:131], v[68:71]
v_mfma_f32_16x16x32_bf16 v[84:87], a[84:87], v[128:131], v[84:87]
v_mfma_f32_16x16x32_bf16 v[100:103], a[88:91], v[128:131], v[100:103]
v_mfma_f32_16x16x32_bf16 v[116:119], a[92:95], v[128:131], v[116:119]
s_add_u32 s60, s73, 148480
buffer_load_dwordx4 v[128:131], v241, s[24:27], s60 offen sc1
buffer_load_dword v10, v11, s[24:27], s79 offen sc1
v_mfma_f32_16x16x32_bf16 v[72:75], a[80:83], v[132:135], v[72:75]
v_mfma_f32_16x16x32_bf16 v[88:91], a[84:87], v[132:135], v[88:91]
v_mfma_f32_16x16x32_bf16 v[104:107], a[88:91], v[132:135], v[104:107]
v_mfma_f32_16x16x32_bf16 v[120:123], a[92:95], v[132:135], v[120:123]
s_add_u32 s60, s73, 3072
buffer_load_dwordx4 v[132:135], v241, s[24:27], s60 offen sc1
v_mfma_f32_16x16x32_bf16 v[64:67], a[96:99], v[136:139], v[64:67]
v_mfma_f32_16x16x32_bf16 v[80:83], a[100:103], v[136:139], v[80:83]
v_mfma_f32_16x16x32_bf16 v[96:99], a[104:107], v[136:139], v[96:99]
v_mfma_f32_16x16x32_bf16 v[112:115], a[108:111], v[136:139], v[112:115]
s_add_u32 s60, s73, 76800
buffer_load_dwordx4 v[136:139], v241, s[24:27], s60 offen sc1
v_mfma_f32_16x16x32_bf16 v[68:71], a[96:99], v[140:143], v[68:71]
v_mfma_f32_16x16x32_bf16 v[84:87], a[100:103], v[140:143], v[84:87]
v_mfma_f32_16x16x32_bf16 v[100:103], a[104:107], v[140:143], v[100:103]
v_mfma_f32_16x16x32_bf16 v[116:119], a[108:111], v[140:143], v[116:119]
s_add_u32 s60, s73, 150528
buffer_load_dwordx4 v[140:143], v241, s[24:27], s60 offen sc1
v_mfma_f32_16x16x32_bf16 v[72:75], a[96:99], v[144:147], v[72:75]
v_mfma_f32_16x16x32_bf16 v[88:91], a[100:103], v[144:147], v[88:91]
v_mfma_f32_16x16x32_bf16 v[104:107], a[104:107], v[144:147], v[104:107]
v_mfma_f32_16x16x32_bf16 v[120:123], a[108:111], v[144:147], v[120:123]
s_add_u32 s60, s73, 0
buffer_load_dwordx4 v[144:147], v241, s[24:27], s60 offen sc1
s_waitcnt vmcnt(16)
v_mfma_f32_16x16x32_bf16 v[64:67], a[112:115], v[148:151], v[64:67]
v_mfma_f32_16x16x32_bf16 v[80:83], a[116:119], v[148:151], v[80:83]
v_mfma_f32_16x16x32_bf16 v[96:99], a[120:123], v[148:151], v[96:99]
v_mfma_f32_16x16x32_bf16 v[112:115], a[124:127], v[148:151], v[112:115]
s_add_u32 s60, s73, 73728
buffer_load_dwordx4 v[148:151], v241, s[24:27], s60 offen sc1
s_waitcnt vmcnt(16)
v_mfma_f32_16x16x32_bf16 v[68:71], a[112:115], v[152:155], v[68:71]
v_mfma_f32_16x16x32_bf16 v[84:87], a[116:119], v[152:155], v[84:87]
v_mfma_f32_16x16x32_bf16 v[100:103], a[120:123], v[152:155], v[100:103]
v_mfma_f32_16x16x32_bf16 v[116:119], a[124:127], v[152:155], v[116:119]
s_add_u32 s60, s73, 147456
buffer_load_dwordx4 v[152:155], v241, s[24:27], s60 offen sc1
s_waitcnt vmcnt(16)
v_mfma_f32_16x16x32_bf16 v[72:75], a[112:115], v[156:159], v[72:75]
v_mfma_f32_16x16x32_bf16 v[88:91], a[116:119], v[156:159], v[88:91]
v_mfma_f32_16x16x32_bf16 v[104:107], a[120:123], v[156:159], v[104:107]
v_mfma_f32_16x16x32_bf16 v[120:123], a[124:127], v[156:159], v[120:123]
s_add_u32 s60, s73, 2048
buffer_load_dwordx4 v[156:159], v241, s[24:27], s60 offen sc1
s_waitcnt vmcnt(16)
v_mfma_f32_16x16x32_bf16 v[64:67], a[128:131], v[160:163], v[64:67]
v_mfma_f32_16x16x32_bf16 v[80:83], a[132:135], v[160:163], v[80:83]
v_mfma_f32_16x16x32_bf16 v[96:99], a[136:139], v[160:163], v[96:99]
v_mfma_f32_16x16x32_bf16 v[112:115], a[140:143], v[160:163], v[112:115]
s_add_u32 s60, s73, 75776
buffer_load_dwordx4 v[160:163], v241, s[24:27], s60 offen sc1
s_waitcnt vmcnt(16)
v_mfma_f32_16x16x32_bf16 v[68:71], a[128:131], v[164:167], v[68:71]
v_mfma_f32_16x16x32_bf16 v[84:87], a[132:135], v[164:167], v[84:87]
v_mfma_f32_16x16x32_bf16 v[100:103], a[136:139], v[164:167], v[100:103]
v_mfma_f32_16x16x32_bf16 v[116:119], a[140:143], v[164:167], v[116:119]
s_add_u32 s60, s73, 149504
buffer_load_dwordx4 v[164:167], v241, s[24:27], s60 offen sc1
s_waitcnt vmcnt(16)
v_mfma_f32_16x16x32_bf16 v[72:75], a[128:131], v[168:171], v[72:75]
v_mfma_f32_16x16x32_bf16 v[88:91], a[132:135], v[168:171], v[88:91]
v_mfma_f32_16x16x32_bf16 v[104:107], a[136:139], v[168:171], v[104:107]
v_mfma_f32_16x16x32_bf16 v[120:123], a[140:143], v[168:171], v[120:123]
s_waitcnt vmcnt(9)
v_cmp_lt_u32 vcc, v10, v15
s_nop 0
s_cmp_eq_u64 vcc, 0
s_cbranch_scc0 L_flg_slow_43
L_flg_back_44:
s_add_u32 s60, s73, 37888
buffer_load_dwordx4 v[168:171], v241, s[24:27], s60 offen sc1
v_mfma_f32_16x16x32_bf16 v[64:67], a[144:147], v[172:175], v[64:67]
v_mfma_f32_16x16x32_bf16 v[80:83], a[148:151], v[172:175], v[80:83]
v_mfma_f32_16x16x32_bf16 v[96:99], a[152:155], v[172:175], v[96:99]
v_mfma_f32_16x16x32_bf16 v[112:115], a[156:159], v[172:175], v[112:115]
s_add_u32 s60, s73, 39936
buffer_load_dwordx4 v[172:175], v241, s[24:27], s60 offen sc1
v_mfma_f32_16x16x32_bf16 v[68:71], a[144:147], v[176:179], v[68:71]
v_mfma_f32_16x16x32_bf16 v[84:87], a[148:151], v[176:179], v[84:87]
v_mfma_f32_16x16x32_bf16 v[100:103], a[152:155], v[176:179], v[100:103]
v_mfma_f32_16x16x32_bf16 v[116:119], a[156:159], v[176:179], v[116:119]
s_add_u32 s60, s73, 36864
buffer_load_dwordx4 v[176:179], v241, s[24:27], s60 offen sc1
v_mfma_f32_16x16x32_bf16 v[72:75], a[144:147], v[180:183], v[72:75]
v_mfma_f32_16x16x32_bf16 v[88:91], a[148:151], v[180:183], v[88:91]
v_mfma_f32_16x16x32_bf16 v[104:107], a[152:155], v[180:183], v[104:107]
v_mfma_f32_16x16x32_bf16 v[120:123], a[156:159], v[180:183], v[120:123]
s_add_u32 s60, s73, 38912
buffer_load_dwordx4 v[180:183], v241, s[24:27], s60 offen sc1
v_mfma_f32_16x16x32_bf16 v[64:67], a[160:163], v[184:187], v[64:67]
v_mfma_f32_16x16x32_bf16 v[80:83], a[164:167], v[184:187], v[80:83]
v_mfma_f32_16x16x32_bf16 v[96:99], a[168:171], v[184:187], v[96:99]
v_mfma_f32_16x16x32_bf16 v[112:115], a[172:175], v[184:187], v[112:115]
s_add_u32 s60, s73, 111616
buffer_load_dwordx4 v[184:187], v241, s[24:27], s60 offen sc1
v_mfma_f32_16x16x32_bf16 v[68:71], a[160:163], v[188:191], v[68:71]
v_mfma_f32_16x16x32_bf16 v[84:87], a[164:167], v[188:191], v[84:87]
v_mfma_f32_16x16x32_bf16 v[100:103], a[168:171], v[188:191], v[100:103]
v_mfma_f32_16x16x32_bf16 v[116:119], a[172:175], v[188:191], v[116:119]
s_add_u32 s60, s73, 113664
buffer_load_dwordx4 v[188:191], v241, s[24:27], s60 offen sc1
v_mfma_f32_16x16x32_bf16 v[72:75], a[160:163], v[128:131], v[72:75]
v_mfma_f32_16x16x32_bf16 v[88:91], a[164:167], v[128:131], v[88:91]
v_mfma_f32_16x16x32_bf16 v[104:107], a[168:171], v[128:131], v[104:107]
v_mfma_f32_16x16x32_bf16 v[120:123], a[172:175], v[128:131], v[120:123]
s_add_u32 s60, s73, 110592
buffer_load_dwordx4 v[128:131], v241, s[24:27], s60 offen sc1
s_waitcnt vmcnt(15)
v_mfma_f32_16x16x32_bf16 v[64:67], a[176:179], v[132:135], v[64:67]
v_mfma_f32_16x16x32_bf16 v[80:83], a[180:183], v[132:135], v[80:83]
v_mfma_f32_16x16x32_bf16 v[96:99], a[184:187], v[132:135], v[96:99]
v_mfma_f32_16x16x32_bf16 v[112:115], a[188:191], v[132:135], v[112:115]
s_add_u32 s60, s73, 112640
buffer_load_dwordx4 v[132:135], v241, s[24:27], s60 offen sc1
s_waitcnt vmcnt(15)
v_mfma_f32_16x16x32_bf16 v[68:71], a[176:179], v[136:139], v[68:71]
v_mfma_f32_16x16x32_bf16 v[84:87], a[180:183], v[136:139], v[84:87]
v_mfma_f32_16x16x32_bf16 v[100:103], a[184:187], v[136:139], v[100:103]
v_mfma_f32_16x16x32_bf16 v[116:119], a[188:191], v[136:139], v[116:119]
s_add_u32 s60, s73, 185344
buffer_load_dwordx4 v[136:139], v241, s[24:27], s60 offen sc1
s_waitcnt vmcnt(15)
v_mfma_f32_16x16x32_bf16 v[72:75], a[176:179], v[140:143], v[72:75]
v_mfma_f32_16x16x32_bf16 v[88:91], a[180:183], v[140:143], v[88:91]
v_mfma_f32_16x16x32_bf16 v[104:107], a[184:187], v[140:143], v[104:107]
v_mfma_f32_16x16x32_bf16 v[120:123], a[188:191], v[140:143], v[120:123]
s_add_u32 s60, s73, 187392
buffer_load_dwordx4 v[140:143], v241, s[24:27], s60 offen sc1
s_waitcnt vmcnt(15)
v_mfma_f32_16x16x32_bf16 v[64:67], a[192:195], v[144:147], v[64:67]
v_mfma_f32_16x16x32_bf16 v[80:83], a[196:199], v[144:147], v[80:83]
v_mfma_f32_16x16x32_bf16 v[96:99], a[200:203], v[144:147], v[96:99]
v_mfma_f32_16x16x32_bf16 v[112:115], a[204:207], v[144:147], v[112:115]
s_add_u32 s60, s73, 184320
buffer_load_dwordx4 v[144:147], v241, s[24:27], s60 offen sc1
s_waitcnt vmcnt(15)
v_mfma_f32_16x16x32_bf16 v[68:71], a[192:195], v[148:151], v[68:71]
v_mfma_f32_16x16x32_bf16 v[84:87], a[196:199], v[148:151], v[84:87]
v_mfma_f32_16x16x32_bf16 v[100:103], a[200:203], v[148:151], v[100:103]
v_mfma_f32_16x16x32_bf16 v[116:119], a[204:207], v[148:151], v[116:119]
s_add_u32 s60, s73, 186368
buffer_load_dwordx4 v[148:151], v241, s[24:27], s60 offen sc1
buffer_load_dwordx4 v[44:47], v40, s[8:11], 0 offen
buffer_load_dwordx4 v[48:51], v40, s[8:11], 0 offen offset:64
s_waitcnt vmcnt(17)
v_mfma_f32_16x16x32_bf16 v[72:75], a[192:195], v[152:155], v[72:75]
v_mfma_f32_16x16x32_bf16 v[88:91], a[196:199], v[152:155], v[88:91]
v_mfma_f32_16x16x32_bf16 v[104:107], a[200:203], v[152:155], v[104:107]
v_mfma_f32_16x16x32_bf16 v[120:123], a[204:207], v[152:155], v[120:123]
s_waitcnt vmcnt(16)
v_mfma_f32_16x16x32_bf16 v[64:67], a[208:211], v[156:159], v[64:67]
v_mfma_f32_16x16x32_bf16 v[80:83], a[212:215], v[156:159], v[80:83]
v_mfma_f32_16x16x32_bf16 v[96:99], a[216:219], v[156:159], v[96:99]
v_mfma_f32_16x16x32_bf16 v[112:115], a[220:223], v[156:159], v[112:115]
s_waitcnt vmcnt(15)
v_mfma_f32_16x16x32_bf16 v[68:71], a[208:211], v[160:163], v[68:71]
v_mfma_f32_16x16x32_bf16 v[84:87], a[212:215], v[160:163], v[84:87]
v_mfma_f32_16x16x32_bf16 v[100:103], a[216:219], v[160:163], v[100:103]
v_mfma_f32_16x16x32_bf16 v[116:119], a[220:223], v[160:163], v[116:119]
s_waitcnt vmcnt(14)
v_mfma_f32_16x16x32_bf16 v[72:75], a[208:211], v[164:167], v[72:75]
v_mfma_f32_16x16x32_bf16 v[88:91], a[212:215], v[164:167], v[88:91]
v_mfma_f32_16x16x32_bf16 v[104:107], a[216:219], v[164:167], v[104:107]
v_mfma_f32_16x16x32_bf16 v[120:123], a[220:223], v[164:167], v[120:123]
s_barrier
s_waitcnt vmcnt(13)
v_mfma_f32_16x16x32_bf16 v[64:67], a[224:227], v[168:171], v[64:67]
v_mfma_f32_16x16x32_bf16 v[80:83], a[228:231], v[168:171], v[80:83]
v_mfma_f32_16x16x32_bf16 v[96:99], a[232:235], v[168:171], v[96:99]
v_mfma_f32_16x16x32_bf16 v[112:115], a[236:239], v[168:171], v[112:115]
s_waitcnt vmcnt(12)
v_mfma_f32_16x16x32_bf16 v[64:67], a[240:243], v[172:175], v[64:67]
v_mfma_f32_16x16x32_bf16 v[80:83], a[244:247], v[172:175], v[80:83]
v_mfma_f32_16x16x32_bf16 v[96:99], a[248:251], v[172:175], v[96:99]
v_mfma_f32_16x16x32_bf16 v[112:115], a[252:255], v[172:175], v[112:115]
s_waitcnt vmcnt(11)
v_mfma_f32_16x16x32_bf16 v[64:67], v[192:195], v[176:179], v[64:67]
v_mfma_f32_16x16x32_bf16 v[80:83], v[196:199], v[176:179], v[80:83]
v_mfma_f32_16x16x32_bf16 v[96:99], v[200:203], v[176:179], v[96:99]
v_mfma_f32_16x16x32_bf16 v[112:115], v[204:207], v[176:179], v[112:115]
s_waitcnt vmcnt(10)
v_mfma_f32_16x16x32_bf16 v[64:67], v[208:211], v[180:183], v[64:67]
v_mfma_f32_16x16x32_bf16 v[80:83], v[212:215], v[180:183], v[80:83]
v_mfma_f32_16x16x32_bf16 v[96:99], v[216:219], v[180:183], v[96:99]
v_mfma_f32_16x16x32_bf16 v[112:115], v[220:223], v[180:183], v[112:115]
s_waitcnt vmcnt(9)
v_mfma_f32_16x16x32_bf16 v[68:71], a[224:227], v[184:187], v[68:71]
v_mfma_f32_16x16x32_bf16 v[84:87], a[228:231], v[184:187], v[84:87]
v_mfma_f32_16x16x32_bf16 v[100:103], a[232:235], v[184:187], v[100:103]
v_mfma_f32_16x16x32_bf16 v[116:119], a[236:239], v[184:187], v[116:119]
ds_write_b128 v38, v[64:67] offset:0
s_waitcnt vmcnt(8)
v_mfma_f32_16x16x32_bf16 v[68:71], a[240:243], v[188:191], v[68:71]
v_mfma_f32_16x16x32_bf16 v[84:87], a[244:247], v[188:191], v[84:87]
v_mfma_f32_16x16x32_bf16 v[100:103], a[248:251], v[188:191], v[100:103]
v_mfma_f32_16x16x32_bf16 v[116:119], a[252:255], v[188:191], v[116:119]
ds_write_b128 v38, v[80:83] offset:64
s_waitcnt vmcnt(7)
v_mfma_f32_16x16x32_bf16 v[68:71], v[192:195], v[128:131], v[68:71]
v_mfma_f32_16x16x32_bf16 v[84:87], v[196:199], v[128:131], v[84:87]
v_mfma_f32_16x16x32_bf16 v[100:103], v[200:203], v[128:131], v[100:103]
v_mfma_f32_16x16x32_bf16 v[116:119], v[204:207], v[128:131], v[116:119]
ds_write_b128 v38, v[96:99] offset:128
s_waitcnt vmcnt(6)
v_mfma_f32_16x16x32_bf16 v[68:71], v[208:211], v[132:135], v[68:71]
v_mfma_f32_16x16x32_bf16 v[84:87], v[212:215], v[132:135], v[84:87]
v_mfma_f32_16x16x32_bf16 v[100:103], v[216:219], v[132:135], v[100:103]
v_mfma_f32_16x16x32_bf16 v[116:119], v[220:223], v[132:135], v[116:119]
ds_write_b128 v38, v[112:115] offset:192
s_waitcnt vmcnt(5)
v_mfma_f32_16x16x32_bf16 v[72:75], a[224:227], v[136:139], v[72:75]
v_mfma_f32_16x16x32_bf16 v[88:91], a[228:231], v[136:139], v[88:91]
v_mfma_f32_16x16x32_bf16 v[104:107], a[232:235], v[136:139], v[104:107]
v_mfma_f32_16x16x32_bf16 v[120:123], a[236:239], v[136:139], v[120:123]
ds_write_b128 v38, v[68:71] offset:4352
s_waitcnt vmcnt(4)
v_mfma_f32_16x16x32_bf16 v[72:75], a[240:243], v[140:143], v[72:75]
v_mfma_f32_16x16x32_bf16 v[88:91], a[244:247], v[140:143], v[88:91]
v_mfma_f32_16x16x32_bf16 v[104:107], a[248:251], v[140:143], v[104:107]
v_mfma_f32_16x16x32_bf16 v[120:123], a[252:255], v[140:143], v[120:123]
ds_write_b128 v38, v[84:87] offset:4416
s_waitcnt vmcnt(3)
v_mfma_f32_16x16x32_bf16 v[72:75], v[192:195], v[144:147], v[72:75]
v_mfma_f32_16x16x32_bf16 v[88:91], v[196:199], v[144:147], v[88:91]
v_mfma_f32_16x16x32_bf16 v[104:107], v[200:203], v[144:147], v[104:107]
v_mfma_f32_16x16x32_bf16 v[120:123], v[204:207], v[144:147], v[120:123]
ds_write_b128 v38, v[100:103] offset:4480
s_waitcnt vmcnt(2)
v_mfma_f32_16x16x32_bf16 v[72:75], v[208:211], v[148:151], v[72:75]
v_mfma_f32_16x16x32_bf16 v[88:91], v[212:215], v[148:151], v[88:91]
v_mfma_f32_16x16x32_bf16 v[104:107], v[216:219], v[148:151], v[104:107]
v_mfma_f32_16x16x32_bf16 v[120:123], v[220:223], v[148:151], v[120:123]
ds_write_b128 v38, v[116:119] offset:4544
s_nop 3
ds_write_b128 v38, v[72:75] offset:8704
ds_write_b128 v38, v[88:91] offset:8768
ds_write_b128 v38, v[104:107] offset:8832
ds_write_b128 v38, v[120:123] offset:8896
s_waitcnt lgkmcnt(0)
s_barrier
s_cmp_ge_u32 s46, 3
s_cbranch_scc1 L_nofin_46
v_add_u32 v41, 34816, v39
ds_read_b128 v[128:131], v39 offset:0
ds_read_b128 v[132:135], v39 offset:64
ds_read_b128 v[136:139], v39 offset:128
ds_read_b128 v[140:143], v39 offset:192
ds_read_b128 v[144:147], v39 offset:17408
ds_read_b128 v[148:151], v39 offset:17472
ds_read_b128 v[152:155], v39 offset:17536
ds_read_b128 v[156:159], v39 offset:17600
ds_read_b128 v[160:163], v41 offset:0
ds_read_b128 v[164:167], v41 offset:64
ds_read_b128 v[168:171], v41 offset:128
ds_read_b128 v[172:175], v41 offset:192
ds_read_b128 v[176:179], v41 offset:17408
ds_read_b128 v[180:183], v41 offset:17472
ds_read_b128 v[184:187], v41 offset:17536
ds_read_b128 v[188:191], v41 offset:17600
s_waitcnt vmcnt(0)
v_lshlrev_b32 v224, 16, v44
v_and_b32 v225, 0xffff0000, v44
v_lshlrev_b32 v226, 16, v45
v_and_b32 v227, 0xffff0000, v45
v_lshlrev_b32 v228, 16, v46
v_and_b32 v229, 0xffff0000, v46
v_lshlrev_b32 v230, 16, v47
v_and_b32 v231, 0xffff0000, v47
v_lshlrev_b32 v232, 16, v48
v_and_b32 v233, 0xffff0000, v48
v_lshlrev_b32 v234, 16, v49
v_and_b32 v235, 0xffff0000, v49
v_lshlrev_b32 v236, 16, v50
v_and_b32 v237, 0xffff0000, v50
v_lshlrev_b32 v238, 16, v51
v_and_b32 v239, 0xffff0000, v51
s_waitcnt lgkmcnt(8)
v_pk_add_f32 v[128:129], v[128:129], v[144:145]
v_pk_add_f32 v[130:131], v[130:131], v[146:147]
v_pk_add_f32 v[132:133], v[132:133], v[148:149]
v_pk_add_f32 v[134:135], v[134:135], v[150:151]
v_pk_add_f32 v[136:137], v[136:137], v[152:153]
v_pk_add_f32 v[138:139], v[138:139], v[154:155]
v_pk_add_f32 v[140:141], v[140:141], v[156:157]
v_pk_add_f32 v[142:143], v[142:143], v[158:159]
s_waitcnt lgkmcnt(0)
v_pk_add_f32 v[160:161], v[160:161], v[176:177]
v_pk_add_f32 v[162:163], v[162:163], v[178:179]
v_pk_add_f32 v[164:165], v[164:165], v[180:181]
v_pk_add_f32 v[166:167], v[166:167], v[182:183]
v_pk_add_f32 v[168:169], v[168:169], v[184:185]
v_pk_add_f32 v[170:171], v[170:171], v[186:187]
v_pk_add_f32 v[172:173], v[172:173], v[188:189]
v_pk_add_f32 v[174:175], v[174:175], v[190:191]
v_pk_add_f32 v[128:129], v[128:129], v[160:161]
v_pk_add_f32 v[130:131], v[130:131], v[162:163]
v_pk_add_f32 v[132:133], v[132:133], v[164:165]
v_pk_add_f32 v[134:135], v[134:135], v[166:167]
v_pk_add_f32 v[136:137], v[136:137], v[168:169]
v_pk_add_f32 v[138:139], v[138:139], v[170:171]
v_pk_add_f32 v[140:141], v[140:141], v[172:173]
v_pk_add_f32 v[142:143], v[142:143], v[174:175]
v_permlane16_swap_b32 v128, v132
v_permlane16_swap_b32 v129, v133
v_permlane16_swap_b32 v130, v134
v_permlane16_swap_b32 v131, v135
v_permlane16_swap_b32 v136, v140
v_permlane16_swap_b32 v137, v141
v_permlane16_swap_b32 v138, v142
v_permlane16_swap_b32 v139, v143
v_pk_add_f32 v[128:129], v[128:129], v[224:225]
v_pk_add_f32 v[130:131], v[130:131], v[226:227]
v_pk_add_f32 v[132:133], v[132:133], v[228:229]
v_pk_add_f32 v[134:135], v[134:135], v[230:231]
v_cvt_pk_bf16_f32 v144, v128, v129
v_cvt_pk_bf16_f32 v145, v130, v131
v_cvt_pk_bf16_f32 v146, v132, v133
v_cvt_pk_bf16_f32 v147, v134, v135
buffer_store_dwordx4 v[144:147], v40, s[40:43], 0 offen offset:0 sc1
v_pk_add_f32 v[136:137], v[136:137], v[232:233]
v_pk_add_f32 v[138:139], v[138:139], v[234:235]
v_pk_add_f32 v[140:141], v[140:141], v[236:237]
v_pk_add_f32 v[142:143], v[142:143], v[238:239]
v_cvt_pk_bf16_f32 v148, v136, v137
v_cvt_pk_bf16_f32 v149, v138, v139
v_cvt_pk_bf16_f32 v150, v140, v141
v_cvt_pk_bf16_f32 v151, v142, v143
buffer_store_dwordx4 v[148:151], v40, s[40:43], 0 offen offset:64 sc1
L_nofin_46:
s_waitcnt vmcnt(0)
s_endpgm
L_cnt_slow_27:
v_mov_b32 v61, 262144
L_cnt_re_29:
buffer_load_dword v60, v35, s[4:7], 0 offen sc1
s_waitcnt vmcnt(0)
v_readlane_b32 s60, v60, 0
v_readlane_b32 s61, v60, 1
v_readlane_b32 s62, v60, 2
v_readlane_b32 s63, v60, 3
s_nop 0
s_add_u32 s60, s60, s61
s_add_u32 s62, s62, s63
s_add_u32 s60, s60, s62
s_cmp_ge_u32 s60, 256
s_cbranch_scc1 L_cnt_back_28
v_add_u32 v61, -1, v61
s_nop 0
v_readfirstlane_b32 s60, v61
s_nop 0
s_cmp_eq_u32 s60, 0
s_cbranch_scc0 L_cnt_re_29
s_branch L_cnt_back_28
L_gat_slow_30:
s_mov_b32 s63, 262144
L_gat_re_32:
s_mov_b32 s62, 9437184
buffer_load_dwordx2 v[40:41], v26, s[24:27], s62 offen sc1
buffer_load_dwordx4 v[44:47], v27, s[24:27], s80 offen sc1
buffer_load_dwordx4 v[48:51], v27, s[24:27], s81 offen sc1
buffer_load_dwordx4 v[52:55], v27, s[24:27], s82 offen sc1
buffer_load_dwordx4 v[56:59], v27, s[24:27], s83 offen sc1
s_waitcnt vmcnt(0)
v_bitop3_b32 v43, v44, v45, v46 bitop3:0x80
v_bitop3_b32 v43, v43, v47, v48 bitop3:0x80
v_bitop3_b32 v43, v43, v49, v50 bitop3:0x80
v_bitop3_b32 v43, v43, v51, v52 bitop3:0x80
v_bitop3_b32 v43, v43, v53, v54 bitop3:0x80
v_bitop3_b32 v42, v56, v57, v58 bitop3:0x80
v_and_b32 v42, v42, v59
v_or_b32 v42, s47, v42
v_bitop3_b32 v43, v43, v55, v42 bitop3:0x80
v_and_b32 v43, 1, v43
v_cmp_eq_u32 vcc, 0, v41
v_cmp_eq_u32 s[60:61], 0, v43
s_nop 1
s_or_b64 vcc, vcc, s[60:61]
s_cmp_eq_u64 vcc, 0
s_cbranch_scc1 L_gat_back_31
s_sub_u32 s63, s63, 1
s_cmp_eq_u32 s63, 0
s_cbranch_scc0 L_gat_re_32
s_branch L_gat_back_31
L_flg_slow_34:
s_mov_b32 s63, 262144
L_flg_re_36:
buffer_load_dword v10, v11, s[24:27], s79 offen sc1
s_waitcnt vmcnt(0)
v_cmp_lt_u32 vcc, v10, v12
s_nop 0
s_cmp_eq_u64 vcc, 0
s_cbranch_scc1 L_flg_back_35
s_sub_u32 s63, s63, 1
s_cmp_eq_u32 s63, 0
s_cbranch_scc0 L_flg_re_36
s_branch L_flg_back_35
L_flg_slow_37:
s_mov_b32 s63, 262144
L_flg_re_39:
buffer_load_dword v10, v11, s[24:27], s79 offen sc1
s_waitcnt vmcnt(0)
v_cmp_lt_u32 vcc, v10, v13
s_nop 0
s_cmp_eq_u64 vcc, 0
s_cbranch_scc1 L_flg_back_38
s_sub_u32 s63, s63, 1
s_cmp_eq_u32 s63, 0
s_cbranch_scc0 L_flg_re_39
s_branch L_flg_back_38
L_flg_slow_40:
s_mov_b32 s63, 262144
L_flg_re_42:
buffer_load_dword v10, v11, s[24:27], s79 offen sc1
s_waitcnt vmcnt(0)
v_cmp_lt_u32 vcc, v10, v14
s_nop 0
s_cmp_eq_u64 vcc, 0
s_cbranch_scc1 L_flg_back_41
s_sub_u32 s63, s63, 1
s_cmp_eq_u32 s63, 0
s_cbranch_scc0 L_flg_re_42
s_branch L_flg_back_41
L_flg_slow_43:
s_mov_b32 s63, 262144
L_flg_re_45:
buffer_load_dword v10, v11, s[24:27], s79 offen sc1
s_waitcnt vmcnt(0)
v_cmp_lt_u32 vcc, v10, v15
s_nop 0
s_cmp_eq_u64 vcc, 0
s_cbranch_scc1 L_flg_back_44
s_sub_u32 s63, s63, 1
s_cmp_eq_u32 s63, 0
s_cbranch_scc0 L_flg_re_45
s_branch L_flg_back_44
L_Y:
s_load_dwordx8 s[68:75], s[0:1], 0
s_load_dwordx8 s[76:83], s[0:1], 32
s_load_dwordx4 s[84:87], s[0:1], 64
v_and_b32 v1, 63, v0
v_lshrrev_b32 v2, 6, v0
s_and_b32 s60, s2, 7
s_lshr_b32 s61, s2, 3
v_readfirstlane_b32 s46, v2
s_and_b32 s62, s60, 1
s_and_b32 s63, s61, 7
s_lshl3_add_u32 s44, s62, s63
s_lshr_b32 s62, s60, 1
s_lshr_b32 s63, s61, 3
s_lshl2_add_u32 s45, s62, s63
s_lshr_b32 s49, s45, 1
s_lshr_b32 s47, s46, 1
s_and_b32 s48, s46, 1
s_lshl_b32 s66, s44, 7
s_mul_i32 s60, s44, 37
s_lshr_b32 s60, s60, 8
s_mul_i32 s60, s60, 7
s_sub_u32 s54, s44, s60
s_lshl_b32 s53, s54, 1
s_and_b32 s60, s45, 3
s_lshl_b32 s60, s60, 2
s_lshr_b32 s60, 0x7c20, s60
s_and_b32 s60, s60, 15
s_lshl_b32 s60, s60, 6
s_lshr_b32 s61, s45, 2
s_mul_i32 s61, s61, 0x380
s_add_u32 s67, s60, s61
s_mov_b32 s10, 1835008
s_mov_b32 s11, 0x20000
s_mov_b32 s14, 1204224
s_mov_b32 s15, 0x20000
s_mov_b32 s18, 1605632
s_mov_b32 s19, 0x20000
s_mov_b32 s22, s18
s_mov_b32 s23, 0x20000
v_lshrrev_b32 v34, 3, v1
v_and_b32 v35, 7, v1
v_lshrrev_b32 v36, 4, v1
v_xor_b32 v35, v35, v36
s_lshl_b32 s60, s46, 5
s_add_u32 s61, s60, s66
v_add_u32 v36, s61, v34
v_mul_u32_u24 v36, 0x380, v36
v_lshl_add_u32 v7, v35, 4, v36
v_xor_b32 v36, 64, v7
v_add_u32 v8, 0x1c00, v36
v_add_u32 v9, 0x3800, v7
v_add_u32 v10, 0x3800, v8
s_lshl_b32 s60, s46, 12
s_add_u32 s58, s60, 81920
s_waitcnt lgkmcnt(0)
s_mov_b64 s[8:9], s[68:69]
s_lshl_b32 s50, s54, 7
s_add_u32 s54, s54, 1
s_cmp_eq_u32 s54, 7
s_cselect_b32 s54, 0, s54
s_add_u32 m0, s58, 0
s_nop 0
buffer_load_dwordx4 v7, s[8:11], s50 offen lds
s_add_u32 m0, s58, 1024
s_nop 0
buffer_load_dwordx4 v8, s[8:11], s50 offen lds
s_add_u32 m0, s58, 2048
s_nop 0
buffer_load_dwordx4 v9, s[8:11], s50 offen lds
s_add_u32 m0, s58, 3072
s_nop 0
buffer_load_dwordx4 v10, s[8:11], s50 offen lds
s_mov_b64 s[12:13], s[70:71]
s_mov_b64 s[16:17], s[76:77]
s_mov_b64 s[20:21], s[78:79]
s_mov_b64 s[32:33], s[72:73]
s_mov_b64 s[36:37], s[80:81]
s_mov_b64 s[40:41], s[82:83]
s_mov_b64 s[4:5], s[84:85]
s_mov_b64 s[24:25], s[86:87]
s_lshl3_add_u32 s60, s45, s66
s_lshl1_add_u32 s80, s46, s60
v_lshrrev_b32 v40, 5, v1
v_add_u32 v40, s80, v40
v_mul_u32_u24 v40, 0x380, v40
v_and_b32 v41, 31, v1
v_lshl_add_u32 v40, v41, 4, v40
v_subrev_u32 v43, 24, v41
v_ashrrev_i32 v43, 31, v43
v_add_u32 v42, 0x200, v40
v_mov_b32 v41, 2146435072
v_bfi_b32 v42, v43, v42, v41
buffer_load_dwordx4 v[44:47], v40, s[8:11], 0 offen
buffer_load_dwordx4 v[48:51], v42, s[8:11], 0 offen
v_and_b32 v43, 1.0, v43
s_and_b32 s60, s46, 1
s_mul_i32 s61, s60, 320
s_mov_b32 s62, 52429
v_add_u32 v34, s61, v1
v_mul_lo_u32 v35, v34, s62
v_lshrrev_b32 v35, 20, v35
v_mul_u32_u24 v36, 20, v35
v_sub_u32 v36, v34, v36
v_bfe_u32 v37, v35, 3, 1
v_lshlrev_b32 v37, 1, v37
v_xor_b32 v36, v36, v37
v_mul_u32_u24 v35, 3584, v35
v_lshl_add_u32 v35, v36, 4, v35
v_add_u32 v2, s67, v35
v_add_u32 v34, s61, v1
v_add_u32 v34, 64, v34
v_mul_lo_u32 v35, v34, s62
v_lshrrev_b32 v35, 20, v35
v_mul_u32_u24 v36, 20, v35
v_sub_u32 v36, v34, v36
v_bfe_u32 v37, v35, 3, 1
v_lshlrev_b32 v37, 1, v37
v_xor_b32 v36, v36, v37
v_mul_u32_u24 v35, 3584, v35
v_lshl_add_u32 v35, v36, 4, v35
v_add_u32 v3, s67, v35
v_add_u32 v34, s61, v1
v_add_u32 v34, 128, v34
v_mul_lo_u32 v35, v34, s62
v_lshrrev_b32 v35, 20, v35
v_mul_u32_u24 v36, 20, v35
v_sub_u32 v36, v34, v36
v_bfe_u32 v37, v35, 3, 1
v_lshlrev_b32 v37, 1, v37
v_xor_b32 v36, v36, v37
v_mul_u32_u24 v35, 3584, v35
v_lshl_add_u32 v35, v36, 4, v35
v_add_u32 v4, s67, v35
v_add_u32 v34, s61, v1
v_add_u32 v34, 192, v34
v_mul_lo_u32 v35, v34, s62
v_lshrrev_b32 v35, 20, v35
v_mul_u32_u24 v36, 20, v35
v_sub_u32 v36, v34, v36
v_bfe_u32 v37, v35, 3, 1
v_lshlrev_b32 v37, 1, v37
v_xor_b32 v36, v36, v37
v_mul_u32_u24 v35, 3584, v35
v_lshl_add_u32 v35, v36, 4, v35
v_add_u32 v5, s67, v35
v_add_u32 v34, s61, v1
v_add_u32 v34, 256, v34
v_mul_lo_u32 v35, v34, s62
v_lshrrev_b32 v35, 20, v35
v_mul_u32_u24 v36, 20, v35
v_sub_u32 v36, v34, v36
v_bfe_u32 v37, v35, 3, 1
v_lshlrev_b32 v37, 1, v37
v_xor_b32 v36, v36, v37
v_mul_u32_u24 v35, 3584, v35
v_lshl_add_u32 v35, v36, 4, v35
v_add_u32 v6, s67, v35
s_lshr_b32 s61, s46, 1
s_mul_i32 s61, s61, 10240
s_mul_i32 s60, s60, 5120
s_add_u32 s55, s61, s60
s_cmp_ge_u32 s46, 2
s_cselect_b32 s28, s20, s16
s_cselect_b32 s29, s21, s17
s_cselect_b32 s30, s22, s18
s_cselect_b32 s31, s23, s19
s_mul_i32 s52, s53, 114688
s_add_u32 s53, s53, 1
s_cmp_eq_u32 s53, 14
s_cselect_b32 s53, 0, s53
s_add_u32 m0, s55, 0
s_nop 0
buffer_load_dwordx4 v2, s[28:31], s52 offen lds
s_add_u32 m0, s55, 1024
s_nop 0
buffer_load_dwordx4 v3, s[28:31], s52 offen lds
s_add_u32 m0, s55, 2048
s_nop 0
buffer_load_dwordx4 v4, s[28:31], s52 offen lds
s_add_u32 m0, s55, 3072
s_nop 0
buffer_load_dwordx4 v5, s[28:31], s52 offen lds
s_add_u32 m0, s55, 4096
s_nop 0
buffer_load_dwordx4 v6, s[28:31], s52 offen lds
s_mul_i32 s52, s53, 114688
s_add_u32 s53, s53, 1
s_cmp_eq_u32 s53, 14
s_cselect_b32 s53, 0, s53
s_add_u32 m0, s55, 20480
s_nop 0
buffer_load_dwordx4 v2, s[28:31], s52 offen lds
s_add_u32 m0, s55, 21504
s_nop 0
buffer_load_dwordx4 v3, s[28:31], s52 offen lds
s_add_u32 m0, s55, 22528
s_nop 0
buffer_load_dwordx4 v4, s[28:31], s52 offen lds
s_add_u32 m0, s55, 23552
s_nop 0
buffer_load_dwordx4 v5, s[28:31], s52 offen lds
s_add_u32 m0, s55, 24576
s_nop 0
buffer_load_dwordx4 v6, s[28:31], s52 offen lds
s_lshl2_add_u32 s60, s2, s46
s_mul_i32 s60, s60, 14
v_min_u32 v38, 13, v1
v_add_u32 v38, s60, v38
v_lshlrev_b32 v38, 7, v38
buffer_load_dword v63, v38, s[8:11], 0 offen
s_mov_b32 s26, 16777216
s_mov_b32 s27, 0x20000
s_mov_b32 s6, 256
s_mov_b32 s7, 0x20000
s_mov_b32 s34, 401408
s_mov_b32 s35, 0x20000
s_mov_b32 s38, 1605632
s_mov_b32 s39, 0x20000
s_mov_b32 s42, 1835008
s_mov_b32 s43, 0x20000
s_lshl_b32 s60, s44, 1
s_add_u32 s60, s60, s47
s_lshl_b32 s60, s60, 4
s_add_u32 s60, s60, s45
s_lshl_b32 s60, s60, 1
s_add_u32 s60, s60, s48
s_lshl_b32 s60, s60, 2
s_add_u32 s77, s60, 9699328
s_cmp_lt_u32 s44, 7
s_cselect_b32 s60, 1, 0
s_xor_b32 s61, s47, 1
s_and_b32 s78, s60, s61
s_mul_i32 s61, s45, 7
s_add_u32 s61, s61, s44
s_lshl_b32 s61, s61, 1
s_add_u32 s61, s61, s48
s_lshl_b32 s61, s61, 10
s_add_u32 s3, s61, 9469952
s_lshl_b32 s61, s80, 3
s_add_u32 s82, s61, 9437184
v_mov_b32 v36, 0
v_mov_b32 v37, 0
v_mov_b32 v38, 0
v_mov_b32 v39, 0
s_cmp_eq_u32 s78, 0
s_cbranch_scc1 L_noclr_47
v_lshlrev_b32 v40, 4, v1
buffer_store_dwordx4 v[36:39], v40, s[24:27], s3 offen sc1
L_noclr_47:
buffer_store_dword v36, v36, s[24:27], s77 offen sc1
buffer_store_dwordx4 v[36:39], v36, s[24:27], s82 offen sc1
s_lshl2_add_u32 s60, s2, s46
s_mul_i32 s61, s60, 13
s_lshl_b32 s62, s60, 2
v_add_u32 v40, s61, v1
v_lshlrev_b32 v40, 7, v40
v_subrev_u32 v42, 13, v1
v_ashrrev_i32 v42, 31, v42
v_bfi_b32 v40, v42, v40, v41
buffer_load_dword v60, v40, s[36:39], 0 offen
v_add_u32 v40, s62, v1
v_lshlrev_b32 v40, 7, v40
v_subrev_u32 v42, 4, v1
v_ashrrev_i32 v42, 31, v42
v_bfi_b32 v40, v42, v40, v41
buffer_load_dword v61, v40, s[32:35], 0 offen
v_and_b32 v34, 15, v1
v_bfe_u32 v35, v34, 1, 3
v_lshrrev_b32 v36, 4, v1
v_lshlrev_b32 v37, 7, v34
s_lshl_b32 s60, s47, 13
s_add_u32 s60, s60, 81920
s_lshl_b32 s62, s48, 12
s_add_u32 s61, s60, 4096
s_sub_u32 s61, s61, s62
s_add_u32 s60, s60, s62
v_or_b32 v38, 0, v36
v_xor_b32 v38, v38, v35
v_lshl_add_u32 v38, v38, 4, v37
v_add_u32 v20, s60, v38
v_add_u32 v22, s61, v38
v_or_b32 v38, 4, v36
v_xor_b32 v38, v38, v35
v_lshl_add_u32 v38, v38, 4, v37
v_add_u32 v21, s60, v38
v_add_u32 v23, s61, v38
v_lshrrev_b32 v34, 4, v1
v_bfe_u32 v35, v1, 2, 2
v_lshl_add_u32 v35, v34, 3, v35
v_mul_u32_u24 v35, 320, v35
v_and_b32 v36, 3, v1
v_lshl_add_u32 v35, v36, 3, v35
v_and_b32 v34, 1, v34
v_lshlrev_b32 v34, 5, v34
v_add_u32 v14, v35, v34
v_sub_u32 v15, v35, v34
s_mul_i32 s60, s48, 192
v_add_u32 v12, s60, v14
v_add_u32 v13, s60, v15
v_add_u32 v16, 40960, v12
v_add_u32 v17, 40960, v13
v_add_u32 v18, 40960, v14
v_add_u32 v19, 40960, v15
s_waitcnt vmcnt(15)
v_lshlrev_b32 v200, 16, v44
v_and_b32 v201, 0xffff0000, v44
v_lshlrev_b32 v202, 16, v45
v_and_b32 v203, 0xffff0000, v45
v_lshlrev_b32 v204, 16, v46
v_and_b32 v205, 0xffff0000, v46
v_lshlrev_b32 v206, 16, v47
v_and_b32 v207, 0xffff0000, v47
v_lshlrev_b32 v208, 16, v48
v_and_b32 v209, 0xffff0000, v48
v_lshlrev_b32 v210, 16, v49
v_and_b32 v211, 0xffff0000, v49
v_lshlrev_b32 v212, 16, v50
v_and_b32 v213, 0xffff0000, v50
v_lshlrev_b32 v214, 16, v51
v_and_b32 v215, 0xffff0000, v51
v_pk_add_f32 v[216:217], v[200:201], v[202:203]
v_pk_add_f32 v[218:219], v[204:205], v[206:207]
v_pk_add_f32 v[220:221], v[208:209], v[210:211]
v_pk_add_f32 v[222:223], v[212:213], v[214:215]
v_pk_add_f32 v[216:217], v[216:217], v[218:219]
v_pk_add_f32 v[220:221], v[220:221], v[222:223]
v_pk_add_f32 v[216:217], v[216:217], v[220:221]
v_add_f32 v216, v216, v217
s_nop 1
v_add_f32_dpp v216, v216, v216 row_ror:8 row_mask:0xf bank_mask:0xf
s_nop 1
v_add_f32_dpp v216, v216, v216 row_ror:4 row_mask:0xf bank_mask:0xf
s_nop 1
v_add_f32_dpp v216, v216, v216 row_ror:2 row_mask:0xf bank_mask:0xf
s_nop 1
v_add_f32_dpp v216, v216, v216 row_ror:1 row_mask:0xf bank_mask:0xf
v_mov_b32 v217, v216
s_nop 1
v_permlane16_swap_b32 v216, v217
v_add_f32 v216, v216, v217
v_mul_f32 v216, 0x3b124925, v216
v_sub_f32 v218, 0, v216
v_pk_add_f32 v[200:201], v[200:201], v[218:219] op_sel_hi:[1,0]
v_pk_add_f32 v[202:203], v[202:203], v[218:219] op_sel_hi:[1,0]
v_pk_add_f32 v[204:205], v[204:205], v[218:219] op_sel_hi:[1,0]
v_pk_add_f32 v[206:207], v[206:207], v[218:219] op_sel_hi:[1,0]
v_pk_add_f32 v[208:209], v[208:209], v[218:219] op_sel_hi:[1,0]
v_pk_add_f32 v[210:211], v[210:211], v[218:219] op_sel_hi:[1,0]
v_pk_add_f32 v[212:213], v[212:213], v[218:219] op_sel_hi:[1,0]
v_pk_add_f32 v[214:215], v[214:215], v[218:219] op_sel_hi:[1,0]
v_pk_mul_f32 v[220:221], v[200:201], v[200:201]
v_pk_mul_f32 v[222:223], v[208:209], v[208:209]
v_pk_fma_f32 v[220:221], v[202:203], v[202:203], v[220:221]
v_pk_fma_f32 v[222:223], v[210:211], v[210:211], v[222:223]
v_pk_fma_f32 v[220:221], v[204:205], v[204:205], v[220:221]
v_pk_fma_f32 v[222:223], v[212:213], v[212:213], v[222:223]
v_pk_fma_f32 v[220:221], v[206:207], v[206:207], v[220:221]
v_pk_fma_f32 v[222:223], v[214:215], v[214:215], v[222:223]
v_add_f32 v220, v220, v221
v_add_f32 v222, v222, v223
v_fma_f32 v220, v222, v43, v220
s_nop 1
v_add_f32_dpp v220, v220, v220 row_ror:8 row_mask:0xf bank_mask:0xf
s_nop 1
v_add_f32_dpp v220, v220, v220 row_ror:4 row_mask:0xf bank_mask:0xf
s_nop 1
v_add_f32_dpp v220, v220, v220 row_ror:2 row_mask:0xf bank_mask:0xf
s_nop 1
v_add_f32_dpp v220, v220, v220 row_ror:1 row_mask:0xf bank_mask:0xf
v_mov_b32 v221, v220
s_nop 1
v_permlane16_swap_b32 v220, v221
v_add_f32 v220, v220, v221
v_mov_b32 v221, 0x3727c5ac
v_fmac_f32 v221, 0x3b124925, v220
v_rsq_f32 v217, v221
s_nop 0
v_or_b32 v217, 1, v217
v_lshrrev_b32 v193, 5, v1
v_lshlrev_b32 v193, 3, v193
buffer_store_dwordx2 v[216:217], v193, s[24:27], s82 offen sc1
s_cmp_eq_u32 s78, 1
s_cbranch_scc1 L_csA_54
s_waitcnt vmcnt(11)
s_barrier
ds_read_b128 a[0:3], v20 offset:0
ds_read_b128 a[4:7], v20 offset:2048
ds_read_b128 a[8:11], v22 offset:0
ds_read_b128 a[12:15], v22 offset:2048
ds_read_b64_tr_b16 a[40:41], v12 offset:0
ds_read_b64_tr_b16 a[42:43], v12 offset:1280
ds_read_b64_tr_b16 a[56:57], v12 offset:10240
ds_read_b64_tr_b16 a[58:59], v12 offset:11520
ds_read_b64_tr_b16 a[44:45], v13 offset:32
ds_read_b64_tr_b16 a[46:47], v13 offset:1312
ds_read_b64_tr_b16 a[60:61], v13 offset:10272
ds_read_b64_tr_b16 a[62:63], v13 offset:11552
ds_read_b64_tr_b16 a[48:49], v12 offset:64
ds_read_b64_tr_b16 a[50:51], v12 offset:1344
ds_read_b64_tr_b16 a[64:65], v12 offset:10304
ds_read_b64_tr_b16 a[66:67], v12 offset:11584
ds_read_b64_tr_b16 a[52:53], v13 offset:96
ds_read_b64_tr_b16 a[54:55], v13 offset:1376
ds_read_b64_tr_b16 a[68:69], v13 offset:10336
ds_read_b64_tr_b16 a[70:71], v13 offset:11616
ds_read_b64_tr_b16 a[72:73], v14 offset:128
ds_read_b64_tr_b16 a[74:75], v14 offset:1408
ds_read_b64_tr_b16 a[80:81], v14 offset:10368
ds_read_b64_tr_b16 a[82:83], v14 offset:11648
ds_read_b64_tr_b16 a[76:77], v15 offset:160
ds_read_b64_tr_b16 a[78:79], v15 offset:1440
ds_read_b64_tr_b16 a[84:85], v15 offset:10400
ds_read_b64_tr_b16 a[86:87], v15 offset:11680
s_waitcnt lgkmcnt(15)
v_mfma_f32_16x16x32_bf16 v[64:67], a[40:43], a[0:3], 0
s_waitcnt vmcnt(6)
s_barrier
v_mfma_f32_16x16x32_bf16 v[68:71], a[40:43], a[4:7], 0
ds_read_b128 a[20:23], v21 offset:0
s_lshl_b32 s50, s54, 7
s_add_u32 s54, s54, 1
s_cmp_eq_u32 s54, 7
s_cselect_b32 s54, 0, s54
s_add_u32 m0, s58, 18432
v_mfma_f32_16x16x32_bf16 v[72:75], a[40:43], a[8:11], 0
buffer_load_dwordx4 v7, s[8:11], s50 offen lds
s_add_u32 m0, s58, 19456
v_mfma_f32_16x16x32_bf16 v[76:79], a[40:43], a[12:15], 0
buffer_load_dwordx4 v8, s[8:11], s50 offen lds
v_mfma_f32_16x16x32_bf16 v[128:131], a[56:59], a[0:3], 0
ds_read_b64_tr_b16 a[40:41], v12 offset:20480
v_mfma_f32_16x16x32_bf16 v[132:135], a[56:59], a[4:7], 0
ds_read_b64_tr_b16 a[42:43], v12 offset:21760
s_add_u32 m0, s58, 20480
v_mfma_f32_16x16x32_bf16 v[136:139], a[56:59], a[8:11], 0
buffer_load_dwordx4 v9, s[8:11], s50 offen lds
s_add_u32 m0, s58, 21504
v_mfma_f32_16x16x32_bf16 v[140:143], a[56:59], a[12:15], 0
buffer_load_dwordx4 v10, s[8:11], s50 offen lds
v_mfma_f32_16x16x32_bf16 v[80:83], a[44:47], a[0:3], 0
ds_read_b128 a[24:27], v21 offset:2048
v_mfma_f32_16x16x32_bf16 v[84:87], a[44:47], a[4:7], 0
ds_read_b64_tr_b16 a[56:57], v12 offset:30720
s_mul_i32 s52, s53, 114688
s_add_u32 s53, s53, 1
s_cmp_eq_u32 s53, 14
s_cselect_b32 s53, 0, s53
s_add_u32 m0, s55, 40960
v_mfma_f32_16x16x32_bf16 v[88:91], a[44:47], a[8:11], 0
buffer_load_dwordx4 v2, s[28:31], s52 offen lds
s_add_u32 m0, s55, 41984
v_mfma_f32_16x16x32_bf16 v[92:95], a[44:47], a[12:15], 0
buffer_load_dwordx4 v3, s[28:31], s52 offen lds
v_mfma_f32_16x16x32_bf16 v[144:147], a[60:63], a[0:3], 0
ds_read_b64_tr_b16 a[58:59], v12 offset:32000
v_mfma_f32_16x16x32_bf16 v[148:151], a[60:63], a[4:7], 0
ds_read_b128 a[28:31], v23 offset:0
s_add_u32 m0, s55, 43008
v_mfma_f32_16x16x32_bf16 v[152:155], a[60:63], a[8:11], 0
buffer_load_dwordx4 v4, s[28:31], s52 offen lds
s_add_u32 m0, s55, 44032
v_mfma_f32_16x16x32_bf16 v[156:159], a[60:63], a[12:15], 0
buffer_load_dwordx4 v5, s[28:31], s52 offen lds
s_waitcnt lgkmcnt(15)
v_mfma_f32_16x16x32_bf16 v[96:99], a[48:51], a[0:3], 0
ds_read_b64_tr_b16 a[44:45], v13 offset:20512
v_mfma_f32_16x16x32_bf16 v[100:103], a[48:51], a[4:7], 0
ds_read_b64_tr_b16 a[46:47], v13 offset:21792
s_add_u32 m0, s55, 45056
v_mfma_f32_16x16x32_bf16 v[104:107], a[48:51], a[8:11], 0
buffer_load_dwordx4 v6, s[28:31], s52 offen lds
s_lshl_b32 s50, s54, 7
s_add_u32 s54, s54, 1
s_cmp_eq_u32 s54, 7
s_cselect_b32 s54, 0, s54
s_add_u32 m0, s58, 36864
v_mfma_f32_16x16x32_bf16 v[108:111], a[48:51], a[12:15], 0
buffer_load_dwordx4 v7, s[8:11], s50 offen lds
v_mfma_f32_16x16x32_bf16 v[160:163], a[64:67], a[0:3], 0
ds_read_b128 a[32:35], v23 offset:2048
v_mfma_f32_16x16x32_bf16 v[164:167], a[64:67], a[4:7], 0
ds_read_b64_tr_b16 a[60:61], v13 offset:30752
s_add_u32 m0, s58, 37888
v_mfma_f32_16x16x32_bf16 v[168:171], a[64:67], a[8:11], 0
buffer_load_dwordx4 v8, s[8:11], s50 offen lds
s_mul_i32 s52, s53, 114688
s_add_u32 s53, s53, 1
s_cmp_eq_u32 s53, 14
s_cselect_b32 s53, 0, s53
s_add_u32 m0, s55, 61440
v_mfma_f32_16x16x32_bf16 v[172:175], a[64:67], a[12:15], 0
buffer_load_dwordx4 v2, s[28:31], s52 offen lds
v_mfma_f32_16x16x32_bf16 v[112:115], a[52:55], a[0:3], 0
ds_read_b64_tr_b16 a[62:63], v13 offset:32032
v_mfma_f32_16x16x32_bf16 v[116:119], a[52:55], a[4:7], 0
ds_read_b64_tr_b16 a[48:49], v12 offset:20544
s_add_u32 m0, s55, 62464
v_mfma_f32_16x16x32_bf16 v[120:123], a[52:55], a[8:11], 0
buffer_load_dwordx4 v3, s[28:31], s52 offen lds
s_add_u32 m0, s55, 63488
v_mfma_f32_16x16x32_bf16 v[124:127], a[52:55], a[12:15], 0
buffer_load_dwordx4 v4, s[28:31], s52 offen lds
v_mfma_f32_16x16x32_bf16 v[176:179], a[68:71], a[0:3], 0
ds_read_b64_tr_b16 a[50:51], v12 offset:21824
v_mfma_f32_16x16x32_bf16 v[180:183], a[68:71], a[4:7], 0
ds_read_b64_tr_b16 a[64:65], v12 offset:30784
s_add_u32 m0, s55, 64512
v_mfma_f32_16x16x32_bf16 v[184:187], a[68:71], a[8:11], 0
buffer_load_dwordx4 v5, s[28:31], s52 offen lds
s_add_u32 m0, s55, 65536
v_mfma_f32_16x16x32_bf16 v[188:191], a[68:71], a[12:15], 0
buffer_load_dwordx4 v6, s[28:31], s52 offen lds
s_waitcnt lgkmcnt(15)
v_mfma_f32_16x16x32_bf16 v[192:195], a[72:75], a[0:3], 0
ds_read_b64_tr_b16 a[66:67], v12 offset:32064
v_mfma_f32_16x16x32_bf16 v[196:199], a[72:75], a[4:7], 0
ds_read_b64_tr_b16 a[52:53], v13 offset:20576
v_mfma_f32_16x16x32_bf16 v[208:211], a[80:83], a[0:3], 0
ds_read_b64_tr_b16 a[54:55], v13 offset:21856
v_mfma_f32_16x16x32_bf16 v[212:215], a[80:83], a[4:7], 0
ds_read_b64_tr_b16 a[68:69], v13 offset:30816
v_mfma_f32_16x16x32_bf16 v[200:203], a[76:79], a[0:3], 0
ds_read_b64_tr_b16 a[70:71], v13 offset:32096
v_mfma_f32_16x16x32_bf16 v[204:207], a[76:79], a[4:7], 0
ds_read_b64_tr_b16 a[72:73], v14 offset:20608
v_mfma_f32_16x16x32_bf16 v[216:219], a[84:87], a[0:3], 0
ds_read_b64_tr_b16 a[74:75], v14 offset:21888
v_mfma_f32_16x16x32_bf16 v[220:223], a[84:87], a[4:7], 0
ds_read_b64_tr_b16 a[80:81], v14 offset:30848
s_waitcnt lgkmcnt(13)
v_mfma_f32_16x16x32_bf16 v[64:67], a[40:43], a[20:23], v[64:67]
s_waitcnt vmcnt(7)
s_barrier
v_mfma_f32_16x16x32_bf16 v[68:71], a[40:43], a[24:27], v[68:71]
ds_read_b64_tr_b16 a[82:83], v14 offset:32128
v_mfma_f32_16x16x32_bf16 v[72:75], a[40:43], a[28:31], v[72:75]
ds_read_b64_tr_b16 a[76:77], v15 offset:20640
s_add_u32 m0, s58, 38912
v_mfma_f32_16x16x32_bf16 v[76:79], a[40:43], a[32:35], v[76:79]
buffer_load_dwordx4 v9, s[8:11], s50 offen lds
v_mfma_f32_16x16x32_bf16 v[128:131], a[56:59], a[20:23], v[128:131]
ds_read_b64_tr_b16 a[78:79], v15 offset:21920
v_mfma_f32_16x16x32_bf16 v[132:135], a[56:59], a[24:27], v[132:135]
ds_read_b64_tr_b16 a[84:85], v15 offset:30880
v_mfma_f32_16x16x32_bf16 v[136:139], a[56:59], a[28:31], v[136:139]
ds_read_b64_tr_b16 a[86:87], v15 offset:32160
s_add_u32 m0, s58, 39936
v_mfma_f32_16x16x32_bf16 v[140:143], a[56:59], a[32:35], v[140:143]
buffer_load_dwordx4 v10, s[8:11], s50 offen lds
s_waitcnt lgkmcnt(15)
v_mfma_f32_16x16x32_bf16 v[80:83], a[44:47], a[20:23], v[80:83]
ds_read_b128 a[0:3], v20 offset:18432
v_mfma_f32_16x16x32_bf16 v[84:87], a[44:47], a[24:27], v[84:87]
ds_read_b64_tr_b16 a[40:41], v16 offset:0
v_mfma_f32_16x16x32_bf16 v[88:91], a[44:47], a[28:31], v[88:91]
ds_read_b64_tr_b16 a[42:43], v16 offset:1280
s_mul_i32 s52, s53, 114688
s_add_u32 s53, s53, 1
s_cmp_eq_u32 s53, 14
s_cselect_b32 s53, 0, s53
s_add_u32 m0, s55, 0
v_mfma_f32_16x16x32_bf16 v[92:95], a[44:47], a[32:35], v[92:95]
buffer_load_dwordx4 v2, s[28:31], s52 offen lds
v_mfma_f32_16x16x32_bf16 v[144:147], a[60:63], a[20:23], v[144:147]
ds_read_b128 a[4:7], v20 offset:20480
v_mfma_f32_16x16x32_bf16 v[148:151], a[60:63], a[24:27], v[148:151]
s_cmp_lg_u32 s46, 0
s_cbranch_scc1 L_noinc_57
s_and_b32 s60, s2, 3
s_lshl_b32 s60, s60, 6
v_mov_b32 v36, 1
v_cmp_eq_u32 vcc, 0, v1
v_mov_b32 v37, 2146435072
v_mov_b32 v38, s60
s_nop 1
v_cndmask_b32 v37, v37, v38, vcc
buffer_atomic_add v36, v37, s[4:7], 0 offen
L_noinc_57:
v_mfma_f32_16x16x32_bf16 v[152:155], a[60:63], a[28:31], v[152:155]
ds_read_b64_tr_b16 a[56:57], v16 offset:10240
s_add_u32 m0, s55, 1024
v_mfma_f32_16x16x32_bf16 v[156:159], a[60:63], a[32:35], v[156:159]
buffer_load_dwordx4 v3, s[28:31], s52 offen lds
s_waitcnt lgkmcnt(15)
v_mfma_f32_16x16x32_bf16 v[96:99], a[48:51], a[20:23], v[96:99]
ds_read_b64_tr_b16 a[58:59], v16 offset:11520
v_mfma_f32_16x16x32_bf16 v[100:103], a[48:51], a[24:27], v[100:103]
ds_read_b128 a[8:11], v22 offset:18432
v_mfma_f32_16x16x32_bf16 v[104:107], a[48:51], a[28:31], v[104:107]
ds_read_b64_tr_b16 a[44:45], v17 offset:32
s_add_u32 m0, s55, 2048
v_mfma_f32_16x16x32_bf16 v[108:111], a[48:51], a[32:35], v[108:111]
buffer_load_dwordx4 v4, s[28:31], s52 offen lds
v_mfma_f32_16x16x32_bf16 v[160:163], a[64:67], a[20:23], v[160:163]
ds_read_b64_tr_b16 a[46:47], v17 offset:1312
v_mfma_f32_16x16x32_bf16 v[164:167], a[64:67], a[24:27], v[164:167]
ds_read_b128 a[12:15], v22 offset:20480
v_mfma_f32_16x16x32_bf16 v[168:171], a[64:67], a[28:31], v[168:171]
ds_read_b64_tr_b16 a[60:61], v17 offset:10272
s_add_u32 m0, s55, 3072
v_mfma_f32_16x16x32_bf16 v[172:175], a[64:67], a[32:35], v[172:175]
buffer_load_dwordx4 v5, s[28:31], s52 offen lds
s_waitcnt lgkmcnt(15)
v_mfma_f32_16x16x32_bf16 v[112:115], a[52:55], a[20:23], v[112:115]
ds_read_b64_tr_b16 a[62:63], v17 offset:11552
v_mfma_f32_16x16x32_bf16 v[116:119], a[52:55], a[24:27], v[116:119]
ds_read_b64_tr_b16 a[48:49], v16 offset:64
v_mfma_f32_16x16x32_bf16 v[120:123], a[52:55], a[28:31], v[120:123]
ds_read_b64_tr_b16 a[50:51], v16 offset:1344
s_add_u32 m0, s55, 4096
v_mfma_f32_16x16x32_bf16 v[124:127], a[52:55], a[32:35], v[124:127]
buffer_load_dwordx4 v6, s[28:31], s52 offen lds
v_mfma_f32_16x16x32_bf16 v[176:179], a[68:71], a[20:23], v[176:179]
ds_read_b64_tr_b16 a[64:65], v16 offset:10304
v_mfma_f32_16x16x32_bf16 v[180:183], a[68:71], a[24:27], v[180:183]
ds_read_b64_tr_b16 a[66:67], v16 offset:11584
v_mfma_f32_16x16x32_bf16 v[184:187], a[68:71], a[28:31], v[184:187]
ds_read_b64_tr_b16 a[52:53], v17 offset:96
v_mfma_f32_16x16x32_bf16 v[188:191], a[68:71], a[32:35], v[188:191]
ds_read_b64_tr_b16 a[54:55], v17 offset:1376
v_mfma_f32_16x16x32_bf16 v[192:195], a[72:75], a[20:23], v[192:195]
ds_read_b64_tr_b16 a[68:69], v17 offset:10336
v_mfma_f32_16x16x32_bf16 v[196:199], a[72:75], a[24:27], v[196:199]
ds_read_b64_tr_b16 a[70:71], v17 offset:11616
v_mfma_f32_16x16x32_bf16 v[208:211], a[80:83], a[20:23], v[208:211]
ds_read_b64_tr_b16 a[72:73], v18 offset:128
v_mfma_f32_16x16x32_bf16 v[212:215], a[80:83], a[24:27], v[212:215]
ds_read_b64_tr_b16 a[74:75], v18 offset:1408
s_waitcnt lgkmcnt(15)
v_mfma_f32_16x16x32_bf16 v[200:203], a[76:79], a[20:23], v[200:203]
ds_read_b64_tr_b16 a[80:81], v18 offset:10368
v_mfma_f32_16x16x32_bf16 v[204:207], a[76:79], a[24:27], v[204:207]
ds_read_b64_tr_b16 a[82:83], v18 offset:11648
v_mfma_f32_16x16x32_bf16 v[216:219], a[84:87], a[20:23], v[216:219]
ds_read_b64_tr_b16 a[76:77], v19 offset:160
v_mfma_f32_16x16x32_bf16 v[220:223], a[84:87], a[24:27], v[220:223]
ds_read_b64_tr_b16 a[78:79], v19 offset:1440
ds_read_b64_tr_b16 a[84:85], v19 offset:10400
ds_read_b64_tr_b16 a[86:87], v19 offset:11680
L_csJ_55:
s_waitcnt lgkmcnt(15)
v_mfma_f32_16x16x32_bf16 v[64:67], a[40:43], a[0:3], v[64:67]
s_waitcnt vmcnt(7)
s_barrier
v_mfma_f32_16x16x32_bf16 v[68:71], a[40:43], a[4:7], v[68:71]
ds_read_b128 a[20:23], v21 offset:18432
v_mfma_f32_16x16x32_bf16 v[72:75], a[40:43], a[8:11], v[72:75]
s_lshl_b32 s50, s54, 7
s_add_u32 s54, s54, 1
s_cmp_eq_u32 s54, 7
s_cselect_b32 s54, 0, s54
s_add_u32 m0, s58, 0
v_mfma_f32_16x16x32_bf16 v[76:79], a[40:43], a[12:15], v[76:79]
buffer_load_dwordx4 v7, s[8:11], s50 offen lds
v_mfma_f32_16x16x32_bf16 v[128:131], a[56:59], a[0:3], v[128:131]
ds_read_b64_tr_b16 a[40:41], v16 offset:20480
v_mfma_f32_16x16x32_bf16 v[132:135], a[56:59], a[4:7], v[132:135]
ds_read_b64_tr_b16 a[42:43], v16 offset:21760
v_mfma_f32_16x16x32_bf16 v[136:139], a[56:59], a[8:11], v[136:139]
ds_read_b128 a[24:27], v21 offset:20480
s_and_b32 s60, s2, 7
s_lshr_b32 s61, s2, 3
s_add_u32 m0, s58, 1024
v_mfma_f32_16x16x32_bf16 v[140:143], a[56:59], a[12:15], v[140:143]
buffer_load_dwordx4 v8, s[8:11], s50 offen lds
s_and_b32 s62, s61, 7
v_mfma_f32_16x16x32_bf16 v[80:83], a[44:47], a[0:3], v[80:83]
ds_read_b64_tr_b16 a[56:57], v16 offset:30720
v_mfma_f32_16x16x32_bf16 v[84:87], a[44:47], a[4:7], v[84:87]
ds_read_b64_tr_b16 a[58:59], v16 offset:32000
v_mfma_f32_16x16x32_bf16 v[88:91], a[44:47], a[8:11], v[88:91]
ds_read_b128 a[28:31], v23 offset:18432
s_lshr_b32 s63, s61, 4
s_lshl3_add_u32 s62, s63, s62
s_mul_i32 s52, s53, 114688
s_add_u32 s53, s53, 1
s_cmp_eq_u32 s53, 14
s_cselect_b32 s53, 0, s53
s_add_u32 m0, s55, 20480
v_mfma_f32_16x16x32_bf16 v[92:95], a[44:47], a[12:15], v[92:95]
buffer_load_dwordx4 v2, s[28:31], s52 offen lds
s_sub_u32 s63, s62, 4
v_mfma_f32_16x16x32_bf16 v[144:147], a[60:63], a[0:3], v[144:147]
ds_read_b64_tr_b16 a[44:45], v17 offset:20512
v_mfma_f32_16x16x32_bf16 v[148:151], a[60:63], a[4:7], v[148:151]
ds_read_b64_tr_b16 a[46:47], v17 offset:21792
v_mfma_f32_16x16x32_bf16 v[152:155], a[60:63], a[8:11], v[152:155]
ds_read_b128 a[32:35], v23 offset:20480
s_lshr_b32 s61, s63, 2
s_add_u32 s61, s61, 4
s_add_u32 m0, s55, 21504
v_mfma_f32_16x16x32_bf16 v[156:159], a[60:63], a[12:15], v[156:159]
buffer_load_dwordx4 v3, s[28:31], s52 offen lds
s_and_b32 s63, s63, 3
s_waitcnt lgkmcnt(15)
v_mfma_f32_16x16x32_bf16 v[96:99], a[48:51], a[0:3], v[96:99]
ds_read_b64_tr_b16 a[60:61], v17 offset:30752
v_mfma_f32_16x16x32_bf16 v[100:103], a[48:51], a[4:7], v[100:103]
ds_read_b64_tr_b16 a[62:63], v17 offset:32032
s_lshl_b32 s63, s63, 2
v_mfma_f32_16x16x32_bf16 v[104:107], a[48:51], a[8:11], v[104:107]
s_cmp_lt_u32 s62, 4
s_cselect_b32 s69, s62, s61
s_cselect_b32 s63, 12, s63
s_add_u32 m0, s55, 22528
v_mfma_f32_16x16x32_bf16 v[108:111], a[48:51], a[12:15], v[108:111]
buffer_load_dwordx4 v4, s[28:31], s52 offen lds
s_lshl4_add_u32 s68, s60, s63
v_mfma_f32_16x16x32_bf16 v[160:163], a[64:67], a[0:3], v[160:163]
ds_read_b64_tr_b16 a[48:49], v16 offset:20544
v_mfma_f32_16x16x32_bf16 v[164:167], a[64:67], a[4:7], v[164:167]
ds_read_b64_tr_b16 a[50:51], v16 offset:21824
s_lshr_b32 s60, s46, 1
s_mul_i32 s60, s60, 448
v_mfma_f32_16x16x32_bf16 v[168:171], a[64:67], a[8:11], v[168:171]
s_and_b32 s61, s46, 1
s_add_u32 m0, s55, 23552
v_mfma_f32_16x16x32_bf16 v[172:175], a[64:67], a[12:15], v[172:175]
buffer_load_dwordx4 v5, s[28:31], s52 offen lds
v_mfma_f32_16x16x32_bf16 v[112:115], a[52:55], a[0:3], v[112:115]
ds_read_b64_tr_b16 a[64:65], v16 offset:30784
v_mfma_f32_16x16x32_bf16 v[116:119], a[52:55], a[4:7], v[116:119]
ds_read_b64_tr_b16 a[66:67], v16 offset:32064
s_mul_i32 s63, s61, 384
s_add_u32 s63, s63, s60
v_mfma_f32_16x16x32_bf16 v[120:123], a[52:55], a[8:11], v[120:123]
s_mul_i32 s71, s63, 0x380
s_add_u32 m0, s55, 24576
v_mfma_f32_16x16x32_bf16 v[124:127], a[52:55], a[12:15], v[124:127]
buffer_load_dwordx4 v6, s[28:31], s52 offen lds
v_mfma_f32_16x16x32_bf16 v[176:179], a[68:71], a[0:3], v[176:179]
ds_read_b64_tr_b16 a[52:53], v17 offset:20576
v_mfma_f32_16x16x32_bf16 v[180:183], a[68:71], a[4:7], v[180:183]
ds_read_b64_tr_b16 a[54:55], v17 offset:21856
s_mul_i32 s63, s61, 160
s_add_u32 s63, s63, s60
v_mfma_f32_16x16x32_bf16 v[184:187], a[68:71], a[8:11], v[184:187]
s_add_u32 s63, s63, 64
v_mfma_f32_16x16x32_bf16 v[188:191], a[68:71], a[12:15], v[188:191]
s_waitcnt lgkmcnt(15)
v_mfma_f32_16x16x32_bf16 v[192:195], a[72:75], a[0:3], v[192:195]
ds_read_b64_tr_b16 a[68:69], v17 offset:30816
v_mfma_f32_16x16x32_bf16 v[196:199], a[72:75], a[4:7], v[196:199]
ds_read_b64_tr_b16 a[70:71], v17 offset:32096
s_mul_i32 s70, s63, 0x380
s_mul_i32 s72, s46, 50176
v_mfma_f32_16x16x32_bf16 v[208:211], a[80:83], a[0:3], v[208:211]
s_lshl_b32 s74, s46, 12
ds_read_b64_tr_b16 a[72:73], v18 offset:20608
v_mfma_f32_16x16x32_bf16 v[212:215], a[80:83], a[4:7], v[212:215]
ds_read_b64_tr_b16 a[74:75], v18 offset:21888
s_mul_i32 s60, s68, 72
s_mul_i32 s61, s46, 9
v_mfma_f32_16x16x32_bf16 v[200:203], a[76:79], a[0:3], v[200:203]
ds_read_b64_tr_b16 a[80:81], v18 offset:30848
v_mfma_f32_16x16x32_bf16 v[204:207], a[76:79], a[4:7], v[204:207]
ds_read_b64_tr_b16 a[82:83], v18 offset:32128
s_add_u32 s60, s60, s61
s_lshl_b32 s73, s60, 10
v_mfma_f32_16x16x32_bf16 v[216:219], a[84:87], a[0:3], v[216:219]
ds_read_b64_tr_b16 a[76:77], v19 offset:20640
v_mfma_f32_16x16x32_bf16 v[220:223], a[84:87], a[4:7], v[220:223]
ds_read_b64_tr_b16 a[78:79], v19 offset:21920
s_lshl_b32 s60, s46, 4
s_add_u32 s79, s60, 9699328
s_waitcnt lgkmcnt(15)
v_mfma_f32_16x16x32_bf16 v[64:67], a[40:43], a[20:23], v[64:67]
s_waitcnt vmcnt(7)
s_barrier
v_mfma_f32_16x16x32_bf16 v[68:71], a[40:43], a[24:27], v[68:71]
ds_read_b64_tr_b16 a[84:85], v19 offset:30880
v_mfma_f32_16x16x32_bf16 v[72:75], a[40:43], a[28:31], v[72:75]
ds_read_b64_tr_b16 a[86:87], v19 offset:32160
s_add_u32 m0, s58, 2048
v_mfma_f32_16x16x32_bf16 v[76:79], a[40:43], a[32:35], v[76:79]
buffer_load_dwordx4 v9, s[8:11], s50 offen lds
v_mfma_f32_16x16x32_bf16 v[128:131], a[56:59], a[20:23], v[128:131]
ds_read_b128 a[0:3], v20 offset:36864
v_mfma_f32_16x16x32_bf16 v[132:135], a[56:59], a[24:27], v[132:135]
ds_read_b64_tr_b16 a[40:41], v12 offset:0
v_mfma_f32_16x16x32_bf16 v[136:139], a[56:59], a[28:31], v[136:139]
ds_read_b64_tr_b16 a[42:43], v12 offset:1280
s_add_u32 m0, s58, 3072
v_mfma_f32_16x16x32_bf16 v[140:143], a[56:59], a[32:35], v[140:143]
buffer_load_dwordx4 v10, s[8:11], s50 offen lds
s_waitcnt lgkmcnt(15)
v_mfma_f32_16x16x32_bf16 v[80:83], a[44:47], a[20:23], v[80:83]
ds_read_b128 a[4:7], v20 offset:38912
v_min_u32 v36, 143, v0
v_mfma_f32_16x16x32_bf16 v[84:87], a[44:47], a[24:27], v[84:87]
v_sub_u32 v37, 127, v36
v_ashrrev_i32 v37, 31, v37
v_mfma_f32_16x16x32_bf16 v[88:91], a[44:47], a[28:31], v[88:91]
v_and_b32 v37, 0xffffff70, v37
ds_read_b64_tr_b16 a[56:57], v12 offset:10240
s_mul_i32 s52, s53, 114688
s_add_u32 s53, s53, 1
s_cmp_eq_u32 s53, 14
s_cselect_b32 s53, 0, s53
s_add_u32 m0, s55, 40960
v_mfma_f32_16x16x32_bf16 v[92:95], a[44:47], a[32:35], v[92:95]
buffer_load_dwordx4 v2, s[28:31], s52 offen lds
v_mfma_f32_16x16x32_bf16 v[144:147], a[60:63], a[20:23], v[144:147]
ds_read_b64_tr_b16 a[58:59], v12 offset:11520
v_mfma_f32_16x16x32_bf16 v[148:151], a[60:63], a[24:27], v[148:151]
ds_read_b128 a[8:11], v22 offset:36864
v_add_u32 v36, v36, v37
v_mfma_f32_16x16x32_bf16 v[152:155], a[60:63], a[28:31], v[152:155]
v_add_u32 v36, s66, v36
v_max_i32 v36, 0, v36
s_add_u32 m0, s55, 41984
v_mfma_f32_16x16x32_bf16 v[156:159], a[60:63], a[32:35], v[156:159]
buffer_load_dwordx4 v3, s[28:31], s52 offen lds
v_lshlrev_b32 v26, 3, v36
v_mfma_f32_16x16x32_bf16 v[96:99], a[48:51], a[20:23], v[96:99]
ds_read_b64_tr_b16 a[44:45], v13 offset:32
v_mfma_f32_16x16x32_bf16 v[100:103], a[48:51], a[24:27], v[100:103]
ds_read_b64_tr_b16 a[46:47], v13 offset:1312
v_mfma_f32_16x16x32_bf16 v[104:107], a[48:51], a[28:31], v[104:107]
ds_read_b128 a[12:15], v22 offset:38912
v_min_u32 v28, 0xef, v0
s_add_u32 m0, s55, 43008
v_mfma_f32_16x16x32_bf16 v[108:111], a[48:51], a[32:35], v[108:111]
buffer_load_dwordx4 v4, s[28:31], s52 offen lds
v_lshlrev_b32 v28, 2, v28
v_mfma_f32_16x16x32_bf16 v[160:163], a[64:67], a[20:23], v[160:163]
v_add_u32 v28, 139392, v28
v_lshlrev_b32 v27, 4, v1
v_mfma_f32_16x16x32_bf16 v[164:167], a[64:67], a[24:27], v[164:167]
ds_read_b64_tr_b16 a[60:61], v13 offset:10272
v_mfma_f32_16x16x32_bf16 v[168:171], a[64:67], a[28:31], v[168:171]
ds_read_b64_tr_b16 a[62:63], v13 offset:11552
v_lshlrev_b32 v35, 6, v1
s_lshl_b32 s60, s46, 10
s_add_u32 s60, s60, 141312
s_add_u32 m0, s55, 44032
v_mfma_f32_16x16x32_bf16 v[172:175], a[64:67], a[32:35], v[172:175]
buffer_load_dwordx4 v5, s[28:31], s52 offen lds
s_waitcnt lgkmcnt(15)
v_mfma_f32_16x16x32_bf16 v[112:115], a[52:55], a[20:23], v[112:115]
ds_read_b64_tr_b16 a[48:49], v12 offset:64
v_mfma_f32_16x16x32_bf16 v[116:119], a[52:55], a[24:27], v[116:119]
ds_read_b64_tr_b16 a[50:51], v12 offset:1344
v_add_u32 v33, s60, v27
s_xor_b32 s61, s46, 2
s_lshl_b32 s61, s61, 10
v_mfma_f32_16x16x32_bf16 v[120:123], a[52:55], a[28:31], v[120:123]
ds_read_b64_tr_b16 a[64:65], v12 offset:10304
s_add_u32 m0, s55, 45056
v_mfma_f32_16x16x32_bf16 v[124:127], a[52:55], a[32:35], v[124:127]
buffer_load_dwordx4 v6, s[28:31], s52 offen lds
v_mfma_f32_16x16x32_bf16 v[176:179], a[68:71], a[20:23], v[176:179]
ds_read_b64_tr_b16 a[66:67], v12 offset:11584
s_add_u32 s61, s61, 141312
v_add_u32 v34, s61, v27
s_mul_i32 s60, s48, 1088
v_mfma_f32_16x16x32_bf16 v[180:183], a[68:71], a[24:27], v[180:183]
ds_read_b64_tr_b16 a[52:53], v13 offset:96
v_mfma_f32_16x16x32_bf16 v[184:187], a[68:71], a[28:31], v[184:187]
ds_read_b64_tr_b16 a[54:55], v13 offset:1376
s_add_u32 s60, s60, 137216
v_lshrrev_b32 v36, 4, v1
v_mfma_f32_16x16x32_bf16 v[188:191], a[68:71], a[32:35], v[188:191]
v_lshl_add_u32 v36, v36, 4, v27
v_mfma_f32_16x16x32_bf16 v[192:195], a[72:75], a[20:23], v[192:195]
ds_read_b64_tr_b16 a[68:69], v13 offset:10336
v_mfma_f32_16x16x32_bf16 v[196:199], a[72:75], a[24:27], v[196:199]
ds_read_b64_tr_b16 a[70:71], v13 offset:11616
v_add_u32 v29, s60, v36
s_mul_i32 s60, s45, 7
s_lshl_b32 s61, s47, 2
v_mfma_f32_16x16x32_bf16 v[208:211], a[80:83], a[20:23], v[208:211]
ds_read_b64_tr_b16 a[72:73], v14 offset:128
v_mfma_f32_16x16x32_bf16 v[212:215], a[80:83], a[24:27], v[212:215]
ds_read_b64_tr_b16 a[74:75], v14 offset:1408
s_add_u32 s60, s60, s61
s_lshl_b32 s60, s60, 1
s_waitcnt lgkmcnt(15)
v_mfma_f32_16x16x32_bf16 v[200:203], a[76:79], a[20:23], v[200:203]
s_add_u32 s60, s60, s48
ds_read_b64_tr_b16 a[80:81], v14 offset:10368
v_mfma_f32_16x16x32_bf16 v[204:207], a[76:79], a[24:27], v[204:207]
ds_read_b64_tr_b16 a[82:83], v14 offset:11648
s_lshl_b32 s60, s60, 10
s_add_u32 s80, s60, 9469952
v_mfma_f32_16x16x32_bf16 v[216:219], a[84:87], a[20:23], v[216:219]
s_add_u32 s81, s80, 2048
ds_read_b64_tr_b16 a[76:77], v15 offset:160
v_mfma_f32_16x16x32_bf16 v[220:223], a[84:87], a[24:27], v[220:223]
ds_read_b64_tr_b16 a[78:79], v15 offset:1440
s_add_u32 s82, s80, 4096
s_add_u32 s83, s80, 6144
s_cmp_eq_u32 s47, 1
s_cselect_b32 s83, 0xf0000000, s83
s_waitcnt lgkmcnt(15)
v_mfma_f32_16x16x32_bf16 v[64:67], a[40:43], a[0:3], v[64:67]
s_waitcnt vmcnt(7)
s_barrier
v_mfma_f32_16x16x32_bf16 v[68:71], a[40:43], a[4:7], v[68:71]
ds_read_b64_tr_b16 a[84:85], v15 offset:10400
v_mfma_f32_16x16x32_bf16 v[72:75], a[40:43], a[8:11], v[72:75]
ds_read_b64_tr_b16 a[86:87], v15 offset:11680
s_lshl_b32 s50, s54, 7
s_add_u32 s54, s54, 1
s_cmp_eq_u32 s54, 7
s_cselect_b32 s54, 0, s54
s_add_u32 m0, s58, 18432
v_mfma_f32_16x16x32_bf16 v[76:79], a[40:43], a[12:15], v[76:79]
buffer_load_dwordx4 v7, s[8:11], s50 offen lds
v_mfma_f32_16x16x32_bf16 v[128:131], a[56:59], a[0:3], v[128:131]
ds_read_b128 a[20:23], v21 offset:36864
v_mfma_f32_16x16x32_bf16 v[132:135], a[56:59], a[4:7], v[132:135]
ds_read_b64_tr_b16 a[40:41], v12 offset:20480
v_mfma_f32_16x16x32_bf16 v[136:139], a[56:59], a[8:11], v[136:139]
ds_read_b64_tr_b16 a[42:43], v12 offset:21760
s_add_u32 m0, s58, 19456
v_mfma_f32_16x16x32_bf16 v[140:143], a[56:59], a[12:15], v[140:143]
buffer_load_dwordx4 v8, s[8:11], s50 offen lds
s_waitcnt lgkmcnt(15)
v_mfma_f32_16x16x32_bf16 v[80:83], a[44:47], a[0:3], v[80:83]
ds_read_b128 a[24:27], v21 offset:38912
v_lshrrev_b32 v60, 3, v1
v_mfma_f32_16x16x32_bf16 v[84:87], a[44:47], a[4:7], v[84:87]
v_and_b32 v61, 7, v1
ds_read_b64_tr_b16 a[56:57], v12 offset:30720
v_mfma_f32_16x16x32_bf16 v[88:91], a[44:47], a[8:11], v[88:91]
ds_read_b64_tr_b16 a[58:59], v12 offset:32000
s_mul_i32 s52, s53, 114688
s_add_u32 s53, s53, 1
s_cmp_eq_u32 s53, 14
s_cselect_b32 s53, 0, s53
s_add_u32 m0, s55, 61440
v_mfma_f32_16x16x32_bf16 v[92:95], a[44:47], a[12:15], v[92:95]
buffer_load_dwordx4 v2, s[28:31], s52 offen lds
v_mfma_f32_16x16x32_bf16 v[144:147], a[60:63], a[0:3], v[144:147]
ds_read_b128 a[28:31], v23 offset:36864
v_bfe_u32 v62, v60, 1, 2
v_mfma_f32_16x16x32_bf16 v[148:151], a[60:63], a[4:7], v[148:151]
ds_read_b64_tr_b16 a[44:45], v13 offset:20512
v_mfma_f32_16x16x32_bf16 v[152:155], a[60:63], a[8:11], v[152:155]
ds_read_b64_tr_b16 a[46:47], v13 offset:21792
s_add_u32 m0, s55, 62464
v_mfma_f32_16x16x32_bf16 v[156:159], a[60:63], a[12:15], v[156:159]
buffer_load_dwordx4 v3, s[28:31], s52 offen lds
v_mfma_f32_16x16x32_bf16 v[96:99], a[48:51], a[0:3], v[96:99]
ds_read_b128 a[32:35], v23 offset:38912
v_lshlrev_b32 v62, 1, v62
v_mfma_f32_16x16x32_bf16 v[100:103], a[48:51], a[4:7], v[100:103]
ds_read_b64_tr_b16 a[60:61], v13 offset:30752
v_mfma_f32_16x16x32_bf16 v[104:107], a[48:51], a[8:11], v[104:107]
ds_read_b64_tr_b16 a[62:63], v13 offset:32032
v_xor_b32 v61, v61, v62
s_add_u32 m0, s55, 63488
v_mfma_f32_16x16x32_bf16 v[108:111], a[48:51], a[12:15], v[108:111]
buffer_load_dwordx4 v4, s[28:31], s52 offen lds
v_mfma_f32_16x16x32_bf16 v[160:163], a[64:67], a[0:3], v[160:163]
ds_read_b64_tr_b16 a[48:49], v12 offset:20544
v_mfma_f32_16x16x32_bf16 v[164:167], a[64:67], a[4:7], v[164:167]
ds_read_b64_tr_b16 a[50:51], v12 offset:21824
v_mul_u32_u24 v60, 896, v60
v_mfma_f32_16x16x32_bf16 v[168:171], a[64:67], a[8:11], v[168:171]
s_add_u32 m0, s55, 64512
v_mfma_f32_16x16x32_bf16 v[172:175], a[64:67], a[12:15], v[172:175]
buffer_load_dwordx4 v5, s[28:31], s52 offen lds
s_waitcnt lgkmcnt(15)
v_mfma_f32_16x16x32_bf16 v[112:115], a[52:55], a[0:3], v[112:115]
ds_read_b64_tr_b16 a[64:65], v12 offset:30784
v_mfma_f32_16x16x32_bf16 v[116:119], a[52:55], a[4:7], v[116:119]
ds_read_b64_tr_b16 a[66:67], v12 offset:32064
v_lshl_add_u32 v60, v61, 4, v60
v_mfma_f32_16x16x32_bf16 v[120:123], a[52:55], a[8:11], v[120:123]
s_add_u32 m0, s55, 65536
v_mfma_f32_16x16x32_bf16 v[124:127], a[52:55], a[12:15], v[124:127]
buffer_load_dwordx4 v6, s[28:31], s52 offen lds
v_mfma_f32_16x16x32_bf16 v[176:179], a[68:71], a[0:3], v[176:179]
ds_read_b64_tr_b16 a[52:53], v13 offset:20576
v_mfma_f32_16x16x32_bf16 v[180:183], a[68:71], a[4:7], v[180:183]
ds_read_b64_tr_b16 a[54:55], v13 offset:21856
s_lshl_b32 s60, s69, 7
v_mfma_f32_16x16x32_bf16 v[184:187], a[68:71], a[8:11], v[184:187]
v_mfma_f32_16x16x32_bf16 v[188:191], a[68:71], a[12:15], v[188:191]
v_mfma_f32_16x16x32_bf16 v[192:195], a[72:75], a[0:3], v[192:195]
ds_read_b64_tr_b16 a[68:69], v13 offset:30816
v_mfma_f32_16x16x32_bf16 v[196:199], a[72:75], a[4:7], v[196:199]
ds_read_b64_tr_b16 a[70:71], v13 offset:32096
v_add_u32 v232, s60, v60
v_mfma_f32_16x16x32_bf16 v[208:211], a[80:83], a[0:3], v[208:211]
ds_read_b64_tr_b16 a[72:73], v14 offset:20608
v_mfma_f32_16x16x32_bf16 v[212:215], a[80:83], a[4:7], v[212:215]
ds_read_b64_tr_b16 a[74:75], v14 offset:21888
v_add_u32 v233, 6144, v232
s_waitcnt lgkmcnt(15)
v_mfma_f32_16x16x32_bf16 v[200:203], a[76:79], a[0:3], v[200:203]
ds_read_b64_tr_b16 a[80:81], v14 offset:30848
v_mfma_f32_16x16x32_bf16 v[204:207], a[76:79], a[4:7], v[204:207]
ds_read_b64_tr_b16 a[82:83], v14 offset:32128
v_add_u32 v234, 12288, v232
v_mfma_f32_16x16x32_bf16 v[216:219], a[84:87], a[0:3], v[216:219]
ds_read_b64_tr_b16 a[76:77], v15 offset:20640
v_mfma_f32_16x16x32_bf16 v[220:223], a[84:87], a[4:7], v[220:223]
ds_read_b64_tr_b16 a[78:79], v15 offset:21920
v_add_u32 v235, 18432, v232
s_waitcnt lgkmcnt(15)
v_mfma_f32_16x16x32_bf16 v[64:67], a[40:43], a[20:23], v[64:67]
s_waitcnt vmcnt(7)
s_barrier
v_mfma_f32_16x16x32_bf16 v[68:71], a[40:43], a[24:27], v[68:71]
ds_read_b64_tr_b16 a[84:85], v15 offset:30880
v_mfma_f32_16x16x32_bf16 v[72:75], a[40:43], a[28:31], v[72:75]
ds_read_b64_tr_b16 a[86:87], v15 offset:32160
s_add_u32 m0, s58, 20480
v_mfma_f32_16x16x32_bf16 v[76:79], a[40:43], a[32:35], v[76:79]
buffer_load_dwordx4 v9, s[8:11], s50 offen lds
v_mfma_f32_16x16x32_bf16 v[128:131], a[56:59], a[20:23], v[128:131]
ds_read_b128 a[0:3], v20 offset:0
v_mfma_f32_16x16x32_bf16 v[132:135], a[56:59], a[24:27], v[132:135]
ds_read_b64_tr_b16 a[40:41], v16 offset:0
v_mfma_f32_16x16x32_bf16 v[136:139], a[56:59], a[28:31], v[136:139]
ds_read_b64_tr_b16 a[42:43], v16 offset:1280
s_add_u32 m0, s58, 21504
v_mfma_f32_16x16x32_bf16 v[140:143], a[56:59], a[32:35], v[140:143]
buffer_load_dwordx4 v10, s[8:11], s50 offen lds
s_waitcnt lgkmcnt(15)
v_mfma_f32_16x16x32_bf16 v[80:83], a[44:47], a[20:23], v[80:83]
ds_read_b128 a[4:7], v20 offset:2048
v_lshrrev_b32 v60, 4, v1
v_mfma_f32_16x16x32_bf16 v[84:87], a[44:47], a[24:27], v[84:87]
v_bfe_u32 v61, v1, 2, 2
ds_read_b64_tr_b16 a[56:57], v16 offset:10240
v_mfma_f32_16x16x32_bf16 v[88:91], a[44:47], a[28:31], v[88:91]
ds_read_b64_tr_b16 a[58:59], v16 offset:11520
s_mul_i32 s52, s53, 114688
s_add_u32 s53, s53, 1
s_cmp_eq_u32 s53, 14
s_cselect_b32 s53, 0, s53
s_add_u32 m0, s55, 0
v_mfma_f32_16x16x32_bf16 v[92:95], a[44:47], a[32:35], v[92:95]
buffer_load_dwordx4 v2, s[28:31], s52 offen lds
v_mfma_f32_16x16x32_bf16 v[144:147], a[60:63], a[20:23], v[144:147]
ds_read_b128 a[8:11], v22 offset:0
v_lshrrev_b32 v62, 1, v61
v_mfma_f32_16x16x32_bf16 v[148:151], a[60:63], a[24:27], v[148:151]
v_lshl_add_u32 v62, v60, 1, v62
ds_read_b64_tr_b16 a[44:45], v17 offset:32
v_mfma_f32_16x16x32_bf16 v[152:155], a[60:63], a[28:31], v[152:155]
ds_read_b64_tr_b16 a[46:47], v17 offset:1312
s_add_u32 m0, s55, 1024
v_mfma_f32_16x16x32_bf16 v[156:159], a[60:63], a[32:35], v[156:159]
buffer_load_dwordx4 v3, s[28:31], s52 offen lds
v_mfma_f32_16x16x32_bf16 v[96:99], a[48:51], a[20:23], v[96:99]
ds_read_b128 a[12:15], v22 offset:2048
v_and_b32 v62, 3, v62
v_mfma_f32_16x16x32_bf16 v[100:103], a[48:51], a[24:27], v[100:103]
v_lshl_add_u32 v61, v60, 2, v61
ds_read_b64_tr_b16 a[60:61], v17 offset:10272
v_mfma_f32_16x16x32_bf16 v[104:107], a[48:51], a[28:31], v[104:107]
ds_read_b64_tr_b16 a[62:63], v17 offset:11552
v_lshlrev_b32 v61, 7, v61
s_add_u32 m0, s55, 2048
v_mfma_f32_16x16x32_bf16 v[108:111], a[48:51], a[32:35], v[108:111]
buffer_load_dwordx4 v4, s[28:31], s52 offen lds
v_and_b32 v63, 3, v1
v_mfma_f32_16x16x32_bf16 v[160:163], a[64:67], a[20:23], v[160:163]
ds_read_b64_tr_b16 a[48:49], v16 offset:64
v_mfma_f32_16x16x32_bf16 v[164:167], a[64:67], a[24:27], v[164:167]
ds_read_b64_tr_b16 a[50:51], v16 offset:1344
v_lshl_add_u32 v61, v63, 3, v61
v_mfma_f32_16x16x32_bf16 v[168:171], a[64:67], a[28:31], v[168:171]
v_add_u32 v61, s74, v61
s_add_u32 m0, s55, 3072
v_mfma_f32_16x16x32_bf16 v[172:175], a[64:67], a[32:35], v[172:175]
buffer_load_dwordx4 v5, s[28:31], s52 offen lds
s_waitcnt lgkmcnt(15)
v_mfma_f32_16x16x32_bf16 v[112:115], a[52:55], a[20:23], v[112:115]
ds_read_b64_tr_b16 a[64:65], v16 offset:10304
v_mfma_f32_16x16x32_bf16 v[116:119], a[52:55], a[24:27], v[116:119]
ds_read_b64_tr_b16 a[66:67], v16 offset:11584
v_xor_b32 v63, 0, v62
v_mfma_f32_16x16x32_bf16 v[120:123], a[52:55], a[28:31], v[120:123]
v_lshl_add_u32 v236, v63, 5, v61
s_add_u32 m0, s55, 4096
v_mfma_f32_16x16x32_bf16 v[124:127], a[52:55], a[32:35], v[124:127]
buffer_load_dwordx4 v6, s[28:31], s52 offen lds
v_mfma_f32_16x16x32_bf16 v[176:179], a[68:71], a[20:23], v[176:179]
ds_read_b64_tr_b16 a[52:53], v17 offset:96
v_mfma_f32_16x16x32_bf16 v[180:183], a[68:71], a[24:27], v[180:183]
ds_read_b64_tr_b16 a[54:55], v17 offset:1376
v_add_u32 v250, 0x10000, v236
v_mfma_f32_16x16x32_bf16 v[184:187], a[68:71], a[28:31], v[184:187]
v_xor_b32 v63, 1, v62
v_mfma_f32_16x16x32_bf16 v[188:191], a[68:71], a[32:35], v[188:191]
v_mfma_f32_16x16x32_bf16 v[192:195], a[72:75], a[20:23], v[192:195]
ds_read_b64_tr_b16 a[68:69], v17 offset:10336
v_mfma_f32_16x16x32_bf16 v[196:199], a[72:75], a[24:27], v[196:199]
ds_read_b64_tr_b16 a[70:71], v17 offset:11616
v_lshl_add_u32 v237, v63, 5, v61
v_mfma_f32_16x16x32_bf16 v[208:211], a[80:83], a[20:23], v[208:211]
v_add_u32 v251, 0x10000, v237
ds_read_b64_tr_b16 a[72:73], v18 offset:128
v_mfma_f32_16x16x32_bf16 v[212:215], a[80:83], a[24:27], v[212:215]
ds_read_b64_tr_b16 a[74:75], v18 offset:1408
v_xor_b32 v63, 2, v62
s_waitcnt lgkmcnt(15)
v_mfma_f32_16x16x32_bf16 v[200:203], a[76:79], a[20:23], v[200:203]
v_lshl_add_u32 v238, v63, 5, v61
ds_read_b64_tr_b16 a[80:81], v18 offset:10368
v_mfma_f32_16x16x32_bf16 v[204:207], a[76:79], a[24:27], v[204:207]
ds_read_b64_tr_b16 a[82:83], v18 offset:11648
v_add_u32 v252, 0x10000, v238
v_mfma_f32_16x16x32_bf16 v[216:219], a[84:87], a[20:23], v[216:219]
v_xor_b32 v63, 3, v62
ds_read_b64_tr_b16 a[76:77], v19 offset:160
v_mfma_f32_16x16x32_bf16 v[220:223], a[84:87], a[24:27], v[220:223]
ds_read_b64_tr_b16 a[78:79], v19 offset:1440
v_lshl_add_u32 v239, v63, 5, v61
v_add_u32 v253, 0x10000, v239
s_waitcnt lgkmcnt(15)
v_mfma_f32_16x16x32_bf16 v[64:67], a[40:43], a[0:3], v[64:67]
s_waitcnt vmcnt(7)
s_barrier
v_mfma_f32_16x16x32_bf16 v[68:71], a[40:43], a[4:7], v[68:71]
ds_read_b64_tr_b16 a[84:85], v19 offset:10400
v_mfma_f32_16x16x32_bf16 v[72:75], a[40:43], a[8:11], v[72:75]
ds_read_b64_tr_b16 a[86:87], v19 offset:11680
s_lshl_b32 s50, s54, 7
s_add_u32 s54, s54, 1
s_cmp_eq_u32 s54, 7
s_cselect_b32 s54, 0, s54
s_add_u32 m0, s58, 36864
v_mfma_f32_16x16x32_bf16 v[76:79], a[40:43], a[12:15], v[76:79]
buffer_load_dwordx4 v7, s[8:11], s50 offen lds
v_mfma_f32_16x16x32_bf16 v[128:131], a[56:59], a[0:3], v[128:131]
ds_read_b128 a[20:23], v21 offset:0
v_mfma_f32_16x16x32_bf16 v[132:135], a[56:59], a[4:7], v[132:135]
ds_read_b64_tr_b16 a[40:41], v16 offset:20480
v_mfma_f32_16x16x32_bf16 v[136:139], a[56:59], a[8:11], v[136:139]
ds_read_b64_tr_b16 a[42:43], v16 offset:21760
s_add_u32 m0, s58, 37888
v_mfma_f32_16x16x32_bf16 v[140:143], a[56:59], a[12:15], v[140:143]
buffer_load_dwordx4 v8, s[8:11], s50 offen lds
s_waitcnt lgkmcnt(15)
v_mfma_f32_16x16x32_bf16 v[80:83], a[44:47], a[0:3], v[80:83]
ds_read_b128 a[24:27], v21 offset:2048
v_mfma_f32_16x16x32_bf16 v[84:87], a[44:47], a[4:7], v[84:87]
ds_read_b64_tr_b16 a[56:57], v16 offset:30720
v_mfma_f32_16x16x32_bf16 v[88:91], a[44:47], a[8:11], v[88:91]
ds_read_b64_tr_b16 a[58:59], v16 offset:32000
s_mul_i32 s52, s53, 114688
s_add_u32 s53, s53, 1
s_cmp_eq_u32 s53, 14
s_cselect_b32 s53, 0, s53
s_add_u32 m0, s55, 20480
v_mfma_f32_16x16x32_bf16 v[92:95], a[44:47], a[12:15], v[92:95]
buffer_load_dwordx4 v2, s[28:31], s52 offen lds
v_mfma_f32_16x16x32_bf16 v[144:147], a[60:63], a[0:3], v[144:147]
ds_read_b128 a[28:31], v23 offset:0
v_mfma_f32_16x16x32_bf16 v[148:151], a[60:63], a[4:7], v[148:151]
ds_read_b64_tr_b16 a[44:45], v17 offset:20512
v_mfma_f32_16x16x32_bf16 v[152:155], a[60:63], a[8:11], v[152:155]
ds_read_b64_tr_b16 a[46:47], v17 offset:21792
s_add_u32 m0, s55, 21504
v_mfma_f32_16x16x32_bf16 v[156:159], a[60:63], a[12:15], v[156:159]
buffer_load_dwordx4 v3, s[28:31], s52 offen lds
v_mfma_f32_16x16x32_bf16 v[96:99], a[48:51], a[0:3], v[96:99]
ds_read_b128 a[32:35], v23 offset:2048
v_mfma_f32_16x16x32_bf16 v[100:103], a[48:51], a[4:7], v[100:103]
ds_read_b64_tr_b16 a[60:61], v17 offset:30752
v_mfma_f32_16x16x32_bf16 v[104:107], a[48:51], a[8:11], v[104:107]
ds_read_b64_tr_b16 a[62:63], v17 offset:32032
s_add_u32 m0, s55, 22528
v_mfma_f32_16x16x32_bf16 v[108:111], a[48:51], a[12:15], v[108:111]
buffer_load_dwordx4 v4, s[28:31], s52 offen lds
v_mfma_f32_16x16x32_bf16 v[160:163], a[64:67], a[0:3], v[160:163]
ds_read_b64_tr_b16 a[48:49], v16 offset:20544
v_mfma_f32_16x16x32_bf16 v[164:167], a[64:67], a[4:7], v[164:167]
ds_read_b64_tr_b16 a[50:51], v16 offset:21824
v_mfma_f32_16x16x32_bf16 v[168:171], a[64:67], a[8:11], v[168:171]
s_add_u32 m0, s55, 23552
v_mfma_f32_16x16x32_bf16 v[172:175], a[64:67], a[12:15], v[172:175]
buffer_load_dwordx4 v5, s[28:31], s52 offen lds
s_waitcnt lgkmcnt(15)
v_mfma_f32_16x16x32_bf16 v[112:115], a[52:55], a[0:3], v[112:115]
ds_read_b64_tr_b16 a[64:65], v16 offset:30784
v_mfma_f32_16x16x32_bf16 v[116:119], a[52:55], a[4:7], v[116:119]
ds_read_b64_tr_b16 a[66:67], v16 offset:32064
v_mfma_f32_16x16x32_bf16 v[120:123], a[52:55], a[8:11], v[120:123]
s_add_u32 m0, s55, 24576
v_mfma_f32_16x16x32_bf16 v[124:127], a[52:55], a[12:15], v[124:127]
buffer_load_dwordx4 v6, s[28:31], s52 offen lds
v_mfma_f32_16x16x32_bf16 v[176:179], a[68:71], a[0:3], v[176:179]
ds_read_b64_tr_b16 a[52:53], v17 offset:20576
v_mfma_f32_16x16x32_bf16 v[180:183], a[68:71], a[4:7], v[180:183]
ds_read_b64_tr_b16 a[54:55], v17 offset:21856
v_mfma_f32_16x16x32_bf16 v[184:187], a[68:71], a[8:11], v[184:187]
v_mfma_f32_16x16x32_bf16 v[188:191], a[68:71], a[12:15], v[188:191]
v_mfma_f32_16x16x32_bf16 v[192:195], a[72:75], a[0:3], v[192:195]
ds_read_b64_tr_b16 a[68:69], v17 offset:30816
v_mfma_f32_16x16x32_bf16 v[196:199], a[72:75], a[4:7], v[196:199]
ds_read_b64_tr_b16 a[70:71], v17 offset:32096
v_mfma_f32_16x16x32_bf16 v[208:211], a[80:83], a[0:3], v[208:211]
ds_read_b64_tr_b16 a[72:73], v18 offset:20608
v_mfma_f32_16x16x32_bf16 v[212:215], a[80:83], a[4:7], v[212:215]
ds_read_b64_tr_b16 a[74:75], v18 offset:21888
s_waitcnt lgkmcnt(15)
v_mfma_f32_16x16x32_bf16 v[200:203], a[76:79], a[0:3], v[200:203]
ds_read_b64_tr_b16 a[80:81], v18 offset:30848
v_mfma_f32_16x16x32_bf16 v[204:207], a[76:79], a[4:7], v[204:207]
ds_read_b64_tr_b16 a[82:83], v18 offset:32128
v_mfma_f32_16x16x32_bf16 v[216:219], a[84:87], a[0:3], v[216:219]
ds_read_b64_tr_b16 a[76:77], v19 offset:20640
v_mfma_f32_16x16x32_bf16 v[220:223], a[84:87], a[4:7], v[220:223]
ds_read_b64_tr_b16 a[78:79], v19 offset:21920
s_waitcnt lgkmcnt(15)
v_mfma_f32_16x16x32_bf16 v[64:67], a[40:43], a[20:23], v[64:67]
s_waitcnt vmcnt(7)
s_barrier
v_mfma_f32_16x16x32_bf16 v[68:71], a[40:43], a[24:27], v[68:71]
ds_read_b64_tr_b16 a[84:85], v19 offset:30880
v_mfma_f32_16x16x32_bf16 v[72:75], a[40:43], a[28:31], v[72:75]
ds_read_b64_tr_b16 a[86:87], v19 offset:32160
s_add_u32 m0, s58, 38912
v_mfma_f32_16x16x32_bf16 v[76:79], a[40:43], a[32:35], v[76:79]
buffer_load_dwordx4 v9, s[8:11], s50 offen lds
v_mfma_f32_16x16x32_bf16 v[128:131], a[56:59], a[20:23], v[128:131]
ds_read_b128 a[0:3], v20 offset:18432
v_mfma_f32_16x16x32_bf16 v[132:135], a[56:59], a[24:27], v[132:135]
ds_read_b64_tr_b16 a[40:41], v12 offset:0
v_mfma_f32_16x16x32_bf16 v[136:139], a[56:59], a[28:31], v[136:139]
ds_read_b64_tr_b16 a[42:43], v12 offset:1280
s_add_u32 m0, s58, 39936
v_mfma_f32_16x16x32_bf16 v[140:143], a[56:59], a[32:35], v[140:143]
buffer_load_dwordx4 v10, s[8:11], s50 offen lds
s_waitcnt lgkmcnt(15)
v_mfma_f32_16x16x32_bf16 v[80:83], a[44:47], a[20:23], v[80:83]
ds_read_b128 a[4:7], v20 offset:20480
v_mfma_f32_16x16x32_bf16 v[84:87], a[44:47], a[24:27], v[84:87]
buffer_load_dword v60, v35, s[4:7], 0 offen sc1
v_mfma_f32_16x16x32_bf16 v[88:91], a[44:47], a[28:31], v[88:91]
ds_read_b64_tr_b16 a[56:57], v12 offset:10240
s_mul_i32 s52, s53, 114688
s_add_u32 s53, s53, 1
s_cmp_eq_u32 s53, 14
s_cselect_b32 s53, 0, s53
s_add_u32 m0, s55, 40960
v_mfma_f32_16x16x32_bf16 v[92:95], a[44:47], a[32:35], v[92:95]
buffer_load_dwordx4 v2, s[28:31], s52 offen lds
v_mfma_f32_16x16x32_bf16 v[144:147], a[60:63], a[20:23], v[144:147]
ds_read_b64_tr_b16 a[58:59], v12 offset:11520
v_mfma_f32_16x16x32_bf16 v[148:151], a[60:63], a[24:27], v[148:151]
ds_read_b128 a[8:11], v22 offset:18432
v_mfma_f32_16x16x32_bf16 v[152:155], a[60:63], a[28:31], v[152:155]
ds_read_b64_tr_b16 a[44:45], v13 offset:32
s_add_u32 m0, s55, 41984
v_mfma_f32_16x16x32_bf16 v[156:159], a[60:63], a[32:35], v[156:159]
buffer_load_dwordx4 v3, s[28:31], s52 offen lds
v_mfma_f32_16x16x32_bf16 v[96:99], a[48:51], a[20:23], v[96:99]
ds_read_b64_tr_b16 a[46:47], v13 offset:1312
v_mfma_f32_16x16x32_bf16 v[100:103], a[48:51], a[24:27], v[100:103]
ds_read_b128 a[12:15], v22 offset:20480
v_mfma_f32_16x16x32_bf16 v[104:107], a[48:51], a[28:31], v[104:107]
ds_read_b64_tr_b16 a[60:61], v13 offset:10272
s_add_u32 m0, s55, 43008
v_mfma_f32_16x16x32_bf16 v[108:111], a[48:51], a[32:35], v[108:111]
buffer_load_dwordx4 v4, s[28:31], s52 offen lds
v_mfma_f32_16x16x32_bf16 v[160:163], a[64:67], a[20:23], v[160:163]
ds_read_b64_tr_b16 a[62:63], v13 offset:11552
v_mfma_f32_16x16x32_bf16 v[164:167], a[64:67], a[24:27], v[164:167]
ds_read_b64_tr_b16 a[48:49], v12 offset:64
v_mfma_f32_16x16x32_bf16 v[168:171], a[64:67], a[28:31], v[168:171]
ds_read_b64_tr_b16 a[50:51], v12 offset:1344
s_add_u32 m0, s55, 44032
v_mfma_f32_16x16x32_bf16 v[172:175], a[64:67], a[32:35], v[172:175]
buffer_load_dwordx4 v5, s[28:31], s52 offen lds
s_waitcnt lgkmcnt(15)
v_mfma_f32_16x16x32_bf16 v[112:115], a[52:55], a[20:23], v[112:115]
ds_read_b64_tr_b16 a[64:65], v12 offset:10304
v_mfma_f32_16x16x32_bf16 v[116:119], a[52:55], a[24:27], v[116:119]
ds_read_b64_tr_b16 a[66:67], v12 offset:11584
v_mfma_f32_16x16x32_bf16 v[120:123], a[52:55], a[28:31], v[120:123]
s_add_u32 m0, s55, 45056
v_mfma_f32_16x16x32_bf16 v[124:127], a[52:55], a[32:35], v[124:127]
buffer_load_dwordx4 v6, s[28:31], s52 offen lds
v_mfma_f32_16x16x32_bf16 v[176:179], a[68:71], a[20:23], v[176:179]
ds_read_b64_tr_b16 a[52:53], v13 offset:96
v_mfma_f32_16x16x32_bf16 v[180:183], a[68:71], a[24:27], v[180:183]
ds_read_b64_tr_b16 a[54:55], v13 offset:1376
v_mfma_f32_16x16x32_bf16 v[184:187], a[68:71], a[28:31], v[184:187]
v_mfma_f32_16x16x32_bf16 v[188:191], a[68:71], a[32:35], v[188:191]
v_mfma_f32_16x16x32_bf16 v[192:195], a[72:75], a[20:23], v[192:195]
ds_read_b64_tr_b16 a[68:69], v13 offset:10336
v_mfma_f32_16x16x32_bf16 v[196:199], a[72:75], a[24:27], v[196:199]
ds_read_b64_tr_b16 a[70:71], v13 offset:11616
v_mfma_f32_16x16x32_bf16 v[208:211], a[80:83], a[20:23], v[208:211]
ds_read_b64_tr_b16 a[72:73], v14 offset:128
v_mfma_f32_16x16x32_bf16 v[212:215], a[80:83], a[24:27], v[212:215]
ds_read_b64_tr_b16 a[74:75], v14 offset:1408
s_waitcnt lgkmcnt(15)
v_mfma_f32_16x16x32_bf16 v[200:203], a[76:79], a[20:23], v[200:203]
ds_read_b64_tr_b16 a[80:81], v14 offset:10368
v_mfma_f32_16x16x32_bf16 v[204:207], a[76:79], a[24:27], v[204:207]
ds_read_b64_tr_b16 a[82:83], v14 offset:11648
v_mfma_f32_16x16x32_bf16 v[216:219], a[84:87], a[20:23], v[216:219]
ds_read_b64_tr_b16 a[76:77], v15 offset:160
v_mfma_f32_16x16x32_bf16 v[220:223], a[84:87], a[24:27], v[220:223]
ds_read_b64_tr_b16 a[78:79], v15 offset:1440
s_waitcnt lgkmcnt(15)
v_mfma_f32_16x16x32_bf16 v[64:67], a[40:43], a[0:3], v[64:67]
s_waitcnt vmcnt(8)
s_barrier
v_mfma_f32_16x16x32_bf16 v[68:71], a[40:43], a[4:7], v[68:71]
ds_read_b64_tr_b16 a[84:85], v15 offset:10400
v_mfma_f32_16x16x32_bf16 v[72:75], a[40:43], a[8:11], v[72:75]
ds_read_b64_tr_b16 a[86:87], v15 offset:11680
s_lshl_b32 s50, s54, 7
s_add_u32 s54, s54, 1
s_cmp_eq_u32 s54, 7
s_cselect_b32 s54, 0, s54
s_add_u32 m0, s58, 0
v_mfma_f32_16x16x32_bf16 v[76:79], a[40:43], a[12:15], v[76:79]
buffer_load_dwordx4 v7, s[8:11], s50 offen lds
v_mfma_f32_16x16x32_bf16 v[128:131], a[56:59], a[0:3], v[128:131]
ds_read_b128 a[20:23], v21 offset:18432
v_mfma_f32_16x16x32_bf16 v[132:135], a[56:59], a[4:7], v[132:135]
ds_read_b64_tr_b16 a[40:41], v12 offset:20480
v_mfma_f32_16x16x32_bf16 v[136:139], a[56:59], a[8:11], v[136:139]
ds_read_b64_tr_b16 a[42:43], v12 offset:21760
s_add_u32 m0, s58, 1024
v_mfma_f32_16x16x32_bf16 v[140:143], a[56:59], a[12:15], v[140:143]
buffer_load_dwordx4 v8, s[8:11], s50 offen lds
s_waitcnt lgkmcnt(15)
v_mfma_f32_16x16x32_bf16 v[80:83], a[44:47], a[0:3], v[80:83]
ds_read_b128 a[24:27], v21 offset:20480
s_waitcnt vmcnt(7)
v_mfma_f32_16x16x32_bf16 v[84:87], a[44:47], a[4:7], v[84:87]
ds_read_b64_tr_b16 a[56:57], v12 offset:30720
v_mfma_f32_16x16x32_bf16 v[88:91], a[44:47], a[8:11], v[88:91]
ds_read_b64_tr_b16 a[58:59], v12 offset:32000
s_mul_i32 s52, s53, 114688
s_add_u32 s53, s53, 1
s_cmp_eq_u32 s53, 14
s_cselect_b32 s53, 0, s53
s_add_u32 m0, s55, 61440
v_mfma_f32_16x16x32_bf16 v[92:95], a[44:47], a[12:15], v[92:95]
buffer_load_dwordx4 v2, s[28:31], s52 offen lds
v_mfma_f32_16x16x32_bf16 v[144:147], a[60:63], a[0:3], v[144:147]
ds_read_b128 a[28:31], v23 offset:18432
v_mfma_f32_16x16x32_bf16 v[148:151], a[60:63], a[4:7], v[148:151]
v_readlane_b32 s60, v60, 0
v_readlane_b32 s61, v60, 1
v_readlane_b32 s62, v60, 2
v_readlane_b32 s63, v60, 3
s_nop 0
s_add_u32 s60, s60, s61
s_add_u32 s62, s62, s63
s_add_u32 s60, s60, s62
s_cmp_ge_u32 s60, 256
s_cbranch_scc0 L_cnt_slow_48
L_cnt_back_49:
v_mfma_f32_16x16x32_bf16 v[152:155], a[60:63], a[8:11], v[152:155]
ds_read_b64_tr_b16 a[44:45], v13 offset:20512
s_add_u32 m0, s55, 62464
v_mfma_f32_16x16x32_bf16 v[156:159], a[60:63], a[12:15], v[156:159]
buffer_load_dwordx4 v3, s[28:31], s52 offen lds
v_mfma_f32_16x16x32_bf16 v[96:99], a[48:51], a[0:3], v[96:99]
ds_read_b64_tr_b16 a[46:47], v13 offset:21792
v_mfma_f32_16x16x32_bf16 v[100:103], a[48:51], a[4:7], v[100:103]
ds_read_b128 a[32:35], v23 offset:20480
s_mov_b32 s62, 9437184
v_mfma_f32_16x16x32_bf16 v[104:107], a[48:51], a[8:11], v[104:107]
ds_read_b64_tr_b16 a[60:61], v13 offset:30752
s_add_u32 m0, s55, 63488
v_mfma_f32_16x16x32_bf16 v[108:111], a[48:51], a[12:15], v[108:111]
buffer_load_dwordx4 v4, s[28:31], s52 offen lds
v_mfma_f32_16x16x32_bf16 v[160:163], a[64:67], a[0:3], v[160:163]
ds_read_b64_tr_b16 a[62:63], v13 offset:32032
v_mfma_f32_16x16x32_bf16 v[164:167], a[64:67], a[4:7], v[164:167]
buffer_load_dwordx2 v[40:41], v26, s[24:27], s62 offen sc1
v_mfma_f32_16x16x32_bf16 v[168:171], a[64:67], a[8:11], v[168:171]
ds_read_b64_tr_b16 a[48:49], v12 offset:20544
s_add_u32 m0, s55, 64512
v_mfma_f32_16x16x32_bf16 v[172:175], a[64:67], a[12:15], v[172:175]
buffer_load_dwordx4 v5, s[28:31], s52 offen lds
s_waitcnt lgkmcnt(15)
v_mfma_f32_16x16x32_bf16 v[112:115], a[52:55], a[0:3], v[112:115]
ds_read_b64_tr_b16 a[50:51], v12 offset:21824
v_mfma_f32_16x16x32_bf16 v[116:119], a[52:55], a[4:7], v[116:119]
buffer_load_dwordx4 v[44:47], v27, s[24:27], s80 offen sc1
v_mfma_f32_16x16x32_bf16 v[120:123], a[52:55], a[8:11], v[120:123]
ds_read_b64_tr_b16 a[64:65], v12 offset:30784
s_add_u32 m0, s55, 65536
v_mfma_f32_16x16x32_bf16 v[124:127], a[52:55], a[12:15], v[124:127]
buffer_load_dwordx4 v6, s[28:31], s52 offen lds
v_mfma_f32_16x16x32_bf16 v[176:179], a[68:71], a[0:3], v[176:179]
ds_read_b64_tr_b16 a[66:67], v12 offset:32064
v_mfma_f32_16x16x32_bf16 v[180:183], a[68:71], a[4:7], v[180:183]
buffer_load_dwordx4 v[48:51], v27, s[24:27], s81 offen sc1
v_mfma_f32_16x16x32_bf16 v[184:187], a[68:71], a[8:11], v[184:187]
ds_read_b64_tr_b16 a[52:53], v13 offset:20576
v_mfma_f32_16x16x32_bf16 v[188:191], a[68:71], a[12:15], v[188:191]
ds_read_b64_tr_b16 a[54:55], v13 offset:21856
v_mfma_f32_16x16x32_bf16 v[192:195], a[72:75], a[0:3], v[192:195]
buffer_load_dwordx4 v[52:55], v27, s[24:27], s82 offen sc1
v_mfma_f32_16x16x32_bf16 v[196:199], a[72:75], a[4:7], v[196:199]
ds_read_b64_tr_b16 a[68:69], v13 offset:30816
v_mfma_f32_16x16x32_bf16 v[208:211], a[80:83], a[0:3], v[208:211]
ds_read_b64_tr_b16 a[70:71], v13 offset:32096
v_mfma_f32_16x16x32_bf16 v[212:215], a[80:83], a[4:7], v[212:215]
buffer_load_dwordx4 v[56:59], v27, s[24:27], s83 offen sc1
s_waitcnt lgkmcnt(15)
v_mfma_f32_16x16x32_bf16 v[200:203], a[76:79], a[0:3], v[200:203]
ds_read_b64_tr_b16 a[72:73], v14 offset:20608
v_mfma_f32_16x16x32_bf16 v[204:207], a[76:79], a[4:7], v[204:207]
ds_read_b64_tr_b16 a[74:75], v14 offset:21888
v_mfma_f32_16x16x32_bf16 v[216:219], a[84:87], a[0:3], v[216:219]
ds_read_b64_tr_b16 a[80:81], v14 offset:30848
v_mfma_f32_16x16x32_bf16 v[220:223], a[84:87], a[4:7], v[220:223]
ds_read_b64_tr_b16 a[82:83], v14 offset:32128
s_waitcnt lgkmcnt(14)
v_mfma_f32_16x16x32_bf16 v[64:67], a[40:43], a[20:23], v[64:67]
s_waitcnt vmcnt(12)
s_barrier
v_mfma_f32_16x16x32_bf16 v[68:71], a[40:43], a[24:27], v[68:71]
ds_read_b64_tr_b16 a[76:77], v15 offset:20640
v_mfma_f32_16x16x32_bf16 v[72:75], a[40:43], a[28:31], v[72:75]
ds_read_b64_tr_b16 a[78:79], v15 offset:21920
s_add_u32 m0, s58, 2048
v_mfma_f32_16x16x32_bf16 v[76:79], a[40:43], a[32:35], v[76:79]
buffer_load_dwordx4 v9, s[8:11], s50 offen lds
v_mfma_f32_16x16x32_bf16 v[128:131], a[56:59], a[20:23], v[128:131]
ds_read_b64_tr_b16 a[84:85], v15 offset:30880
v_mfma_f32_16x16x32_bf16 v[132:135], a[56:59], a[24:27], v[132:135]
ds_read_b64_tr_b16 a[86:87], v15 offset:32160
v_mfma_f32_16x16x32_bf16 v[136:139], a[56:59], a[28:31], v[136:139]
ds_read_b128 a[0:3], v20 offset:36864
s_add_u32 m0, s58, 3072
v_mfma_f32_16x16x32_bf16 v[140:143], a[56:59], a[32:35], v[140:143]
buffer_load_dwordx4 v10, s[8:11], s50 offen lds
s_waitcnt lgkmcnt(15)
v_mfma_f32_16x16x32_bf16 v[80:83], a[44:47], a[20:23], v[80:83]
ds_read_b64_tr_b16 a[40:41], v16 offset:0
v_mfma_f32_16x16x32_bf16 v[84:87], a[44:47], a[24:27], v[84:87]
ds_read_b64_tr_b16 a[42:43], v16 offset:1280
v_mfma_f32_16x16x32_bf16 v[88:91], a[44:47], a[28:31], v[88:91]
ds_read_b128 a[4:7], v20 offset:38912
s_mul_i32 s52, s53, 114688
s_add_u32 s53, s53, 1
s_cmp_eq_u32 s53, 14
s_cselect_b32 s53, 0, s53
s_add_u32 m0, s55, 0
v_mfma_f32_16x16x32_bf16 v[92:95], a[44:47], a[32:35], v[92:95]
buffer_load_dwordx4 v2, s[28:31], s52 offen lds
v_mfma_f32_16x16x32_bf16 v[144:147], a[60:63], a[20:23], v[144:147]
ds_read_b64_tr_b16 a[56:57], v16 offset:10240
v_mfma_f32_16x16x32_bf16 v[148:151], a[60:63], a[24:27], v[148:151]
ds_read_b64_tr_b16 a[58:59], v16 offset:11520
v_mfma_f32_16x16x32_bf16 v[152:155], a[60:63], a[28:31], v[152:155]
ds_read_b128 a[8:11], v22 offset:36864
s_add_u32 m0, s55, 1024
v_mfma_f32_16x16x32_bf16 v[156:159], a[60:63], a[32:35], v[156:159]
buffer_load_dwordx4 v3, s[28:31], s52 offen lds
s_waitcnt lgkmcnt(15)
v_mfma_f32_16x16x32_bf16 v[96:99], a[48:51], a[20:23], v[96:99]
ds_read_b64_tr_b16 a[44:45], v17 offset:32
v_mfma_f32_16x16x32_bf16 v[100:103], a[48:51], a[24:27], v[100:103]
ds_read_b64_tr_b16 a[46:47], v17 offset:1312
v_mfma_f32_16x16x32_bf16 v[104:107], a[48:51], a[28:31], v[104:107]
ds_read_b128 a[12:15], v22 offset:38912
s_add_u32 m0, s55, 2048
v_mfma_f32_16x16x32_bf16 v[108:111], a[48:51], a[32:35], v[108:111]
buffer_load_dwordx4 v4, s[28:31], s52 offen lds
v_mfma_f32_16x16x32_bf16 v[160:163], a[64:67], a[20:23], v[160:163]
ds_read_b64_tr_b16 a[60:61], v17 offset:10272
v_mfma_f32_16x16x32_bf16 v[164:167], a[64:67], a[24:27], v[164:167]
ds_read_b64_tr_b16 a[62:63], v17 offset:11552
v_mfma_f32_16x16x32_bf16 v[168:171], a[64:67], a[28:31], v[168:171]
ds_read_b64_tr_b16 a[48:49], v16 offset:64
s_add_u32 m0, s55, 3072
v_mfma_f32_16x16x32_bf16 v[172:175], a[64:67], a[32:35], v[172:175]
buffer_load_dwordx4 v5, s[28:31], s52 offen lds
v_mfma_f32_16x16x32_bf16 v[112:115], a[52:55], a[20:23], v[112:115]
ds_read_b64_tr_b16 a[50:51], v16 offset:1344
v_mfma_f32_16x16x32_bf16 v[116:119], a[52:55], a[24:27], v[116:119]
ds_read_b64_tr_b16 a[64:65], v16 offset:10304
v_mfma_f32_16x16x32_bf16 v[120:123], a[52:55], a[28:31], v[120:123]
ds_read_b64_tr_b16 a[66:67], v16 offset:11584
s_add_u32 m0, s55, 4096
v_mfma_f32_16x16x32_bf16 v[124:127], a[52:55], a[32:35], v[124:127]
buffer_load_dwordx4 v6, s[28:31], s52 offen lds
v_mfma_f32_16x16x32_bf16 v[176:179], a[68:71], a[20:23], v[176:179]
ds_read_b64_tr_b16 a[52:53], v17 offset:96
v_mfma_f32_16x16x32_bf16 v[180:183], a[68:71], a[24:27], v[180:183]
ds_read_b64_tr_b16 a[54:55], v17 offset:1376
v_mfma_f32_16x16x32_bf16 v[184:187], a[68:71], a[28:31], v[184:187]
v_mfma_f32_16x16x32_bf16 v[188:191], a[68:71], a[32:35], v[188:191]
s_waitcnt lgkmcnt(15)
v_mfma_f32_16x16x32_bf16 v[192:195], a[72:75], a[20:23], v[192:195]
ds_read_b64_tr_b16 a[68:69], v17 offset:10336
v_mfma_f32_16x16x32_bf16 v[196:199], a[72:75], a[24:27], v[196:199]
ds_read_b64_tr_b16 a[70:71], v17 offset:11616
v_mfma_f32_16x16x32_bf16 v[208:211], a[80:83], a[20:23], v[208:211]
ds_read_b64_tr_b16 a[72:73], v18 offset:128
v_mfma_f32_16x16x32_bf16 v[212:215], a[80:83], a[24:27], v[212:215]
ds_read_b64_tr_b16 a[74:75], v18 offset:1408
v_mfma_f32_16x16x32_bf16 v[200:203], a[76:79], a[20:23], v[200:203]
ds_read_b64_tr_b16 a[80:81], v18 offset:10368
v_mfma_f32_16x16x32_bf16 v[204:207], a[76:79], a[24:27], v[204:207]
ds_read_b64_tr_b16 a[82:83], v18 offset:11648
v_mfma_f32_16x16x32_bf16 v[216:219], a[84:87], a[20:23], v[216:219]
ds_read_b64_tr_b16 a[76:77], v19 offset:160
v_mfma_f32_16x16x32_bf16 v[220:223], a[84:87], a[24:27], v[220:223]
ds_read_b64_tr_b16 a[78:79], v19 offset:1440
s_waitcnt lgkmcnt(15)
v_mfma_f32_16x16x32_bf16 v[64:67], a[40:43], a[0:3], v[64:67]
s_waitcnt vmcnt(10)
s_barrier
v_mfma_f32_16x16x32_bf16 v[68:71], a[40:43], a[4:7], v[68:71]
ds_read_b64_tr_b16 a[84:85], v19 offset:10400
v_mfma_f32_16x16x32_bf16 v[72:75], a[40:43], a[8:11], v[72:75]
ds_read_b64_tr_b16 a[86:87], v19 offset:11680
s_mul_i32 s52, s53, 114688
s_add_u32 s53, s53, 1
s_cmp_eq_u32 s53, 14
s_cselect_b32 s53, 0, s53
s_add_u32 m0, s55, 20480
v_mfma_f32_16x16x32_bf16 v[76:79], a[40:43], a[12:15], v[76:79]
buffer_load_dwordx4 v2, s[28:31], s52 offen lds
v_mfma_f32_16x16x32_bf16 v[128:131], a[56:59], a[0:3], v[128:131]
ds_read_b128 a[20:23], v21 offset:36864
v_mfma_f32_16x16x32_bf16 v[132:135], a[56:59], a[4:7], v[132:135]
ds_read_b64_tr_b16 a[40:41], v16 offset:20480
v_mfma_f32_16x16x32_bf16 v[136:139], a[56:59], a[8:11], v[136:139]
ds_read_b64_tr_b16 a[42:43], v16 offset:21760
s_add_u32 m0, s55, 21504
v_mfma_f32_16x16x32_bf16 v[140:143], a[56:59], a[12:15], v[140:143]
buffer_load_dwordx4 v3, s[28:31], s52 offen lds
s_waitcnt lgkmcnt(15)
v_mfma_f32_16x16x32_bf16 v[80:83], a[44:47], a[0:3], v[80:83]
ds_read_b128 a[24:27], v21 offset:38912
s_waitcnt vmcnt(9)
v_bitop3_b32 v43, v44, v45, v46 bitop3:0x80
v_mfma_f32_16x16x32_bf16 v[84:87], a[44:47], a[4:7], v[84:87]
v_bitop3_b32 v43, v43, v47, v48 bitop3:0x80
ds_read_b64_tr_b16 a[56:57], v16 offset:30720
v_mfma_f32_16x16x32_bf16 v[88:91], a[44:47], a[8:11], v[88:91]
ds_read_b64_tr_b16 a[58:59], v16 offset:32000
v_mfma_f32_16x16x32_bf16 v[92:95], a[44:47], a[12:15], v[92:95]
ds_read_b128 a[28:31], v23 offset:36864
v_bitop3_b32 v43, v43, v49, v50 bitop3:0x80
v_mfma_f32_16x16x32_bf16 v[144:147], a[60:63], a[0:3], v[144:147]
v_bitop3_b32 v43, v43, v51, v52 bitop3:0x80
v_bitop3_b32 v43, v43, v53, v54 bitop3:0x80
v_mfma_f32_16x16x32_bf16 v[148:151], a[60:63], a[4:7], v[148:151]
ds_read_b64_tr_b16 a[44:45], v17 offset:20512
v_mfma_f32_16x16x32_bf16 v[152:155], a[60:63], a[8:11], v[152:155]
ds_read_b64_tr_b16 a[46:47], v17 offset:21792
s_add_u32 m0, s55, 22528
v_mfma_f32_16x16x32_bf16 v[156:159], a[60:63], a[12:15], v[156:159]
buffer_load_dwordx4 v4, s[28:31], s52 offen lds
v_mfma_f32_16x16x32_bf16 v[96:99], a[48:51], a[0:3], v[96:99]
ds_read_b128 a[32:35], v23 offset:38912
v_bitop3_b32 v42, v56, v57, v58 bitop3:0x80
v_mfma_f32_16x16x32_bf16 v[100:103], a[48:51], a[4:7], v[100:103]
v_and_b32 v42, v42, v59
v_or_b32 v42, s47, v42
v_mfma_f32_16x16x32_bf16 v[104:107], a[48:51], a[8:11], v[104:107]
ds_read_b64_tr_b16 a[60:61], v17 offset:30752
s_add_u32 m0, s55, 23552
v_mfma_f32_16x16x32_bf16 v[108:111], a[48:51], a[12:15], v[108:111]
buffer_load_dwordx4 v5, s[28:31], s52 offen lds
v_mfma_f32_16x16x32_bf16 v[160:163], a[64:67], a[0:3], v[160:163]
ds_read_b64_tr_b16 a[62:63], v17 offset:32032
v_bitop3_b32 v43, v43, v55, v42 bitop3:0x80
v_mfma_f32_16x16x32_bf16 v[164:167], a[64:67], a[4:7], v[164:167]
v_and_b32 v43, 1, v43
v_mfma_f32_16x16x32_bf16 v[168:171], a[64:67], a[8:11], v[168:171]
v_cmp_eq_u32 vcc, 0, v41
v_cmp_eq_u32 s[60:61], 0, v43
s_nop 1
s_or_b64 vcc, vcc, s[60:61]
s_cmp_eq_u64 vcc, 0
s_cbranch_scc0 L_gat_slow_51
L_gat_back_52:
v_mfma_f32_16x16x32_bf16 v[172:175], a[64:67], a[12:15], v[172:175]
ds_read_b64_tr_b16 a[48:49], v16 offset:20544
s_waitcnt lgkmcnt(15)
v_mfma_f32_16x16x32_bf16 v[112:115], a[52:55], a[0:3], v[112:115]
ds_read_b64_tr_b16 a[50:51], v16 offset:21824
v_add_f32 v44, v44, v48
v_mfma_f32_16x16x32_bf16 v[116:119], a[52:55], a[4:7], v[116:119]
v_add_f32 v52, v52, v56
v_add_f32 v45, v45, v49
v_mfma_f32_16x16x32_bf16 v[120:123], a[52:55], a[8:11], v[120:123]
ds_read_b64_tr_b16 a[64:65], v16 offset:30784
s_add_u32 m0, s55, 24576
v_mfma_f32_16x16x32_bf16 v[124:127], a[52:55], a[12:15], v[124:127]
buffer_load_dwordx4 v6, s[28:31], s52 offen lds
v_mfma_f32_16x16x32_bf16 v[176:179], a[68:71], a[0:3], v[176:179]
ds_read_b64_tr_b16 a[66:67], v16 offset:32064
v_add_f32 v53, v53, v57
v_mfma_f32_16x16x32_bf16 v[180:183], a[68:71], a[4:7], v[180:183]
v_add_f32 v46, v46, v50
v_add_f32 v54, v54, v58
v_mfma_f32_16x16x32_bf16 v[184:187], a[68:71], a[8:11], v[184:187]
ds_read_b64_tr_b16 a[52:53], v17 offset:20576
v_mfma_f32_16x16x32_bf16 v[188:191], a[68:71], a[12:15], v[188:191]
ds_read_b64_tr_b16 a[54:55], v17 offset:21856
v_add_f32 v47, v47, v51
v_mfma_f32_16x16x32_bf16 v[192:195], a[72:75], a[0:3], v[192:195]
v_add_f32 v55, v55, v59
ds_read_b64_tr_b16 a[68:69], v17 offset:30816
v_mfma_f32_16x16x32_bf16 v[196:199], a[72:75], a[4:7], v[196:199]
ds_read_b64_tr_b16 a[70:71], v17 offset:32096
v_add_f32 v44, v44, v52
v_mfma_f32_16x16x32_bf16 v[208:211], a[80:83], a[0:3], v[208:211]
v_add_f32 v45, v45, v53
ds_read_b64_tr_b16 a[72:73], v18 offset:20608
v_mfma_f32_16x16x32_bf16 v[212:215], a[80:83], a[4:7], v[212:215]
ds_read_b64_tr_b16 a[74:75], v18 offset:21888
v_add_f32 v46, v46, v54
s_waitcnt lgkmcnt(15)
v_mfma_f32_16x16x32_bf16 v[200:203], a[76:79], a[0:3], v[200:203]
v_add_f32 v47, v47, v55
ds_read_b64_tr_b16 a[80:81], v18 offset:30848
v_mfma_f32_16x16x32_bf16 v[204:207], a[76:79], a[4:7], v[204:207]
ds_read_b64_tr_b16 a[82:83], v18 offset:32128
v_mfma_f32_16x16x32_bf16 v[216:219], a[84:87], a[0:3], v[216:219]
ds_write_b32 v28, v40
v_mfma_f32_16x16x32_bf16 v[220:223], a[84:87], a[4:7], v[220:223]
ds_write_b32 v28, v41 offset:960
ds_read_b64_tr_b16 a[76:77], v19 offset:20640
ds_read_b64_tr_b16 a[78:79], v19 offset:21920
ds_write_b128 v33, v[44:47]
s_waitcnt lgkmcnt(0)
v_mfma_f32_16x16x32_bf16 v[64:67], a[40:43], a[20:23], v[64:67]
s_waitcnt vmcnt(5)
s_barrier
v_mfma_f32_16x16x32_bf16 v[68:71], a[40:43], a[24:27], v[68:71]
ds_read_b64_tr_b16 a[84:85], v19 offset:30880
v_mfma_f32_16x16x32_bf16 v[72:75], a[40:43], a[28:31], v[72:75]
ds_read_b64_tr_b16 a[86:87], v19 offset:32160
v_mfma_f32_16x16x32_bf16 v[76:79], a[40:43], a[32:35], v[76:79]
ds_read_b128 a[0:3], v20 offset:0
v_mfma_f32_16x16x32_bf16 v[128:131], a[56:59], a[20:23], v[128:131]
ds_read_b64_tr_b16 a[40:41], v12 offset:0
v_mfma_f32_16x16x32_bf16 v[132:135], a[56:59], a[24:27], v[132:135]
ds_read_b64_tr_b16 a[42:43], v12 offset:1280
v_mfma_f32_16x16x32_bf16 v[136:139], a[56:59], a[28:31], v[136:139]
ds_read_b128 a[4:7], v20 offset:2048
v_mfma_f32_16x16x32_bf16 v[140:143], a[56:59], a[32:35], v[140:143]
ds_read_b128 v[48:51], v34
s_waitcnt lgkmcnt(0)
v_mfma_f32_16x16x32_bf16 v[80:83], a[44:47], a[20:23], v[80:83]
ds_read_b64_tr_b16 a[56:57], v12 offset:10240
v_mfma_f32_16x16x32_bf16 v[84:87], a[44:47], a[24:27], v[84:87]
ds_read_b64_tr_b16 a[58:59], v12 offset:11520
v_mfma_f32_16x16x32_bf16 v[88:91], a[44:47], a[28:31], v[88:91]
ds_read_b128 a[8:11], v22 offset:0
v_add_f32 v44, v44, v48
v_mfma_f32_16x16x32_bf16 v[92:95], a[44:47], a[32:35], v[92:95]
v_add_f32 v45, v45, v49
v_mfma_f32_16x16x32_bf16 v[144:147], a[60:63], a[20:23], v[144:147]
ds_read_b64_tr_b16 a[44:45], v13 offset:32
v_mfma_f32_16x16x32_bf16 v[148:151], a[60:63], a[24:27], v[148:151]
ds_read_b64_tr_b16 a[46:47], v13 offset:1312
v_mfma_f32_16x16x32_bf16 v[152:155], a[60:63], a[28:31], v[152:155]
ds_read_b128 a[12:15], v22 offset:2048
v_add_f32 v46, v46, v50
v_mfma_f32_16x16x32_bf16 v[156:159], a[60:63], a[32:35], v[156:159]
v_add_f32 v47, v47, v51
v_mfma_f32_16x16x32_bf16 v[96:99], a[48:51], a[20:23], v[96:99]
ds_read_b64_tr_b16 a[60:61], v13 offset:10272
v_mfma_f32_16x16x32_bf16 v[100:103], a[48:51], a[24:27], v[100:103]
ds_read_b64_tr_b16 a[62:63], v13 offset:11552
v_mfma_f32_16x16x32_bf16 v[104:107], a[48:51], a[28:31], v[104:107]
ds_write_b128 v29, v[44:47]
s_waitcnt lgkmcnt(0)
v_mfma_f32_16x16x32_bf16 v[108:111], a[48:51], a[32:35], v[108:111]
v_mfma_f32_16x16x32_bf16 v[160:163], a[64:67], a[20:23], v[160:163]
ds_read_b64_tr_b16 a[48:49], v12 offset:64
v_mfma_f32_16x16x32_bf16 v[164:167], a[64:67], a[24:27], v[164:167]
ds_read_b64_tr_b16 a[50:51], v12 offset:1344
s_add_u32 s3, s70, 0
s_add_u32 m0, s74, 40960
v_mfma_f32_16x16x32_bf16 v[168:171], a[64:67], a[28:31], v[168:171]
v_mfma_f32_16x16x32_bf16 v[172:175], a[64:67], a[32:35], v[172:175]
v_mfma_f32_16x16x32_bf16 v[112:115], a[52:55], a[20:23], v[112:115]
ds_read_b64_tr_b16 a[64:65], v12 offset:10304
v_mfma_f32_16x16x32_bf16 v[116:119], a[52:55], a[24:27], v[116:119]
ds_read_b64_tr_b16 a[66:67], v12 offset:11584
v_mfma_f32_16x16x32_bf16 v[120:123], a[52:55], a[28:31], v[120:123]
buffer_load_dwordx4 v232, s[36:39], s3 offen offset:0 lds
v_mfma_f32_16x16x32_bf16 v[124:127], a[52:55], a[32:35], v[124:127]
buffer_load_dwordx4 v233, s[36:39], s3 offen offset:1024 lds
v_mfma_f32_16x16x32_bf16 v[176:179], a[68:71], a[20:23], v[176:179]
ds_read_b64_tr_b16 a[52:53], v13 offset:96
v_mfma_f32_16x16x32_bf16 v[180:183], a[68:71], a[24:27], v[180:183]
ds_read_b64_tr_b16 a[54:55], v13 offset:1376
v_mfma_f32_16x16x32_bf16 v[184:187], a[68:71], a[28:31], v[184:187]
buffer_load_dwordx4 v234, s[36:39], s3 offen offset:2048 lds
v_mfma_f32_16x16x32_bf16 v[188:191], a[68:71], a[32:35], v[188:191]
buffer_load_dwordx4 v235, s[36:39], s3 offen offset:3072 lds
v_mfma_f32_16x16x32_bf16 v[192:195], a[72:75], a[20:23], v[192:195]
ds_read_b64_tr_b16 a[68:69], v13 offset:10336
v_mfma_f32_16x16x32_bf16 v[196:199], a[72:75], a[24:27], v[196:199]
ds_read_b64_tr_b16 a[70:71], v13 offset:11616
s_add_u32 s3, s70, 28672
s_add_u32 m0, s74, 100352
v_mfma_f32_16x16x32_bf16 v[208:211], a[80:83], a[20:23], v[208:211]
ds_read_b64_tr_b16 a[72:73], v14 offset:128
v_mfma_f32_16x16x32_bf16 v[212:215], a[80:83], a[24:27], v[212:215]
ds_read_b64_tr_b16 a[74:75], v14 offset:1408
v_mfma_f32_16x16x32_bf16 v[200:203], a[76:79], a[20:23], v[200:203]
buffer_load_dwordx4 v232, s[36:39], s3 offen offset:0 lds
v_mfma_f32_16x16x32_bf16 v[204:207], a[76:79], a[24:27], v[204:207]
buffer_load_dwordx4 v233, s[36:39], s3 offen offset:1024 lds
v_mfma_f32_16x16x32_bf16 v[216:219], a[84:87], a[20:23], v[216:219]
ds_read_b64_tr_b16 a[80:81], v14 offset:10368
v_mfma_f32_16x16x32_bf16 v[220:223], a[84:87], a[24:27], v[220:223]
ds_read_b64_tr_b16 a[82:83], v14 offset:11648
buffer_load_dwordx4 v234, s[36:39], s3 offen offset:2048 lds
ds_read_b64_tr_b16 a[76:77], v15 offset:160
ds_read_b64_tr_b16 a[78:79], v15 offset:1440
buffer_load_dwordx4 v235, s[36:39], s3 offen offset:3072 lds
v_mfma_f32_16x16x32_bf16 v[64:67], a[40:43], a[0:3], v[64:67]
s_waitcnt vmcnt(8)
s_barrier
v_mfma_f32_16x16x32_bf16 v[68:71], a[40:43], a[4:7], v[68:71]
ds_read_b64_tr_b16 a[84:85], v15 offset:10400
v_mfma_f32_16x16x32_bf16 v[72:75], a[40:43], a[8:11], v[72:75]
ds_read_b64_tr_b16 a[86:87], v15 offset:11680
v_mfma_f32_16x16x32_bf16 v[76:79], a[40:43], a[12:15], v[76:79]
ds_read_b128 a[20:23], v21 offset:0
v_mfma_f32_16x16x32_bf16 v[128:131], a[56:59], a[0:3], v[128:131]
ds_read_b64_tr_b16 a[40:41], v12 offset:20480
v_mfma_f32_16x16x32_bf16 v[132:135], a[56:59], a[4:7], v[132:135]
ds_read_b64_tr_b16 a[42:43], v12 offset:21760
v_mfma_f32_16x16x32_bf16 v[136:139], a[56:59], a[8:11], v[136:139]
ds_read_b128 a[24:27], v21 offset:2048
v_and_b32 v34, 15, v1
v_mfma_f32_16x16x32_bf16 v[140:143], a[56:59], a[12:15], v[140:143]
v_lshlrev_b32 v34, 2, v34
s_lshl_b32 s60, s47, 8
s_add_u32 s60, s60, 139392
v_mfma_f32_16x16x32_bf16 v[80:83], a[44:47], a[0:3], v[80:83]
ds_read_b64_tr_b16 a[56:57], v12 offset:30720
v_mfma_f32_16x16x32_bf16 v[84:87], a[44:47], a[4:7], v[84:87]
ds_read_b64_tr_b16 a[58:59], v12 offset:32000
v_mfma_f32_16x16x32_bf16 v[88:91], a[44:47], a[8:11], v[88:91]
ds_read_b128 a[28:31], v23 offset:0
s_lshl_b32 s62, s48, 7
s_add_u32 s61, s60, 128
v_mfma_f32_16x16x32_bf16 v[92:95], a[44:47], a[12:15], v[92:95]
s_sub_u32 s61, s61, s62
s_add_u32 s60, s60, s62
v_mfma_f32_16x16x32_bf16 v[144:147], a[60:63], a[0:3], v[144:147]
ds_read_b64_tr_b16 a[44:45], v13 offset:20512
v_mfma_f32_16x16x32_bf16 v[148:151], a[60:63], a[4:7], v[148:151]
ds_read_b64_tr_b16 a[46:47], v13 offset:21792
v_mfma_f32_16x16x32_bf16 v[152:155], a[60:63], a[8:11], v[152:155]
ds_read_b128 a[32:35], v23 offset:2048
v_add_u32 v35, s60, v34
v_mfma_f32_16x16x32_bf16 v[156:159], a[60:63], a[12:15], v[156:159]
v_add_u32 v58, s61, v34
ds_read_b32 v26, v35 offset:0
s_waitcnt lgkmcnt(15)
v_mfma_f32_16x16x32_bf16 v[96:99], a[48:51], a[0:3], v[96:99]
ds_read_b32 v27, v35 offset:960
v_mfma_f32_16x16x32_bf16 v[100:103], a[48:51], a[4:7], v[100:103]
ds_read_b64_tr_b16 a[60:61], v13 offset:30752
v_mfma_f32_16x16x32_bf16 v[104:107], a[48:51], a[8:11], v[104:107]
ds_read_b64_tr_b16 a[62:63], v13 offset:32032
v_mfma_f32_16x16x32_bf16 v[108:111], a[48:51], a[12:15], v[108:111]
ds_read_b32 v28, v35 offset:64
v_mfma_f32_16x16x32_bf16 v[160:163], a[64:67], a[0:3], v[160:163]
ds_read_b32 v29, v35 offset:1024
v_mfma_f32_16x16x32_bf16 v[164:167], a[64:67], a[4:7], v[164:167]
ds_read_b32 v30, v58 offset:0
v_mfma_f32_16x16x32_bf16 v[168:171], a[64:67], a[8:11], v[168:171]
ds_read_b32 v31, v58 offset:960
v_mfma_f32_16x16x32_bf16 v[172:175], a[64:67], a[12:15], v[172:175]
ds_read_b64_tr_b16 a[48:49], v12 offset:20544
v_mfma_f32_16x16x32_bf16 v[112:115], a[52:55], a[0:3], v[112:115]
ds_read_b64_tr_b16 a[50:51], v12 offset:21824
v_mfma_f32_16x16x32_bf16 v[116:119], a[52:55], a[4:7], v[116:119]
ds_read_b32 v32, v58 offset:64
v_mfma_f32_16x16x32_bf16 v[120:123], a[52:55], a[8:11], v[120:123]
ds_read_b32 v33, v58 offset:1024
v_lshrrev_b32 v240, 4, v1
v_mfma_f32_16x16x32_bf16 v[124:127], a[52:55], a[12:15], v[124:127]
v_mul_u32_u24 v240, 0x110, v240
ds_read_b64_tr_b16 a[64:65], v12 offset:30784
v_mfma_f32_16x16x32_bf16 v[176:179], a[68:71], a[0:3], v[176:179]
ds_read_b64_tr_b16 a[66:67], v12 offset:32064
s_mul_i32 s60, s48, 1088
s_add_u32 s60, s60, 137216
v_add_u32 v240, s60, v240
v_mfma_f32_16x16x32_bf16 v[180:183], a[68:71], a[4:7], v[180:183]
v_lshlrev_b32 v241, 4, v1
ds_read_b64_tr_b16 a[52:53], v13 offset:20576
v_mfma_f32_16x16x32_bf16 v[184:187], a[68:71], a[8:11], v[184:187]
ds_read_b64_tr_b16 a[54:55], v13 offset:21856
s_lshl_b32 s60, s44, 3
s_lshl_b32 s61, s47, 2
v_mfma_f32_16x16x32_bf16 v[188:191], a[68:71], a[12:15], v[188:191]
s_add_u32 s60, s60, s61
s_mul_i32 s60, s60, 72
v_mfma_f32_16x16x32_bf16 v[192:195], a[72:75], a[0:3], v[192:195]
ds_read_b64_tr_b16 a[68:69], v13 offset:30816
v_mfma_f32_16x16x32_bf16 v[196:199], a[72:75], a[4:7], v[196:199]
ds_read_b64_tr_b16 a[70:71], v13 offset:32096
s_mul_i32 s61, s49, 9
s_and_b32 s62, s45, 1
v_mfma_f32_16x16x32_bf16 v[208:211], a[80:83], a[0:3], v[208:211]
s_lshl_b32 s62, s62, 2
s_add_u32 s61, s61, s62
ds_read_b64_tr_b16 a[72:73], v14 offset:20608
v_mfma_f32_16x16x32_bf16 v[212:215], a[80:83], a[4:7], v[212:215]
ds_read_b64_tr_b16 a[74:75], v14 offset:21888
s_add_u32 s60, s60, s61
s_lshl_b32 s60, s60, 10
s_waitcnt lgkmcnt(15)
v_mfma_f32_16x16x32_bf16 v[200:203], a[76:79], a[0:3], v[200:203]
s_mul_i32 s61, s48, 147456
s_add_u32 s64, s60, s61
ds_read_b64_tr_b16 a[80:81], v14 offset:30848
v_mfma_f32_16x16x32_bf16 v[204:207], a[76:79], a[4:7], v[204:207]
ds_read_b64_tr_b16 a[82:83], v14 offset:32128
s_add_u32 s65, s60, 147456
s_sub_u32 s65, s65, s61
v_mfma_f32_16x16x32_bf16 v[216:219], a[84:87], a[0:3], v[216:219]
s_add_u32 s3, s70, 57344
s_add_u32 m0, s74, 61440
ds_read_b64_tr_b16 a[76:77], v15 offset:20640
v_mfma_f32_16x16x32_bf16 v[220:223], a[84:87], a[4:7], v[220:223]
ds_read_b64_tr_b16 a[78:79], v15 offset:21920
buffer_load_dwordx4 v232, s[36:39], s3 offen offset:0 lds
buffer_load_dwordx4 v233, s[36:39], s3 offen offset:1024 lds
buffer_load_dwordx4 v234, s[36:39], s3 offen offset:2048 lds
buffer_load_dwordx4 v235, s[36:39], s3 offen offset:3072 lds
v_mfma_f32_16x16x32_bf16 v[64:67], a[40:43], a[20:23], v[64:67]
s_barrier
v_mfma_f32_16x16x32_bf16 v[68:71], a[40:43], a[24:27], v[68:71]
ds_read_b64_tr_b16 a[84:85], v15 offset:30880
v_mfma_f32_16x16x32_bf16 v[72:75], a[40:43], a[28:31], v[72:75]
ds_read_b64_tr_b16 a[86:87], v15 offset:32160
v_mfma_f32_16x16x32_bf16 v[76:79], a[40:43], a[32:35], v[76:79]
v_mfma_f32_16x16x32_bf16 v[128:131], a[56:59], a[20:23], v[128:131]
s_add_u32 s3, s70, 86016
s_add_u32 m0, s74, 118784
v_mfma_f32_16x16x32_bf16 v[132:135], a[56:59], a[24:27], v[132:135]
buffer_load_dwordx4 v232, s[36:39], s3 offen offset:0 lds
v_mfma_f32_16x16x32_bf16 v[136:139], a[56:59], a[28:31], v[136:139]
v_mfma_f32_16x16x32_bf16 v[140:143], a[56:59], a[32:35], v[140:143]
v_mfma_f32_16x16x32_bf16 v[80:83], a[44:47], a[20:23], v[80:83]
buffer_load_dwordx4 v233, s[36:39], s3 offen offset:1024 lds
v_mfma_f32_16x16x32_bf16 v[84:87], a[44:47], a[24:27], v[84:87]
buffer_load_dwordx4 v234, s[36:39], s3 offen offset:2048 lds
v_mfma_f32_16x16x32_bf16 v[88:91], a[44:47], a[28:31], v[88:91]
buffer_load_dwordx4 v235, s[36:39], s3 offen offset:3072 lds
v_mfma_f32_16x16x32_bf16 v[92:95], a[44:47], a[32:35], v[92:95]
v_mfma_f32_16x16x32_bf16 v[144:147], a[60:63], a[20:23], v[144:147]
s_add_u32 s3, s70, 114688
s_add_u32 m0, s74, 0
v_mfma_f32_16x16x32_bf16 v[148:151], a[60:63], a[24:27], v[148:151]
buffer_load_dwordx4 v232, s[36:39], s3 offen offset:0 lds
v_mfma_f32_16x16x32_bf16 v[152:155], a[60:63], a[28:31], v[152:155]
v_mfma_f32_16x16x32_bf16 v[156:159], a[60:63], a[32:35], v[156:159]
s_waitcnt lgkmcnt(12)
v_mfma_f32_16x16x32_bf16 v[96:99], a[48:51], a[20:23], v[96:99]
buffer_load_dwordx4 v233, s[36:39], s3 offen offset:1024 lds
v_mfma_f32_16x16x32_bf16 v[100:103], a[48:51], a[24:27], v[100:103]
buffer_load_dwordx4 v234, s[36:39], s3 offen offset:2048 lds
v_mfma_f32_16x16x32_bf16 v[104:107], a[48:51], a[28:31], v[104:107]
buffer_load_dwordx4 v235, s[36:39], s3 offen offset:3072 lds
v_mfma_f32_16x16x32_bf16 v[108:111], a[48:51], a[32:35], v[108:111]
v_mfma_f32_16x16x32_bf16 v[160:163], a[64:67], a[20:23], v[160:163]
v_sub_f32 v242, 0, v26
v_mul_f32 v243, v27, v27
v_mfma_f32_16x16x32_bf16 v[164:167], a[64:67], a[24:27], v[164:167]
v_mfma_f32_16x16x32_bf16 v[168:171], a[64:67], a[28:31], v[168:171]
v_mfma_f32_16x16x32_bf16 v[172:175], a[64:67], a[32:35], v[172:175]
s_waitcnt lgkmcnt(8)
v_mfma_f32_16x16x32_bf16 v[112:115], a[52:55], a[20:23], v[112:115]
v_sub_f32 v244, 0, v28
v_mul_f32 v245, v29, v29
v_mfma_f32_16x16x32_bf16 v[116:119], a[52:55], a[24:27], v[116:119]
v_sub_f32 v246, 0, v30
v_mfma_f32_16x16x32_bf16 v[120:123], a[52:55], a[28:31], v[120:123]
v_mfma_f32_16x16x32_bf16 v[124:127], a[52:55], a[32:35], v[124:127]
v_mfma_f32_16x16x32_bf16 v[176:179], a[68:71], a[20:23], v[176:179]
v_mul_f32 v247, v31, v31
v_sub_f32 v248, 0, v32
v_mfma_f32_16x16x32_bf16 v[180:183], a[68:71], a[24:27], v[180:183]
v_mfma_f32_16x16x32_bf16 v[184:187], a[68:71], a[28:31], v[184:187]
v_mfma_f32_16x16x32_bf16 v[188:191], a[68:71], a[32:35], v[188:191]
s_waitcnt lgkmcnt(4)
v_mfma_f32_16x16x32_bf16 v[192:195], a[72:75], a[20:23], v[192:195]
v_mul_f32 v249, v33, v33
s_mul_i32 s61, s48, 3072
v_mfma_f32_16x16x32_bf16 v[196:199], a[72:75], a[24:27], v[196:199]
v_mfma_f32_16x16x32_bf16 v[208:211], a[80:83], a[20:23], v[208:211]
s_add_u32 s75, s64, s61
s_add_u32 s76, s65, s61
v_mfma_f32_16x16x32_bf16 v[212:215], a[80:83], a[24:27], v[212:215]
s_waitcnt lgkmcnt(0)
v_mfma_f32_16x16x32_bf16 v[200:203], a[76:79], a[20:23], v[200:203]
ds_read_b128 v[36:39], v240 offset:0
v_mfma_f32_16x16x32_bf16 v[204:207], a[76:79], a[24:27], v[204:207]
ds_read_b128 v[40:43], v240 offset:16
v_mfma_f32_16x16x32_bf16 v[216:219], a[84:87], a[20:23], v[216:219]
ds_read_b128 v[44:47], v240 offset:32
v_mfma_f32_16x16x32_bf16 v[220:223], a[84:87], a[24:27], v[220:223]
ds_read_b128 v[48:51], v240 offset:48
s_waitcnt lgkmcnt(0)
s_barrier
ds_read_b128 v[52:55], v240 offset:64
ds_read_b128 v[56:59], v240 offset:80
ds_read_b128 v[4:7], v240 offset:96
ds_read_b128 v[8:11], v240 offset:112
v_pk_fma_f32 v[64:65], v[36:37], v[242:243], v[64:65] op_sel_hi:[1,0,1]
v_pk_fma_f32 v[68:69], v[36:37], v[244:245], v[68:69] op_sel_hi:[1,0,1]
v_pk_fma_f32 v[80:81], v[44:45], v[242:243], v[80:81] op_sel_hi:[1,0,1]
v_pk_fma_f32 v[84:85], v[44:45], v[244:245], v[84:85] op_sel_hi:[1,0,1]
v_pk_fma_f32 v[66:67], v[38:39], v[242:243], v[66:67] op_sel_hi:[1,0,1]
v_pk_fma_f32 v[70:71], v[38:39], v[244:245], v[70:71] op_sel_hi:[1,0,1]
v_pk_fma_f32 v[82:83], v[46:47], v[242:243], v[82:83] op_sel_hi:[1,0,1]
v_pk_fma_f32 v[86:87], v[46:47], v[244:245], v[86:87] op_sel_hi:[1,0,1]
v_pk_fma_f32 v[128:129], v[40:41], v[242:243], v[128:129] op_sel_hi:[1,0,1]
v_pk_fma_f32 v[132:133], v[40:41], v[244:245], v[132:133] op_sel_hi:[1,0,1]
v_pk_fma_f32 v[144:145], v[48:49], v[242:243], v[144:145] op_sel_hi:[1,0,1]
v_pk_fma_f32 v[148:149], v[48:49], v[244:245], v[148:149] op_sel_hi:[1,0,1]
v_pk_fma_f32 v[130:131], v[42:43], v[242:243], v[130:131] op_sel_hi:[1,0,1]
v_pk_fma_f32 v[134:135], v[42:43], v[244:245], v[134:135] op_sel_hi:[1,0,1]
v_pk_fma_f32 v[146:147], v[50:51], v[242:243], v[146:147] op_sel_hi:[1,0,1]
v_pk_fma_f32 v[150:151], v[50:51], v[244:245], v[150:151] op_sel_hi:[1,0,1]
v_pk_mul_f32 v[64:65], v[64:65], v[128:129]
v_pk_mul_f32 v[68:69], v[68:69], v[132:133]
v_pk_mul_f32 v[80:81], v[80:81], v[144:145]
v_pk_mul_f32 v[84:85], v[84:85], v[148:149]
v_pk_mul_f32 v[66:67], v[66:67], v[130:131]
v_pk_mul_f32 v[70:71], v[70:71], v[134:135]
v_pk_mul_f32 v[82:83], v[82:83], v[146:147]
v_pk_mul_f32 v[86:87], v[86:87], v[150:151]
v_pk_mul_f32 v[64:65], v[64:65], v[242:243] op_sel:[0,1] op_sel_hi:[1,1]
v_pk_mul_f32 v[68:69], v[68:69], v[244:245] op_sel:[0,1] op_sel_hi:[1,1]
v_pk_mul_f32 v[80:81], v[80:81], v[242:243] op_sel:[0,1] op_sel_hi:[1,1]
v_pk_mul_f32 v[84:85], v[84:85], v[244:245] op_sel:[0,1] op_sel_hi:[1,1]
v_pk_mul_f32 v[66:67], v[66:67], v[242:243] op_sel:[0,1] op_sel_hi:[1,1]
v_pk_mul_f32 v[70:71], v[70:71], v[244:245] op_sel:[0,1] op_sel_hi:[1,1]
v_pk_mul_f32 v[82:83], v[82:83], v[242:243] op_sel:[0,1] op_sel_hi:[1,1]
v_pk_mul_f32 v[86:87], v[86:87], v[244:245] op_sel:[0,1] op_sel_hi:[1,1]
v_cvt_pk_bf16_f32 v128, v64, v65
v_cvt_pk_bf16_f32 v132, v68, v69
v_cvt_pk_bf16_f32 v130, v80, v81
v_cvt_pk_bf16_f32 v134, v84, v85
v_cvt_pk_bf16_f32 v129, v66, v67
v_cvt_pk_bf16_f32 v133, v70, v71
v_cvt_pk_bf16_f32 v131, v82, v83
v_cvt_pk_bf16_f32 v135, v86, v87
s_add_u32 s60, s75, 0
buffer_store_dwordx4 v[128:131], v241, s[24:27], s60 offen sc1
s_add_u32 s60, s75, 73728
buffer_store_dwordx4 v[132:135], v241, s[24:27], s60 offen sc1
v_pk_fma_f32 v[72:73], v[36:37], v[246:247], v[72:73] op_sel_hi:[1,0,1]
v_pk_fma_f32 v[76:77], v[36:37], v[248:249], v[76:77] op_sel_hi:[1,0,1]
v_pk_fma_f32 v[88:89], v[44:45], v[246:247], v[88:89] op_sel_hi:[1,0,1]
v_pk_fma_f32 v[92:93], v[44:45], v[248:249], v[92:93] op_sel_hi:[1,0,1]
v_pk_fma_f32 v[74:75], v[38:39], v[246:247], v[74:75] op_sel_hi:[1,0,1]
v_pk_fma_f32 v[78:79], v[38:39], v[248:249], v[78:79] op_sel_hi:[1,0,1]
v_pk_fma_f32 v[90:91], v[46:47], v[246:247], v[90:91] op_sel_hi:[1,0,1]
v_pk_fma_f32 v[94:95], v[46:47], v[248:249], v[94:95] op_sel_hi:[1,0,1]
v_pk_fma_f32 v[136:137], v[40:41], v[246:247], v[136:137] op_sel_hi:[1,0,1]
v_pk_fma_f32 v[140:141], v[40:41], v[248:249], v[140:141] op_sel_hi:[1,0,1]
v_pk_fma_f32 v[152:153], v[48:49], v[246:247], v[152:153] op_sel_hi:[1,0,1]
v_pk_fma_f32 v[156:157], v[48:49], v[248:249], v[156:157] op_sel_hi:[1,0,1]
v_pk_fma_f32 v[138:139], v[42:43], v[246:247], v[138:139] op_sel_hi:[1,0,1]
v_pk_fma_f32 v[142:143], v[42:43], v[248:249], v[142:143] op_sel_hi:[1,0,1]
v_pk_fma_f32 v[154:155], v[50:51], v[246:247], v[154:155] op_sel_hi:[1,0,1]
v_pk_fma_f32 v[158:159], v[50:51], v[248:249], v[158:159] op_sel_hi:[1,0,1]
v_pk_mul_f32 v[72:73], v[72:73], v[136:137]
v_pk_mul_f32 v[76:77], v[76:77], v[140:141]
v_pk_mul_f32 v[88:89], v[88:89], v[152:153]
v_pk_mul_f32 v[92:93], v[92:93], v[156:157]
v_pk_mul_f32 v[74:75], v[74:75], v[138:139]
v_pk_mul_f32 v[78:79], v[78:79], v[142:143]
v_pk_mul_f32 v[90:91], v[90:91], v[154:155]
v_pk_mul_f32 v[94:95], v[94:95], v[158:159]
v_pk_mul_f32 v[72:73], v[72:73], v[246:247] op_sel:[0,1] op_sel_hi:[1,1]
v_pk_mul_f32 v[76:77], v[76:77], v[248:249] op_sel:[0,1] op_sel_hi:[1,1]
v_pk_mul_f32 v[88:89], v[88:89], v[246:247] op_sel:[0,1] op_sel_hi:[1,1]
v_pk_mul_f32 v[92:93], v[92:93], v[248:249] op_sel:[0,1] op_sel_hi:[1,1]
v_pk_mul_f32 v[74:75], v[74:75], v[246:247] op_sel:[0,1] op_sel_hi:[1,1]
v_pk_mul_f32 v[78:79], v[78:79], v[248:249] op_sel:[0,1] op_sel_hi:[1,1]
v_pk_mul_f32 v[90:91], v[90:91], v[246:247] op_sel:[0,1] op_sel_hi:[1,1]
v_pk_mul_f32 v[94:95], v[94:95], v[248:249] op_sel:[0,1] op_sel_hi:[1,1]
v_cvt_pk_bf16_f32 v136, v72, v73
v_cvt_pk_bf16_f32 v140, v76, v77
v_cvt_pk_bf16_f32 v138, v88, v89
v_cvt_pk_bf16_f32 v142, v92, v93
v_cvt_pk_bf16_f32 v137, v74, v75
v_cvt_pk_bf16_f32 v141, v78, v79
v_cvt_pk_bf16_f32 v139, v90, v91
v_cvt_pk_bf16_f32 v143, v94, v95
s_add_u32 s60, s76, 0
buffer_store_dwordx4 v[136:139], v241, s[24:27], s60 offen sc1
s_add_u32 s60, s76, 73728
buffer_store_dwordx4 v[140:143], v241, s[24:27], s60 offen sc1
ds_read_b128 v[36:39], v240 offset:128
ds_read_b128 v[40:43], v240 offset:144
ds_read_b128 v[44:47], v240 offset:160
ds_read_b128 v[48:51], v240 offset:176
s_waitcnt lgkmcnt(4)
v_pk_fma_f32 v[96:97], v[52:53], v[242:243], v[96:97] op_sel_hi:[1,0,1]
v_pk_fma_f32 v[100:101], v[52:53], v[244:245], v[100:101] op_sel_hi:[1,0,1]
v_pk_fma_f32 v[112:113], v[4:5], v[242:243], v[112:113] op_sel_hi:[1,0,1]
v_pk_fma_f32 v[116:117], v[4:5], v[244:245], v[116:117] op_sel_hi:[1,0,1]
v_pk_fma_f32 v[98:99], v[54:55], v[242:243], v[98:99] op_sel_hi:[1,0,1]
v_pk_fma_f32 v[102:103], v[54:55], v[244:245], v[102:103] op_sel_hi:[1,0,1]
v_pk_fma_f32 v[114:115], v[6:7], v[242:243], v[114:115] op_sel_hi:[1,0,1]
v_pk_fma_f32 v[118:119], v[6:7], v[244:245], v[118:119] op_sel_hi:[1,0,1]
v_pk_fma_f32 v[160:161], v[56:57], v[242:243], v[160:161] op_sel_hi:[1,0,1]
v_pk_fma_f32 v[164:165], v[56:57], v[244:245], v[164:165] op_sel_hi:[1,0,1]
v_pk_fma_f32 v[176:177], v[8:9], v[242:243], v[176:177] op_sel_hi:[1,0,1]
v_pk_fma_f32 v[180:181], v[8:9], v[244:245], v[180:181] op_sel_hi:[1,0,1]
v_pk_fma_f32 v[162:163], v[58:59], v[242:243], v[162:163] op_sel_hi:[1,0,1]
v_pk_fma_f32 v[166:167], v[58:59], v[244:245], v[166:167] op_sel_hi:[1,0,1]
v_pk_fma_f32 v[178:179], v[10:11], v[242:243], v[178:179] op_sel_hi:[1,0,1]
v_pk_fma_f32 v[182:183], v[10:11], v[244:245], v[182:183] op_sel_hi:[1,0,1]
v_pk_mul_f32 v[96:97], v[96:97], v[160:161]
v_pk_mul_f32 v[100:101], v[100:101], v[164:165]
v_pk_mul_f32 v[112:113], v[112:113], v[176:177]
v_pk_mul_f32 v[116:117], v[116:117], v[180:181]
v_pk_mul_f32 v[98:99], v[98:99], v[162:163]
v_pk_mul_f32 v[102:103], v[102:103], v[166:167]
v_pk_mul_f32 v[114:115], v[114:115], v[178:179]
v_pk_mul_f32 v[118:119], v[118:119], v[182:183]
v_pk_mul_f32 v[96:97], v[96:97], v[242:243] op_sel:[0,1] op_sel_hi:[1,1]
v_pk_mul_f32 v[100:101], v[100:101], v[244:245] op_sel:[0,1] op_sel_hi:[1,1]
v_pk_mul_f32 v[112:113], v[112:113], v[242:243] op_sel:[0,1] op_sel_hi:[1,1]
v_pk_mul_f32 v[116:117], v[116:117], v[244:245] op_sel:[0,1] op_sel_hi:[1,1]
v_pk_mul_f32 v[98:99], v[98:99], v[242:243] op_sel:[0,1] op_sel_hi:[1,1]
v_pk_mul_f32 v[102:103], v[102:103], v[244:245] op_sel:[0,1] op_sel_hi:[1,1]
v_pk_mul_f32 v[114:115], v[114:115], v[242:243] op_sel:[0,1] op_sel_hi:[1,1]
v_pk_mul_f32 v[118:119], v[118:119], v[244:245] op_sel:[0,1] op_sel_hi:[1,1]
v_cvt_pk_bf16_f32 v160, v96, v97
v_cvt_pk_bf16_f32 v164, v100, v101
v_cvt_pk_bf16_f32 v162, v112, v113
v_cvt_pk_bf16_f32 v166, v116, v117
v_cvt_pk_bf16_f32 v161, v98, v99
v_cvt_pk_bf16_f32 v165, v102, v103
v_cvt_pk_bf16_f32 v163, v114, v115
v_cvt_pk_bf16_f32 v167, v118, v119
s_add_u32 s60, s75, 1024
buffer_store_dwordx4 v[160:163], v241, s[24:27], s60 offen sc1
s_add_u32 s60, s75, 74752
buffer_store_dwordx4 v[164:167], v241, s[24:27], s60 offen sc1
v_pk_fma_f32 v[104:105], v[52:53], v[246:247], v[104:105] op_sel_hi:[1,0,1]
v_pk_fma_f32 v[108:109], v[52:53], v[248:249], v[108:109] op_sel_hi:[1,0,1]
v_pk_fma_f32 v[120:121], v[4:5], v[246:247], v[120:121] op_sel_hi:[1,0,1]
v_pk_fma_f32 v[124:125], v[4:5], v[248:249], v[124:125] op_sel_hi:[1,0,1]
v_pk_fma_f32 v[106:107], v[54:55], v[246:247], v[106:107] op_sel_hi:[1,0,1]
v_pk_fma_f32 v[110:111], v[54:55], v[248:249], v[110:111] op_sel_hi:[1,0,1]
v_pk_fma_f32 v[122:123], v[6:7], v[246:247], v[122:123] op_sel_hi:[1,0,1]
v_pk_fma_f32 v[126:127], v[6:7], v[248:249], v[126:127] op_sel_hi:[1,0,1]
v_pk_fma_f32 v[168:169], v[56:57], v[246:247], v[168:169] op_sel_hi:[1,0,1]
v_pk_fma_f32 v[172:173], v[56:57], v[248:249], v[172:173] op_sel_hi:[1,0,1]
v_pk_fma_f32 v[184:185], v[8:9], v[246:247], v[184:185] op_sel_hi:[1,0,1]
v_pk_fma_f32 v[188:189], v[8:9], v[248:249], v[188:189] op_sel_hi:[1,0,1]
v_pk_fma_f32 v[170:171], v[58:59], v[246:247], v[170:171] op_sel_hi:[1,0,1]
v_pk_fma_f32 v[174:175], v[58:59], v[248:249], v[174:175] op_sel_hi:[1,0,1]
v_pk_fma_f32 v[186:187], v[10:11], v[246:247], v[186:187] op_sel_hi:[1,0,1]
v_pk_fma_f32 v[190:191], v[10:11], v[248:249], v[190:191] op_sel_hi:[1,0,1]
v_pk_mul_f32 v[104:105], v[104:105], v[168:169]
v_pk_mul_f32 v[108:109], v[108:109], v[172:173]
v_pk_mul_f32 v[120:121], v[120:121], v[184:185]
v_pk_mul_f32 v[124:125], v[124:125], v[188:189]
v_pk_mul_f32 v[106:107], v[106:107], v[170:171]
v_pk_mul_f32 v[110:111], v[110:111], v[174:175]
v_pk_mul_f32 v[122:123], v[122:123], v[186:187]
v_pk_mul_f32 v[126:127], v[126:127], v[190:191]
v_pk_mul_f32 v[104:105], v[104:105], v[246:247] op_sel:[0,1] op_sel_hi:[1,1]
v_pk_mul_f32 v[108:109], v[108:109], v[248:249] op_sel:[0,1] op_sel_hi:[1,1]
v_pk_mul_f32 v[120:121], v[120:121], v[246:247] op_sel:[0,1] op_sel_hi:[1,1]
v_pk_mul_f32 v[124:125], v[124:125], v[248:249] op_sel:[0,1] op_sel_hi:[1,1]
v_pk_mul_f32 v[106:107], v[106:107], v[246:247] op_sel:[0,1] op_sel_hi:[1,1]
v_pk_mul_f32 v[110:111], v[110:111], v[248:249] op_sel:[0,1] op_sel_hi:[1,1]
v_pk_mul_f32 v[122:123], v[122:123], v[246:247] op_sel:[0,1] op_sel_hi:[1,1]
v_pk_mul_f32 v[126:127], v[126:127], v[248:249] op_sel:[0,1] op_sel_hi:[1,1]
v_cvt_pk_bf16_f32 v168, v104, v105
v_cvt_pk_bf16_f32 v172, v108, v109
v_cvt_pk_bf16_f32 v170, v120, v121
v_cvt_pk_bf16_f32 v174, v124, v125
v_cvt_pk_bf16_f32 v169, v106, v107
v_cvt_pk_bf16_f32 v173, v110, v111
v_cvt_pk_bf16_f32 v171, v122, v123
v_cvt_pk_bf16_f32 v175, v126, v127
s_add_u32 s60, s76, 1024
buffer_store_dwordx4 v[168:171], v241, s[24:27], s60 offen sc1
s_add_u32 s60, s76, 74752
buffer_store_dwordx4 v[172:175], v241, s[24:27], s60 offen sc1
s_waitcnt lgkmcnt(0)
v_pk_fma_f32 v[192:193], v[36:37], v[242:243], v[192:193] op_sel_hi:[1,0,1]
v_pk_fma_f32 v[196:197], v[36:37], v[244:245], v[196:197] op_sel_hi:[1,0,1]
v_pk_fma_f32 v[200:201], v[44:45], v[242:243], v[200:201] op_sel_hi:[1,0,1]
v_pk_fma_f32 v[204:205], v[44:45], v[244:245], v[204:205] op_sel_hi:[1,0,1]
v_pk_fma_f32 v[194:195], v[38:39], v[242:243], v[194:195] op_sel_hi:[1,0,1]
v_pk_fma_f32 v[198:199], v[38:39], v[244:245], v[198:199] op_sel_hi:[1,0,1]
v_pk_fma_f32 v[202:203], v[46:47], v[242:243], v[202:203] op_sel_hi:[1,0,1]
v_pk_fma_f32 v[206:207], v[46:47], v[244:245], v[206:207] op_sel_hi:[1,0,1]
v_pk_fma_f32 v[208:209], v[40:41], v[242:243], v[208:209] op_sel_hi:[1,0,1]
v_pk_fma_f32 v[212:213], v[40:41], v[244:245], v[212:213] op_sel_hi:[1,0,1]
v_pk_fma_f32 v[216:217], v[48:49], v[242:243], v[216:217] op_sel_hi:[1,0,1]
v_pk_fma_f32 v[220:221], v[48:49], v[244:245], v[220:221] op_sel_hi:[1,0,1]
v_pk_fma_f32 v[210:211], v[42:43], v[242:243], v[210:211] op_sel_hi:[1,0,1]
v_pk_fma_f32 v[214:215], v[42:43], v[244:245], v[214:215] op_sel_hi:[1,0,1]
v_pk_fma_f32 v[218:219], v[50:51], v[242:243], v[218:219] op_sel_hi:[1,0,1]
v_pk_fma_f32 v[222:223], v[50:51], v[244:245], v[222:223] op_sel_hi:[1,0,1]
v_pk_mul_f32 v[192:193], v[192:193], v[208:209]
v_pk_mul_f32 v[196:197], v[196:197], v[212:213]
v_pk_mul_f32 v[200:201], v[200:201], v[216:217]
v_pk_mul_f32 v[204:205], v[204:205], v[220:221]
v_pk_mul_f32 v[194:195], v[194:195], v[210:211]
v_pk_mul_f32 v[198:199], v[198:199], v[214:215]
v_pk_mul_f32 v[202:203], v[202:203], v[218:219]
v_pk_mul_f32 v[206:207], v[206:207], v[222:223]
v_pk_mul_f32 v[192:193], v[192:193], v[242:243] op_sel:[0,1] op_sel_hi:[1,1]
v_pk_mul_f32 v[196:197], v[196:197], v[244:245] op_sel:[0,1] op_sel_hi:[1,1]
v_pk_mul_f32 v[200:201], v[200:201], v[242:243] op_sel:[0,1] op_sel_hi:[1,1]
v_pk_mul_f32 v[204:205], v[204:205], v[244:245] op_sel:[0,1] op_sel_hi:[1,1]
v_pk_mul_f32 v[194:195], v[194:195], v[242:243] op_sel:[0,1] op_sel_hi:[1,1]
v_pk_mul_f32 v[198:199], v[198:199], v[244:245] op_sel:[0,1] op_sel_hi:[1,1]
v_pk_mul_f32 v[202:203], v[202:203], v[242:243] op_sel:[0,1] op_sel_hi:[1,1]
v_pk_mul_f32 v[206:207], v[206:207], v[244:245] op_sel:[0,1] op_sel_hi:[1,1]
v_cvt_pk_bf16_f32 v208, v192, v193
v_cvt_pk_bf16_f32 v212, v196, v197
v_cvt_pk_bf16_f32 v210, v200, v201
v_cvt_pk_bf16_f32 v214, v204, v205
v_cvt_pk_bf16_f32 v209, v194, v195
v_cvt_pk_bf16_f32 v213, v198, v199
v_cvt_pk_bf16_f32 v211, v202, v203
v_cvt_pk_bf16_f32 v215, v206, v207
s_add_u32 s60, s64, 2048
buffer_store_dwordx4 v[208:211], v241, s[24:27], s60 offen sc1
s_add_u32 s60, s64, 75776
buffer_store_dwordx4 v[212:215], v241, s[24:27], s60 offen sc1
s_lshr_b32 s60, s68, 2
s_add_u32 s61, s68, 3
s_lshr_b32 s61, s61, 2
v_mov_b32 v60, s60
v_mov_b32 v61, s61
v_cmp_gt_u32 vcc, 8, v1
s_nop 0
s_nop 0
v_cndmask_b32 v60, v61, v60, vcc
v_and_b32 v61, 3, v1
v_lshlrev_b32 v61, 2, v61
v_lshl_add_u32 v61, v60, 7, v61
v_bfe_u32 v60, v1, 2, 1
v_lshl_add_u32 v11, v60, 6, v61
v_cmp_gt_u32 vcc, 16, v1
v_mov_b32 v61, 2146435072
s_nop 0
v_cndmask_b32 v11, v61, v11, vcc
v_bfe_u32 v60, v1, 1, 2
v_cndmask_b32 v60, 7, v60, vcc
v_cmp_eq_u32 vcc, 1, v60
s_nop 1
v_cndmask_b32_e64 v12, 0, 1, vcc
v_cmp_eq_u32 vcc, 3, v60
s_nop 1
v_cndmask_b32_e64 v13, 0, 1, vcc
v_cmp_eq_u32 vcc, 0, v60
s_nop 1
v_cndmask_b32_e64 v14, 0, 1, vcc
v_cmp_eq_u32 vcc, 2, v60
s_nop 1
v_cndmask_b32_e64 v15, 0, 1, vcc
s_add_u32 s3, s70, 802816
s_add_u32 m0, s74, 20480
s_nop 0
buffer_load_dwordx4 v232, s[36:39], s3 offen lds
buffer_load_dwordx4 v233, s[36:39], s3 offen offset:1024 lds
buffer_load_dwordx4 v234, s[36:39], s3 offen offset:2048 lds
buffer_load_dwordx4 v235, s[36:39], s3 offen offset:3072 lds
s_add_u32 s3, s70, 831488
s_add_u32 m0, s74, 81920
s_nop 0
buffer_load_dwordx4 v232, s[36:39], s3 offen lds
buffer_load_dwordx4 v233, s[36:39], s3 offen offset:1024 lds
buffer_load_dwordx4 v234, s[36:39], s3 offen offset:2048 lds
buffer_load_dwordx4 v235, s[36:39], s3 offen offset:3072 lds
s_waitcnt vmcnt(34)
ds_read_b64_tr_b16 a[0:1], v236 offset:40960
ds_read_b64_tr_b16 a[2:3], v236 offset:43008
ds_read_b64_tr_b16 a[4:5], v237 offset:40960
ds_read_b64_tr_b16 a[6:7], v237 offset:43008
ds_read_b64_tr_b16 a[8:9], v238 offset:40960
ds_read_b64_tr_b16 a[10:11], v238 offset:43008
ds_read_b64_tr_b16 a[12:13], v239 offset:40960
ds_read_b64_tr_b16 a[14:15], v239 offset:43008
s_waitcnt vmcnt(30)
ds_read_b64_tr_b16 a[16:17], v250 offset:34816
ds_read_b64_tr_b16 a[18:19], v250 offset:36864
ds_read_b64_tr_b16 a[20:21], v251 offset:34816
ds_read_b64_tr_b16 a[22:23], v251 offset:36864
ds_read_b64_tr_b16 a[24:25], v252 offset:34816
ds_read_b64_tr_b16 a[26:27], v252 offset:36864
ds_read_b64_tr_b16 a[28:29], v253 offset:34816
ds_read_b64_tr_b16 a[30:31], v253 offset:36864
s_waitcnt lgkmcnt(8)
s_add_u32 s3, s70, 860160
s_add_u32 m0, s74, 40960
s_nop 0
buffer_load_dwordx4 v232, s[36:39], s3 offen lds
buffer_load_dwordx4 v233, s[36:39], s3 offen offset:1024 lds
buffer_load_dwordx4 v234, s[36:39], s3 offen offset:2048 lds
buffer_load_dwordx4 v235, s[36:39], s3 offen offset:3072 lds
s_waitcnt vmcnt(30)
ds_read_b64_tr_b16 a[32:33], v236 offset:61440
ds_read_b64_tr_b16 a[34:35], v236 offset:63488
ds_read_b64_tr_b16 a[36:37], v237 offset:61440
ds_read_b64_tr_b16 a[38:39], v237 offset:63488
ds_read_b64_tr_b16 a[40:41], v238 offset:61440
ds_read_b64_tr_b16 a[42:43], v238 offset:63488
ds_read_b64_tr_b16 a[44:45], v239 offset:61440
ds_read_b64_tr_b16 a[46:47], v239 offset:63488
s_waitcnt lgkmcnt(8)
s_add_u32 s3, s70, 888832
s_add_u32 m0, s74, 100352
s_nop 0
buffer_load_dwordx4 v232, s[36:39], s3 offen lds
buffer_load_dwordx4 v233, s[36:39], s3 offen offset:1024 lds
buffer_load_dwordx4 v234, s[36:39], s3 offen offset:2048 lds
buffer_load_dwordx4 v235, s[36:39], s3 offen offset:3072 lds
s_waitcnt vmcnt(30)
ds_read_b64_tr_b16 a[48:49], v250 offset:53248
ds_read_b64_tr_b16 a[50:51], v250 offset:55296
ds_read_b64_tr_b16 a[52:53], v251 offset:53248
ds_read_b64_tr_b16 a[54:55], v251 offset:55296
ds_read_b64_tr_b16 a[56:57], v252 offset:53248
ds_read_b64_tr_b16 a[58:59], v252 offset:55296
ds_read_b64_tr_b16 a[60:61], v253 offset:53248
ds_read_b64_tr_b16 a[62:63], v253 offset:55296
s_waitcnt lgkmcnt(8)
s_add_u32 s3, s70, 917504
s_add_u32 m0, s74, 61440
s_nop 0
buffer_load_dwordx4 v232, s[36:39], s3 offen lds
buffer_load_dwordx4 v233, s[36:39], s3 offen offset:1024 lds
buffer_load_dwordx4 v234, s[36:39], s3 offen offset:2048 lds
buffer_load_dwordx4 v235, s[36:39], s3 offen offset:3072 lds
s_waitcnt vmcnt(30)
ds_read_b64_tr_b16 a[64:65], v236 offset:0
ds_read_b64_tr_b16 a[66:67], v236 offset:2048
ds_read_b64_tr_b16 a[68:69], v237 offset:0
ds_read_b64_tr_b16 a[70:71], v237 offset:2048
ds_read_b64_tr_b16 a[72:73], v238 offset:0
ds_read_b64_tr_b16 a[74:75], v238 offset:2048
ds_read_b64_tr_b16 a[76:77], v239 offset:0
ds_read_b64_tr_b16 a[78:79], v239 offset:2048
s_waitcnt lgkmcnt(8)
s_add_u32 s3, s71, 0
s_add_u32 m0, s74, 118784
s_nop 0
buffer_load_dwordx4 v232, s[36:39], s3 offen lds
buffer_load_dwordx4 v233, s[36:39], s3 offen offset:1024 lds
buffer_load_dwordx4 v234, s[36:39], s3 offen offset:2048 lds
buffer_load_dwordx4 v235, s[36:39], s3 offen offset:3072 lds
s_waitcnt vmcnt(24)
v_mov_b32 v62, 1
v_mov_b32 v63, 0
buffer_store_dword v62, v63, s[24:27], s77 offen sc1
s_waitcnt vmcnt(21)
ds_read_b64_tr_b16 a[80:81], v236 offset:20480
ds_read_b64_tr_b16 a[82:83], v236 offset:22528
ds_read_b64_tr_b16 a[84:85], v237 offset:20480
ds_read_b64_tr_b16 a[86:87], v237 offset:22528
ds_read_b64_tr_b16 a[88:89], v238 offset:20480
ds_read_b64_tr_b16 a[90:91], v238 offset:22528
ds_read_b64_tr_b16 a[92:93], v239 offset:20480
ds_read_b64_tr_b16 a[94:95], v239 offset:22528
s_waitcnt lgkmcnt(8)
s_add_u32 s3, s71, 28672
s_add_u32 m0, s74, 0
s_nop 0
buffer_load_dwordx4 v232, s[36:39], s3 offen lds
buffer_load_dwordx4 v233, s[36:39], s3 offen offset:1024 lds
buffer_load_dwordx4 v234, s[36:39], s3 offen offset:2048 lds
buffer_load_dwordx4 v235, s[36:39], s3 offen offset:3072 lds
s_waitcnt vmcnt(21)
ds_read_b64_tr_b16 a[96:97], v250 offset:16384
ds_read_b64_tr_b16 a[98:99], v250 offset:18432
ds_read_b64_tr_b16 a[100:101], v251 offset:16384
ds_read_b64_tr_b16 a[102:103], v251 offset:18432
ds_read_b64_tr_b16 a[104:105], v252 offset:16384
ds_read_b64_tr_b16 a[106:107], v252 offset:18432
ds_read_b64_tr_b16 a[108:109], v253 offset:16384
ds_read_b64_tr_b16 a[110:111], v253 offset:18432
s_waitcnt lgkmcnt(8)
s_add_u32 s3, s72, 0
s_add_u32 m0, s74, 20480
s_nop 0
buffer_load_dwordx4 v232, s[32:35], s3 offen lds
buffer_load_dwordx4 v233, s[32:35], s3 offen offset:1024 lds
buffer_load_dwordx4 v234, s[32:35], s3 offen offset:2048 lds
buffer_load_dwordx4 v235, s[32:35], s3 offen offset:3072 lds
s_waitcnt vmcnt(21)
ds_read_b64_tr_b16 a[112:113], v236 offset:40960
ds_read_b64_tr_b16 a[114:115], v236 offset:43008
ds_read_b64_tr_b16 a[116:117], v237 offset:40960
ds_read_b64_tr_b16 a[118:119], v237 offset:43008
ds_read_b64_tr_b16 a[120:121], v238 offset:40960
ds_read_b64_tr_b16 a[122:123], v238 offset:43008
ds_read_b64_tr_b16 a[124:125], v239 offset:40960
ds_read_b64_tr_b16 a[126:127], v239 offset:43008
s_waitcnt lgkmcnt(8)
s_add_u32 s3, s72, 25088
s_add_u32 m0, s74, 81920
s_nop 0
buffer_load_dwordx4 v232, s[32:35], s3 offen lds
buffer_load_dwordx4 v233, s[32:35], s3 offen offset:1024 lds
buffer_load_dwordx4 v234, s[32:35], s3 offen offset:2048 lds
buffer_load_dwordx4 v235, s[32:35], s3 offen offset:3072 lds
s_waitcnt vmcnt(21)
ds_read_b64_tr_b16 a[128:129], v250 offset:34816
ds_read_b64_tr_b16 a[130:131], v250 offset:36864
ds_read_b64_tr_b16 a[132:133], v251 offset:34816
ds_read_b64_tr_b16 a[134:135], v251 offset:36864
ds_read_b64_tr_b16 a[136:137], v252 offset:34816
ds_read_b64_tr_b16 a[138:139], v252 offset:36864
ds_read_b64_tr_b16 a[140:141], v253 offset:34816
ds_read_b64_tr_b16 a[142:143], v253 offset:36864
s_waitcnt lgkmcnt(8)
s_add_u32 s3, s71, 802816
s_add_u32 m0, s74, 40960
s_nop 0
buffer_load_dwordx4 v232, s[36:39], s3 offen lds
buffer_load_dwordx4 v233, s[36:39], s3 offen offset:1024 lds
buffer_load_dwordx4 v234, s[36:39], s3 offen offset:2048 lds
buffer_load_dwordx4 v235, s[36:39], s3 offen offset:3072 lds
s_waitcnt vmcnt(21)
ds_read_b64_tr_b16 a[144:145], v236 offset:61440
ds_read_b64_tr_b16 a[146:147], v236 offset:63488
ds_read_b64_tr_b16 a[148:149], v237 offset:61440
ds_read_b64_tr_b16 a[150:151], v237 offset:63488
ds_read_b64_tr_b16 a[152:153], v238 offset:61440
ds_read_b64_tr_b16 a[154:155], v238 offset:63488
ds_read_b64_tr_b16 a[156:157], v239 offset:61440
ds_read_b64_tr_b16 a[158:159], v239 offset:63488
s_waitcnt lgkmcnt(8)
s_add_u32 s3, s71, 831488
s_add_u32 m0, s74, 100352
s_nop 0
buffer_load_dwordx4 v232, s[36:39], s3 offen lds
buffer_load_dwordx4 v233, s[36:39], s3 offen offset:1024 lds
buffer_load_dwordx4 v234, s[36:39], s3 offen offset:2048 lds
buffer_load_dwordx4 v235, s[36:39], s3 offen offset:3072 lds
s_waitcnt vmcnt(21)
ds_read_b64_tr_b16 a[160:161], v250 offset:53248
ds_read_b64_tr_b16 a[162:163], v250 offset:55296
ds_read_b64_tr_b16 a[164:165], v251 offset:53248
ds_read_b64_tr_b16 a[166:167], v251 offset:55296
ds_read_b64_tr_b16 a[168:169], v252 offset:53248
ds_read_b64_tr_b16 a[170:171], v252 offset:55296
ds_read_b64_tr_b16 a[172:173], v253 offset:53248
ds_read_b64_tr_b16 a[174:175], v253 offset:55296
s_waitcnt lgkmcnt(8)
s_add_u32 s3, s72, 200704
s_add_u32 m0, s74, 61440
s_nop 0
buffer_load_dwordx4 v232, s[32:35], s3 offen lds
buffer_load_dwordx4 v233, s[32:35], s3 offen offset:1024 lds
buffer_load_dwordx4 v234, s[32:35], s3 offen offset:2048 lds
buffer_load_dwordx4 v235, s[32:35], s3 offen offset:3072 lds
s_waitcnt vmcnt(20)
ds_read_b64_tr_b16 a[176:177], v236 offset:0
ds_read_b64_tr_b16 a[178:179], v236 offset:2048
ds_read_b64_tr_b16 a[180:181], v237 offset:0
ds_read_b64_tr_b16 a[182:183], v237 offset:2048
ds_read_b64_tr_b16 a[184:185], v238 offset:0
buffer_load_dword v10, v11, s[24:27], s79 offen sc1
ds_read_b64_tr_b16 a[186:187], v238 offset:2048
ds_read_b64_tr_b16 a[188:189], v239 offset:0
ds_read_b64_tr_b16 a[190:191], v239 offset:2048
s_waitcnt lgkmcnt(8)
s_add_u32 s3, s72, 225792
s_add_u32 m0, s74, 118784
s_nop 0
buffer_load_dwordx4 v232, s[32:35], s3 offen lds
buffer_load_dwordx4 v233, s[32:35], s3 offen offset:1024 lds
buffer_load_dwordx4 v234, s[32:35], s3 offen offset:2048 lds
buffer_load_dwordx4 v235, s[32:35], s3 offen offset:3072 lds
s_waitcnt vmcnt(4)
v_cmp_lt_u32 vcc, v10, v12
s_nop 0
s_cmp_eq_u64 vcc, 0
s_cbranch_scc0 L_flg_slow_58
L_flg_back_59:
s_add_u32 s60, s73, 4096
buffer_load_dwordx4 v[128:131], v241, s[24:27], s60 offen sc1
s_add_u32 s60, s73, 77824
buffer_load_dwordx4 v[132:135], v241, s[24:27], s60 offen sc1
s_add_u32 s60, s73, 151552
buffer_load_dwordx4 v[136:139], v241, s[24:27], s60 offen sc1
s_add_u32 s60, s73, 225280
buffer_load_dwordx4 v[140:143], v241, s[24:27], s60 offen sc1
s_add_u32 s60, s73, 5120
buffer_load_dwordx4 v[144:147], v241, s[24:27], s60 offen sc1
s_add_u32 s60, s73, 78848
buffer_load_dwordx4 v[148:151], v241, s[24:27], s60 offen sc1
s_add_u32 s60, s73, 152576
buffer_load_dwordx4 v[152:155], v241, s[24:27], s60 offen sc1
s_add_u32 s60, s73, 226304
buffer_load_dwordx4 v[156:159], v241, s[24:27], s60 offen sc1
s_add_u32 s60, s73, 6144
buffer_load_dwordx4 v[160:163], v241, s[24:27], s60 offen sc1
s_add_u32 s60, s73, 79872
buffer_load_dwordx4 v[164:167], v241, s[24:27], s60 offen sc1
s_add_u32 s60, s73, 153600
buffer_load_dwordx4 v[168:171], v241, s[24:27], s60 offen sc1
buffer_load_dword v10, v11, s[24:27], s79 offen sc1
s_add_u32 s60, s73, 227328
buffer_load_dwordx4 v[172:175], v241, s[24:27], s60 offen sc1
s_add_u32 s60, s73, 7168
buffer_load_dwordx4 v[176:179], v241, s[24:27], s60 offen sc1
s_add_u32 s60, s73, 80896
buffer_load_dwordx4 v[180:183], v241, s[24:27], s60 offen sc1
s_add_u32 s60, s73, 154624
buffer_load_dwordx4 v[184:187], v241, s[24:27], s60 offen sc1
s_add_u32 s60, s73, 228352
buffer_load_dwordx4 v[188:191], v241, s[24:27], s60 offen sc1
ds_read_b64_tr_b16 a[192:193], v236 offset:20480
ds_read_b64_tr_b16 a[194:195], v236 offset:22528
ds_read_b64_tr_b16 a[196:197], v237 offset:20480
ds_read_b64_tr_b16 a[198:199], v237 offset:22528
ds_read_b64_tr_b16 a[200:201], v238 offset:20480
ds_read_b64_tr_b16 a[202:203], v238 offset:22528
ds_read_b64_tr_b16 a[204:205], v239 offset:20480
ds_read_b64_tr_b16 a[206:207], v239 offset:22528
ds_read_b64_tr_b16 a[208:209], v250 offset:16384
ds_read_b64_tr_b16 a[210:211], v250 offset:18432
ds_read_b64_tr_b16 a[212:213], v251 offset:16384
ds_read_b64_tr_b16 a[214:215], v251 offset:18432
ds_read_b64_tr_b16 a[216:217], v252 offset:16384
ds_read_b64_tr_b16 a[218:219], v252 offset:18432
ds_read_b64_tr_b16 a[220:221], v253 offset:16384
ds_read_b64_tr_b16 a[222:223], v253 offset:18432
ds_read_b64_tr_b16 a[224:225], v236 offset:40960
ds_read_b64_tr_b16 a[226:227], v236 offset:43008
ds_read_b64_tr_b16 a[228:229], v237 offset:40960
ds_read_b64_tr_b16 a[230:231], v237 offset:43008
ds_read_b64_tr_b16 a[232:233], v238 offset:40960
ds_read_b64_tr_b16 a[234:235], v238 offset:43008
ds_read_b64_tr_b16 a[236:237], v239 offset:40960
ds_read_b64_tr_b16 a[238:239], v239 offset:43008
ds_read_b64_tr_b16 a[240:241], v250 offset:34816
ds_read_b64_tr_b16 a[242:243], v250 offset:36864
ds_read_b64_tr_b16 a[244:245], v251 offset:34816
ds_read_b64_tr_b16 a[246:247], v251 offset:36864
ds_read_b64_tr_b16 a[248:249], v252 offset:34816
ds_read_b64_tr_b16 a[250:251], v252 offset:36864
ds_read_b64_tr_b16 a[252:253], v253 offset:34816
ds_read_b64_tr_b16 a[254:255], v253 offset:36864
ds_read_b64_tr_b16 v[192:193], v236 offset:61440
ds_read_b64_tr_b16 v[194:195], v236 offset:63488
ds_read_b64_tr_b16 v[196:197], v237 offset:61440
ds_read_b64_tr_b16 v[198:199], v237 offset:63488
ds_read_b64_tr_b16 v[200:201], v238 offset:61440
ds_read_b64_tr_b16 v[202:203], v238 offset:63488
ds_read_b64_tr_b16 v[204:205], v239 offset:61440
ds_read_b64_tr_b16 v[206:207], v239 offset:63488
s_waitcnt vmcnt(17)
ds_read_b64_tr_b16 v[208:209], v250 offset:53248
ds_read_b64_tr_b16 v[210:211], v250 offset:55296
ds_read_b64_tr_b16 v[212:213], v251 offset:53248
ds_read_b64_tr_b16 v[214:215], v251 offset:55296
ds_read_b64_tr_b16 v[216:217], v252 offset:53248
ds_read_b64_tr_b16 v[218:219], v252 offset:55296
ds_read_b64_tr_b16 v[220:221], v253 offset:53248
ds_read_b64_tr_b16 v[222:223], v253 offset:55296
v_and_b32 v34, 15, v1
v_mul_u32_u24 v35, 0x110, v34
v_lshrrev_b32 v36, 4, v1
v_lshl_add_u32 v35, v36, 4, v35
s_mul_i32 s61, s46, 17408
v_add_u32 v38, s61, v35
s_mul_i32 s61, s46, 4352
v_add_u32 v39, s61, v35
s_add_u32 s61, s68, s46
s_lshl_b32 s61, s61, 4
v_add_u32 v34, s61, v34
v_mul_u32_u24 v34, 0x380, v34
v_and_b32 v37, 1, v36
v_lshlrev_b32 v37, 1, v37
v_lshrrev_b32 v36, 1, v36
v_or_b32 v36, v36, v37
v_lshl_add_u32 v34, v36, 4, v34
s_lshl_b32 s61, s69, 7
v_add_u32 v40, s61, v34
s_waitcnt vmcnt(16)
v_mfma_f32_16x16x32_bf16 v[64:67], a[0:3], v[128:131], 0
v_mfma_f32_16x16x32_bf16 v[80:83], a[4:7], v[128:131], 0
v_mfma_f32_16x16x32_bf16 v[96:99], a[8:11], v[128:131], 0
v_mfma_f32_16x16x32_bf16 v[112:115], a[12:15], v[128:131], 0
s_add_u32 s60, s73, 8192
buffer_load_dwordx4 v[128:131], v241, s[24:27], s60 offen sc1
s_waitcnt vmcnt(16)
v_mfma_f32_16x16x32_bf16 v[68:71], a[0:3], v[132:135], 0
v_mfma_f32_16x16x32_bf16 v[84:87], a[4:7], v[132:135], 0
v_mfma_f32_16x16x32_bf16 v[100:103], a[8:11], v[132:135], 0
v_mfma_f32_16x16x32_bf16 v[116:119], a[12:15], v[132:135], 0
s_add_u32 s60, s73, 81920
buffer_load_dwordx4 v[132:135], v241, s[24:27], s60 offen sc1
s_waitcnt vmcnt(16)
v_mfma_f32_16x16x32_bf16 v[72:75], a[0:3], v[136:139], 0
v_mfma_f32_16x16x32_bf16 v[88:91], a[4:7], v[136:139], 0
v_mfma_f32_16x16x32_bf16 v[104:107], a[8:11], v[136:139], 0
v_mfma_f32_16x16x32_bf16 v[120:123], a[12:15], v[136:139], 0
s_add_u32 s60, s73, 155648
buffer_load_dwordx4 v[136:139], v241, s[24:27], s60 offen sc1
s_waitcnt vmcnt(16)
v_mfma_f32_16x16x32_bf16 v[76:79], a[0:3], v[140:143], 0
v_mfma_f32_16x16x32_bf16 v[92:95], a[4:7], v[140:143], 0
v_mfma_f32_16x16x32_bf16 v[108:111], a[8:11], v[140:143], 0
v_mfma_f32_16x16x32_bf16 v[124:127], a[12:15], v[140:143], 0
s_add_u32 s60, s73, 229376
buffer_load_dwordx4 v[140:143], v241, s[24:27], s60 offen sc1
s_waitcnt vmcnt(16)
v_mfma_f32_16x16x32_bf16 v[64:67], a[16:19], v[144:147], v[64:67]
v_mfma_f32_16x16x32_bf16 v[80:83], a[20:23], v[144:147], v[80:83]
v_mfma_f32_16x16x32_bf16 v[96:99], a[24:27], v[144:147], v[96:99]
v_mfma_f32_16x16x32_bf16 v[112:115], a[28:31], v[144:147], v[112:115]
s_waitcnt vmcnt(9)
v_cmp_lt_u32 vcc, v10, v13
s_nop 0
s_cmp_eq_u64 vcc, 0
s_cbranch_scc0 L_flg_slow_61
L_flg_back_62:
s_add_u32 s60, s73, 40960
buffer_load_dwordx4 v[144:147], v241, s[24:27], s60 offen sc1
v_mfma_f32_16x16x32_bf16 v[68:71], a[16:19], v[148:151], v[68:71]
v_mfma_f32_16x16x32_bf16 v[84:87], a[20:23], v[148:151], v[84:87]
v_mfma_f32_16x16x32_bf16 v[100:103], a[24:27], v[148:151], v[100:103]
v_mfma_f32_16x16x32_bf16 v[116:119], a[28:31], v[148:151], v[116:119]
s_add_u32 s60, s73, 114688
buffer_load_dwordx4 v[148:151], v241, s[24:27], s60 offen sc1
v_mfma_f32_16x16x32_bf16 v[72:75], a[16:19], v[152:155], v[72:75]
v_mfma_f32_16x16x32_bf16 v[88:91], a[20:23], v[152:155], v[88:91]
v_mfma_f32_16x16x32_bf16 v[104:107], a[24:27], v[152:155], v[104:107]
v_mfma_f32_16x16x32_bf16 v[120:123], a[28:31], v[152:155], v[120:123]
s_add_u32 s60, s73, 188416
buffer_load_dwordx4 v[152:155], v241, s[24:27], s60 offen sc1
v_mfma_f32_16x16x32_bf16 v[76:79], a[16:19], v[156:159], v[76:79]
v_mfma_f32_16x16x32_bf16 v[92:95], a[20:23], v[156:159], v[92:95]
v_mfma_f32_16x16x32_bf16 v[108:111], a[24:27], v[156:159], v[108:111]
v_mfma_f32_16x16x32_bf16 v[124:127], a[28:31], v[156:159], v[124:127]
s_add_u32 s60, s73, 262144
buffer_load_dwordx4 v[156:159], v241, s[24:27], s60 offen sc1
v_mfma_f32_16x16x32_bf16 v[64:67], a[32:35], v[160:163], v[64:67]
v_mfma_f32_16x16x32_bf16 v[80:83], a[36:39], v[160:163], v[80:83]
v_mfma_f32_16x16x32_bf16 v[96:99], a[40:43], v[160:163], v[96:99]
v_mfma_f32_16x16x32_bf16 v[112:115], a[44:47], v[160:163], v[112:115]
s_add_u32 s60, s73, 41984
buffer_load_dwordx4 v[160:163], v241, s[24:27], s60 offen sc1
v_mfma_f32_16x16x32_bf16 v[68:71], a[32:35], v[164:167], v[68:71]
v_mfma_f32_16x16x32_bf16 v[84:87], a[36:39], v[164:167], v[84:87]
v_mfma_f32_16x16x32_bf16 v[100:103], a[40:43], v[164:167], v[100:103]
v_mfma_f32_16x16x32_bf16 v[116:119], a[44:47], v[164:167], v[116:119]
s_add_u32 s60, s73, 115712
buffer_load_dwordx4 v[164:167], v241, s[24:27], s60 offen sc1
v_mfma_f32_16x16x32_bf16 v[72:75], a[32:35], v[168:171], v[72:75]
v_mfma_f32_16x16x32_bf16 v[88:91], a[36:39], v[168:171], v[88:91]
v_mfma_f32_16x16x32_bf16 v[104:107], a[40:43], v[168:171], v[104:107]
v_mfma_f32_16x16x32_bf16 v[120:123], a[44:47], v[168:171], v[120:123]
s_add_u32 s60, s73, 189440
buffer_load_dwordx4 v[168:171], v241, s[24:27], s60 offen sc1
s_waitcnt vmcnt(15)
v_mfma_f32_16x16x32_bf16 v[76:79], a[32:35], v[172:175], v[76:79]
v_mfma_f32_16x16x32_bf16 v[92:95], a[36:39], v[172:175], v[92:95]
v_mfma_f32_16x16x32_bf16 v[108:111], a[40:43], v[172:175], v[108:111]
v_mfma_f32_16x16x32_bf16 v[124:127], a[44:47], v[172:175], v[124:127]
s_add_u32 s60, s73, 263168
buffer_load_dwordx4 v[172:175], v241, s[24:27], s60 offen sc1
s_waitcnt vmcnt(15)
v_mfma_f32_16x16x32_bf16 v[64:67], a[48:51], v[176:179], v[64:67]
v_mfma_f32_16x16x32_bf16 v[80:83], a[52:55], v[176:179], v[80:83]
v_mfma_f32_16x16x32_bf16 v[96:99], a[56:59], v[176:179], v[96:99]
v_mfma_f32_16x16x32_bf16 v[112:115], a[60:63], v[176:179], v[112:115]
s_add_u32 s60, s73, 43008
buffer_load_dwordx4 v[176:179], v241, s[24:27], s60 offen sc1
s_waitcnt vmcnt(15)
v_mfma_f32_16x16x32_bf16 v[68:71], a[48:51], v[180:183], v[68:71]
v_mfma_f32_16x16x32_bf16 v[84:87], a[52:55], v[180:183], v[84:87]
v_mfma_f32_16x16x32_bf16 v[100:103], a[56:59], v[180:183], v[100:103]
v_mfma_f32_16x16x32_bf16 v[116:119], a[60:63], v[180:183], v[116:119]
s_add_u32 s60, s73, 116736
buffer_load_dwordx4 v[180:183], v241, s[24:27], s60 offen sc1
s_waitcnt vmcnt(15)
v_mfma_f32_16x16x32_bf16 v[72:75], a[48:51], v[184:187], v[72:75]
v_mfma_f32_16x16x32_bf16 v[88:91], a[52:55], v[184:187], v[88:91]
v_mfma_f32_16x16x32_bf16 v[104:107], a[56:59], v[184:187], v[104:107]
v_mfma_f32_16x16x32_bf16 v[120:123], a[60:63], v[184:187], v[120:123]
s_add_u32 s60, s73, 190464
buffer_load_dwordx4 v[184:187], v241, s[24:27], s60 offen sc1
buffer_load_dword v10, v11, s[24:27], s79 offen sc1
s_waitcnt vmcnt(16)
v_mfma_f32_16x16x32_bf16 v[76:79], a[48:51], v[188:191], v[76:79]
v_mfma_f32_16x16x32_bf16 v[92:95], a[52:55], v[188:191], v[92:95]
v_mfma_f32_16x16x32_bf16 v[108:111], a[56:59], v[188:191], v[108:111]
v_mfma_f32_16x16x32_bf16 v[124:127], a[60:63], v[188:191], v[124:127]
s_add_u32 s60, s73, 264192
buffer_load_dwordx4 v[188:191], v241, s[24:27], s60 offen sc1
s_waitcnt vmcnt(16)
v_mfma_f32_16x16x32_bf16 v[64:67], a[64:67], v[128:131], v[64:67]
v_mfma_f32_16x16x32_bf16 v[80:83], a[68:71], v[128:131], v[80:83]
v_mfma_f32_16x16x32_bf16 v[96:99], a[72:75], v[128:131], v[96:99]
v_mfma_f32_16x16x32_bf16 v[112:115], a[76:79], v[128:131], v[112:115]
s_add_u32 s60, s73, 44032
buffer_load_dwordx4 v[128:131], v241, s[24:27], s60 offen sc1
s_waitcnt vmcnt(16)
v_mfma_f32_16x16x32_bf16 v[68:71], a[64:67], v[132:135], v[68:71]
v_mfma_f32_16x16x32_bf16 v[84:87], a[68:71], v[132:135], v[84:87]
v_mfma_f32_16x16x32_bf16 v[100:103], a[72:75], v[132:135], v[100:103]
v_mfma_f32_16x16x32_bf16 v[116:119], a[76:79], v[132:135], v[116:119]
s_add_u32 s60, s73, 117760
buffer_load_dwordx4 v[132:135], v241, s[24:27], s60 offen sc1
s_waitcnt vmcnt(16)
v_mfma_f32_16x16x32_bf16 v[72:75], a[64:67], v[136:139], v[72:75]
v_mfma_f32_16x16x32_bf16 v[88:91], a[68:71], v[136:139], v[88:91]
v_mfma_f32_16x16x32_bf16 v[104:107], a[72:75], v[136:139], v[104:107]
v_mfma_f32_16x16x32_bf16 v[120:123], a[76:79], v[136:139], v[120:123]
s_add_u32 s60, s73, 191488
buffer_load_dwordx4 v[136:139], v241, s[24:27], s60 offen sc1
s_waitcnt vmcnt(16)
v_mfma_f32_16x16x32_bf16 v[76:79], a[64:67], v[140:143], v[76:79]
v_mfma_f32_16x16x32_bf16 v[92:95], a[68:71], v[140:143], v[92:95]
v_mfma_f32_16x16x32_bf16 v[108:111], a[72:75], v[140:143], v[108:111]
v_mfma_f32_16x16x32_bf16 v[124:127], a[76:79], v[140:143], v[124:127]
s_add_u32 s60, s73, 265216
buffer_load_dwordx4 v[140:143], v241, s[24:27], s60 offen sc1
s_waitcnt vmcnt(16)
v_mfma_f32_16x16x32_bf16 v[64:67], a[80:83], v[144:147], v[64:67]
v_mfma_f32_16x16x32_bf16 v[80:83], a[84:87], v[144:147], v[80:83]
v_mfma_f32_16x16x32_bf16 v[96:99], a[88:91], v[144:147], v[96:99]
v_mfma_f32_16x16x32_bf16 v[112:115], a[92:95], v[144:147], v[112:115]
s_add_u32 s60, s73, 45056
buffer_load_dwordx4 v[144:147], v241, s[24:27], s60 offen sc1
s_waitcnt vmcnt(16)
v_mfma_f32_16x16x32_bf16 v[68:71], a[80:83], v[148:151], v[68:71]
v_mfma_f32_16x16x32_bf16 v[84:87], a[84:87], v[148:151], v[84:87]
v_mfma_f32_16x16x32_bf16 v[100:103], a[88:91], v[148:151], v[100:103]
v_mfma_f32_16x16x32_bf16 v[116:119], a[92:95], v[148:151], v[116:119]
s_add_u32 s60, s73, 118784
buffer_load_dwordx4 v[148:151], v241, s[24:27], s60 offen sc1
s_waitcnt vmcnt(16)
v_mfma_f32_16x16x32_bf16 v[72:75], a[80:83], v[152:155], v[72:75]
v_mfma_f32_16x16x32_bf16 v[88:91], a[84:87], v[152:155], v[88:91]
v_mfma_f32_16x16x32_bf16 v[104:107], a[88:91], v[152:155], v[104:107]
v_mfma_f32_16x16x32_bf16 v[120:123], a[92:95], v[152:155], v[120:123]
s_add_u32 s60, s73, 192512
buffer_load_dwordx4 v[152:155], v241, s[24:27], s60 offen sc1
s_waitcnt vmcnt(16)
v_mfma_f32_16x16x32_bf16 v[76:79], a[80:83], v[156:159], v[76:79]
v_mfma_f32_16x16x32_bf16 v[92:95], a[84:87], v[156:159], v[92:95]
v_mfma_f32_16x16x32_bf16 v[108:111], a[88:91], v[156:159], v[108:111]
v_mfma_f32_16x16x32_bf16 v[124:127], a[92:95], v[156:159], v[124:127]
s_add_u32 s60, s73, 266240
buffer_load_dwordx4 v[156:159], v241, s[24:27], s60 offen sc1
s_waitcnt vmcnt(16)
v_mfma_f32_16x16x32_bf16 v[64:67], a[96:99], v[160:163], v[64:67]
v_mfma_f32_16x16x32_bf16 v[80:83], a[100:103], v[160:163], v[80:83]
v_mfma_f32_16x16x32_bf16 v[96:99], a[104:107], v[160:163], v[96:99]
v_mfma_f32_16x16x32_bf16 v[112:115], a[108:111], v[160:163], v[112:115]
s_waitcnt vmcnt(9)
v_cmp_lt_u32 vcc, v10, v14
s_nop 0
s_cmp_eq_u64 vcc, 0
s_cbranch_scc0 L_flg_slow_64
L_flg_back_65:
s_add_u32 s60, s73, 1024
buffer_load_dwordx4 v[160:163], v241, s[24:27], s60 offen sc1
v_mfma_f32_16x16x32_bf16 v[68:71], a[96:99], v[164:167], v[68:71]
v_mfma_f32_16x16x32_bf16 v[84:87], a[100:103], v[164:167], v[84:87]
v_mfma_f32_16x16x32_bf16 v[100:103], a[104:107], v[164:167], v[100:103]
v_mfma_f32_16x16x32_bf16 v[116:119], a[108:111], v[164:167], v[116:119]
s_add_u32 s60, s73, 74752
buffer_load_dwordx4 v[164:167], v241, s[24:27], s60 offen sc1
v_mfma_f32_16x16x32_bf16 v[72:75], a[96:99], v[168:171], v[72:75]
v_mfma_f32_16x16x32_bf16 v[88:91], a[100:103], v[168:171], v[88:91]
v_mfma_f32_16x16x32_bf16 v[104:107], a[104:107], v[168:171], v[104:107]
v_mfma_f32_16x16x32_bf16 v[120:123], a[108:111], v[168:171], v[120:123]
s_add_u32 s60, s73, 148480
buffer_load_dwordx4 v[168:171], v241, s[24:27], s60 offen sc1
v_mfma_f32_16x16x32_bf16 v[76:79], a[96:99], v[172:175], v[76:79]
v_mfma_f32_16x16x32_bf16 v[92:95], a[100:103], v[172:175], v[92:95]
v_mfma_f32_16x16x32_bf16 v[108:111], a[104:107], v[172:175], v[108:111]
v_mfma_f32_16x16x32_bf16 v[124:127], a[108:111], v[172:175], v[124:127]
s_add_u32 s60, s73, 222208
buffer_load_dwordx4 v[172:175], v241, s[24:27], s60 offen sc1
v_mfma_f32_16x16x32_bf16 v[64:67], a[112:115], v[176:179], v[64:67]
v_mfma_f32_16x16x32_bf16 v[80:83], a[116:119], v[176:179], v[80:83]
v_mfma_f32_16x16x32_bf16 v[96:99], a[120:123], v[176:179], v[96:99]
v_mfma_f32_16x16x32_bf16 v[112:115], a[124:127], v[176:179], v[112:115]
s_add_u32 s60, s73, 3072
buffer_load_dwordx4 v[176:179], v241, s[24:27], s60 offen sc1
v_mfma_f32_16x16x32_bf16 v[68:71], a[112:115], v[180:183], v[68:71]
v_mfma_f32_16x16x32_bf16 v[84:87], a[116:119], v[180:183], v[84:87]
v_mfma_f32_16x16x32_bf16 v[100:103], a[120:123], v[180:183], v[100:103]
v_mfma_f32_16x16x32_bf16 v[116:119], a[124:127], v[180:183], v[116:119]
s_add_u32 s60, s73, 76800
buffer_load_dwordx4 v[180:183], v241, s[24:27], s60 offen sc1
v_mfma_f32_16x16x32_bf16 v[72:75], a[112:115], v[184:187], v[72:75]
v_mfma_f32_16x16x32_bf16 v[88:91], a[116:119], v[184:187], v[88:91]
v_mfma_f32_16x16x32_bf16 v[104:107], a[120:123], v[184:187], v[104:107]
v_mfma_f32_16x16x32_bf16 v[120:123], a[124:127], v[184:187], v[120:123]
s_add_u32 s60, s73, 150528
buffer_load_dwordx4 v[184:187], v241, s[24:27], s60 offen sc1
buffer_load_dword v10, v11, s[24:27], s79 offen sc1
s_waitcnt vmcnt(16)
v_mfma_f32_16x16x32_bf16 v[76:79], a[112:115], v[188:191], v[76:79]
v_mfma_f32_16x16x32_bf16 v[92:95], a[116:119], v[188:191], v[92:95]
v_mfma_f32_16x16x32_bf16 v[108:111], a[120:123], v[188:191], v[108:111]
v_mfma_f32_16x16x32_bf16 v[124:127], a[124:127], v[188:191], v[124:127]
s_add_u32 s60, s73, 224256
buffer_load_dwordx4 v[188:191], v241, s[24:27], s60 offen sc1
s_waitcnt vmcnt(16)
v_mfma_f32_16x16x32_bf16 v[64:67], a[128:131], v[128:131], v[64:67]
v_mfma_f32_16x16x32_bf16 v[80:83], a[132:135], v[128:131], v[80:83]
v_mfma_f32_16x16x32_bf16 v[96:99], a[136:139], v[128:131], v[96:99]
v_mfma_f32_16x16x32_bf16 v[112:115], a[140:143], v[128:131], v[112:115]
s_add_u32 s60, s73, 0
buffer_load_dwordx4 v[128:131], v241, s[24:27], s60 offen sc1
s_waitcnt vmcnt(16)
v_mfma_f32_16x16x32_bf16 v[68:71], a[128:131], v[132:135], v[68:71]
v_mfma_f32_16x16x32_bf16 v[84:87], a[132:135], v[132:135], v[84:87]
v_mfma_f32_16x16x32_bf16 v[100:103], a[136:139], v[132:135], v[100:103]
v_mfma_f32_16x16x32_bf16 v[116:119], a[140:143], v[132:135], v[116:119]
s_add_u32 s60, s73, 73728
buffer_load_dwordx4 v[132:135], v241, s[24:27], s60 offen sc1
s_waitcnt vmcnt(16)
v_mfma_f32_16x16x32_bf16 v[72:75], a[128:131], v[136:139], v[72:75]
v_mfma_f32_16x16x32_bf16 v[88:91], a[132:135], v[136:139], v[88:91]
v_mfma_f32_16x16x32_bf16 v[104:107], a[136:139], v[136:139], v[104:107]
v_mfma_f32_16x16x32_bf16 v[120:123], a[140:143], v[136:139], v[120:123]
s_add_u32 s60, s73, 147456
buffer_load_dwordx4 v[136:139], v241, s[24:27], s60 offen sc1
s_waitcnt vmcnt(16)
v_mfma_f32_16x16x32_bf16 v[76:79], a[128:131], v[140:143], v[76:79]
v_mfma_f32_16x16x32_bf16 v[92:95], a[132:135], v[140:143], v[92:95]
v_mfma_f32_16x16x32_bf16 v[108:111], a[136:139], v[140:143], v[108:111]
v_mfma_f32_16x16x32_bf16 v[124:127], a[140:143], v[140:143], v[124:127]
s_add_u32 s60, s73, 221184
buffer_load_dwordx4 v[140:143], v241, s[24:27], s60 offen sc1
s_waitcnt vmcnt(16)
v_mfma_f32_16x16x32_bf16 v[64:67], a[144:147], v[144:147], v[64:67]
v_mfma_f32_16x16x32_bf16 v[80:83], a[148:151], v[144:147], v[80:83]
v_mfma_f32_16x16x32_bf16 v[96:99], a[152:155], v[144:147], v[96:99]
v_mfma_f32_16x16x32_bf16 v[112:115], a[156:159], v[144:147], v[112:115]
s_add_u32 s60, s73, 2048
buffer_load_dwordx4 v[144:147], v241, s[24:27], s60 offen sc1
s_waitcnt vmcnt(16)
v_mfma_f32_16x16x32_bf16 v[68:71], a[144:147], v[148:151], v[68:71]
v_mfma_f32_16x16x32_bf16 v[84:87], a[148:151], v[148:151], v[84:87]
v_mfma_f32_16x16x32_bf16 v[100:103], a[152:155], v[148:151], v[100:103]
v_mfma_f32_16x16x32_bf16 v[116:119], a[156:159], v[148:151], v[116:119]
s_add_u32 s60, s73, 75776
buffer_load_dwordx4 v[148:151], v241, s[24:27], s60 offen sc1
s_waitcnt vmcnt(16)
v_mfma_f32_16x16x32_bf16 v[72:75], a[144:147], v[152:155], v[72:75]
v_mfma_f32_16x16x32_bf16 v[88:91], a[148:151], v[152:155], v[88:91]
v_mfma_f32_16x16x32_bf16 v[104:107], a[152:155], v[152:155], v[104:107]
v_mfma_f32_16x16x32_bf16 v[120:123], a[156:159], v[152:155], v[120:123]
s_add_u32 s60, s73, 149504
buffer_load_dwordx4 v[152:155], v241, s[24:27], s60 offen sc1
s_waitcnt vmcnt(16)
v_mfma_f32_16x16x32_bf16 v[76:79], a[144:147], v[156:159], v[76:79]
v_mfma_f32_16x16x32_bf16 v[92:95], a[148:151], v[156:159], v[92:95]
v_mfma_f32_16x16x32_bf16 v[108:111], a[152:155], v[156:159], v[108:111]
v_mfma_f32_16x16x32_bf16 v[124:127], a[156:159], v[156:159], v[124:127]
s_add_u32 s60, s73, 223232
buffer_load_dwordx4 v[156:159], v241, s[24:27], s60 offen sc1
s_waitcnt vmcnt(16)
v_mfma_f32_16x16x32_bf16 v[64:67], a[160:163], v[160:163], v[64:67]
v_mfma_f32_16x16x32_bf16 v[80:83], a[164:167], v[160:163], v[80:83]
v_mfma_f32_16x16x32_bf16 v[96:99], a[168:171], v[160:163], v[96:99]
v_mfma_f32_16x16x32_bf16 v[112:115], a[172:175], v[160:163], v[112:115]
s_waitcnt vmcnt(9)
v_cmp_lt_u32 vcc, v10, v15
s_nop 0
s_cmp_eq_u64 vcc, 0
s_cbranch_scc0 L_flg_slow_67
L_flg_back_68:
s_add_u32 s60, s73, 37888
buffer_load_dwordx4 v[160:163], v241, s[24:27], s60 offen sc1
v_mfma_f32_16x16x32_bf16 v[68:71], a[160:163], v[164:167], v[68:71]
v_mfma_f32_16x16x32_bf16 v[84:87], a[164:167], v[164:167], v[84:87]
v_mfma_f32_16x16x32_bf16 v[100:103], a[168:171], v[164:167], v[100:103]
v_mfma_f32_16x16x32_bf16 v[116:119], a[172:175], v[164:167], v[116:119]
s_add_u32 s60, s73, 39936
buffer_load_dwordx4 v[164:167], v241, s[24:27], s60 offen sc1
v_mfma_f32_16x16x32_bf16 v[72:75], a[160:163], v[168:171], v[72:75]
v_mfma_f32_16x16x32_bf16 v[88:91], a[164:167], v[168:171], v[88:91]
v_mfma_f32_16x16x32_bf16 v[104:107], a[168:171], v[168:171], v[104:107]
v_mfma_f32_16x16x32_bf16 v[120:123], a[172:175], v[168:171], v[120:123]
s_add_u32 s60, s73, 36864
buffer_load_dwordx4 v[168:171], v241, s[24:27], s60 offen sc1
v_mfma_f32_16x16x32_bf16 v[76:79], a[160:163], v[172:175], v[76:79]
v_mfma_f32_16x16x32_bf16 v[92:95], a[164:167], v[172:175], v[92:95]
v_mfma_f32_16x16x32_bf16 v[108:111], a[168:171], v[172:175], v[108:111]
v_mfma_f32_16x16x32_bf16 v[124:127], a[172:175], v[172:175], v[124:127]
s_add_u32 s60, s73, 38912
buffer_load_dwordx4 v[172:175], v241, s[24:27], s60 offen sc1
v_mfma_f32_16x16x32_bf16 v[64:67], a[176:179], v[176:179], v[64:67]
v_mfma_f32_16x16x32_bf16 v[80:83], a[180:183], v[176:179], v[80:83]
v_mfma_f32_16x16x32_bf16 v[96:99], a[184:187], v[176:179], v[96:99]
v_mfma_f32_16x16x32_bf16 v[112:115], a[188:191], v[176:179], v[112:115]
s_add_u32 s60, s73, 111616
buffer_load_dwordx4 v[176:179], v241, s[24:27], s60 offen sc1
v_mfma_f32_16x16x32_bf16 v[68:71], a[176:179], v[180:183], v[68:71]
v_mfma_f32_16x16x32_bf16 v[84:87], a[180:183], v[180:183], v[84:87]
v_mfma_f32_16x16x32_bf16 v[100:103], a[184:187], v[180:183], v[100:103]
v_mfma_f32_16x16x32_bf16 v[116:119], a[188:191], v[180:183], v[116:119]
s_add_u32 s60, s73, 113664
buffer_load_dwordx4 v[180:183], v241, s[24:27], s60 offen sc1
v_mfma_f32_16x16x32_bf16 v[72:75], a[176:179], v[184:187], v[72:75]
v_mfma_f32_16x16x32_bf16 v[88:91], a[180:183], v[184:187], v[88:91]
v_mfma_f32_16x16x32_bf16 v[104:107], a[184:187], v[184:187], v[104:107]
v_mfma_f32_16x16x32_bf16 v[120:123], a[188:191], v[184:187], v[120:123]
s_add_u32 s60, s73, 110592
buffer_load_dwordx4 v[184:187], v241, s[24:27], s60 offen sc1
s_waitcnt vmcnt(15)
v_mfma_f32_16x16x32_bf16 v[76:79], a[176:179], v[188:191], v[76:79]
v_mfma_f32_16x16x32_bf16 v[92:95], a[180:183], v[188:191], v[92:95]
v_mfma_f32_16x16x32_bf16 v[108:111], a[184:187], v[188:191], v[108:111]
v_mfma_f32_16x16x32_bf16 v[124:127], a[188:191], v[188:191], v[124:127]
s_add_u32 s60, s73, 112640
buffer_load_dwordx4 v[188:191], v241, s[24:27], s60 offen sc1
s_waitcnt vmcnt(15)
v_mfma_f32_16x16x32_bf16 v[64:67], a[192:195], v[128:131], v[64:67]
v_mfma_f32_16x16x32_bf16 v[80:83], a[196:199], v[128:131], v[80:83]
v_mfma_f32_16x16x32_bf16 v[96:99], a[200:203], v[128:131], v[96:99]
v_mfma_f32_16x16x32_bf16 v[112:115], a[204:207], v[128:131], v[112:115]
s_add_u32 s60, s73, 185344
buffer_load_dwordx4 v[128:131], v241, s[24:27], s60 offen sc1
s_waitcnt vmcnt(15)
v_mfma_f32_16x16x32_bf16 v[68:71], a[192:195], v[132:135], v[68:71]
v_mfma_f32_16x16x32_bf16 v[84:87], a[196:199], v[132:135], v[84:87]
v_mfma_f32_16x16x32_bf16 v[100:103], a[200:203], v[132:135], v[100:103]
v_mfma_f32_16x16x32_bf16 v[116:119], a[204:207], v[132:135], v[116:119]
s_add_u32 s60, s73, 187392
buffer_load_dwordx4 v[132:135], v241, s[24:27], s60 offen sc1
s_waitcnt vmcnt(15)
v_mfma_f32_16x16x32_bf16 v[72:75], a[192:195], v[136:139], v[72:75]
v_mfma_f32_16x16x32_bf16 v[88:91], a[196:199], v[136:139], v[88:91]
v_mfma_f32_16x16x32_bf16 v[104:107], a[200:203], v[136:139], v[104:107]
v_mfma_f32_16x16x32_bf16 v[120:123], a[204:207], v[136:139], v[120:123]
s_add_u32 s60, s73, 184320
buffer_load_dwordx4 v[136:139], v241, s[24:27], s60 offen sc1
s_waitcnt vmcnt(15)
v_mfma_f32_16x16x32_bf16 v[76:79], a[192:195], v[140:143], v[76:79]
v_mfma_f32_16x16x32_bf16 v[92:95], a[196:199], v[140:143], v[92:95]
v_mfma_f32_16x16x32_bf16 v[108:111], a[200:203], v[140:143], v[108:111]
v_mfma_f32_16x16x32_bf16 v[124:127], a[204:207], v[140:143], v[124:127]
s_add_u32 s60, s73, 186368
buffer_load_dwordx4 v[140:143], v241, s[24:27], s60 offen sc1
s_waitcnt vmcnt(15)
v_mfma_f32_16x16x32_bf16 v[64:67], a[208:211], v[144:147], v[64:67]
v_mfma_f32_16x16x32_bf16 v[80:83], a[212:215], v[144:147], v[80:83]
v_mfma_f32_16x16x32_bf16 v[96:99], a[216:219], v[144:147], v[96:99]
v_mfma_f32_16x16x32_bf16 v[112:115], a[220:223], v[144:147], v[112:115]
s_add_u32 s60, s73, 259072
buffer_load_dwordx4 v[144:147], v241, s[24:27], s60 offen sc1
s_waitcnt vmcnt(15)
v_mfma_f32_16x16x32_bf16 v[68:71], a[208:211], v[148:151], v[68:71]
v_mfma_f32_16x16x32_bf16 v[84:87], a[212:215], v[148:151], v[84:87]
v_mfma_f32_16x16x32_bf16 v[100:103], a[216:219], v[148:151], v[100:103]
v_mfma_f32_16x16x32_bf16 v[116:119], a[220:223], v[148:151], v[116:119]
s_add_u32 s60, s73, 261120
buffer_load_dwordx4 v[148:151], v241, s[24:27], s60 offen sc1
s_waitcnt vmcnt(15)
v_mfma_f32_16x16x32_bf16 v[72:75], a[208:211], v[152:155], v[72:75]
v_mfma_f32_16x16x32_bf16 v[88:91], a[212:215], v[152:155], v[88:91]
v_mfma_f32_16x16x32_bf16 v[104:107], a[216:219], v[152:155], v[104:107]
v_mfma_f32_16x16x32_bf16 v[120:123], a[220:223], v[152:155], v[120:123]
s_add_u32 s60, s73, 258048
buffer_load_dwordx4 v[152:155], v241, s[24:27], s60 offen sc1
s_waitcnt vmcnt(15)
v_mfma_f32_16x16x32_bf16 v[76:79], a[208:211], v[156:159], v[76:79]
v_mfma_f32_16x16x32_bf16 v[92:95], a[212:215], v[156:159], v[92:95]
v_mfma_f32_16x16x32_bf16 v[108:111], a[216:219], v[156:159], v[108:111]
v_mfma_f32_16x16x32_bf16 v[124:127], a[220:223], v[156:159], v[124:127]
s_add_u32 s60, s73, 260096
buffer_load_dwordx4 v[156:159], v241, s[24:27], s60 offen sc1
buffer_load_dwordx4 v[44:47], v40, s[8:11], 0 offen
buffer_load_dwordx4 v[48:51], v40, s[8:11], 0 offen offset:64
s_barrier
s_waitcnt vmcnt(17)
v_mfma_f32_16x16x32_bf16 v[64:67], a[224:227], v[160:163], v[64:67]
v_mfma_f32_16x16x32_bf16 v[80:83], a[228:231], v[160:163], v[80:83]
v_mfma_f32_16x16x32_bf16 v[96:99], a[232:235], v[160:163], v[96:99]
v_mfma_f32_16x16x32_bf16 v[112:115], a[236:239], v[160:163], v[112:115]
s_waitcnt vmcnt(16)
v_mfma_f32_16x16x32_bf16 v[64:67], a[240:243], v[164:167], v[64:67]
v_mfma_f32_16x16x32_bf16 v[80:83], a[244:247], v[164:167], v[80:83]
v_mfma_f32_16x16x32_bf16 v[96:99], a[248:251], v[164:167], v[96:99]
v_mfma_f32_16x16x32_bf16 v[112:115], a[252:255], v[164:167], v[112:115]
s_waitcnt vmcnt(15)
v_mfma_f32_16x16x32_bf16 v[64:67], v[192:195], v[168:171], v[64:67]
v_mfma_f32_16x16x32_bf16 v[80:83], v[196:199], v[168:171], v[80:83]
v_mfma_f32_16x16x32_bf16 v[96:99], v[200:203], v[168:171], v[96:99]
v_mfma_f32_16x16x32_bf16 v[112:115], v[204:207], v[168:171], v[112:115]
s_waitcnt vmcnt(14)
v_mfma_f32_16x16x32_bf16 v[64:67], v[208:211], v[172:175], v[64:67]
v_mfma_f32_16x16x32_bf16 v[80:83], v[212:215], v[172:175], v[80:83]
v_mfma_f32_16x16x32_bf16 v[96:99], v[216:219], v[172:175], v[96:99]
v_mfma_f32_16x16x32_bf16 v[112:115], v[220:223], v[172:175], v[112:115]
s_waitcnt vmcnt(13)
v_mfma_f32_16x16x32_bf16 v[68:71], a[224:227], v[176:179], v[68:71]
v_mfma_f32_16x16x32_bf16 v[84:87], a[228:231], v[176:179], v[84:87]
v_mfma_f32_16x16x32_bf16 v[100:103], a[232:235], v[176:179], v[100:103]
v_mfma_f32_16x16x32_bf16 v[116:119], a[236:239], v[176:179], v[116:119]
ds_write_b128 v38, v[64:67] offset:0
s_waitcnt vmcnt(12)
v_mfma_f32_16x16x32_bf16 v[68:71], a[240:243], v[180:183], v[68:71]
v_mfma_f32_16x16x32_bf16 v[84:87], a[244:247], v[180:183], v[84:87]
v_mfma_f32_16x16x32_bf16 v[100:103], a[248:251], v[180:183], v[100:103]
v_mfma_f32_16x16x32_bf16 v[116:119], a[252:255], v[180:183], v[116:119]
ds_write_b128 v38, v[80:83] offset:64
s_waitcnt vmcnt(11)
v_mfma_f32_16x16x32_bf16 v[68:71], v[192:195], v[184:187], v[68:71]
v_mfma_f32_16x16x32_bf16 v[84:87], v[196:199], v[184:187], v[84:87]
v_mfma_f32_16x16x32_bf16 v[100:103], v[200:203], v[184:187], v[100:103]
v_mfma_f32_16x16x32_bf16 v[116:119], v[204:207], v[184:187], v[116:119]
ds_write_b128 v38, v[96:99] offset:128
s_waitcnt vmcnt(10)
v_mfma_f32_16x16x32_bf16 v[68:71], v[208:211], v[188:191], v[68:71]
v_mfma_f32_16x16x32_bf16 v[84:87], v[212:215], v[188:191], v[84:87]
v_mfma_f32_16x16x32_bf16 v[100:103], v[216:219], v[188:191], v[100:103]
v_mfma_f32_16x16x32_bf16 v[116:119], v[220:223], v[188:191], v[116:119]
ds_write_b128 v38, v[112:115] offset:192
s_waitcnt vmcnt(9)
v_mfma_f32_16x16x32_bf16 v[72:75], a[224:227], v[128:131], v[72:75]
v_mfma_f32_16x16x32_bf16 v[88:91], a[228:231], v[128:131], v[88:91]
v_mfma_f32_16x16x32_bf16 v[104:107], a[232:235], v[128:131], v[104:107]
v_mfma_f32_16x16x32_bf16 v[120:123], a[236:239], v[128:131], v[120:123]
ds_write_b128 v38, v[68:71] offset:4352
s_waitcnt vmcnt(8)
v_mfma_f32_16x16x32_bf16 v[72:75], a[240:243], v[132:135], v[72:75]
v_mfma_f32_16x16x32_bf16 v[88:91], a[244:247], v[132:135], v[88:91]
v_mfma_f32_16x16x32_bf16 v[104:107], a[248:251], v[132:135], v[104:107]
v_mfma_f32_16x16x32_bf16 v[120:123], a[252:255], v[132:135], v[120:123]
ds_write_b128 v38, v[84:87] offset:4416
s_waitcnt vmcnt(7)
v_mfma_f32_16x16x32_bf16 v[72:75], v[192:195], v[136:139], v[72:75]
v_mfma_f32_16x16x32_bf16 v[88:91], v[196:199], v[136:139], v[88:91]
v_mfma_f32_16x16x32_bf16 v[104:107], v[200:203], v[136:139], v[104:107]
v_mfma_f32_16x16x32_bf16 v[120:123], v[204:207], v[136:139], v[120:123]
ds_write_b128 v38, v[100:103] offset:4480
s_waitcnt vmcnt(6)
v_mfma_f32_16x16x32_bf16 v[72:75], v[208:211], v[140:143], v[72:75]
v_mfma_f32_16x16x32_bf16 v[88:91], v[212:215], v[140:143], v[88:91]
v_mfma_f32_16x16x32_bf16 v[104:107], v[216:219], v[140:143], v[104:107]
v_mfma_f32_16x16x32_bf16 v[120:123], v[220:223], v[140:143], v[120:123]
ds_write_b128 v38, v[116:119] offset:4544
s_waitcnt vmcnt(5)
v_mfma_f32_16x16x32_bf16 v[76:79], a[224:227], v[144:147], v[76:79]
v_mfma_f32_16x16x32_bf16 v[92:95], a[228:231], v[144:147], v[92:95]
v_mfma_f32_16x16x32_bf16 v[108:111], a[232:235], v[144:147], v[108:111]
v_mfma_f32_16x16x32_bf16 v[124:127], a[236:239], v[144:147], v[124:127]
ds_write_b128 v38, v[72:75] offset:8704
s_waitcnt vmcnt(4)
v_mfma_f32_16x16x32_bf16 v[76:79], a[240:243], v[148:151], v[76:79]
v_mfma_f32_16x16x32_bf16 v[92:95], a[244:247], v[148:151], v[92:95]
v_mfma_f32_16x16x32_bf16 v[108:111], a[248:251], v[148:151], v[108:111]
v_mfma_f32_16x16x32_bf16 v[124:127], a[252:255], v[148:151], v[124:127]
ds_write_b128 v38, v[88:91] offset:8768
s_waitcnt vmcnt(3)
v_mfma_f32_16x16x32_bf16 v[76:79], v[192:195], v[152:155], v[76:79]
v_mfma_f32_16x16x32_bf16 v[92:95], v[196:199], v[152:155], v[92:95]
v_mfma_f32_16x16x32_bf16 v[108:111], v[200:203], v[152:155], v[108:111]
v_mfma_f32_16x16x32_bf16 v[124:127], v[204:207], v[152:155], v[124:127]
ds_write_b128 v38, v[104:107] offset:8832
s_waitcnt vmcnt(2)
v_mfma_f32_16x16x32_bf16 v[76:79], v[208:211], v[156:159], v[76:79]
v_mfma_f32_16x16x32_bf16 v[92:95], v[212:215], v[156:159], v[92:95]
v_mfma_f32_16x16x32_bf16 v[108:111], v[216:219], v[156:159], v[108:111]
v_mfma_f32_16x16x32_bf16 v[124:127], v[220:223], v[156:159], v[124:127]
ds_write_b128 v38, v[120:123] offset:8896
s_nop 3
ds_write_b128 v38, v[76:79] offset:13056
ds_write_b128 v38, v[92:95] offset:13120
ds_write_b128 v38, v[108:111] offset:13184
ds_write_b128 v38, v[124:127] offset:13248
s_waitcnt lgkmcnt(0)
s_barrier
v_add_u32 v41, 34816, v39
ds_read_b128 v[128:131], v39 offset:0
ds_read_b128 v[132:135], v39 offset:64
ds_read_b128 v[136:139], v39 offset:128
ds_read_b128 v[140:143], v39 offset:192
ds_read_b128 v[144:147], v39 offset:17408
ds_read_b128 v[148:151], v39 offset:17472
ds_read_b128 v[152:155], v39 offset:17536
ds_read_b128 v[156:159], v39 offset:17600
ds_read_b128 v[160:163], v41 offset:0
ds_read_b128 v[164:167], v41 offset:64
ds_read_b128 v[168:171], v41 offset:128
ds_read_b128 v[172:175], v41 offset:192
ds_read_b128 v[176:179], v41 offset:17408
ds_read_b128 v[180:183], v41 offset:17472
ds_read_b128 v[184:187], v41 offset:17536
ds_read_b128 v[188:191], v41 offset:17600
s_waitcnt vmcnt(0)
v_lshlrev_b32 v224, 16, v44
v_and_b32 v225, 0xffff0000, v44
v_lshlrev_b32 v226, 16, v45
v_and_b32 v227, 0xffff0000, v45
v_lshlrev_b32 v228, 16, v46
v_and_b32 v229, 0xffff0000, v46
v_lshlrev_b32 v230, 16, v47
v_and_b32 v231, 0xffff0000, v47
v_lshlrev_b32 v232, 16, v48
v_and_b32 v233, 0xffff0000, v48
v_lshlrev_b32 v234, 16, v49
v_and_b32 v235, 0xffff0000, v49
v_lshlrev_b32 v236, 16, v50
v_and_b32 v237, 0xffff0000, v50
v_lshlrev_b32 v238, 16, v51
v_and_b32 v239, 0xffff0000, v51
s_waitcnt lgkmcnt(8)
v_pk_add_f32 v[128:129], v[128:129], v[144:145]
v_pk_add_f32 v[130:131], v[130:131], v[146:147]
v_pk_add_f32 v[132:133], v[132:133], v[148:149]
v_pk_add_f32 v[134:135], v[134:135], v[150:151]
v_pk_add_f32 v[136:137], v[136:137], v[152:153]
v_pk_add_f32 v[138:139], v[138:139], v[154:155]
v_pk_add_f32 v[140:141], v[140:141], v[156:157]
v_pk_add_f32 v[142:143], v[142:143], v[158:159]
s_waitcnt lgkmcnt(0)
v_pk_add_f32 v[160:161], v[160:161], v[176:177]
v_pk_add_f32 v[162:163], v[162:163], v[178:179]
v_pk_add_f32 v[164:165], v[164:165], v[180:181]
v_pk_add_f32 v[166:167], v[166:167], v[182:183]
v_pk_add_f32 v[168:169], v[168:169], v[184:185]
v_pk_add_f32 v[170:171], v[170:171], v[186:187]
v_pk_add_f32 v[172:173], v[172:173], v[188:189]
v_pk_add_f32 v[174:175], v[174:175], v[190:191]
v_pk_add_f32 v[128:129], v[128:129], v[160:161]
v_pk_add_f32 v[130:131], v[130:131], v[162:163]
v_pk_add_f32 v[132:133], v[132:133], v[164:165]
v_pk_add_f32 v[134:135], v[134:135], v[166:167]
v_pk_add_f32 v[136:137], v[136:137], v[168:169]
v_pk_add_f32 v[138:139], v[138:139], v[170:171]
v_pk_add_f32 v[140:141], v[140:141], v[172:173]
v_pk_add_f32 v[142:143], v[142:143], v[174:175]
v_permlane16_swap_b32 v128, v132
v_permlane16_swap_b32 v129, v133
v_permlane16_swap_b32 v130, v134
v_permlane16_swap_b32 v131, v135
v_permlane16_swap_b32 v136, v140
v_permlane16_swap_b32 v137, v141
v_permlane16_swap_b32 v138, v142
v_permlane16_swap_b32 v139, v143
v_pk_add_f32 v[128:129], v[128:129], v[224:225]
v_pk_add_f32 v[130:131], v[130:131], v[226:227]
v_pk_add_f32 v[132:133], v[132:133], v[228:229]
v_pk_add_f32 v[134:135], v[134:135], v[230:231]
v_cvt_pk_bf16_f32 v144, v128, v129
v_cvt_pk_bf16_f32 v145, v130, v131
v_cvt_pk_bf16_f32 v146, v132, v133
v_cvt_pk_bf16_f32 v147, v134, v135
buffer_store_dwordx4 v[144:147], v40, s[40:43], 0 offen offset:0 sc1
v_pk_add_f32 v[136:137], v[136:137], v[232:233]
v_pk_add_f32 v[138:139], v[138:139], v[234:235]
v_pk_add_f32 v[140:141], v[140:141], v[236:237]
v_pk_add_f32 v[142:143], v[142:143], v[238:239]
v_cvt_pk_bf16_f32 v148, v136, v137
v_cvt_pk_bf16_f32 v149, v138, v139
v_cvt_pk_bf16_f32 v150, v140, v141
v_cvt_pk_bf16_f32 v151, v142, v143
buffer_store_dwordx4 v[148:151], v40, s[40:43], 0 offen offset:64 sc1
s_waitcnt vmcnt(0)
s_endpgm
L_csA_54:
v_and_b32 v252, 15, v1
v_mov_b32 v253, 0x3f803f80
v_cmp_eq_u32 vcc, 0, v252
s_nop 1
v_cndmask_b32_e64 v232, 0, v253, vcc
v_mov_b32 v233, v232
v_mov_b32 v234, v232
v_mov_b32 v235, v232
s_waitcnt vmcnt(11)
s_barrier
ds_read_b128 a[0:3], v20 offset:0
ds_read_b128 a[4:7], v20 offset:2048
ds_read_b128 a[8:11], v22 offset:0
ds_read_b128 a[12:15], v22 offset:2048
ds_read_b64_tr_b16 a[40:41], v12 offset:0
ds_read_b64_tr_b16 a[42:43], v12 offset:1280
ds_read_b64_tr_b16 a[56:57], v12 offset:10240
ds_read_b64_tr_b16 a[58:59], v12 offset:11520
ds_read_b64_tr_b16 a[44:45], v13 offset:32
ds_read_b64_tr_b16 a[46:47], v13 offset:1312
ds_read_b64_tr_b16 a[60:61], v13 offset:10272
ds_read_b64_tr_b16 a[62:63], v13 offset:11552
ds_read_b64_tr_b16 a[48:49], v12 offset:64
ds_read_b64_tr_b16 a[50:51], v12 offset:1344
ds_read_b64_tr_b16 a[64:65], v12 offset:10304
ds_read_b64_tr_b16 a[66:67], v12 offset:11584
ds_read_b64_tr_b16 a[52:53], v13 offset:96
ds_read_b64_tr_b16 a[54:55], v13 offset:1376
ds_read_b64_tr_b16 a[68:69], v13 offset:10336
ds_read_b64_tr_b16 a[70:71], v13 offset:11616
ds_read_b64_tr_b16 a[72:73], v14 offset:128
ds_read_b64_tr_b16 a[74:75], v14 offset:1408
ds_read_b64_tr_b16 a[80:81], v14 offset:10368
ds_read_b64_tr_b16 a[82:83], v14 offset:11648
ds_read_b64_tr_b16 a[76:77], v15 offset:160
ds_read_b64_tr_b16 a[78:79], v15 offset:1440
ds_read_b64_tr_b16 a[84:85], v15 offset:10400
ds_read_b64_tr_b16 a[86:87], v15 offset:11680
s_waitcnt lgkmcnt(15)
v_mfma_f32_16x16x32_bf16 v[64:67], a[40:43], a[0:3], 0
s_waitcnt vmcnt(6)
s_barrier
v_mfma_f32_16x16x32_bf16 v[68:71], a[40:43], a[4:7], 0
ds_read_b128 a[20:23], v21 offset:0
s_lshl_b32 s50, s54, 7
s_add_u32 s54, s54, 1
s_cmp_eq_u32 s54, 7
s_cselect_b32 s54, 0, s54
s_add_u32 m0, s58, 18432
v_mfma_f32_16x16x32_bf16 v[72:75], a[40:43], a[8:11], 0
buffer_load_dwordx4 v7, s[8:11], s50 offen lds
s_add_u32 m0, s58, 19456
v_mfma_f32_16x16x32_bf16 v[76:79], a[40:43], a[12:15], 0
buffer_load_dwordx4 v8, s[8:11], s50 offen lds
v_mfma_f32_16x16x32_bf16 v[252:255], a[40:43], v[232:235], 0
v_mfma_f32_16x16x32_bf16 v[128:131], a[56:59], a[0:3], 0
v_mov_b32_dpp v236, v232 row_shr:1 row_mask:0xf bank_mask:0xf bound_ctrl:1
ds_read_b64_tr_b16 a[40:41], v12 offset:20480
v_mfma_f32_16x16x32_bf16 v[132:135], a[56:59], a[4:7], 0
v_mov_b32_dpp v237, v233 row_shr:1 row_mask:0xf bank_mask:0xf bound_ctrl:1
ds_read_b64_tr_b16 a[42:43], v12 offset:21760
s_add_u32 m0, s58, 20480
v_mfma_f32_16x16x32_bf16 v[136:139], a[56:59], a[8:11], 0
buffer_load_dwordx4 v9, s[8:11], s50 offen lds
v_mov_b32_dpp v238, v234 row_shr:1 row_mask:0xf bank_mask:0xf bound_ctrl:1
s_add_u32 m0, s58, 21504
v_mfma_f32_16x16x32_bf16 v[140:143], a[56:59], a[12:15], 0
buffer_load_dwordx4 v10, s[8:11], s50 offen lds
v_mov_b32_dpp v239, v235 row_shr:1 row_mask:0xf bank_mask:0xf bound_ctrl:1
s_nop 1
v_mfma_f32_16x16x32_bf16 v[252:255], a[56:59], v[236:239], v[252:255]
v_mfma_f32_16x16x32_bf16 v[80:83], a[44:47], a[0:3], 0
v_mov_b32_dpp v240, v236 row_shr:1 row_mask:0xf bank_mask:0xf bound_ctrl:1
ds_read_b128 a[24:27], v21 offset:2048
v_mfma_f32_16x16x32_bf16 v[84:87], a[44:47], a[4:7], 0
v_mov_b32_dpp v241, v237 row_shr:1 row_mask:0xf bank_mask:0xf bound_ctrl:1
ds_read_b64_tr_b16 a[56:57], v12 offset:30720
s_mul_i32 s52, s53, 114688
s_add_u32 s53, s53, 1
s_cmp_eq_u32 s53, 14
s_cselect_b32 s53, 0, s53
s_add_u32 m0, s55, 40960
v_mfma_f32_16x16x32_bf16 v[88:91], a[44:47], a[8:11], 0
buffer_load_dwordx4 v2, s[28:31], s52 offen lds
v_mov_b32_dpp v242, v238 row_shr:1 row_mask:0xf bank_mask:0xf bound_ctrl:1
s_add_u32 m0, s55, 41984
v_mfma_f32_16x16x32_bf16 v[92:95], a[44:47], a[12:15], 0
buffer_load_dwordx4 v3, s[28:31], s52 offen lds
v_mov_b32_dpp v243, v239 row_shr:1 row_mask:0xf bank_mask:0xf bound_ctrl:1
s_nop 1
v_mfma_f32_16x16x32_bf16 v[252:255], a[44:47], v[240:243], v[252:255]
v_mfma_f32_16x16x32_bf16 v[144:147], a[60:63], a[0:3], 0
v_mov_b32_dpp v236, v240 row_shr:1 row_mask:0xf bank_mask:0xf bound_ctrl:1
ds_read_b64_tr_b16 a[58:59], v12 offset:32000
v_mfma_f32_16x16x32_bf16 v[148:151], a[60:63], a[4:7], 0
v_mov_b32_dpp v237, v241 row_shr:1 row_mask:0xf bank_mask:0xf bound_ctrl:1
ds_read_b128 a[28:31], v23 offset:0
s_add_u32 m0, s55, 43008
v_mfma_f32_16x16x32_bf16 v[152:155], a[60:63], a[8:11], 0
buffer_load_dwordx4 v4, s[28:31], s52 offen lds
v_mov_b32_dpp v238, v242 row_shr:1 row_mask:0xf bank_mask:0xf bound_ctrl:1
s_add_u32 m0, s55, 44032
v_mfma_f32_16x16x32_bf16 v[156:159], a[60:63], a[12:15], 0
buffer_load_dwordx4 v5, s[28:31], s52 offen lds
v_mov_b32_dpp v239, v243 row_shr:1 row_mask:0xf bank_mask:0xf bound_ctrl:1
s_nop 1
v_mfma_f32_16x16x32_bf16 v[252:255], a[60:63], v[236:239], v[252:255]
s_waitcnt lgkmcnt(15)
v_mfma_f32_16x16x32_bf16 v[96:99], a[48:51], a[0:3], 0
v_mov_b32_dpp v240, v236 row_shr:1 row_mask:0xf bank_mask:0xf bound_ctrl:1
ds_read_b64_tr_b16 a[44:45], v13 offset:20512
v_mfma_f32_16x16x32_bf16 v[100:103], a[48:51], a[4:7], 0
v_mov_b32_dpp v241, v237 row_shr:1 row_mask:0xf bank_mask:0xf bound_ctrl:1
ds_read_b64_tr_b16 a[46:47], v13 offset:21792
s_add_u32 m0, s55, 45056
v_mfma_f32_16x16x32_bf16 v[104:107], a[48:51], a[8:11], 0
buffer_load_dwordx4 v6, s[28:31], s52 offen lds
v_mov_b32_dpp v242, v238 row_shr:1 row_mask:0xf bank_mask:0xf bound_ctrl:1
s_lshl_b32 s50, s54, 7
s_add_u32 s54, s54, 1
s_cmp_eq_u32 s54, 7
s_cselect_b32 s54, 0, s54
s_add_u32 m0, s58, 36864
v_mfma_f32_16x16x32_bf16 v[108:111], a[48:51], a[12:15], 0
buffer_load_dwordx4 v7, s[8:11], s50 offen lds
v_mov_b32_dpp v243, v239 row_shr:1 row_mask:0xf bank_mask:0xf bound_ctrl:1
s_nop 1
v_mfma_f32_16x16x32_bf16 v[252:255], a[48:51], v[240:243], v[252:255]
v_mfma_f32_16x16x32_bf16 v[160:163], a[64:67], a[0:3], 0
v_mov_b32_dpp v236, v240 row_shr:1 row_mask:0xf bank_mask:0xf bound_ctrl:1
ds_read_b128 a[32:35], v23 offset:2048
v_mfma_f32_16x16x32_bf16 v[164:167], a[64:67], a[4:7], 0
v_mov_b32_dpp v237, v241 row_shr:1 row_mask:0xf bank_mask:0xf bound_ctrl:1
ds_read_b64_tr_b16 a[60:61], v13 offset:30752
s_add_u32 m0, s58, 37888
v_mfma_f32_16x16x32_bf16 v[168:171], a[64:67], a[8:11], 0
buffer_load_dwordx4 v8, s[8:11], s50 offen lds
v_mov_b32_dpp v238, v242 row_shr:1 row_mask:0xf bank_mask:0xf bound_ctrl:1
s_mul_i32 s52, s53, 114688
s_add_u32 s53, s53, 1
s_cmp_eq_u32 s53, 14
s_cselect_b32 s53, 0, s53
s_add_u32 m0, s55, 61440
v_mfma_f32_16x16x32_bf16 v[172:175], a[64:67], a[12:15], 0
buffer_load_dwordx4 v2, s[28:31], s52 offen lds
v_mov_b32_dpp v239, v243 row_shr:1 row_mask:0xf bank_mask:0xf bound_ctrl:1
s_nop 1
v_mfma_f32_16x16x32_bf16 v[252:255], a[64:67], v[236:239], v[252:255]
v_mfma_f32_16x16x32_bf16 v[112:115], a[52:55], a[0:3], 0
v_mov_b32_dpp v240, v236 row_shr:1 row_mask:0xf bank_mask:0xf bound_ctrl:1
ds_read_b64_tr_b16 a[62:63], v13 offset:32032
v_mfma_f32_16x16x32_bf16 v[116:119], a[52:55], a[4:7], 0
v_mov_b32_dpp v241, v237 row_shr:1 row_mask:0xf bank_mask:0xf bound_ctrl:1
ds_read_b64_tr_b16 a[48:49], v12 offset:20544
s_add_u32 m0, s55, 62464
v_mfma_f32_16x16x32_bf16 v[120:123], a[52:55], a[8:11], 0
buffer_load_dwordx4 v3, s[28:31], s52 offen lds
v_mov_b32_dpp v242, v238 row_shr:1 row_mask:0xf bank_mask:0xf bound_ctrl:1
s_add_u32 m0, s55, 63488
v_mfma_f32_16x16x32_bf16 v[124:127], a[52:55], a[12:15], 0
buffer_load_dwordx4 v4, s[28:31], s52 offen lds
v_mov_b32_dpp v243, v239 row_shr:1 row_mask:0xf bank_mask:0xf bound_ctrl:1
s_nop 1
v_mfma_f32_16x16x32_bf16 v[252:255], a[52:55], v[240:243], v[252:255]
v_mfma_f32_16x16x32_bf16 v[176:179], a[68:71], a[0:3], 0
v_mov_b32_dpp v236, v240 row_shr:1 row_mask:0xf bank_mask:0xf bound_ctrl:1
ds_read_b64_tr_b16 a[50:51], v12 offset:21824
v_mfma_f32_16x16x32_bf16 v[180:183], a[68:71], a[4:7], 0
v_mov_b32_dpp v237, v241 row_shr:1 row_mask:0xf bank_mask:0xf bound_ctrl:1
ds_read_b64_tr_b16 a[64:65], v12 offset:30784
s_add_u32 m0, s55, 64512
v_mfma_f32_16x16x32_bf16 v[184:187], a[68:71], a[8:11], 0
buffer_load_dwordx4 v5, s[28:31], s52 offen lds
v_mov_b32_dpp v238, v242 row_shr:1 row_mask:0xf bank_mask:0xf bound_ctrl:1
s_add_u32 m0, s55, 65536
v_mfma_f32_16x16x32_bf16 v[188:191], a[68:71], a[12:15], 0
buffer_load_dwordx4 v6, s[28:31], s52 offen lds
v_mov_b32_dpp v239, v243 row_shr:1 row_mask:0xf bank_mask:0xf bound_ctrl:1
s_nop 1
v_mfma_f32_16x16x32_bf16 v[252:255], a[68:71], v[236:239], v[252:255]
s_waitcnt lgkmcnt(15)
v_mfma_f32_16x16x32_bf16 v[192:195], a[72:75], a[0:3], 0
v_mov_b32_dpp v240, v236 row_shr:1 row_mask:0xf bank_mask:0xf bound_ctrl:1
ds_read_b64_tr_b16 a[66:67], v12 offset:32064
v_mfma_f32_16x16x32_bf16 v[196:199], a[72:75], a[4:7], 0
v_mov_b32_dpp v241, v237 row_shr:1 row_mask:0xf bank_mask:0xf bound_ctrl:1
v_mov_b32_dpp v242, v238 row_shr:1 row_mask:0xf bank_mask:0xf bound_ctrl:1
v_mov_b32_dpp v243, v239 row_shr:1 row_mask:0xf bank_mask:0xf bound_ctrl:1
s_nop 1
v_mfma_f32_16x16x32_bf16 v[252:255], a[72:75], v[240:243], v[252:255]
ds_read_b64_tr_b16 a[52:53], v13 offset:20576
v_mfma_f32_16x16x32_bf16 v[208:211], a[80:83], a[0:3], 0
v_mov_b32_dpp v236, v240 row_shr:1 row_mask:0xf bank_mask:0xf bound_ctrl:1
ds_read_b64_tr_b16 a[54:55], v13 offset:21856
v_mfma_f32_16x16x32_bf16 v[212:215], a[80:83], a[4:7], 0
v_mov_b32_dpp v237, v241 row_shr:1 row_mask:0xf bank_mask:0xf bound_ctrl:1
v_mov_b32_dpp v238, v242 row_shr:1 row_mask:0xf bank_mask:0xf bound_ctrl:1
v_mov_b32_dpp v239, v243 row_shr:1 row_mask:0xf bank_mask:0xf bound_ctrl:1
s_nop 1
v_mfma_f32_16x16x32_bf16 v[252:255], a[80:83], v[236:239], v[252:255]
ds_read_b64_tr_b16 a[68:69], v13 offset:30816
v_mfma_f32_16x16x32_bf16 v[200:203], a[76:79], a[0:3], 0
v_mov_b32_dpp v240, v236 row_shr:1 row_mask:0xf bank_mask:0xf bound_ctrl:1
ds_read_b64_tr_b16 a[70:71], v13 offset:32096
v_mfma_f32_16x16x32_bf16 v[204:207], a[76:79], a[4:7], 0
v_mov_b32_dpp v241, v237 row_shr:1 row_mask:0xf bank_mask:0xf bound_ctrl:1
v_mov_b32_dpp v242, v238 row_shr:1 row_mask:0xf bank_mask:0xf bound_ctrl:1
v_mov_b32_dpp v243, v239 row_shr:1 row_mask:0xf bank_mask:0xf bound_ctrl:1
s_nop 1
v_mfma_f32_16x16x32_bf16 v[252:255], a[76:79], v[240:243], v[252:255]
ds_read_b64_tr_b16 a[72:73], v14 offset:20608
v_mfma_f32_16x16x32_bf16 v[216:219], a[84:87], a[0:3], 0
v_mov_b32_dpp v236, v240 row_shr:1 row_mask:0xf bank_mask:0xf bound_ctrl:1
ds_read_b64_tr_b16 a[74:75], v14 offset:21888
v_mfma_f32_16x16x32_bf16 v[220:223], a[84:87], a[4:7], 0
v_mov_b32_dpp v237, v241 row_shr:1 row_mask:0xf bank_mask:0xf bound_ctrl:1
v_mov_b32_dpp v238, v242 row_shr:1 row_mask:0xf bank_mask:0xf bound_ctrl:1
v_mov_b32_dpp v239, v243 row_shr:1 row_mask:0xf bank_mask:0xf bound_ctrl:1
s_nop 1
v_mfma_f32_16x16x32_bf16 v[252:255], a[84:87], v[236:239], v[252:255]
ds_read_b64_tr_b16 a[80:81], v14 offset:30848
s_waitcnt lgkmcnt(13)
v_mfma_f32_16x16x32_bf16 v[64:67], a[40:43], a[20:23], v[64:67]
s_waitcnt vmcnt(7)
s_barrier
v_mfma_f32_16x16x32_bf16 v[68:71], a[40:43], a[24:27], v[68:71]
ds_read_b64_tr_b16 a[82:83], v14 offset:32128
v_mfma_f32_16x16x32_bf16 v[72:75], a[40:43], a[28:31], v[72:75]
ds_read_b64_tr_b16 a[76:77], v15 offset:20640
s_add_u32 m0, s58, 38912
v_mfma_f32_16x16x32_bf16 v[76:79], a[40:43], a[32:35], v[76:79]
buffer_load_dwordx4 v9, s[8:11], s50 offen lds
v_mfma_f32_16x16x32_bf16 v[252:255], a[40:43], v[232:235], v[252:255]
v_mfma_f32_16x16x32_bf16 v[128:131], a[56:59], a[20:23], v[128:131]
v_mov_b32_dpp v236, v232 row_shr:1 row_mask:0xf bank_mask:0xf bound_ctrl:1
ds_read_b64_tr_b16 a[78:79], v15 offset:21920
v_mfma_f32_16x16x32_bf16 v[132:135], a[56:59], a[24:27], v[132:135]
v_mov_b32_dpp v237, v233 row_shr:1 row_mask:0xf bank_mask:0xf bound_ctrl:1
ds_read_b64_tr_b16 a[84:85], v15 offset:30880
v_mfma_f32_16x16x32_bf16 v[136:139], a[56:59], a[28:31], v[136:139]
v_mov_b32_dpp v238, v234 row_shr:1 row_mask:0xf bank_mask:0xf bound_ctrl:1
ds_read_b64_tr_b16 a[86:87], v15 offset:32160
s_add_u32 m0, s58, 39936
v_mfma_f32_16x16x32_bf16 v[140:143], a[56:59], a[32:35], v[140:143]
buffer_load_dwordx4 v10, s[8:11], s50 offen lds
v_mov_b32_dpp v239, v235 row_shr:1 row_mask:0xf bank_mask:0xf bound_ctrl:1
s_nop 1
v_mfma_f32_16x16x32_bf16 v[252:255], a[56:59], v[236:239], v[252:255]
s_waitcnt lgkmcnt(15)
v_mfma_f32_16x16x32_bf16 v[80:83], a[44:47], a[20:23], v[80:83]
v_mov_b32_dpp v240, v236 row_shr:1 row_mask:0xf bank_mask:0xf bound_ctrl:1
ds_read_b128 a[0:3], v20 offset:18432
v_mfma_f32_16x16x32_bf16 v[84:87], a[44:47], a[24:27], v[84:87]
v_mov_b32_dpp v241, v237 row_shr:1 row_mask:0xf bank_mask:0xf bound_ctrl:1
ds_read_b64_tr_b16 a[40:41], v16 offset:0
v_mfma_f32_16x16x32_bf16 v[88:91], a[44:47], a[28:31], v[88:91]
v_mov_b32_dpp v242, v238 row_shr:1 row_mask:0xf bank_mask:0xf bound_ctrl:1
ds_read_b64_tr_b16 a[42:43], v16 offset:1280
s_mul_i32 s52, s53, 114688
s_add_u32 s53, s53, 1
s_cmp_eq_u32 s53, 14
s_cselect_b32 s53, 0, s53
s_add_u32 m0, s55, 0
v_mfma_f32_16x16x32_bf16 v[92:95], a[44:47], a[32:35], v[92:95]
buffer_load_dwordx4 v2, s[28:31], s52 offen lds
v_mov_b32_dpp v243, v239 row_shr:1 row_mask:0xf bank_mask:0xf bound_ctrl:1
s_nop 1
v_mfma_f32_16x16x32_bf16 v[252:255], a[44:47], v[240:243], v[252:255]
v_mfma_f32_16x16x32_bf16 v[144:147], a[60:63], a[20:23], v[144:147]
v_mov_b32_dpp v236, v240 row_shr:1 row_mask:0xf bank_mask:0xf bound_ctrl:1
ds_read_b128 a[4:7], v20 offset:20480
v_mfma_f32_16x16x32_bf16 v[148:151], a[60:63], a[24:27], v[148:151]
v_mov_b32_dpp v237, v241 row_shr:1 row_mask:0xf bank_mask:0xf bound_ctrl:1
s_cmp_lg_u32 s46, 0
s_cbranch_scc1 L_noinc_56
s_and_b32 s60, s2, 3
s_lshl_b32 s60, s60, 6
v_mov_b32 v36, 1
v_cmp_eq_u32 vcc, 0, v1
v_mov_b32 v37, 2146435072
v_mov_b32 v38, s60
s_nop 1
v_cndmask_b32 v37, v37, v38, vcc
buffer_atomic_add v36, v37, s[4:7], 0 offen
L_noinc_56:
v_mfma_f32_16x16x32_bf16 v[152:155], a[60:63], a[28:31], v[152:155]
v_mov_b32_dpp v238, v242 row_shr:1 row_mask:0xf bank_mask:0xf bound_ctrl:1
ds_read_b64_tr_b16 a[56:57], v16 offset:10240
s_add_u32 m0, s55, 1024
v_mfma_f32_16x16x32_bf16 v[156:159], a[60:63], a[32:35], v[156:159]
buffer_load_dwordx4 v3, s[28:31], s52 offen lds
v_mov_b32_dpp v239, v243 row_shr:1 row_mask:0xf bank_mask:0xf bound_ctrl:1
s_nop 1
v_mfma_f32_16x16x32_bf16 v[252:255], a[60:63], v[236:239], v[252:255]
s_waitcnt lgkmcnt(15)
v_mfma_f32_16x16x32_bf16 v[96:99], a[48:51], a[20:23], v[96:99]
v_mov_b32_dpp v240, v236 row_shr:1 row_mask:0xf bank_mask:0xf bound_ctrl:1
ds_read_b64_tr_b16 a[58:59], v16 offset:11520
v_mfma_f32_16x16x32_bf16 v[100:103], a[48:51], a[24:27], v[100:103]
v_mov_b32_dpp v241, v237 row_shr:1 row_mask:0xf bank_mask:0xf bound_ctrl:1
ds_read_b128 a[8:11], v22 offset:18432
v_mfma_f32_16x16x32_bf16 v[104:107], a[48:51], a[28:31], v[104:107]
v_mov_b32_dpp v242, v238 row_shr:1 row_mask:0xf bank_mask:0xf bound_ctrl:1
ds_read_b64_tr_b16 a[44:45], v17 offset:32
s_add_u32 m0, s55, 2048
v_mfma_f32_16x16x32_bf16 v[108:111], a[48:51], a[32:35], v[108:111]
buffer_load_dwordx4 v4, s[28:31], s52 offen lds
v_mov_b32_dpp v243, v239 row_shr:1 row_mask:0xf bank_mask:0xf bound_ctrl:1
s_nop 1
v_mfma_f32_16x16x32_bf16 v[252:255], a[48:51], v[240:243], v[252:255]
v_mfma_f32_16x16x32_bf16 v[160:163], a[64:67], a[20:23], v[160:163]
v_mov_b32_dpp v236, v240 row_shr:1 row_mask:0xf bank_mask:0xf bound_ctrl:1
ds_read_b64_tr_b16 a[46:47], v17 offset:1312
v_mfma_f32_16x16x32_bf16 v[164:167], a[64:67], a[24:27], v[164:167]
v_mov_b32_dpp v237, v241 row_shr:1 row_mask:0xf bank_mask:0xf bound_ctrl:1
ds_read_b128 a[12:15], v22 offset:20480
v_mfma_f32_16x16x32_bf16 v[168:171], a[64:67], a[28:31], v[168:171]
v_mov_b32_dpp v238, v242 row_shr:1 row_mask:0xf bank_mask:0xf bound_ctrl:1
ds_read_b64_tr_b16 a[60:61], v17 offset:10272
s_add_u32 m0, s55, 3072
v_mfma_f32_16x16x32_bf16 v[172:175], a[64:67], a[32:35], v[172:175]
buffer_load_dwordx4 v5, s[28:31], s52 offen lds
v_mov_b32_dpp v239, v243 row_shr:1 row_mask:0xf bank_mask:0xf bound_ctrl:1
s_nop 1
v_mfma_f32_16x16x32_bf16 v[252:255], a[64:67], v[236:239], v[252:255]
s_waitcnt lgkmcnt(15)
v_mfma_f32_16x16x32_bf16 v[112:115], a[52:55], a[20:23], v[112:115]
v_mov_b32_dpp v240, v236 row_shr:1 row_mask:0xf bank_mask:0xf bound_ctrl:1
ds_read_b64_tr_b16 a[62:63], v17 offset:11552
v_mfma_f32_16x16x32_bf16 v[116:119], a[52:55], a[24:27], v[116:119]
v_mov_b32_dpp v241, v237 row_shr:1 row_mask:0xf bank_mask:0xf bound_ctrl:1
ds_read_b64_tr_b16 a[48:49], v16 offset:64
v_mfma_f32_16x16x32_bf16 v[120:123], a[52:55], a[28:31], v[120:123]
v_mov_b32_dpp v242, v238 row_shr:1 row_mask:0xf bank_mask:0xf bound_ctrl:1
ds_read_b64_tr_b16 a[50:51], v16 offset:1344
s_add_u32 m0, s55, 4096
v_mfma_f32_16x16x32_bf16 v[124:127], a[52:55], a[32:35], v[124:127]
buffer_load_dwordx4 v6, s[28:31], s52 offen lds
v_mov_b32_dpp v243, v239 row_shr:1 row_mask:0xf bank_mask:0xf bound_ctrl:1
s_nop 1
v_mfma_f32_16x16x32_bf16 v[252:255], a[52:55], v[240:243], v[252:255]
v_mfma_f32_16x16x32_bf16 v[176:179], a[68:71], a[20:23], v[176:179]
v_mov_b32_dpp v236, v240 row_shr:1 row_mask:0xf bank_mask:0xf bound_ctrl:1
ds_read_b64_tr_b16 a[64:65], v16 offset:10304
v_mfma_f32_16x16x32_bf16 v[180:183], a[68:71], a[24:27], v[180:183]
v_mov_b32_dpp v237, v241 row_shr:1 row_mask:0xf bank_mask:0xf bound_ctrl:1
ds_read_b64_tr_b16 a[66:67], v16 offset:11584
v_mfma_f32_16x16x32_bf16 v[184:187], a[68:71], a[28:31], v[184:187]
v_mov_b32_dpp v238, v242 row_shr:1 row_mask:0xf bank_mask:0xf bound_ctrl:1
ds_read_b64_tr_b16 a[52:53], v17 offset:96
v_mfma_f32_16x16x32_bf16 v[188:191], a[68:71], a[32:35], v[188:191]
v_mov_b32_dpp v239, v243 row_shr:1 row_mask:0xf bank_mask:0xf bound_ctrl:1
s_nop 1
v_mfma_f32_16x16x32_bf16 v[252:255], a[68:71], v[236:239], v[252:255]
ds_read_b64_tr_b16 a[54:55], v17 offset:1376
v_mfma_f32_16x16x32_bf16 v[192:195], a[72:75], a[20:23], v[192:195]
v_mov_b32_dpp v240, v236 row_shr:1 row_mask:0xf bank_mask:0xf bound_ctrl:1
ds_read_b64_tr_b16 a[68:69], v17 offset:10336
v_mfma_f32_16x16x32_bf16 v[196:199], a[72:75], a[24:27], v[196:199]
v_mov_b32_dpp v241, v237 row_shr:1 row_mask:0xf bank_mask:0xf bound_ctrl:1
v_mov_b32_dpp v242, v238 row_shr:1 row_mask:0xf bank_mask:0xf bound_ctrl:1
v_mov_b32_dpp v243, v239 row_shr:1 row_mask:0xf bank_mask:0xf bound_ctrl:1
s_nop 1
v_mfma_f32_16x16x32_bf16 v[252:255], a[72:75], v[240:243], v[252:255]
ds_read_b64_tr_b16 a[70:71], v17 offset:11616
v_mfma_f32_16x16x32_bf16 v[208:211], a[80:83], a[20:23], v[208:211]
v_mov_b32_dpp v236, v240 row_shr:1 row_mask:0xf bank_mask:0xf bound_ctrl:1
ds_read_b64_tr_b16 a[72:73], v18 offset:128
v_mfma_f32_16x16x32_bf16 v[212:215], a[80:83], a[24:27], v[212:215]
v_mov_b32_dpp v237, v241 row_shr:1 row_mask:0xf bank_mask:0xf bound_ctrl:1
v_mov_b32_dpp v238, v242 row_shr:1 row_mask:0xf bank_mask:0xf bound_ctrl:1
v_mov_b32_dpp v239, v243 row_shr:1 row_mask:0xf bank_mask:0xf bound_ctrl:1
s_nop 1
v_mfma_f32_16x16x32_bf16 v[252:255], a[80:83], v[236:239], v[252:255]
ds_read_b64_tr_b16 a[74:75], v18 offset:1408
s_waitcnt lgkmcnt(15)
v_mfma_f32_16x16x32_bf16 v[200:203], a[76:79], a[20:23], v[200:203]
v_mov_b32_dpp v240, v236 row_shr:1 row_mask:0xf bank_mask:0xf bound_ctrl:1
ds_read_b64_tr_b16 a[80:81], v18 offset:10368
v_mfma_f32_16x16x32_bf16 v[204:207], a[76:79], a[24:27], v[204:207]
v_mov_b32_dpp v241, v237 row_shr:1 row_mask:0xf bank_mask:0xf bound_ctrl:1
v_mov_b32_dpp v242, v238 row_shr:1 row_mask:0xf bank_mask:0xf bound_ctrl:1
v_mov_b32_dpp v243, v239 row_shr:1 row_mask:0xf bank_mask:0xf bound_ctrl:1
s_nop 1
v_mfma_f32_16x16x32_bf16 v[252:255], a[76:79], v[240:243], v[252:255]
ds_read_b64_tr_b16 a[82:83], v18 offset:11648
v_mfma_f32_16x16x32_bf16 v[216:219], a[84:87], a[20:23], v[216:219]
v_mov_b32_dpp v236, v240 row_shr:1 row_mask:0xf bank_mask:0xf bound_ctrl:1
ds_read_b64_tr_b16 a[76:77], v19 offset:160
v_mfma_f32_16x16x32_bf16 v[220:223], a[84:87], a[24:27], v[220:223]
v_mov_b32_dpp v237, v241 row_shr:1 row_mask:0xf bank_mask:0xf bound_ctrl:1
v_mov_b32_dpp v238, v242 row_shr:1 row_mask:0xf bank_mask:0xf bound_ctrl:1
v_mov_b32_dpp v239, v243 row_shr:1 row_mask:0xf bank_mask:0xf bound_ctrl:1
s_nop 1
v_mfma_f32_16x16x32_bf16 v[252:255], a[84:87], v[236:239], v[252:255]
ds_read_b64_tr_b16 a[78:79], v19 offset:1440
ds_read_b64_tr_b16 a[84:85], v19 offset:10400
ds_read_b64_tr_b16 a[86:87], v19 offset:11680
s_nop 7
v_or_b32 v252, 1, v252
v_or_b32 v253, 1, v253
v_or_b32 v254, 1, v254
v_or_b32 v255, 1, v255
v_lshlrev_b32 v36, 4, v1
buffer_store_dwordx4 v[252:255], v36, s[24:27], s3 offen sc1
s_branch L_csJ_55
L_cnt_slow_48:
v_mov_b32 v61, 262144
L_cnt_re_50:
buffer_load_dword v60, v35, s[4:7], 0 offen sc1
s_waitcnt vmcnt(0)
v_readlane_b32 s60, v60, 0
v_readlane_b32 s61, v60, 1
v_readlane_b32 s62, v60, 2
v_readlane_b32 s63, v60, 3
s_nop 0
s_add_u32 s60, s60, s61
s_add_u32 s62, s62, s63
s_add_u32 s60, s60, s62
s_cmp_ge_u32 s60, 256
s_cbranch_scc1 L_cnt_back_49
v_add_u32 v61, -1, v61
s_nop 0
v_readfirstlane_b32 s60, v61
s_nop 0
s_cmp_eq_u32 s60, 0
s_cbranch_scc0 L_cnt_re_50
s_branch L_cnt_back_49
L_gat_slow_51:
s_mov_b32 s63, 262144
L_gat_re_53:
s_mov_b32 s62, 9437184
buffer_load_dwordx2 v[40:41], v26, s[24:27], s62 offen sc1
buffer_load_dwordx4 v[44:47], v27, s[24:27], s80 offen sc1
buffer_load_dwordx4 v[48:51], v27, s[24:27], s81 offen sc1
buffer_load_dwordx4 v[52:55], v27, s[24:27], s82 offen sc1
buffer_load_dwordx4 v[56:59], v27, s[24:27], s83 offen sc1
s_waitcnt vmcnt(0)
v_bitop3_b32 v43, v44, v45, v46 bitop3:0x80
v_bitop3_b32 v43, v43, v47, v48 bitop3:0x80
v_bitop3_b32 v43, v43, v49, v50 bitop3:0x80
v_bitop3_b32 v43, v43, v51, v52 bitop3:0x80
v_bitop3_b32 v43, v43, v53, v54 bitop3:0x80
v_bitop3_b32 v42, v56, v57, v58 bitop3:0x80
v_and_b32 v42, v42, v59
v_or_b32 v42, s47, v42
v_bitop3_b32 v43, v43, v55, v42 bitop3:0x80
v_and_b32 v43, 1, v43
v_cmp_eq_u32 vcc, 0, v41
v_cmp_eq_u32 s[60:61], 0, v43
s_nop 1
s_or_b64 vcc, vcc, s[60:61]
s_cmp_eq_u64 vcc, 0
s_cbranch_scc1 L_gat_back_52
s_sub_u32 s63, s63, 1
s_cmp_eq_u32 s63, 0
s_cbranch_scc0 L_gat_re_53
s_branch L_gat_back_52
L_flg_slow_58:
s_mov_b32 s63, 262144
L_flg_re_60:
buffer_load_dword v10, v11, s[24:27], s79 offen sc1
s_waitcnt vmcnt(0)
v_cmp_lt_u32 vcc, v10, v12
s_nop 0
s_cmp_eq_u64 vcc, 0
s_cbranch_scc1 L_flg_back_59
s_sub_u32 s63, s63, 1
s_cmp_eq_u32 s63, 0
s_cbranch_scc0 L_flg_re_60
s_branch L_flg_back_59
L_flg_slow_61:
s_mov_b32 s63, 262144
L_flg_re_63:
buffer_load_dword v10, v11, s[24:27], s79 offen sc1
s_waitcnt vmcnt(0)
v_cmp_lt_u32 vcc, v10, v13
s_nop 0
s_cmp_eq_u64 vcc, 0
s_cbranch_scc1 L_flg_back_62
s_sub_u32 s63, s63, 1
s_cmp_eq_u32 s63, 0
s_cbranch_scc0 L_flg_re_63
s_branch L_flg_back_62
L_flg_slow_64:
s_mov_b32 s63, 262144
L_flg_re_66:
buffer_load_dword v10, v11, s[24:27], s79 offen sc1
s_waitcnt vmcnt(0)
v_cmp_lt_u32 vcc, v10, v14
s_nop 0
s_cmp_eq_u64 vcc, 0
s_cbranch_scc1 L_flg_back_65
s_sub_u32 s63, s63, 1
s_cmp_eq_u32 s63, 0
s_cbranch_scc0 L_flg_re_66
s_branch L_flg_back_65
L_flg_slow_67:
s_mov_b32 s63, 262144
L_flg_re_69:
buffer_load_dword v10, v11, s[24:27], s79 offen sc1
s_waitcnt vmcnt(0)
v_cmp_lt_u32 vcc, v10, v15
s_nop 0
s_cmp_eq_u64 vcc, 0
s_cbranch_scc1 L_flg_back_68
s_sub_u32 s63, s63, 1
s_cmp_eq_u32 s63, 0
s_cbranch_scc0 L_flg_re_69
s_branch L_flg_back_68
L_end:

s_endpgm
.section .rodata,"a"
.p2align 6
.amdhsa_kernel parallel_sum__sliding_local_dilated__glu_gated_bilinear__prompt_kernel
  .amdhsa_next_free_vgpr 512
  .amdhsa_next_free_sgpr 102
  .amdhsa_accum_offset 256
  .amdhsa_group_segment_fixed_size 0
  .amdhsa_kernarg_size 80
  .amdhsa_user_sgpr_count 2
  .amdhsa_user_sgpr_kernarg_segment_ptr 1
  .amdhsa_system_sgpr_workgroup_id_x 1
  .amdhsa_float_denorm_mode_32 3
.end_amdhsa_kernel
```
